```python
import torch

def _softmax(x, axis=-1):
    return torch.softmax(x, dim=axis)

def _gelu(x):
    return torch.nn.functional.gelu(x, approximate='tanh')

def _silu(x):
    return torch.nn.functional.silu(x)

def _sigmoid(x):
    return torch.sigmoid(x)

def _layernorm(x, axis=-1, eps=1e-05):
    m = x.mean(dim=axis, keepdim=True)
    v = x.var(dim=axis, keepdim=True, unbiased=False)
    return (x - m) / torch.sqrt(v + eps)

def _scatter_add(tgt, idx, src, axis=0):
    return tgt.clone().index_add_(axis, idx, src)

def _segment_sum(src, seg, n):
    out = torch.zeros((n,) + src.shape[1:], dtype=src.dtype)
    return out.index_add_(0, seg, src)

def _pad(x, pw):
    flat = tuple((v for pair in reversed(pw) for v in pair))
    return torch.nn.functional.pad(x, flat)
kernel_name = 'adaLN_cond__gqa_block_cached__mixer_channel_mlp__prompt'

def setup_inputs():

    _w = lambda a: (lambda t: t.to(torch.bfloat16) if t.is_floating_point() else t)(torch.as_tensor(a))

    def _A_setup():
        B, Sq, D = (1, 2048, 448)
        Hq, Hkv, Sk, Dh = (16, 8, 2048, 256)
        assert Hq % Hkv == 0, (Hq, Hkv)
        return {'x': _w((lambda *s: torch.randn(*s, dtype=torch.bfloat16) * 0.1)(B, Sq, D)), 'k_cache': _w((lambda *s: torch.randn(*s, dtype=torch.bfloat16) * 0.8)(B, Hkv, Sk, Dh)), 'v_cache': _w((lambda *s: torch.randn(*s, dtype=torch.bfloat16) * 1.6)(B, Hkv, Sk, Dh)), 'wq': _w((lambda *s: torch.randn(*s, dtype=torch.bfloat16) * 0.8)(D, Hq * Dh) * D ** (-0.5)), 'wo': _w((lambda *s: torch.randn(*s, dtype=torch.bfloat16) * 1.6)(Hq * Dh, D) * (Hq * Dh) ** (-0.5))}
    _A_in = _A_setup()

    def _B_setup():
        B, S, D, F = (1, 2048, 448, 1792)
        return {'x': _w((lambda *s: torch.randn(*s, dtype=torch.bfloat16) * 0.1)(B, S, D)), 'w1': _w((lambda *s: torch.randn(*s, dtype=torch.bfloat16) * 3.2)(D, F) * D ** (-0.5)), 'b1': _w((lambda *s: torch.randn(*s, dtype=torch.bfloat16) * 3.2)(F)), 'w2': _w((lambda *s: torch.randn(*s, dtype=torch.bfloat16) * 3.2)(F, D) * F ** (-0.5)), 'b2': _w((lambda *s: torch.randn(*s, dtype=torch.bfloat16) * 3.2)(D))}
    _B_in = _B_setup()
    return {'A_x': _A_in['x'], 'A_k_cache': _A_in['k_cache'], 'A_v_cache': _A_in['v_cache'], 'A_wq': _A_in['wq'], 'A_wo': _A_in['wo'], 'B_x': _B_in['x'], 'B_w1': _B_in['w1'], 'B_b1': _B_in['b1'], 'B_w2': _B_in['w2'], 'B_b2': _B_in['b2'], 'c': _w((lambda *s: torch.randn(*s, dtype=torch.bfloat16) * 0.2)(1, 448) * 8.0), 'w_mod': _w((lambda *s: torch.randn(*s, dtype=torch.bfloat16) * 0.2)(448, 6 * 448) * 448 ** (-0.5) * 8.0)}

def reference(A_x, A_k_cache, A_v_cache, A_wq, A_wo, B_x, B_w1, B_b1, B_w2, B_b2, c, w_mod):

    def _A_ref(x, k_cache, v_cache, wq, wo):
        B, Sq, D = x.shape
        Hq, Dh = (16, 256)
        Hkv = k_cache.shape[1]
        rep = Hq // Hkv
        q = (lambda x, *d: x.permute(*d))((x @ wq).reshape(B, Sq, Hq, Dh), 0, 2, 1, 3)
        k = (lambda x, n, axis: torch.repeat_interleave(x, n, dim=axis))(k_cache, rep, axis=1)
        v = (lambda x, n, axis: torch.repeat_interleave(x, n, dim=axis))(v_cache, rep, axis=1)
        scores = torch.einsum('bhqd,bhkd->bhqk', q, k) * Dh ** (-0.5)
        p = _softmax(scores, axis=-1)
        o = torch.einsum('bhqk,bhkd->bhqd', p, v)
        return (lambda x, *d: x.permute(*d))(o, 0, 2, 1, 3).reshape(B, Sq, Hq * Dh) @ wo

    def _B_ref(x, w1, b1, w2, b2):
        y = _layernorm(x, axis=-1)
        h = _gelu(torch.einsum('bsd,df->bsf', y, w1) + b1)
        return torch.einsum('bsf,fd->bsd', h, w2) + b2
    x = A_x
    mod = (_silu(c) @ w_mod).reshape(c.shape[0], 6, 1, -1)
    sa, ca, ga, sb, cb, gb = (mod[:, 0].clone(), mod[:, 1].clone(), mod[:, 2].clone(), mod[:, 3].clone(), mod[:, 4].clone(), mod[:, 5].clone())
    h = _layernorm(x, axis=-1) * (1 + ca) + sa
    x = x + ga * _A_ref(h, A_k_cache, A_v_cache, A_wq, A_wo)
    h = _layernorm(x, axis=-1) * (1 + cb) + sb
    x = x + gb * _B_ref(h, B_w1, B_b1, B_w2, B_b2)
    return x
```

```asm
; @launch grid=(256,1,1) block=(256,1,1) lds=163840
.amdgcn_target "amdgcn-amd-amdhsa--gfx950"
.text
CODE_BEGIN:
.text
.globl adaLN_cond__gqa_block_cached__mixer_channel_mlp__prompt_kernel
.p2align 8
.type adaLN_cond__gqa_block_cached__mixer_channel_mlp__prompt_kernel,@function
adaLN_cond__gqa_block_cached__mixer_channel_mlp__prompt_kernel:
    s_cmp_ge_u32 s2, 256
    s_cbranch_scc1 K2_end
    s_load_dwordx4 s[32:35], s[0:1], 8
    s_load_dwordx4 s[36:39], s[0:1], 24
    s_load_dwordx2 s[72:73], s[0:1], 112
    s_load_dwordx2 s[74:75], s[0:1], 0
    s_load_dwordx2 s[92:93], s[0:1], 48
    s_load_dwordx2 s[94:95], s[0:1], 64
    s_load_dwordx4 s[4:7], s[0:1], 80
    s_load_dwordx2 s[96:97], s[0:1], 104
    s_memrealtime s[28:29]
    v_and_b32 v226, 63, v0
    v_lshrrev_b32 v204, 6, v0
    v_lshrrev_b32 v227, 4, v226
    v_readfirstlane_b32 s27, v204
    s_and_b32 s40, s2, 7
    s_lshr_b32 s41, s2, 3
    s_and_b32 s42, s27, 1
    s_lshr_b32 s43, s27, 1
    v_bfe_u32 v228, v226, 2, 2
    v_and_b32 v229, 3, v226
    v_lshlrev_b32 v230, 4, v226
    v_lshlrev_b32 v205, 5, v226
    s_lshl_b32 s44, s41, 2
    s_add_u32 s44, s44, s27
    s_lshl_b32 s49, s44, 8
    s_add_u32 s49, s49, 65536
    s_mul_i32 s44, s44, 14336
    s_lshl_b32 s45, s40, 10
    s_lshl_b32 s46, s27, 16
    s_add_u32 s45, s45, s46
    s_lshl_b32 s46, s42, 3
    s_add_u32 s48, s46, 0
    v_xor_b32 v206, s48, v226
    v_lshlrev_b32 v206, 4, v206
    s_add_u32 s48, s45, 0
    v_add_u32 v208, s48, v206
    s_add_u32 s48, s46, 2
    v_xor_b32 v206, s48, v226
    v_lshlrev_b32 v206, 4, v206
    s_add_u32 s48, s45, 7168
    v_add_u32 v209, s48, v206
    s_add_u32 s48, s46, 4
    v_xor_b32 v206, s48, v226
    v_lshlrev_b32 v206, 4, v206
    s_add_u32 s48, s45, 14336
    v_add_u32 v210, s48, v206
    s_add_u32 s48, s46, 6
    v_xor_b32 v206, s48, v226
    v_lshlrev_b32 v206, 4, v206
    s_add_u32 s48, s45, 21504
    v_add_u32 v211, s48, v206
    s_add_u32 s48, s46, 0
    v_xor_b32 v206, s48, v226
    v_lshlrev_b32 v206, 4, v206
    s_add_u32 s48, s45, 32768
    v_add_u32 v212, s48, v206
    s_add_u32 s48, s46, 2
    v_xor_b32 v206, s48, v226
    v_lshlrev_b32 v206, 4, v206
    s_add_u32 s48, s45, 39936
    v_add_u32 v213, s48, v206
    s_add_u32 s48, s46, 4
    v_xor_b32 v206, s48, v226
    v_lshlrev_b32 v206, 4, v206
    s_add_u32 s48, s45, 47104
    v_add_u32 v214, s48, v206
    s_add_u32 s48, s46, 6
    v_xor_b32 v206, s48, v226
    v_lshlrev_b32 v206, 4, v206
    s_add_u32 s48, s45, 54272
    v_add_u32 v215, s48, v206
    s_lshl_b32 s24, s27, 13
    v_mov_b32 v206, 0
    s_waitcnt lgkmcnt(0)
    s_mov_b32 s16, s72
    s_mov_b32 s17, s73
    s_mov_b32 s18, 0x10000000
    s_mov_b32 s19, 0x20000
    s_mov_b32 s56, s36
    s_mov_b32 s57, s37
    s_mov_b32 s58, 0x380000
    s_mov_b32 s59, 0x20000
    s_mov_b32 s64, s74
    s_mov_b32 s65, s75
    s_mov_b32 s66, 0x1c0000
    s_mov_b32 s67, 0x20000
    s_mov_b32 s98, 256
    s_mov_b32 s99, 0x20000
    s_getpc_b64 s[60:61]
K2_pc0:
    s_add_u32 s60, s60, CODE_BEGIN-K2_pc0
    s_addc_u32 s61, s61, -1
    s_mov_b32 s62, CODE_END-CODE_BEGIN
    s_mov_b32 s63, 0x20000
    v_lshlrev_b32 v250, 6, v226
    s_lshl_b32 s45, s41, 12
    s_lshl_b32 s46, s27, 17
    s_add_u32 s45, s45, s46
    buffer_load_dword v255, v250, s[60:63], s45 offen
    s_cmp_ge_u32 s2, 8
    s_cbranch_scc1 K2_noz
    s_cmp_lg_u32 s27, 0
    s_cbranch_scc1 K2_noz
    v_mov_b32 v176, 0
    v_mov_b32 v177, 0
    v_mov_b32 v178, 0
    v_mov_b32 v179, 0
    s_lshl_b32 s45, s2, 10
    s_add_u32 s45, s45, 131072
    buffer_store_dwordx4 v[176:179], v230, s[16:19], s45 offen sc1
    s_cmp_lg_u32 s2, 0
    s_cbranch_scc1 K2_noz
    s_or_b32 s45, s28, 1
    v_mov_b32 v180, s45
    s_mov_b64 exec, 1
    buffer_store_dword v180, v176, s[96:99], 0 offen sc1
    s_mov_b64 exec, -1
K2_noz:
    v_mov_b32 v204, 0x40000000
    v_cmp_gt_u32 vcc, 56, v226
    s_mov_b32 s100, s44
    s_add_u32 s101, s44, 3584
    v_cndmask_b32 v231, v204, v230, vcc
    s_cmp_ge_u32 s2, 84
    s_cbranch_scc1 K2_nog1
    s_mov_b32 s8, s4
    s_mov_b32 s9, s5
    s_mov_b32 s10, 0x380
    s_mov_b32 s11, 0x20000
    s_mov_b32 s12, s6
    s_mov_b32 s13, s7
    s_mov_b32 s14, 0x24c000
    s_mov_b32 s15, 0x20000
    v_lshrrev_b32 v160, 2, v0
    v_and_b32 v161, 3, v0
    v_mul_u32_u24 v204, 5376, v160
    v_lshl_add_u32 v204, v161, 4, v204
    v_lshlrev_b32 v206, 1, v160
    s_lshl_b32 s45, s2, 6
    buffer_load_ushort v164, v206, s[8:11], 0 offen offset:0
    buffer_load_ushort v165, v206, s[8:11], 0 offen offset:128
    buffer_load_ushort v166, v206, s[8:11], 0 offen offset:256
    buffer_load_ushort v167, v206, s[8:11], 0 offen offset:384
    buffer_load_ushort v168, v206, s[8:11], 0 offen offset:512
    buffer_load_ushort v169, v206, s[8:11], 0 offen offset:640
    buffer_load_ushort v170, v206, s[8:11], 0 offen offset:768
    buffer_load_dwordx4 v[128:131], v204, s[12:15], s45 offen
    s_add_u32 s45, s45, 344064
    buffer_load_dwordx4 v[132:135], v204, s[12:15], s45 offen
    s_add_u32 s45, s45, 344064
    buffer_load_dwordx4 v[136:139], v204, s[12:15], s45 offen
    s_add_u32 s45, s45, 344064
    buffer_load_dwordx4 v[140:143], v204, s[12:15], s45 offen
    s_add_u32 s45, s45, 344064
    buffer_load_dwordx4 v[144:147], v204, s[12:15], s45 offen
    s_add_u32 s45, s45, 344064
    buffer_load_dwordx4 v[148:151], v204, s[12:15], s45 offen
    s_add_u32 s45, s45, 344064
    buffer_load_dwordx4 v[152:155], v204, s[12:15], s45 offen
    s_add_u32 s45, s45, 344064
    v_lshrrev_b32 v160, 4, v0
    s_branch K2_nog1b
K2_nog1:
    v_lshlrev_b32 v233, 7, v0
    s_cmp_lt_u32 s41, 11
    s_cbranch_scc1 K2_nohelp0
    s_sub_u32 s45, s41, 11
    s_lshl_b32 s45, s45, 15
    buffer_load_dword v255, v233, s[64:67], s45 offen
K2_nohelp0:
    buffer_load_dwordx4 v[0:3], v231, s[64:67], s100 offen offset:0
    buffer_load_dwordx4 v[4:7], v231, s[64:67], s100 offen offset:896
    buffer_load_dwordx4 v[8:11], v231, s[64:67], s100 offen offset:1792
    buffer_load_dwordx4 v[12:15], v231, s[64:67], s100 offen offset:2688
    s_add_u32 s100, s100, 7168
    buffer_load_dwordx4 v[16:19], v231, s[64:67], s101 offen offset:0
    buffer_load_dwordx4 v[20:23], v231, s[64:67], s101 offen offset:896
    buffer_load_dwordx4 v[24:27], v231, s[64:67], s101 offen offset:1792
    buffer_load_dwordx4 v[28:31], v231, s[64:67], s101 offen offset:2688
    s_add_u32 s101, s101, 7168
    buffer_load_dwordx4 v[32:35], v231, s[64:67], s100 offen offset:0
    buffer_load_dwordx4 v[36:39], v231, s[64:67], s100 offen offset:896
    buffer_load_dwordx4 v[40:43], v231, s[64:67], s100 offen offset:1792
    buffer_load_dwordx4 v[44:47], v231, s[64:67], s100 offen offset:2688
    s_add_u32 s100, s100, 7168
    buffer_load_dwordx4 v[48:51], v231, s[64:67], s101 offen offset:0
    buffer_load_dwordx4 v[52:55], v231, s[64:67], s101 offen offset:896
    buffer_load_dwordx4 v[56:59], v231, s[64:67], s101 offen offset:1792
    buffer_load_dwordx4 v[60:63], v231, s[64:67], s101 offen offset:2688
    s_add_u32 s101, s101, 7168
K2_nog1b:
    v_lshrrev_b32 v232, 3, v226
    v_and_b32 v206, 7, v226
    v_lshlrev_b32 v232, 13, v232
    v_lshl_add_u32 v232, v206, 7, v232
    s_lshl_b32 s45, s40, 10
    s_mul_i32 s46, s41, 114688
    s_add_u32 s45, s45, s46
    s_and_b32 s46, s27, 1
    s_lshl_b32 s46, s46, 16
    s_add_u32 s45, s45, s46
    v_add_u32 v232, s45, v232
    s_lshl_b32 s44, s40, 20
    s_add_u32 s60, s32, s44
    s_addc_u32 s61, s33, 0
    s_mov_b32 s62, 0x100000
    s_mov_b32 s63, 0x20000
    s_add_u32 s34, s34, s44
    s_addc_u32 s35, s35, 0
    s_mul_i32 s45, s40, 458752
    s_add_u32 s68, s38, s45
    s_addc_u32 s69, s39, 0
    s_mov_b32 s70, 0x70000
    s_mov_b32 s71, 0x20000
    s_lshl_b32 s45, s43, 14
    s_sub_u32 s46, 0x100000, s45
    s_add_u32 s12, s60, s45
    s_addc_u32 s13, s61, 0
    s_mov_b32 s14, s46
    s_mov_b32 s15, 0x20000
    s_add_u32 s8, s34, s45
    s_addc_u32 s9, s35, 0
    s_mov_b32 s10, s46
    s_mov_b32 s11, 0x20000
    s_sub_u32 s46, s46, 65536
    s_add_u32 s4, s12, 65536
    s_addc_u32 s5, s13, 0
    s_mov_b32 s6, s46
    s_mov_b32 s7, 0x20000
    v_lshrrev_b32 v207, 5, v226
    s_mul_i32 s46, s43, 16896
    s_mul_i32 s45, s42, 8448
    s_add_u32 s22, s46, s45
    s_mul_i32 s51, s43, 17408
    s_add_u32 s51, s51, 69632
    s_mul_i32 s45, s42, 8704
    s_add_u32 s23, s51, s45
    v_and_b32 v204, 31, v226
    v_xor_b32 v205, v204, v207
    v_lshlrev_b32 v205, 4, v205
    v_lshl_add_u32 v205, v207, 9, v205
    s_lshl_b32 s45, s42, 13
    v_add_u32 v239, s45, v205
    v_lshlrev_b32 v206, 1, v207
    v_xor_b32 v205, v204, v206
    v_lshlrev_b32 v205, 4, v205
    v_lshl_add_u32 v205, v207, 9, v205
    v_add_u32 v240, s45, v205
    v_bfe_u32 v205, v226, 1, 3
    v_mul_u32_u24 v205, 1056, v205
    v_and_b32 v206, 1, v226
    v_lshl_add_u32 v205, v206, 9, v205
    v_xor_b32 v204, v206, v227
    v_lshl_add_u32 v204, v204, 4, v205
    v_add_u32 v236, s46, v204
    s_mul_i32 s45, s42, 33792
    s_add_u32 s45, s45, 96256
    v_add_u32 v251, s45, v204
    v_lshrrev_b32 v204, 1, v227
    v_xor_b32 v204, v204, v206
    v_lshl_add_u32 v204, v204, 4, v205
    v_and_b32 v206, 1, v227
    v_lshl_add_u32 v204, v206, 3, v204
    s_lshl_b32 s46, s43, 8
    s_add_u32 s45, s45, s46
    v_add_u32 v249, s45, v204
    v_bfe_u32 v204, v226, 3, 1
    v_lshl_add_u32 v204, v227, 1, v204
    v_mul_u32_u24 v204, 1088, v204
    v_bfe_u32 v205, v226, 2, 1
    v_lshl_add_u32 v204, v205, 9, v204
    v_lshl_add_u32 v204, v229, 3, v204
    v_add_u32 v204, s51, v204
    v_lshl_add_u32 v237, v205, 5, v204
    v_xor_b32 v205, 1, v205
    v_lshl_add_u32 v238, v205, 5, v204
    v_and_b32 v204, 15, v226
    v_mul_u32_u24 v205, 896, v204
    v_add_u32 v205, 104448, v205
    v_lshrrev_b32 v204, 1, v204
    v_xor_b32 v204, v204, v227
    v_lshl_add_u32 v216, v204, 4, v205
    v_xor_b32 v204, 4, v204
    v_lshl_add_u32 v217, v204, 4, v205
    s_mov_b32 s25, 0x4f800000
    s_mov_b32 s52, 0
    s_mov_b32 s53, 4096
    s_mov_b32 s54, 32768
    s_mov_b32 s55, 36864
    v_lshlrev_b32 v250, 6, v226
    v_mov_b32 v241, 0
    v_mov_b32 v242, 0
    v_mov_b32 v243, 0
    v_mov_b32 v244, 0
    v_mov_b32 v245, 0
    v_mov_b32 v246, 0
    v_mov_b32 v247, 0
    v_mov_b32 v248, 0
    s_mov_b32 s26, 0
    s_cmp_ge_u32 s2, 84
    s_cbranch_scc1 K2_nog2
    v_mov_b32 v176, 0
    v_mov_b32 v177, 0
    v_mov_b32 v178, 0
    v_mov_b32 v179, 0
    v_mov_b32 v180, 0
    v_mov_b32 v181, 0
    v_mov_b32 v182, 0
    v_mov_b32 v183, 0
    s_mov_b32 s45, 0xbfb8aa3b
    s_waitcnt vmcnt(7)
    v_mov_b32 v173, 0
    buffer_load_dword v172, v173, s[96:99], 0 offen sc1
    v_lshlrev_b32 v164, 16, v164
    v_lshlrev_b32 v165, 16, v165
    v_lshlrev_b32 v166, 16, v166
    v_lshlrev_b32 v167, 16, v167
    v_lshlrev_b32 v168, 16, v168
    v_lshlrev_b32 v169, 16, v169
    v_lshlrev_b32 v170, 16, v170
    v_mul_f32 v184, s45, v164
    v_mul_f32 v185, s45, v165
    v_mul_f32 v186, s45, v166
    v_mul_f32 v187, s45, v167
    v_mul_f32 v188, s45, v168
    v_mul_f32 v189, s45, v169
    v_mul_f32 v190, s45, v170
    v_exp_f32 v184, v184
    v_exp_f32 v185, v185
    v_exp_f32 v186, v186
    v_exp_f32 v187, v187
    v_exp_f32 v188, v188
    v_exp_f32 v189, v189
    v_exp_f32 v190, v190
    v_add_f32 v184, 1.0, v184
    v_add_f32 v185, 1.0, v185
    v_add_f32 v186, 1.0, v186
    v_add_f32 v187, 1.0, v187
    v_add_f32 v188, 1.0, v188
    v_add_f32 v189, 1.0, v189
    v_add_f32 v190, 1.0, v190
    v_rcp_f32 v184, v184
    v_rcp_f32 v185, v185
    v_rcp_f32 v186, v186
    v_rcp_f32 v187, v187
    v_rcp_f32 v188, v188
    v_rcp_f32 v189, v189
    v_rcp_f32 v190, v190
    v_mul_f32 v164, v164, v184
    v_mul_f32 v165, v165, v185
    v_mul_f32 v166, v166, v186
    v_mul_f32 v167, v167, v187
    v_mul_f32 v168, v168, v188
    v_mul_f32 v169, v169, v189
    v_mul_f32 v170, v170, v190
    v_cvt_pk_bf16_f32 v164, v164, v164
    v_cvt_pk_bf16_f32 v165, v165, v165
    v_cvt_pk_bf16_f32 v166, v166, v166
    v_cvt_pk_bf16_f32 v167, v167, v167
    v_cvt_pk_bf16_f32 v168, v168, v168
    v_cvt_pk_bf16_f32 v169, v169, v169
    v_cvt_pk_bf16_f32 v170, v170, v170
    v_and_b32 v164, 0xffff0000, v164
    v_and_b32 v165, 0xffff0000, v165
    v_and_b32 v166, 0xffff0000, v166
    v_and_b32 v167, 0xffff0000, v167
    v_and_b32 v168, 0xffff0000, v168
    v_and_b32 v169, 0xffff0000, v169
    v_and_b32 v170, 0xffff0000, v170
    s_waitcnt vmcnt(7)
    v_lshlrev_b32 v192, 16, v128
    v_and_b32 v193, 0xffff0000, v128
    v_lshlrev_b32 v194, 16, v129
    v_and_b32 v195, 0xffff0000, v129
    v_lshlrev_b32 v196, 16, v130
    v_and_b32 v197, 0xffff0000, v130
    v_lshlrev_b32 v198, 16, v131
    v_and_b32 v199, 0xffff0000, v131
    v_fmac_f32 v176, v164, v192
    v_fmac_f32 v177, v164, v193
    v_fmac_f32 v178, v164, v194
    v_fmac_f32 v179, v164, v195
    v_fmac_f32 v180, v164, v196
    v_fmac_f32 v181, v164, v197
    v_fmac_f32 v182, v164, v198
    v_fmac_f32 v183, v164, v199
    s_waitcnt vmcnt(6)
    v_lshlrev_b32 v192, 16, v132
    v_and_b32 v193, 0xffff0000, v132
    v_lshlrev_b32 v194, 16, v133
    v_and_b32 v195, 0xffff0000, v133
    v_lshlrev_b32 v196, 16, v134
    v_and_b32 v197, 0xffff0000, v134
    v_lshlrev_b32 v198, 16, v135
    v_and_b32 v199, 0xffff0000, v135
    v_fmac_f32 v176, v165, v192
    v_fmac_f32 v177, v165, v193
    v_fmac_f32 v178, v165, v194
    v_fmac_f32 v179, v165, v195
    v_fmac_f32 v180, v165, v196
    v_fmac_f32 v181, v165, v197
    v_fmac_f32 v182, v165, v198
    v_fmac_f32 v183, v165, v199
    s_waitcnt vmcnt(5)
    v_lshlrev_b32 v192, 16, v136
    v_and_b32 v193, 0xffff0000, v136
    v_lshlrev_b32 v194, 16, v137
    v_and_b32 v195, 0xffff0000, v137
    v_lshlrev_b32 v196, 16, v138
    v_and_b32 v197, 0xffff0000, v138
    v_lshlrev_b32 v198, 16, v139
    v_and_b32 v199, 0xffff0000, v139
    v_fmac_f32 v176, v166, v192
    v_fmac_f32 v177, v166, v193
    v_fmac_f32 v178, v166, v194
    v_fmac_f32 v179, v166, v195
    v_fmac_f32 v180, v166, v196
    v_fmac_f32 v181, v166, v197
    v_fmac_f32 v182, v166, v198
    v_fmac_f32 v183, v166, v199
    s_waitcnt vmcnt(4)
    v_lshlrev_b32 v192, 16, v140
    v_and_b32 v193, 0xffff0000, v140
    v_lshlrev_b32 v194, 16, v141
    v_and_b32 v195, 0xffff0000, v141
    v_lshlrev_b32 v196, 16, v142
    v_and_b32 v197, 0xffff0000, v142
    v_lshlrev_b32 v198, 16, v143
    v_and_b32 v199, 0xffff0000, v143
    v_fmac_f32 v176, v167, v192
    v_fmac_f32 v177, v167, v193
    v_fmac_f32 v178, v167, v194
    v_fmac_f32 v179, v167, v195
    v_fmac_f32 v180, v167, v196
    v_fmac_f32 v181, v167, v197
    v_fmac_f32 v182, v167, v198
    v_fmac_f32 v183, v167, v199
    s_waitcnt vmcnt(3)
    v_lshlrev_b32 v192, 16, v144
    v_and_b32 v193, 0xffff0000, v144
    v_lshlrev_b32 v194, 16, v145
    v_and_b32 v195, 0xffff0000, v145
    v_lshlrev_b32 v196, 16, v146
    v_and_b32 v197, 0xffff0000, v146
    v_lshlrev_b32 v198, 16, v147
    v_and_b32 v199, 0xffff0000, v147
    v_fmac_f32 v176, v168, v192
    v_fmac_f32 v177, v168, v193
    v_fmac_f32 v178, v168, v194
    v_fmac_f32 v179, v168, v195
    v_fmac_f32 v180, v168, v196
    v_fmac_f32 v181, v168, v197
    v_fmac_f32 v182, v168, v198
    v_fmac_f32 v183, v168, v199
    s_waitcnt vmcnt(2)
    v_lshlrev_b32 v192, 16, v148
    v_and_b32 v193, 0xffff0000, v148
    v_lshlrev_b32 v194, 16, v149
    v_and_b32 v195, 0xffff0000, v149
    v_lshlrev_b32 v196, 16, v150
    v_and_b32 v197, 0xffff0000, v150
    v_lshlrev_b32 v198, 16, v151
    v_and_b32 v199, 0xffff0000, v151
    v_fmac_f32 v176, v169, v192
    v_fmac_f32 v177, v169, v193
    v_fmac_f32 v178, v169, v194
    v_fmac_f32 v179, v169, v195
    v_fmac_f32 v180, v169, v196
    v_fmac_f32 v181, v169, v197
    v_fmac_f32 v182, v169, v198
    v_fmac_f32 v183, v169, v199
    s_waitcnt vmcnt(1)
    v_lshlrev_b32 v192, 16, v152
    v_and_b32 v193, 0xffff0000, v152
    v_lshlrev_b32 v194, 16, v153
    v_and_b32 v195, 0xffff0000, v153
    v_lshlrev_b32 v196, 16, v154
    v_and_b32 v197, 0xffff0000, v154
    v_lshlrev_b32 v198, 16, v155
    v_and_b32 v199, 0xffff0000, v155
    v_fmac_f32 v176, v170, v192
    v_fmac_f32 v177, v170, v193
    v_fmac_f32 v178, v170, v194
    v_fmac_f32 v179, v170, v195
    v_fmac_f32 v180, v170, v196
    v_fmac_f32 v181, v170, v197
    v_fmac_f32 v182, v170, v198
    v_fmac_f32 v183, v170, v199
    s_nop 1
    v_add_f32_dpp v176, v176, v176 row_ror:8 row_mask:0xf bank_mask:0xf
    v_add_f32_dpp v177, v177, v177 row_ror:8 row_mask:0xf bank_mask:0xf
    v_add_f32_dpp v178, v178, v178 row_ror:8 row_mask:0xf bank_mask:0xf
    v_add_f32_dpp v179, v179, v179 row_ror:8 row_mask:0xf bank_mask:0xf
    v_add_f32_dpp v180, v180, v180 row_ror:8 row_mask:0xf bank_mask:0xf
    v_add_f32_dpp v181, v181, v181 row_ror:8 row_mask:0xf bank_mask:0xf
    v_add_f32_dpp v182, v182, v182 row_ror:8 row_mask:0xf bank_mask:0xf
    v_add_f32_dpp v183, v183, v183 row_ror:8 row_mask:0xf bank_mask:0xf
    s_nop 1
    v_add_f32_dpp v176, v176, v176 row_ror:4 row_mask:0xf bank_mask:0xf
    v_add_f32_dpp v177, v177, v177 row_ror:4 row_mask:0xf bank_mask:0xf
    v_add_f32_dpp v178, v178, v178 row_ror:4 row_mask:0xf bank_mask:0xf
    v_add_f32_dpp v179, v179, v179 row_ror:4 row_mask:0xf bank_mask:0xf
    v_add_f32_dpp v180, v180, v180 row_ror:4 row_mask:0xf bank_mask:0xf
    v_add_f32_dpp v181, v181, v181 row_ror:4 row_mask:0xf bank_mask:0xf
    v_add_f32_dpp v182, v182, v182 row_ror:4 row_mask:0xf bank_mask:0xf
    v_add_f32_dpp v183, v183, v183 row_ror:4 row_mask:0xf bank_mask:0xf
    v_lshlrev_b32 v204, 7, v160
    v_lshl_add_u32 v204, v161, 5, v204
    v_add_u32 v204, 161792, v204
    s_mov_b32 exec_lo, 0x000f000f
    s_mov_b32 exec_hi, 0x000f000f
    ds_write_b128 v204, v[176:179]
    ds_write_b128 v204, v[180:183] offset:16
    s_mov_b64 exec, -1
    s_waitcnt lgkmcnt(0)
    s_barrier
    s_cmp_lg_u32 s27, 0
    s_cbranch_scc1 K2_gx
    v_and_b32 v204, 31, v226
    v_lshlrev_b32 v204, 2, v204
    v_add_u32 v205, 161792, v204
    ds_read_b32 v176, v205 offset:0
    ds_read_b32 v177, v205 offset:128
    ds_read_b32 v178, v205 offset:256
    ds_read_b32 v179, v205 offset:384
    ds_read_b32 v180, v205 offset:512
    ds_read_b32 v181, v205 offset:640
    ds_read_b32 v182, v205 offset:768
    ds_read_b32 v183, v205 offset:896
    ds_read_b32 v184, v205 offset:1024
    ds_read_b32 v185, v205 offset:1152
    ds_read_b32 v186, v205 offset:1280
    ds_read_b32 v187, v205 offset:1408
    ds_read_b32 v188, v205 offset:1536
    ds_read_b32 v189, v205 offset:1664
    ds_read_b32 v190, v205 offset:1792
    ds_read_b32 v191, v205 offset:1920
    s_waitcnt lgkmcnt(0)
    v_add_f32 v176, v176, v184
    v_add_f32 v177, v177, v185
    v_add_f32 v178, v178, v186
    v_add_f32 v179, v179, v187
    v_add_f32 v180, v180, v188
    v_add_f32 v181, v181, v189
    v_add_f32 v182, v182, v190
    v_add_f32 v183, v183, v191
    v_add_f32 v176, v176, v180
    v_add_f32 v177, v177, v181
    v_add_f32 v178, v178, v182
    v_add_f32 v179, v179, v183
    v_add_f32 v176, v176, v178
    v_add_f32 v177, v177, v179
    v_add_f32 v176, v176, v177
    v_cvt_pk_bf16_f32 v176, v176, v176
    v_and_b32 v176, 0xffff0000, v176
    v_add_f32 v177, 1.0, v176
    v_cvt_pk_bf16_f32 v177, v177, v177
    v_and_b32 v177, 0xffff0000, v177
    s_sub_u32 s45, s2, 14
    s_cmp_lt_u32 s45, 14
    s_cselect_b32 s46, 1, 0
    s_sub_u32 s45, s2, 56
    s_cmp_lt_u32 s45, 14
    s_cselect_b32 s45, 1, 0
    s_or_b32 s46, s46, s45
    s_cmp_eq_u32 s46, 0
    s_cbranch_scc1 K2_gst
    v_mov_b32 v176, v177
K2_gst:
    s_cmp_ge_u32 s2, 28
    s_cbranch_scc1 K2_glate
    v_mov_b32 v173, 0
    s_mov_b32 s46, 0x40000
    s_branch K2_tagwg
K2_tagg:
    buffer_load_dword v172, v173, s[96:99], 0 offen sc1
K2_tagwg:
    s_waitcnt vmcnt(0)
    v_readfirstlane_b32 s47, v172
    s_sub_u32 s46, s46, 1
    s_cmp_eq_u32 s46, 0
    s_cbranch_scc1 K2_tagdg
    s_cmp_eq_u32 s47, 0
    s_cbranch_scc1 K2_tagg
K2_tagdg:
    v_mov_b32 v177, s47
    v_lshlrev_b32 v204, 1, v204
    s_lshl_b32 s45, s2, 8
    s_add_u32 s45, s45, 32768
    s_mov_b32 exec_hi, 0
    buffer_store_dwordx2 v[176:177], v204, s[16:19], s45 offen sc1
    s_branch K2_gdone
K2_glate:
    s_lshl_b32 s45, s2, 7
    s_mov_b32 exec_hi, 0
    buffer_store_dword v176, v204, s[16:19], s45 offen offset:0 sc1
    s_mov_b32 s26, 1
K2_gdone:
    s_mov_b64 exec, -1
K2_gx:
    buffer_load_dwordx4 v[0:3], v231, s[64:67], s100 offen offset:0
    buffer_load_dwordx4 v[4:7], v231, s[64:67], s100 offen offset:896
    buffer_load_dwordx4 v[8:11], v231, s[64:67], s100 offen offset:1792
    buffer_load_dwordx4 v[12:15], v231, s[64:67], s100 offen offset:2688
    s_add_u32 s100, s100, 7168
    buffer_load_dwordx4 v[16:19], v231, s[64:67], s101 offen offset:0
    buffer_load_dwordx4 v[20:23], v231, s[64:67], s101 offen offset:896
    buffer_load_dwordx4 v[24:27], v231, s[64:67], s101 offen offset:1792
    buffer_load_dwordx4 v[28:31], v231, s[64:67], s101 offen offset:2688
    s_add_u32 s101, s101, 7168
    buffer_load_dwordx4 v[32:35], v231, s[64:67], s100 offen offset:0
    buffer_load_dwordx4 v[36:39], v231, s[64:67], s100 offen offset:896
    buffer_load_dwordx4 v[40:43], v231, s[64:67], s100 offen offset:1792
    buffer_load_dwordx4 v[44:47], v231, s[64:67], s100 offen offset:2688
    s_add_u32 s100, s100, 7168
    buffer_load_dwordx4 v[48:51], v231, s[64:67], s101 offen offset:0
    buffer_load_dwordx4 v[52:55], v231, s[64:67], s101 offen offset:896
    buffer_load_dwordx4 v[56:59], v231, s[64:67], s101 offen offset:1792
    buffer_load_dwordx4 v[60:63], v231, s[64:67], s101 offen offset:2688
    s_add_u32 s101, s101, 7168
K2_nog2:
    v_mov_b32 v160, 0x3f803f80
    buffer_load_dword v255, v232, s[56:59], 0 offen
    s_waitcnt vmcnt(16)
    v_dot2_f32_bf16 v128, v0, v160, 0
    v_dot2_f32_bf16 v144, v0, v0, 0
    v_dot2_f32_bf16 v128, v1, v160, v128
    v_dot2_f32_bf16 v144, v1, v1, v144
    v_dot2_f32_bf16 v128, v2, v160, v128
    v_dot2_f32_bf16 v144, v2, v2, v144
    v_dot2_f32_bf16 v128, v3, v160, v128
    v_dot2_f32_bf16 v144, v3, v3, v144
    s_waitcnt vmcnt(15)
    v_dot2_f32_bf16 v129, v4, v160, 0
    v_dot2_f32_bf16 v145, v4, v4, 0
    v_dot2_f32_bf16 v129, v5, v160, v129
    v_dot2_f32_bf16 v145, v5, v5, v145
    v_dot2_f32_bf16 v129, v6, v160, v129
    v_dot2_f32_bf16 v145, v6, v6, v145
    v_dot2_f32_bf16 v129, v7, v160, v129
    v_dot2_f32_bf16 v145, v7, v7, v145
    s_waitcnt vmcnt(14)
    v_dot2_f32_bf16 v130, v8, v160, 0
    v_dot2_f32_bf16 v146, v8, v8, 0
    v_dot2_f32_bf16 v130, v9, v160, v130
    v_dot2_f32_bf16 v146, v9, v9, v146
    v_dot2_f32_bf16 v130, v10, v160, v130
    v_dot2_f32_bf16 v146, v10, v10, v146
    v_dot2_f32_bf16 v130, v11, v160, v130
    v_dot2_f32_bf16 v146, v11, v11, v146
    s_waitcnt vmcnt(13)
    v_dot2_f32_bf16 v131, v12, v160, 0
    v_dot2_f32_bf16 v147, v12, v12, 0
    v_dot2_f32_bf16 v131, v13, v160, v131
    v_dot2_f32_bf16 v147, v13, v13, v147
    v_dot2_f32_bf16 v131, v14, v160, v131
    v_dot2_f32_bf16 v147, v14, v14, v147
    v_dot2_f32_bf16 v131, v15, v160, v131
    v_dot2_f32_bf16 v147, v15, v15, v147
    s_waitcnt vmcnt(12)
    v_dot2_f32_bf16 v132, v16, v160, 0
    v_dot2_f32_bf16 v148, v16, v16, 0
    v_dot2_f32_bf16 v132, v17, v160, v132
    v_dot2_f32_bf16 v148, v17, v17, v148
    v_dot2_f32_bf16 v132, v18, v160, v132
    v_dot2_f32_bf16 v148, v18, v18, v148
    v_dot2_f32_bf16 v132, v19, v160, v132
    v_dot2_f32_bf16 v148, v19, v19, v148
    s_waitcnt vmcnt(11)
    v_dot2_f32_bf16 v133, v20, v160, 0
    v_dot2_f32_bf16 v149, v20, v20, 0
    v_dot2_f32_bf16 v133, v21, v160, v133
    v_dot2_f32_bf16 v149, v21, v21, v149
    v_dot2_f32_bf16 v133, v22, v160, v133
    v_dot2_f32_bf16 v149, v22, v22, v149
    v_dot2_f32_bf16 v133, v23, v160, v133
    v_dot2_f32_bf16 v149, v23, v23, v149
    s_waitcnt vmcnt(10)
    v_dot2_f32_bf16 v134, v24, v160, 0
    v_dot2_f32_bf16 v150, v24, v24, 0
    v_dot2_f32_bf16 v134, v25, v160, v134
    v_dot2_f32_bf16 v150, v25, v25, v150
    v_dot2_f32_bf16 v134, v26, v160, v134
    v_dot2_f32_bf16 v150, v26, v26, v150
    v_dot2_f32_bf16 v134, v27, v160, v134
    v_dot2_f32_bf16 v150, v27, v27, v150
    s_waitcnt vmcnt(9)
    v_dot2_f32_bf16 v135, v28, v160, 0
    v_dot2_f32_bf16 v151, v28, v28, 0
    v_dot2_f32_bf16 v135, v29, v160, v135
    v_dot2_f32_bf16 v151, v29, v29, v151
    v_dot2_f32_bf16 v135, v30, v160, v135
    v_dot2_f32_bf16 v151, v30, v30, v151
    v_dot2_f32_bf16 v135, v31, v160, v135
    v_dot2_f32_bf16 v151, v31, v31, v151
    s_waitcnt vmcnt(8)
    v_dot2_f32_bf16 v136, v32, v160, 0
    v_dot2_f32_bf16 v152, v32, v32, 0
    v_dot2_f32_bf16 v136, v33, v160, v136
    v_dot2_f32_bf16 v152, v33, v33, v152
    v_dot2_f32_bf16 v136, v34, v160, v136
    v_dot2_f32_bf16 v152, v34, v34, v152
    v_dot2_f32_bf16 v136, v35, v160, v136
    v_dot2_f32_bf16 v152, v35, v35, v152
    s_mov_b32 s48, 0
    s_add_u32 m0, s24, 34816
    s_nop 0
    buffer_load_dwordx4 v208, s[56:59], s48 offen offset:0 lds
    s_waitcnt vmcnt(8)
    v_dot2_f32_bf16 v137, v36, v160, 0
    v_dot2_f32_bf16 v153, v36, v36, 0
    v_dot2_f32_bf16 v137, v37, v160, v137
    v_dot2_f32_bf16 v153, v37, v37, v153
    v_dot2_f32_bf16 v137, v38, v160, v137
    v_dot2_f32_bf16 v153, v38, v38, v153
    v_dot2_f32_bf16 v137, v39, v160, v137
    v_dot2_f32_bf16 v153, v39, v39, v153
    buffer_load_dwordx4 v209, s[56:59], s48 offen offset:1024 lds
    s_waitcnt vmcnt(8)
    v_dot2_f32_bf16 v138, v40, v160, 0
    v_dot2_f32_bf16 v154, v40, v40, 0
    v_dot2_f32_bf16 v138, v41, v160, v138
    v_dot2_f32_bf16 v154, v41, v41, v154
    v_dot2_f32_bf16 v138, v42, v160, v138
    v_dot2_f32_bf16 v154, v42, v42, v154
    v_dot2_f32_bf16 v138, v43, v160, v138
    v_dot2_f32_bf16 v154, v43, v43, v154
    buffer_load_dwordx4 v210, s[56:59], s48 offen offset:2048 lds
    s_waitcnt vmcnt(8)
    v_dot2_f32_bf16 v139, v44, v160, 0
    v_dot2_f32_bf16 v155, v44, v44, 0
    v_dot2_f32_bf16 v139, v45, v160, v139
    v_dot2_f32_bf16 v155, v45, v45, v155
    v_dot2_f32_bf16 v139, v46, v160, v139
    v_dot2_f32_bf16 v155, v46, v46, v155
    v_dot2_f32_bf16 v139, v47, v160, v139
    v_dot2_f32_bf16 v155, v47, v47, v155
    buffer_load_dwordx4 v211, s[56:59], s48 offen offset:3072 lds
    s_waitcnt vmcnt(8)
    v_dot2_f32_bf16 v140, v48, v160, 0
    v_dot2_f32_bf16 v156, v48, v48, 0
    v_dot2_f32_bf16 v140, v49, v160, v140
    v_dot2_f32_bf16 v156, v49, v49, v156
    v_dot2_f32_bf16 v140, v50, v160, v140
    v_dot2_f32_bf16 v156, v50, v50, v156
    v_dot2_f32_bf16 v140, v51, v160, v140
    v_dot2_f32_bf16 v156, v51, v51, v156
    s_add_u32 m0, s24, 38912
    s_nop 0
    buffer_load_dwordx4 v212, s[56:59], s48 offen offset:0 lds
    s_waitcnt vmcnt(8)
    v_dot2_f32_bf16 v141, v52, v160, 0
    v_dot2_f32_bf16 v157, v52, v52, 0
    v_dot2_f32_bf16 v141, v53, v160, v141
    v_dot2_f32_bf16 v157, v53, v53, v157
    v_dot2_f32_bf16 v141, v54, v160, v141
    v_dot2_f32_bf16 v157, v54, v54, v157
    v_dot2_f32_bf16 v141, v55, v160, v141
    v_dot2_f32_bf16 v157, v55, v55, v157
    buffer_load_dwordx4 v213, s[56:59], s48 offen offset:1024 lds
    s_waitcnt vmcnt(8)
    v_dot2_f32_bf16 v142, v56, v160, 0
    v_dot2_f32_bf16 v158, v56, v56, 0
    v_dot2_f32_bf16 v142, v57, v160, v142
    v_dot2_f32_bf16 v158, v57, v57, v158
    v_dot2_f32_bf16 v142, v58, v160, v142
    v_dot2_f32_bf16 v158, v58, v58, v158
    v_dot2_f32_bf16 v142, v59, v160, v142
    v_dot2_f32_bf16 v158, v59, v59, v158
    buffer_load_dwordx4 v214, s[56:59], s48 offen offset:2048 lds
    s_waitcnt vmcnt(8)
    v_dot2_f32_bf16 v143, v60, v160, 0
    v_dot2_f32_bf16 v159, v60, v60, 0
    v_dot2_f32_bf16 v143, v61, v160, v143
    v_dot2_f32_bf16 v159, v61, v61, v159
    v_dot2_f32_bf16 v143, v62, v160, v143
    v_dot2_f32_bf16 v159, v62, v62, v159
    v_dot2_f32_bf16 v143, v63, v160, v143
    v_dot2_f32_bf16 v159, v63, v63, v159
    buffer_load_dwordx4 v215, s[56:59], s48 offen offset:3072 lds
    s_nop 3
    v_permlane32_swap_b32 v128, v136
    v_permlane32_swap_b32 v129, v137
    v_permlane32_swap_b32 v130, v138
    v_permlane32_swap_b32 v131, v139
    v_permlane32_swap_b32 v132, v140
    v_permlane32_swap_b32 v133, v141
    v_permlane32_swap_b32 v134, v142
    v_permlane32_swap_b32 v135, v143
    v_permlane32_swap_b32 v144, v152
    v_permlane32_swap_b32 v145, v153
    v_permlane32_swap_b32 v146, v154
    v_permlane32_swap_b32 v147, v155
    v_permlane32_swap_b32 v148, v156
    v_permlane32_swap_b32 v149, v157
    v_permlane32_swap_b32 v150, v158
    v_permlane32_swap_b32 v151, v159
    s_nop 1
    v_add_f32 v128, v128, v136
    v_add_f32 v129, v129, v137
    v_add_f32 v130, v130, v138
    v_add_f32 v131, v131, v139
    v_add_f32 v132, v132, v140
    v_add_f32 v133, v133, v141
    v_add_f32 v134, v134, v142
    v_add_f32 v135, v135, v143
    v_add_f32 v144, v144, v152
    v_add_f32 v145, v145, v153
    v_add_f32 v146, v146, v154
    v_add_f32 v147, v147, v155
    v_add_f32 v148, v148, v156
    v_add_f32 v149, v149, v157
    v_add_f32 v150, v150, v158
    v_add_f32 v151, v151, v159
    s_nop 1
    v_permlane16_swap_b32 v128, v132
    v_permlane16_swap_b32 v129, v133
    v_permlane16_swap_b32 v130, v134
    v_permlane16_swap_b32 v131, v135
    v_permlane16_swap_b32 v144, v148
    v_permlane16_swap_b32 v145, v149
    v_permlane16_swap_b32 v146, v150
    v_permlane16_swap_b32 v147, v151
    s_nop 1
    v_add_f32 v128, v128, v132
    v_add_f32 v129, v129, v133
    v_add_f32 v130, v130, v134
    v_add_f32 v131, v131, v135
    v_add_f32 v144, v144, v148
    v_add_f32 v145, v145, v149
    v_add_f32 v146, v146, v150
    v_add_f32 v147, v147, v151
    s_nop 1
    v_add_f32_dpp v128, v128, v128 row_ror:8 row_mask:0xf bank_mask:0xf
    v_add_f32_dpp v129, v129, v129 row_ror:8 row_mask:0xf bank_mask:0xf
    v_add_f32_dpp v130, v130, v130 row_ror:8 row_mask:0xf bank_mask:0xf
    v_add_f32_dpp v131, v131, v131 row_ror:8 row_mask:0xf bank_mask:0xf
    v_add_f32_dpp v144, v144, v144 row_ror:8 row_mask:0xf bank_mask:0xf
    v_add_f32_dpp v145, v145, v145 row_ror:8 row_mask:0xf bank_mask:0xf
    v_add_f32_dpp v146, v146, v146 row_ror:8 row_mask:0xf bank_mask:0xf
    v_add_f32_dpp v147, v147, v147 row_ror:8 row_mask:0xf bank_mask:0xf
    v_add_f32_dpp v128, v128, v128 row_ror:4 row_mask:0xf bank_mask:0xf
    v_add_f32_dpp v129, v129, v129 row_ror:4 row_mask:0xf bank_mask:0xf
    v_add_f32_dpp v130, v130, v130 row_ror:4 row_mask:0xf bank_mask:0xf
    v_add_f32_dpp v131, v131, v131 row_ror:4 row_mask:0xf bank_mask:0xf
    v_add_f32_dpp v144, v144, v144 row_ror:4 row_mask:0xf bank_mask:0xf
    v_add_f32_dpp v145, v145, v145 row_ror:4 row_mask:0xf bank_mask:0xf
    v_add_f32_dpp v146, v146, v146 row_ror:4 row_mask:0xf bank_mask:0xf
    v_add_f32_dpp v147, v147, v147 row_ror:4 row_mask:0xf bank_mask:0xf
    v_add_f32_dpp v128, v128, v128 row_ror:2 row_mask:0xf bank_mask:0xf
    v_add_f32_dpp v129, v129, v129 row_ror:2 row_mask:0xf bank_mask:0xf
    v_add_f32_dpp v130, v130, v130 row_ror:2 row_mask:0xf bank_mask:0xf
    v_add_f32_dpp v131, v131, v131 row_ror:2 row_mask:0xf bank_mask:0xf
    v_add_f32_dpp v144, v144, v144 row_ror:2 row_mask:0xf bank_mask:0xf
    v_add_f32_dpp v145, v145, v145 row_ror:2 row_mask:0xf bank_mask:0xf
    v_add_f32_dpp v146, v146, v146 row_ror:2 row_mask:0xf bank_mask:0xf
    v_add_f32_dpp v147, v147, v147 row_ror:2 row_mask:0xf bank_mask:0xf
    v_add_f32_dpp v128, v128, v128 row_ror:1 row_mask:0xf bank_mask:0xf
    v_add_f32_dpp v129, v129, v129 row_ror:1 row_mask:0xf bank_mask:0xf
    v_add_f32_dpp v130, v130, v130 row_ror:1 row_mask:0xf bank_mask:0xf
    v_add_f32_dpp v131, v131, v131 row_ror:1 row_mask:0xf bank_mask:0xf
    v_add_f32_dpp v144, v144, v144 row_ror:1 row_mask:0xf bank_mask:0xf
    v_add_f32_dpp v145, v145, v145 row_ror:1 row_mask:0xf bank_mask:0xf
    v_add_f32_dpp v146, v146, v146 row_ror:1 row_mask:0xf bank_mask:0xf
    v_add_f32_dpp v147, v147, v147 row_ror:1 row_mask:0xf bank_mask:0xf
    s_mov_b32 s45, 0x3b124925
    s_mov_b32 s46, 0x3727c5ac
    v_mul_f32 v128, s45, v128
    v_mul_f32 v144, s45, v144
    v_mul_f32 v129, s45, v129
    v_mul_f32 v145, s45, v145
    v_mul_f32 v130, s45, v130
    v_mul_f32 v146, s45, v146
    v_mul_f32 v131, s45, v131
    v_mul_f32 v147, s45, v147
    v_fma_f32 v144, -v128, v128, v144
    v_fma_f32 v145, -v129, v129, v145
    v_fma_f32 v146, -v130, v130, v146
    v_fma_f32 v147, -v131, v131, v147
    v_max_f32 v144, 0, v144
    v_max_f32 v145, 0, v145
    v_max_f32 v146, 0, v146
    v_max_f32 v147, 0, v147
    v_add_f32 v144, s46, v144
    v_add_f32 v145, s46, v145
    v_add_f32 v146, s46, v146
    v_add_f32 v147, s46, v147
    v_rsq_f32 v164, v144
    v_rsq_f32 v168, v145
    v_rsq_f32 v172, v146
    v_rsq_f32 v176, v147
    s_nop 0
    v_mov_b32 v165, v164
    v_mul_f32 v166, -v128, v164
    v_mul_f32 v167, -v128, v164
    v_mov_b32 v169, v168
    v_mul_f32 v170, -v129, v168
    v_mul_f32 v171, -v129, v168
    v_mov_b32 v173, v172
    v_mul_f32 v174, -v130, v172
    v_mul_f32 v175, -v130, v172
    v_mov_b32 v177, v176
    v_mul_f32 v178, -v131, v176
    v_mul_f32 v179, -v131, v176
    s_lshl_b32 s45, s27, 8
    s_add_u32 s45, s45, 32768
    v_lshlrev_b32 v204, 6, v227
    v_add_u32 v204, s45, v204
    v_mov_b32 v206, s45
    s_mov_b32 exec_lo, 0x00010001
    s_mov_b32 exec_hi, 0x00010001
    ds_write_b128 v204, v[164:167] offset:0
    ds_write_b128 v204, v[168:171] offset:16
    ds_write_b128 v204, v[172:175] offset:32
    ds_write_b128 v204, v[176:179] offset:48
    s_mov_b64 exec, -1
    s_waitcnt lgkmcnt(0)
    ds_read_b128 v[192:195], v206 offset:0
    ds_read_b128 v[196:199], v206 offset:16
    ds_read_b128 v[200:203], v206 offset:32
    v_lshlrev_b32 v64, 16, v0
    v_and_b32 v65, 0xffff0000, v0
    v_lshlrev_b32 v66, 16, v1
    v_and_b32 v67, 0xffff0000, v1
    v_lshlrev_b32 v68, 16, v2
    v_and_b32 v69, 0xffff0000, v2
    v_lshlrev_b32 v70, 16, v3
    v_and_b32 v71, 0xffff0000, v3
    s_mov_b32 s48, 262144
    s_add_u32 m0, s24, 69632
    s_nop 0
    buffer_load_dwordx4 v208, s[56:59], s48 offen offset:0 lds
    s_waitcnt lgkmcnt(2)
    v_pk_fma_f32 v[64:65], v[64:65], v[192:193], v[194:195]
    v_pk_fma_f32 v[66:67], v[66:67], v[192:193], v[194:195]
    v_pk_fma_f32 v[68:69], v[68:69], v[192:193], v[194:195]
    v_pk_fma_f32 v[70:71], v[70:71], v[192:193], v[194:195]
    ds_read_b128 v[192:195], v206 offset:48
    v_lshlrev_b32 v72, 16, v4
    v_and_b32 v73, 0xffff0000, v4
    v_lshlrev_b32 v74, 16, v5
    v_and_b32 v75, 0xffff0000, v5
    v_lshlrev_b32 v76, 16, v6
    v_and_b32 v77, 0xffff0000, v6
    v_lshlrev_b32 v78, 16, v7
    v_and_b32 v79, 0xffff0000, v7
    buffer_load_dwordx4 v209, s[56:59], s48 offen offset:1024 lds
    s_waitcnt lgkmcnt(2)
    v_pk_fma_f32 v[72:73], v[72:73], v[196:197], v[198:199]
    v_pk_fma_f32 v[74:75], v[74:75], v[196:197], v[198:199]
    v_pk_fma_f32 v[76:77], v[76:77], v[196:197], v[198:199]
    v_pk_fma_f32 v[78:79], v[78:79], v[196:197], v[198:199]
    ds_read_b128 v[196:199], v206 offset:64
    v_lshlrev_b32 v80, 16, v8
    v_and_b32 v81, 0xffff0000, v8
    v_lshlrev_b32 v82, 16, v9
    v_and_b32 v83, 0xffff0000, v9
    v_lshlrev_b32 v84, 16, v10
    v_and_b32 v85, 0xffff0000, v10
    v_lshlrev_b32 v86, 16, v11
    v_and_b32 v87, 0xffff0000, v11
    buffer_load_dwordx4 v210, s[56:59], s48 offen offset:2048 lds
    s_waitcnt lgkmcnt(2)
    v_pk_fma_f32 v[80:81], v[80:81], v[200:201], v[202:203]
    v_pk_fma_f32 v[82:83], v[82:83], v[200:201], v[202:203]
    v_pk_fma_f32 v[84:85], v[84:85], v[200:201], v[202:203]
    v_pk_fma_f32 v[86:87], v[86:87], v[200:201], v[202:203]
    ds_read_b128 v[200:203], v206 offset:80
    v_lshlrev_b32 v88, 16, v12
    v_and_b32 v89, 0xffff0000, v12
    v_lshlrev_b32 v90, 16, v13
    v_and_b32 v91, 0xffff0000, v13
    v_lshlrev_b32 v92, 16, v14
    v_and_b32 v93, 0xffff0000, v14
    v_lshlrev_b32 v94, 16, v15
    v_and_b32 v95, 0xffff0000, v15
    buffer_load_dwordx4 v211, s[56:59], s48 offen offset:3072 lds
    s_waitcnt lgkmcnt(2)
    v_pk_fma_f32 v[88:89], v[88:89], v[192:193], v[194:195]
    v_pk_fma_f32 v[90:91], v[90:91], v[192:193], v[194:195]
    v_pk_fma_f32 v[92:93], v[92:93], v[192:193], v[194:195]
    v_pk_fma_f32 v[94:95], v[94:95], v[192:193], v[194:195]
    ds_read_b128 v[192:195], v206 offset:96
    v_lshlrev_b32 v96, 16, v16
    v_and_b32 v97, 0xffff0000, v16
    v_lshlrev_b32 v98, 16, v17
    v_and_b32 v99, 0xffff0000, v17
    v_lshlrev_b32 v100, 16, v18
    v_and_b32 v101, 0xffff0000, v18
    v_lshlrev_b32 v102, 16, v19
    v_and_b32 v103, 0xffff0000, v19
    s_add_u32 m0, s24, 73728
    s_nop 0
    buffer_load_dwordx4 v212, s[56:59], s48 offen offset:0 lds
    s_waitcnt lgkmcnt(2)
    v_pk_fma_f32 v[96:97], v[96:97], v[196:197], v[198:199]
    v_pk_fma_f32 v[98:99], v[98:99], v[196:197], v[198:199]
    v_pk_fma_f32 v[100:101], v[100:101], v[196:197], v[198:199]
    v_pk_fma_f32 v[102:103], v[102:103], v[196:197], v[198:199]
    ds_read_b128 v[196:199], v206 offset:112
    v_lshlrev_b32 v104, 16, v20
    v_and_b32 v105, 0xffff0000, v20
    v_lshlrev_b32 v106, 16, v21
    v_and_b32 v107, 0xffff0000, v21
    v_lshlrev_b32 v108, 16, v22
    v_and_b32 v109, 0xffff0000, v22
    v_lshlrev_b32 v110, 16, v23
    v_and_b32 v111, 0xffff0000, v23
    buffer_load_dwordx4 v213, s[56:59], s48 offen offset:1024 lds
    s_waitcnt lgkmcnt(2)
    v_pk_fma_f32 v[104:105], v[104:105], v[200:201], v[202:203]
    v_pk_fma_f32 v[106:107], v[106:107], v[200:201], v[202:203]
    v_pk_fma_f32 v[108:109], v[108:109], v[200:201], v[202:203]
    v_pk_fma_f32 v[110:111], v[110:111], v[200:201], v[202:203]
    ds_read_b128 v[200:203], v206 offset:128
    v_lshlrev_b32 v112, 16, v24
    v_and_b32 v113, 0xffff0000, v24
    v_lshlrev_b32 v114, 16, v25
    v_and_b32 v115, 0xffff0000, v25
    v_lshlrev_b32 v116, 16, v26
    v_and_b32 v117, 0xffff0000, v26
    v_lshlrev_b32 v118, 16, v27
    v_and_b32 v119, 0xffff0000, v27
    buffer_load_dwordx4 v214, s[56:59], s48 offen offset:2048 lds
    s_waitcnt lgkmcnt(2)
    v_pk_fma_f32 v[112:113], v[112:113], v[192:193], v[194:195]
    v_pk_fma_f32 v[114:115], v[114:115], v[192:193], v[194:195]
    v_pk_fma_f32 v[116:117], v[116:117], v[192:193], v[194:195]
    v_pk_fma_f32 v[118:119], v[118:119], v[192:193], v[194:195]
    ds_read_b128 v[192:195], v206 offset:144
    v_lshlrev_b32 v120, 16, v28
    v_and_b32 v121, 0xffff0000, v28
    v_lshlrev_b32 v122, 16, v29
    v_and_b32 v123, 0xffff0000, v29
    v_lshlrev_b32 v124, 16, v30
    v_and_b32 v125, 0xffff0000, v30
    v_lshlrev_b32 v126, 16, v31
    v_and_b32 v127, 0xffff0000, v31
    buffer_load_dwordx4 v215, s[56:59], s48 offen offset:3072 lds
    s_waitcnt lgkmcnt(2)
    v_pk_fma_f32 v[120:121], v[120:121], v[196:197], v[198:199]
    v_pk_fma_f32 v[122:123], v[122:123], v[196:197], v[198:199]
    v_pk_fma_f32 v[124:125], v[124:125], v[196:197], v[198:199]
    v_pk_fma_f32 v[126:127], v[126:127], v[196:197], v[198:199]
    ds_read_b128 v[196:199], v206 offset:160
    v_lshlrev_b32 v128, 16, v32
    v_and_b32 v129, 0xffff0000, v32
    v_lshlrev_b32 v130, 16, v33
    v_and_b32 v131, 0xffff0000, v33
    v_lshlrev_b32 v132, 16, v34
    v_and_b32 v133, 0xffff0000, v34
    v_lshlrev_b32 v134, 16, v35
    v_and_b32 v135, 0xffff0000, v35
    s_mov_b32 s48, 524288
    s_add_u32 m0, s24, 0
    s_nop 0
    buffer_load_dwordx4 v208, s[56:59], s48 offen offset:0 lds
    s_waitcnt lgkmcnt(2)
    v_pk_fma_f32 v[128:129], v[128:129], v[200:201], v[202:203]
    v_pk_fma_f32 v[130:131], v[130:131], v[200:201], v[202:203]
    v_pk_fma_f32 v[132:133], v[132:133], v[200:201], v[202:203]
    v_pk_fma_f32 v[134:135], v[134:135], v[200:201], v[202:203]
    ds_read_b128 v[200:203], v206 offset:176
    v_lshlrev_b32 v136, 16, v36
    v_and_b32 v137, 0xffff0000, v36
    v_lshlrev_b32 v138, 16, v37
    v_and_b32 v139, 0xffff0000, v37
    v_lshlrev_b32 v140, 16, v38
    v_and_b32 v141, 0xffff0000, v38
    v_lshlrev_b32 v142, 16, v39
    v_and_b32 v143, 0xffff0000, v39
    buffer_load_dwordx4 v209, s[56:59], s48 offen offset:1024 lds
    s_waitcnt lgkmcnt(2)
    v_pk_fma_f32 v[136:137], v[136:137], v[192:193], v[194:195]
    v_pk_fma_f32 v[138:139], v[138:139], v[192:193], v[194:195]
    v_pk_fma_f32 v[140:141], v[140:141], v[192:193], v[194:195]
    v_pk_fma_f32 v[142:143], v[142:143], v[192:193], v[194:195]
    ds_read_b128 v[192:195], v206 offset:192
    v_lshlrev_b32 v144, 16, v40
    v_and_b32 v145, 0xffff0000, v40
    v_lshlrev_b32 v146, 16, v41
    v_and_b32 v147, 0xffff0000, v41
    v_lshlrev_b32 v148, 16, v42
    v_and_b32 v149, 0xffff0000, v42
    v_lshlrev_b32 v150, 16, v43
    v_and_b32 v151, 0xffff0000, v43
    buffer_load_dwordx4 v210, s[56:59], s48 offen offset:2048 lds
    s_waitcnt lgkmcnt(2)
    v_pk_fma_f32 v[144:145], v[144:145], v[196:197], v[198:199]
    v_pk_fma_f32 v[146:147], v[146:147], v[196:197], v[198:199]
    v_pk_fma_f32 v[148:149], v[148:149], v[196:197], v[198:199]
    v_pk_fma_f32 v[150:151], v[150:151], v[196:197], v[198:199]
    ds_read_b128 v[196:199], v206 offset:208
    v_lshlrev_b32 v152, 16, v44
    v_and_b32 v153, 0xffff0000, v44
    v_lshlrev_b32 v154, 16, v45
    v_and_b32 v155, 0xffff0000, v45
    v_lshlrev_b32 v156, 16, v46
    v_and_b32 v157, 0xffff0000, v46
    v_lshlrev_b32 v158, 16, v47
    v_and_b32 v159, 0xffff0000, v47
    buffer_load_dwordx4 v211, s[56:59], s48 offen offset:3072 lds
    s_waitcnt lgkmcnt(2)
    v_pk_fma_f32 v[152:153], v[152:153], v[200:201], v[202:203]
    v_pk_fma_f32 v[154:155], v[154:155], v[200:201], v[202:203]
    v_pk_fma_f32 v[156:157], v[156:157], v[200:201], v[202:203]
    v_pk_fma_f32 v[158:159], v[158:159], v[200:201], v[202:203]
    ds_read_b128 v[200:203], v206 offset:224
    v_lshlrev_b32 v160, 16, v48
    v_and_b32 v161, 0xffff0000, v48
    v_lshlrev_b32 v162, 16, v49
    v_and_b32 v163, 0xffff0000, v49
    v_lshlrev_b32 v164, 16, v50
    v_and_b32 v165, 0xffff0000, v50
    v_lshlrev_b32 v166, 16, v51
    v_and_b32 v167, 0xffff0000, v51
    s_add_u32 m0, s24, 4096
    s_nop 0
    buffer_load_dwordx4 v212, s[56:59], s48 offen offset:0 lds
    s_waitcnt lgkmcnt(2)
    v_pk_fma_f32 v[160:161], v[160:161], v[192:193], v[194:195]
    v_pk_fma_f32 v[162:163], v[162:163], v[192:193], v[194:195]
    v_pk_fma_f32 v[164:165], v[164:165], v[192:193], v[194:195]
    v_pk_fma_f32 v[166:167], v[166:167], v[192:193], v[194:195]
    ds_read_b128 v[192:195], v206 offset:240
    v_lshlrev_b32 v168, 16, v52
    v_and_b32 v169, 0xffff0000, v52
    v_lshlrev_b32 v170, 16, v53
    v_and_b32 v171, 0xffff0000, v53
    v_lshlrev_b32 v172, 16, v54
    v_and_b32 v173, 0xffff0000, v54
    v_lshlrev_b32 v174, 16, v55
    v_and_b32 v175, 0xffff0000, v55
    buffer_load_dwordx4 v213, s[56:59], s48 offen offset:1024 lds
    s_waitcnt lgkmcnt(2)
    v_pk_fma_f32 v[168:169], v[168:169], v[196:197], v[198:199]
    v_pk_fma_f32 v[170:171], v[170:171], v[196:197], v[198:199]
    v_pk_fma_f32 v[172:173], v[172:173], v[196:197], v[198:199]
    v_pk_fma_f32 v[174:175], v[174:175], v[196:197], v[198:199]
    v_lshlrev_b32 v176, 16, v56
    v_and_b32 v177, 0xffff0000, v56
    v_lshlrev_b32 v178, 16, v57
    v_and_b32 v179, 0xffff0000, v57
    v_lshlrev_b32 v180, 16, v58
    v_and_b32 v181, 0xffff0000, v58
    v_lshlrev_b32 v182, 16, v59
    v_and_b32 v183, 0xffff0000, v59
    buffer_load_dwordx4 v214, s[56:59], s48 offen offset:2048 lds
    s_waitcnt lgkmcnt(1)
    v_pk_fma_f32 v[176:177], v[176:177], v[200:201], v[202:203]
    v_pk_fma_f32 v[178:179], v[178:179], v[200:201], v[202:203]
    v_pk_fma_f32 v[180:181], v[180:181], v[200:201], v[202:203]
    v_pk_fma_f32 v[182:183], v[182:183], v[200:201], v[202:203]
    v_lshlrev_b32 v184, 16, v60
    v_and_b32 v185, 0xffff0000, v60
    v_lshlrev_b32 v186, 16, v61
    v_and_b32 v187, 0xffff0000, v61
    v_lshlrev_b32 v188, 16, v62
    v_and_b32 v189, 0xffff0000, v62
    v_lshlrev_b32 v190, 16, v63
    v_and_b32 v191, 0xffff0000, v63
    buffer_load_dwordx4 v215, s[56:59], s48 offen offset:3072 lds
    s_waitcnt lgkmcnt(0)
    v_pk_fma_f32 v[184:185], v[184:185], v[192:193], v[194:195]
    v_pk_fma_f32 v[186:187], v[186:187], v[192:193], v[194:195]
    v_pk_fma_f32 v[188:189], v[188:189], v[192:193], v[194:195]
    v_pk_fma_f32 v[190:191], v[190:191], v[192:193], v[194:195]
    v_lshlrev_b32 v205, 5, v226
    v_add_u32 v205, 67584, v205
    s_cmp_lg_u32 s27, 0
    s_cbranch_scc1 K2_gotmod
    v_mov_b32 v206, 0
    s_mov_b32 s46, 0x40000
K2_tagc:
    buffer_load_dword v204, v206, s[96:99], 0 offen sc1
K2_tagwc:
    s_waitcnt vmcnt(0)
    v_readfirstlane_b32 s47, v204
    s_sub_u32 s46, s46, 1
    s_cmp_eq_u32 s46, 0
    s_cbranch_scc1 K2_tagdc
    s_cmp_eq_u32 s47, 0
    s_cbranch_scc1 K2_tagc
K2_tagdc:
    v_min_u32 v204, 55, v226
    v_lshlrev_b32 v204, 6, v204
    s_mov_b32 s45, 32768
    s_mov_b32 s48, 36352
    s_mov_b32 s46, 0x40000
K2_sweep:
    buffer_load_dwordx4 v[0:3], v204, s[16:19], s48 offen offset:0 sc1
    buffer_load_dwordx4 v[16:19], v204, s[16:19], s45 offen offset:0 sc1
    buffer_load_dwordx4 v[4:7], v204, s[16:19], s48 offen offset:16 sc1
    buffer_load_dwordx4 v[20:23], v204, s[16:19], s45 offen offset:16 sc1
    buffer_load_dwordx4 v[8:11], v204, s[16:19], s48 offen offset:32 sc1
    buffer_load_dwordx4 v[24:27], v204, s[16:19], s45 offen offset:32 sc1
    buffer_load_dwordx4 v[12:15], v204, s[16:19], s48 offen offset:48 sc1
    buffer_load_dwordx4 v[28:31], v204, s[16:19], s45 offen offset:48 sc1
    s_waitcnt vmcnt(0)
    v_xor_b32 v1, s47, v1
    v_xor_b32 v3, s47, v3
    v_xor_b32 v5, s47, v5
    v_xor_b32 v7, s47, v7
    v_xor_b32 v9, s47, v9
    v_xor_b32 v11, s47, v11
    v_xor_b32 v13, s47, v13
    v_xor_b32 v15, s47, v15
    v_xor_b32 v17, s47, v17
    v_xor_b32 v19, s47, v19
    v_xor_b32 v21, s47, v21
    v_xor_b32 v23, s47, v23
    v_xor_b32 v25, s47, v25
    v_xor_b32 v27, s47, v27
    v_xor_b32 v29, s47, v29
    v_xor_b32 v31, s47, v31
    v_or3_b32 v206, v1, v3, v5
    v_or3_b32 v206, v206, v7, v9
    v_or3_b32 v206, v206, v11, v13
    v_or3_b32 v206, v206, v15, v17
    v_or3_b32 v206, v206, v19, v21
    v_or3_b32 v206, v206, v23, v25
    v_or3_b32 v206, v206, v27, v29
    v_or_b32 v206, v206, v31
    v_cmp_ne_u32 vcc, 0, v206
    s_nop 1
    s_cbranch_vccz K2_swept
    s_sleep 4
    s_sub_u32 s46, s46, 1
    s_cmp_lg_u32 s46, 0
    s_cbranch_scc1 K2_sweep
K2_swept:
    s_cmp_eq_u32 s26, 0
    s_cbranch_scc1 K2_nocnt
    v_mov_b32 v204, 1
    v_mov_b32 v206, 0
    s_mov_b64 exec, 1
    buffer_atomic_add v204, v206, s[96:99], 0 offen offset:128 sc1
    s_mov_b64 exec, -1
K2_nocnt:
    s_mov_b32 s49, 0x3db8aa3b
    v_mul_f32 v32, s49, v0
    v_mul_f32 v33, s49, v2
    v_mul_f32 v34, s49, v4
    v_mul_f32 v35, s49, v6
    v_mul_f32 v36, s49, v8
    v_mul_f32 v37, s49, v10
    v_mul_f32 v38, s49, v12
    v_mul_f32 v39, s49, v14
    v_mul_f32 v40, s49, v16
    v_mul_f32 v41, s49, v18
    v_mul_f32 v42, s49, v20
    v_mul_f32 v43, s49, v22
    v_mul_f32 v44, s49, v24
    v_mul_f32 v45, s49, v26
    v_mul_f32 v46, s49, v28
    v_mul_f32 v47, s49, v30
    ds_write_b128 v205, v[32:35] offset:0
    ds_write_b128 v205, v[40:43] offset:34816
    ds_write_b128 v205, v[36:39] offset:16
    ds_write_b128 v205, v[44:47] offset:34832
    s_waitcnt lgkmcnt(0)
K2_gotmod:
    s_barrier
    ds_read_b128 v[32:35], v205 offset:0
    ds_read_b128 v[40:43], v205 offset:34816
    ds_read_b128 v[36:39], v205 offset:16
    ds_read_b128 v[44:47], v205 offset:34832
    s_mul_i32 s50, s27, 14336
    s_add_u32 s50, s50, 104448
    v_xor_b32 v0, 0, v230
    v_add_u32 v0, s50, v0
    v_xor_b32 v1, 16, v230
    v_add_u32 v1, s50, v1
    v_xor_b32 v2, 32, v230
    v_add_u32 v2, s50, v2
    v_xor_b32 v3, 48, v230
    v_add_u32 v3, s50, v3
    v_xor_b32 v4, 64, v230
    v_add_u32 v4, s50, v4
    v_xor_b32 v5, 80, v230
    v_add_u32 v5, s50, v5
    v_xor_b32 v6, 96, v230
    v_add_u32 v6, s50, v6
    v_xor_b32 v7, 112, v230
    v_add_u32 v7, s50, v7
    s_waitcnt lgkmcnt(0)
    s_mov_b32 exec_hi, 0x00ffffff
    v_pk_fma_f32 v[64:65], v[64:65], v[32:33], v[40:41]
    v_pk_fma_f32 v[66:67], v[66:67], v[34:35], v[42:43]
    v_pk_fma_f32 v[68:69], v[68:69], v[36:37], v[44:45]
    v_pk_fma_f32 v[70:71], v[70:71], v[38:39], v[46:47]
    v_cvt_pk_bf16_f32 v64, v64, v65
    v_cvt_pk_bf16_f32 v65, v66, v67
    v_cvt_pk_bf16_f32 v66, v68, v69
    v_cvt_pk_bf16_f32 v67, v70, v71
    ds_write_b128 v0, v[64:67] offset:0
    v_pk_fma_f32 v[72:73], v[72:73], v[32:33], v[40:41]
    v_pk_fma_f32 v[74:75], v[74:75], v[34:35], v[42:43]
    v_pk_fma_f32 v[76:77], v[76:77], v[36:37], v[44:45]
    v_pk_fma_f32 v[78:79], v[78:79], v[38:39], v[46:47]
    v_cvt_pk_bf16_f32 v72, v72, v73
    v_cvt_pk_bf16_f32 v73, v74, v75
    v_cvt_pk_bf16_f32 v74, v76, v77
    v_cvt_pk_bf16_f32 v75, v78, v79
    ds_write_b128 v0, v[72:75] offset:896
    v_pk_fma_f32 v[80:81], v[80:81], v[32:33], v[40:41]
    v_pk_fma_f32 v[82:83], v[82:83], v[34:35], v[42:43]
    v_pk_fma_f32 v[84:85], v[84:85], v[36:37], v[44:45]
    v_pk_fma_f32 v[86:87], v[86:87], v[38:39], v[46:47]
    v_cvt_pk_bf16_f32 v80, v80, v81
    v_cvt_pk_bf16_f32 v81, v82, v83
    v_cvt_pk_bf16_f32 v82, v84, v85
    v_cvt_pk_bf16_f32 v83, v86, v87
    ds_write_b128 v1, v[80:83] offset:1792
    v_pk_fma_f32 v[88:89], v[88:89], v[32:33], v[40:41]
    v_pk_fma_f32 v[90:91], v[90:91], v[34:35], v[42:43]
    v_pk_fma_f32 v[92:93], v[92:93], v[36:37], v[44:45]
    v_pk_fma_f32 v[94:95], v[94:95], v[38:39], v[46:47]
    v_cvt_pk_bf16_f32 v88, v88, v89
    v_cvt_pk_bf16_f32 v89, v90, v91
    v_cvt_pk_bf16_f32 v90, v92, v93
    v_cvt_pk_bf16_f32 v91, v94, v95
    ds_write_b128 v1, v[88:91] offset:2688
    v_pk_fma_f32 v[96:97], v[96:97], v[32:33], v[40:41]
    v_pk_fma_f32 v[98:99], v[98:99], v[34:35], v[42:43]
    v_pk_fma_f32 v[100:101], v[100:101], v[36:37], v[44:45]
    v_pk_fma_f32 v[102:103], v[102:103], v[38:39], v[46:47]
    v_cvt_pk_bf16_f32 v96, v96, v97
    v_cvt_pk_bf16_f32 v97, v98, v99
    v_cvt_pk_bf16_f32 v98, v100, v101
    v_cvt_pk_bf16_f32 v99, v102, v103
    ds_write_b128 v2, v[96:99] offset:3584
    v_pk_fma_f32 v[104:105], v[104:105], v[32:33], v[40:41]
    v_pk_fma_f32 v[106:107], v[106:107], v[34:35], v[42:43]
    v_pk_fma_f32 v[108:109], v[108:109], v[36:37], v[44:45]
    v_pk_fma_f32 v[110:111], v[110:111], v[38:39], v[46:47]
    v_cvt_pk_bf16_f32 v104, v104, v105
    v_cvt_pk_bf16_f32 v105, v106, v107
    v_cvt_pk_bf16_f32 v106, v108, v109
    v_cvt_pk_bf16_f32 v107, v110, v111
    ds_write_b128 v2, v[104:107] offset:4480
    v_pk_fma_f32 v[112:113], v[112:113], v[32:33], v[40:41]
    v_pk_fma_f32 v[114:115], v[114:115], v[34:35], v[42:43]
    v_pk_fma_f32 v[116:117], v[116:117], v[36:37], v[44:45]
    v_pk_fma_f32 v[118:119], v[118:119], v[38:39], v[46:47]
    v_cvt_pk_bf16_f32 v112, v112, v113
    v_cvt_pk_bf16_f32 v113, v114, v115
    v_cvt_pk_bf16_f32 v114, v116, v117
    v_cvt_pk_bf16_f32 v115, v118, v119
    ds_write_b128 v3, v[112:115] offset:5376
    v_pk_fma_f32 v[120:121], v[120:121], v[32:33], v[40:41]
    v_pk_fma_f32 v[122:123], v[122:123], v[34:35], v[42:43]
    v_pk_fma_f32 v[124:125], v[124:125], v[36:37], v[44:45]
    v_pk_fma_f32 v[126:127], v[126:127], v[38:39], v[46:47]
    v_cvt_pk_bf16_f32 v120, v120, v121
    v_cvt_pk_bf16_f32 v121, v122, v123
    v_cvt_pk_bf16_f32 v122, v124, v125
    v_cvt_pk_bf16_f32 v123, v126, v127
    ds_write_b128 v3, v[120:123] offset:6272
    v_pk_fma_f32 v[128:129], v[128:129], v[32:33], v[40:41]
    v_pk_fma_f32 v[130:131], v[130:131], v[34:35], v[42:43]
    v_pk_fma_f32 v[132:133], v[132:133], v[36:37], v[44:45]
    v_pk_fma_f32 v[134:135], v[134:135], v[38:39], v[46:47]
    v_cvt_pk_bf16_f32 v128, v128, v129
    v_cvt_pk_bf16_f32 v129, v130, v131
    v_cvt_pk_bf16_f32 v130, v132, v133
    v_cvt_pk_bf16_f32 v131, v134, v135
    ds_write_b128 v4, v[128:131] offset:7168
    v_pk_fma_f32 v[136:137], v[136:137], v[32:33], v[40:41]
    v_pk_fma_f32 v[138:139], v[138:139], v[34:35], v[42:43]
    v_pk_fma_f32 v[140:141], v[140:141], v[36:37], v[44:45]
    v_pk_fma_f32 v[142:143], v[142:143], v[38:39], v[46:47]
    v_cvt_pk_bf16_f32 v136, v136, v137
    v_cvt_pk_bf16_f32 v137, v138, v139
    v_cvt_pk_bf16_f32 v138, v140, v141
    v_cvt_pk_bf16_f32 v139, v142, v143
    ds_write_b128 v4, v[136:139] offset:8064
    v_pk_fma_f32 v[144:145], v[144:145], v[32:33], v[40:41]
    v_pk_fma_f32 v[146:147], v[146:147], v[34:35], v[42:43]
    v_pk_fma_f32 v[148:149], v[148:149], v[36:37], v[44:45]
    v_pk_fma_f32 v[150:151], v[150:151], v[38:39], v[46:47]
    v_cvt_pk_bf16_f32 v144, v144, v145
    v_cvt_pk_bf16_f32 v145, v146, v147
    v_cvt_pk_bf16_f32 v146, v148, v149
    v_cvt_pk_bf16_f32 v147, v150, v151
    ds_write_b128 v5, v[144:147] offset:8960
    v_pk_fma_f32 v[152:153], v[152:153], v[32:33], v[40:41]
    v_pk_fma_f32 v[154:155], v[154:155], v[34:35], v[42:43]
    v_pk_fma_f32 v[156:157], v[156:157], v[36:37], v[44:45]
    v_pk_fma_f32 v[158:159], v[158:159], v[38:39], v[46:47]
    v_cvt_pk_bf16_f32 v152, v152, v153
    v_cvt_pk_bf16_f32 v153, v154, v155
    v_cvt_pk_bf16_f32 v154, v156, v157
    v_cvt_pk_bf16_f32 v155, v158, v159
    ds_write_b128 v5, v[152:155] offset:9856
    v_pk_fma_f32 v[160:161], v[160:161], v[32:33], v[40:41]
    v_pk_fma_f32 v[162:163], v[162:163], v[34:35], v[42:43]
    v_pk_fma_f32 v[164:165], v[164:165], v[36:37], v[44:45]
    v_pk_fma_f32 v[166:167], v[166:167], v[38:39], v[46:47]
    v_cvt_pk_bf16_f32 v160, v160, v161
    v_cvt_pk_bf16_f32 v161, v162, v163
    v_cvt_pk_bf16_f32 v162, v164, v165
    v_cvt_pk_bf16_f32 v163, v166, v167
    ds_write_b128 v6, v[160:163] offset:10752
    v_pk_fma_f32 v[168:169], v[168:169], v[32:33], v[40:41]
    v_pk_fma_f32 v[170:171], v[170:171], v[34:35], v[42:43]
    v_pk_fma_f32 v[172:173], v[172:173], v[36:37], v[44:45]
    v_pk_fma_f32 v[174:175], v[174:175], v[38:39], v[46:47]
    v_cvt_pk_bf16_f32 v168, v168, v169
    v_cvt_pk_bf16_f32 v169, v170, v171
    v_cvt_pk_bf16_f32 v170, v172, v173
    v_cvt_pk_bf16_f32 v171, v174, v175
    ds_write_b128 v6, v[168:171] offset:11648
    v_pk_fma_f32 v[176:177], v[176:177], v[32:33], v[40:41]
    v_pk_fma_f32 v[178:179], v[178:179], v[34:35], v[42:43]
    v_pk_fma_f32 v[180:181], v[180:181], v[36:37], v[44:45]
    v_pk_fma_f32 v[182:183], v[182:183], v[38:39], v[46:47]
    v_cvt_pk_bf16_f32 v176, v176, v177
    v_cvt_pk_bf16_f32 v177, v178, v179
    v_cvt_pk_bf16_f32 v178, v180, v181
    v_cvt_pk_bf16_f32 v179, v182, v183
    ds_write_b128 v7, v[176:179] offset:12544
    v_pk_fma_f32 v[184:185], v[184:185], v[32:33], v[40:41]
    v_pk_fma_f32 v[186:187], v[186:187], v[34:35], v[42:43]
    v_pk_fma_f32 v[188:189], v[188:189], v[36:37], v[44:45]
    v_pk_fma_f32 v[190:191], v[190:191], v[38:39], v[46:47]
    v_cvt_pk_bf16_f32 v184, v184, v185
    v_cvt_pk_bf16_f32 v185, v186, v187
    v_cvt_pk_bf16_f32 v186, v188, v189
    v_cvt_pk_bf16_f32 v187, v190, v191
    ds_write_b128 v7, v[184:187] offset:13440
    s_mov_b32 exec_hi, -1
    s_waitcnt lgkmcnt(0)
    s_lshl_b32 s46, s43, 8
    v_and_b32 v204, 1, v227
    v_lshl_add_u32 v204, v204, 2, v228
    v_lshl_add_u32 v205, v227, 3, v228
    v_lshlrev_b32 v205, 10, v205
    v_lshl_add_u32 v205, v229, 3, v205
    s_lshl_b32 s45, s42, 9
    s_add_u32 s45, s45, s46
    v_add_u32 v205, s45, v205
    v_xor_b32 v206, 0, v204
    v_lshl_add_u32 v160, v206, 5, v205
    v_add_u32 v168, 69632, v160
    v_xor_b32 v206, 1, v204
    v_lshl_add_u32 v161, v206, 5, v205
    v_add_u32 v169, 69632, v161
    v_xor_b32 v206, 2, v204
    v_lshl_add_u32 v162, v206, 5, v205
    v_add_u32 v170, 69632, v162
    v_xor_b32 v206, 3, v204
    v_lshl_add_u32 v163, v206, 5, v205
    v_add_u32 v171, 69632, v163
    v_xor_b32 v206, 4, v204
    v_lshl_add_u32 v164, v206, 5, v205
    v_add_u32 v172, 69632, v164
    v_xor_b32 v206, 5, v204
    v_lshl_add_u32 v165, v206, 5, v205
    v_add_u32 v173, 69632, v165
    v_xor_b32 v206, 6, v204
    v_lshl_add_u32 v166, v206, 5, v205
    v_add_u32 v174, 69632, v166
    v_xor_b32 v206, 7, v204
    v_lshl_add_u32 v167, v206, 5, v205
    v_add_u32 v175, 69632, v167
    s_cmp_eq_u32 s43, 0
    s_cselect_b32 s64, s60, s34
    s_cselect_b32 s65, s61, s35
    s_mov_b32 s66, 0x100000
    s_mov_b32 s67, 0x20000
    s_lshl_b32 s74, s42, 17
    s_lshl_b32 s75, s41, 12
    s_add_u32 s74, s74, s75
    s_mov_b32 s46, 0x3f803f80
    s_mov_b32 s44, 0
    s_mov_b32 s45, 0x2f800000
    s_waitcnt vmcnt(16)
    s_waitcnt lgkmcnt(0)
    s_barrier
    ds_read_b128 a[0:3], v216 offset:0
    ds_read_b128 a[56:59], v216 offset:14336
    ds_read_b128 a[112:115], v216 offset:28672
    ds_read_b128 a[168:171], v216 offset:43008
    ds_read_b64_tr_b16 v[176:177], v160 offset:34816
    ds_read_b64_tr_b16 v[178:179], v160 offset:38912
    ds_read_b64_tr_b16 v[180:181], v161 offset:34816
    ds_read_b64_tr_b16 v[182:183], v161 offset:38912
    ds_read_b64_tr_b16 v[184:185], v162 offset:34816
    ds_read_b64_tr_b16 v[186:187], v162 offset:38912
    ds_read_b64_tr_b16 v[188:189], v163 offset:34816
    ds_read_b64_tr_b16 v[190:191], v163 offset:38912
    ds_read_b64_tr_b16 v[192:193], v164 offset:34816
    ds_read_b64_tr_b16 v[194:195], v164 offset:38912
    s_waitcnt lgkmcnt(6)
    v_mfma_f32_16x16x32_bf16 v[0:3], v[176:179], a[0:3], 0
    ds_read_b64_tr_b16 v[196:197], v165 offset:34816
    ds_read_b64_tr_b16 v[198:199], v165 offset:38912
    v_mfma_f32_16x16x32_bf16 v[4:7], v[176:179], a[56:59], 0
    ds_read_b128 a[4:7], v217 offset:0
    v_mfma_f32_16x16x32_bf16 v[8:11], v[176:179], a[112:115], 0
    v_mfma_f32_16x16x32_bf16 v[12:15], v[176:179], a[168:171], 0
    v_mfma_f32_16x16x32_bf16 v[16:19], v[180:183], a[0:3], 0
    ds_read_b64_tr_b16 v[200:201], v166 offset:34816
    ds_read_b64_tr_b16 v[202:203], v166 offset:38912
    v_mfma_f32_16x16x32_bf16 v[20:23], v[180:183], a[56:59], 0
    v_mfma_f32_16x16x32_bf16 v[24:27], v[180:183], a[112:115], 0
    ds_read_b128 a[60:63], v217 offset:14336
    v_mfma_f32_16x16x32_bf16 v[28:31], v[180:183], a[168:171], 0
    s_waitcnt lgkmcnt(8)
    v_mfma_f32_16x16x32_bf16 v[32:35], v[184:187], a[0:3], 0
    ds_read_b64_tr_b16 v[176:177], v167 offset:34816
    ds_read_b64_tr_b16 v[178:179], v167 offset:38912
    v_mfma_f32_16x16x32_bf16 v[36:39], v[184:187], a[56:59], 0
    v_mfma_f32_16x16x32_bf16 v[40:43], v[184:187], a[112:115], 0
    v_mfma_f32_16x16x32_bf16 v[44:47], v[184:187], a[168:171], 0
    s_waitcnt vmcnt(8)
    s_waitcnt lgkmcnt(0)
    s_barrier
    v_mfma_f32_16x16x32_bf16 v[48:51], v[188:191], a[0:3], 0
    ds_read_b64_tr_b16 v[180:181], v168 offset:0
    ds_read_b64_tr_b16 v[182:183], v168 offset:4096
    v_mfma_f32_16x16x32_bf16 v[52:55], v[188:191], a[56:59], 0
    s_mov_b32 s48, 786432
    s_add_u32 m0, s24, 34816
    v_mfma_f32_16x16x32_bf16 v[56:59], v[188:191], a[112:115], 0
    ds_read_b128 a[116:119], v217 offset:28672
    buffer_load_dwordx4 v208, s[56:59], s48 offen offset:0 lds
    v_mfma_f32_16x16x32_bf16 v[60:63], v[188:191], a[168:171], 0
    v_mfma_f32_16x16x32_bf16 v[64:67], v[192:195], a[0:3], 0
    ds_read_b64_tr_b16 v[184:185], v169 offset:0
    ds_read_b64_tr_b16 v[186:187], v169 offset:4096
    v_mfma_f32_16x16x32_bf16 v[68:71], v[192:195], a[56:59], 0
    buffer_load_dwordx4 v209, s[56:59], s48 offen offset:1024 lds
    v_mfma_f32_16x16x32_bf16 v[72:75], v[192:195], a[112:115], 0
    ds_read_b128 a[172:175], v217 offset:43008
    v_mfma_f32_16x16x32_bf16 v[76:79], v[192:195], a[168:171], 0
    v_mfma_f32_16x16x32_bf16 v[80:83], v[196:199], a[0:3], 0
    ds_read_b64_tr_b16 v[188:189], v170 offset:0
    ds_read_b64_tr_b16 v[190:191], v170 offset:4096
    v_mfma_f32_16x16x32_bf16 v[84:87], v[196:199], a[56:59], 0
    buffer_load_dwordx4 v210, s[56:59], s48 offen offset:2048 lds
    v_mfma_f32_16x16x32_bf16 v[88:91], v[196:199], a[112:115], 0
    v_mfma_f32_16x16x32_bf16 v[92:95], v[196:199], a[168:171], 0
    v_mfma_f32_16x16x32_bf16 v[96:99], v[200:203], a[0:3], 0
    ds_read_b64_tr_b16 v[192:193], v171 offset:0
    ds_read_b64_tr_b16 v[194:195], v171 offset:4096
    v_mfma_f32_16x16x32_bf16 v[100:103], v[200:203], a[56:59], 0
    ds_read_b128 a[8:11], v216 offset:128
    buffer_load_dwordx4 v211, s[56:59], s48 offen offset:3072 lds
    v_mfma_f32_16x16x32_bf16 v[104:107], v[200:203], a[112:115], 0
    v_mfma_f32_16x16x32_bf16 v[108:111], v[200:203], a[168:171], 0
    v_mfma_f32_16x16x32_bf16 v[112:115], v[176:179], a[0:3], 0
    ds_read_b64_tr_b16 v[196:197], v172 offset:0
    ds_read_b64_tr_b16 v[198:199], v172 offset:4096
    v_mfma_f32_16x16x32_bf16 v[116:119], v[176:179], a[56:59], 0
    s_add_u32 m0, s24, 38912
    v_mfma_f32_16x16x32_bf16 v[120:123], v[176:179], a[112:115], 0
    buffer_load_dwordx4 v212, s[56:59], s48 offen offset:0 lds
    ds_read_b128 a[64:67], v216 offset:14464
    v_mfma_f32_16x16x32_bf16 v[124:127], v[176:179], a[168:171], 0
    s_waitcnt lgkmcnt(8)
    v_mfma_f32_16x16x32_bf16 v[0:3], v[180:183], a[4:7], v[0:3]
    ds_read_b64_tr_b16 v[200:201], v173 offset:0
    ds_read_b64_tr_b16 v[202:203], v173 offset:4096
    v_mfma_f32_16x16x32_bf16 v[4:7], v[180:183], a[60:63], v[4:7]
    buffer_load_dwordx4 v213, s[56:59], s48 offen offset:1024 lds
    v_mfma_f32_16x16x32_bf16 v[8:11], v[180:183], a[116:119], v[8:11]
    v_mfma_f32_16x16x32_bf16 v[12:15], v[180:183], a[172:175], v[12:15]
    v_mfma_f32_16x16x32_bf16 v[16:19], v[184:187], a[4:7], v[16:19]
    ds_read_b64_tr_b16 v[176:177], v174 offset:0
    ds_read_b64_tr_b16 v[178:179], v174 offset:4096
    v_mfma_f32_16x16x32_bf16 v[20:23], v[184:187], a[60:63], v[20:23]
    ds_read_b128 a[120:123], v216 offset:28800
    buffer_load_dwordx4 v214, s[56:59], s48 offen offset:2048 lds
    v_mfma_f32_16x16x32_bf16 v[24:27], v[184:187], a[116:119], v[24:27]
    v_mfma_f32_16x16x32_bf16 v[28:31], v[184:187], a[172:175], v[28:31]
    s_waitcnt lgkmcnt(9)
    v_mfma_f32_16x16x32_bf16 v[32:35], v[188:191], a[4:7], v[32:35]
    ds_read_b64_tr_b16 v[180:181], v175 offset:0
    ds_read_b64_tr_b16 v[182:183], v175 offset:4096
    v_mfma_f32_16x16x32_bf16 v[36:39], v[188:191], a[60:63], v[36:39]
    buffer_load_dwordx4 v215, s[56:59], s48 offen offset:3072 lds
    v_mfma_f32_16x16x32_bf16 v[40:43], v[188:191], a[116:119], v[40:43]
    ds_read_b128 a[176:179], v216 offset:43136
    v_mfma_f32_16x16x32_bf16 v[44:47], v[188:191], a[172:175], v[44:47]
    s_waitcnt vmcnt(8)
    s_waitcnt lgkmcnt(1)
    s_barrier
    v_mfma_f32_16x16x32_bf16 v[48:51], v[192:195], a[4:7], v[48:51]
    ds_read_b64_tr_b16 v[184:185], v160 offset:0
    ds_read_b64_tr_b16 v[186:187], v160 offset:4096
    v_mfma_f32_16x16x32_bf16 v[52:55], v[192:195], a[60:63], v[52:55]
    s_mov_b32 s48, 1048576
    s_add_u32 m0, s24, 69632
    v_mfma_f32_16x16x32_bf16 v[56:59], v[192:195], a[116:119], v[56:59]
    buffer_load_dwordx4 v208, s[56:59], s48 offen offset:0 lds
    v_mfma_f32_16x16x32_bf16 v[60:63], v[192:195], a[172:175], v[60:63]
    v_mfma_f32_16x16x32_bf16 v[64:67], v[196:199], a[4:7], v[64:67]
    ds_read_b64_tr_b16 v[188:189], v161 offset:0
    ds_read_b64_tr_b16 v[190:191], v161 offset:4096
    v_mfma_f32_16x16x32_bf16 v[68:71], v[196:199], a[60:63], v[68:71]
    ds_read_b128 a[12:15], v217 offset:128
    buffer_load_dwordx4 v209, s[56:59], s48 offen offset:1024 lds
    v_mfma_f32_16x16x32_bf16 v[72:75], v[196:199], a[116:119], v[72:75]
    v_mfma_f32_16x16x32_bf16 v[76:79], v[196:199], a[172:175], v[76:79]
    v_mfma_f32_16x16x32_bf16 v[80:83], v[200:203], a[4:7], v[80:83]
    ds_read_b64_tr_b16 v[192:193], v162 offset:0
    ds_read_b64_tr_b16 v[194:195], v162 offset:4096
    v_mfma_f32_16x16x32_bf16 v[84:87], v[200:203], a[60:63], v[84:87]
    buffer_load_dwordx4 v210, s[56:59], s48 offen offset:2048 lds
    v_mfma_f32_16x16x32_bf16 v[88:91], v[200:203], a[116:119], v[88:91]
    ds_read_b128 a[68:71], v217 offset:14464
    v_mfma_f32_16x16x32_bf16 v[92:95], v[200:203], a[172:175], v[92:95]
    v_mfma_f32_16x16x32_bf16 v[96:99], v[176:179], a[4:7], v[96:99]
    ds_read_b64_tr_b16 v[196:197], v163 offset:0
    ds_read_b64_tr_b16 v[198:199], v163 offset:4096
    v_mfma_f32_16x16x32_bf16 v[100:103], v[176:179], a[60:63], v[100:103]
    buffer_load_dwordx4 v211, s[56:59], s48 offen offset:3072 lds
    v_mfma_f32_16x16x32_bf16 v[104:107], v[176:179], a[116:119], v[104:107]
    v_mfma_f32_16x16x32_bf16 v[108:111], v[176:179], a[172:175], v[108:111]
    v_mfma_f32_16x16x32_bf16 v[112:115], v[180:183], a[4:7], v[112:115]
    ds_read_b64_tr_b16 v[200:201], v164 offset:0
    ds_read_b64_tr_b16 v[202:203], v164 offset:4096
    v_mfma_f32_16x16x32_bf16 v[116:119], v[180:183], a[60:63], v[116:119]
    s_add_u32 m0, s24, 73728
    ds_read_b128 a[124:127], v217 offset:28800
    v_mfma_f32_16x16x32_bf16 v[120:123], v[180:183], a[116:119], v[120:123]
    buffer_load_dwordx4 v212, s[56:59], s48 offen offset:0 lds
    v_mfma_f32_16x16x32_bf16 v[124:127], v[180:183], a[172:175], v[124:127]
    s_waitcnt lgkmcnt(9)
    v_mfma_f32_16x16x32_bf16 v[0:3], v[184:187], a[8:11], v[0:3]
    ds_read_b64_tr_b16 v[176:177], v165 offset:0
    ds_read_b64_tr_b16 v[178:179], v165 offset:4096
    v_mfma_f32_16x16x32_bf16 v[4:7], v[184:187], a[64:67], v[4:7]
    buffer_load_dwordx4 v213, s[56:59], s48 offen offset:1024 lds
    v_mfma_f32_16x16x32_bf16 v[8:11], v[184:187], a[120:123], v[8:11]
    ds_read_b128 a[180:183], v217 offset:43136
    v_mfma_f32_16x16x32_bf16 v[12:15], v[184:187], a[176:179], v[12:15]
    v_mfma_f32_16x16x32_bf16 v[16:19], v[188:191], a[8:11], v[16:19]
    ds_read_b64_tr_b16 v[180:181], v166 offset:0
    ds_read_b64_tr_b16 v[182:183], v166 offset:4096
    v_mfma_f32_16x16x32_bf16 v[20:23], v[188:191], a[64:67], v[20:23]
    buffer_load_dwordx4 v214, s[56:59], s48 offen offset:2048 lds
    v_mfma_f32_16x16x32_bf16 v[24:27], v[188:191], a[120:123], v[24:27]
    v_mfma_f32_16x16x32_bf16 v[28:31], v[188:191], a[176:179], v[28:31]
    s_waitcnt lgkmcnt(8)
    v_mfma_f32_16x16x32_bf16 v[32:35], v[192:195], a[8:11], v[32:35]
    ds_read_b64_tr_b16 v[184:185], v167 offset:0
    ds_read_b64_tr_b16 v[186:187], v167 offset:4096
    v_mfma_f32_16x16x32_bf16 v[36:39], v[192:195], a[64:67], v[36:39]
    ds_read_b128 a[16:19], v216 offset:256
    buffer_load_dwordx4 v215, s[56:59], s48 offen offset:3072 lds
    v_mfma_f32_16x16x32_bf16 v[40:43], v[192:195], a[120:123], v[40:43]
    v_mfma_f32_16x16x32_bf16 v[44:47], v[192:195], a[176:179], v[44:47]
    s_waitcnt vmcnt(8)
    s_waitcnt lgkmcnt(1)
    s_barrier
    v_mfma_f32_16x16x32_bf16 v[48:51], v[196:199], a[8:11], v[48:51]
    ds_read_b64_tr_b16 v[188:189], v160 offset:34816
    ds_read_b64_tr_b16 v[190:191], v160 offset:38912
    v_mfma_f32_16x16x32_bf16 v[52:55], v[196:199], a[64:67], v[52:55]
    s_mov_b32 s48, 1310720
    s_add_u32 m0, s24, 0
    v_mfma_f32_16x16x32_bf16 v[56:59], v[196:199], a[120:123], v[56:59]
    buffer_load_dwordx4 v208, s[56:59], s48 offen offset:0 lds
    ds_read_b128 a[72:75], v216 offset:14592
    v_mfma_f32_16x16x32_bf16 v[60:63], v[196:199], a[176:179], v[60:63]
    v_mfma_f32_16x16x32_bf16 v[64:67], v[200:203], a[8:11], v[64:67]
    ds_read_b64_tr_b16 v[192:193], v161 offset:34816
    ds_read_b64_tr_b16 v[194:195], v161 offset:38912
    v_mfma_f32_16x16x32_bf16 v[68:71], v[200:203], a[64:67], v[68:71]
    buffer_load_dwordx4 v209, s[56:59], s48 offen offset:1024 lds
    v_mfma_f32_16x16x32_bf16 v[72:75], v[200:203], a[120:123], v[72:75]
    v_mfma_f32_16x16x32_bf16 v[76:79], v[200:203], a[176:179], v[76:79]
    v_mfma_f32_16x16x32_bf16 v[80:83], v[176:179], a[8:11], v[80:83]
    ds_read_b64_tr_b16 v[196:197], v162 offset:34816
    ds_read_b64_tr_b16 v[198:199], v162 offset:38912
    v_mfma_f32_16x16x32_bf16 v[84:87], v[176:179], a[64:67], v[84:87]
    ds_read_b128 a[128:131], v216 offset:28928
    buffer_load_dwordx4 v210, s[56:59], s48 offen offset:2048 lds
    v_mfma_f32_16x16x32_bf16 v[88:91], v[176:179], a[120:123], v[88:91]
    v_mfma_f32_16x16x32_bf16 v[92:95], v[176:179], a[176:179], v[92:95]
    v_mfma_f32_16x16x32_bf16 v[96:99], v[180:183], a[8:11], v[96:99]
    ds_read_b64_tr_b16 v[200:201], v163 offset:34816
    ds_read_b64_tr_b16 v[202:203], v163 offset:38912
    v_mfma_f32_16x16x32_bf16 v[100:103], v[180:183], a[64:67], v[100:103]
    buffer_load_dwordx4 v211, s[56:59], s48 offen offset:3072 lds
    v_mfma_f32_16x16x32_bf16 v[104:107], v[180:183], a[120:123], v[104:107]
    ds_read_b128 a[184:187], v216 offset:43264
    v_mfma_f32_16x16x32_bf16 v[108:111], v[180:183], a[176:179], v[108:111]
    v_mfma_f32_16x16x32_bf16 v[112:115], v[184:187], a[8:11], v[112:115]
    ds_read_b64_tr_b16 v[176:177], v164 offset:34816
    ds_read_b64_tr_b16 v[178:179], v164 offset:38912
    v_mfma_f32_16x16x32_bf16 v[116:119], v[184:187], a[64:67], v[116:119]
    s_add_u32 m0, s24, 4096
    v_mfma_f32_16x16x32_bf16 v[120:123], v[184:187], a[120:123], v[120:123]
    buffer_load_dwordx4 v212, s[56:59], s48 offen offset:0 lds
    v_mfma_f32_16x16x32_bf16 v[124:127], v[184:187], a[176:179], v[124:127]
    s_waitcnt lgkmcnt(8)
    v_mfma_f32_16x16x32_bf16 v[0:3], v[188:191], a[12:15], v[0:3]
    ds_read_b64_tr_b16 v[180:181], v165 offset:34816
    ds_read_b64_tr_b16 v[182:183], v165 offset:38912
    v_mfma_f32_16x16x32_bf16 v[4:7], v[188:191], a[68:71], v[4:7]
    ds_read_b128 a[20:23], v217 offset:256
    buffer_load_dwordx4 v213, s[56:59], s48 offen offset:1024 lds
    v_mfma_f32_16x16x32_bf16 v[8:11], v[188:191], a[124:127], v[8:11]
    v_mfma_f32_16x16x32_bf16 v[12:15], v[188:191], a[180:183], v[12:15]
    v_mfma_f32_16x16x32_bf16 v[16:19], v[192:195], a[12:15], v[16:19]
    ds_read_b64_tr_b16 v[184:185], v166 offset:34816
    ds_read_b64_tr_b16 v[186:187], v166 offset:38912
    v_mfma_f32_16x16x32_bf16 v[20:23], v[192:195], a[68:71], v[20:23]
    buffer_load_dwordx4 v214, s[56:59], s48 offen offset:2048 lds
    v_mfma_f32_16x16x32_bf16 v[24:27], v[192:195], a[124:127], v[24:27]
    ds_read_b128 a[76:79], v217 offset:14592
    v_mfma_f32_16x16x32_bf16 v[28:31], v[192:195], a[180:183], v[28:31]
    s_waitcnt lgkmcnt(9)
    v_mfma_f32_16x16x32_bf16 v[32:35], v[196:199], a[12:15], v[32:35]
    ds_read_b64_tr_b16 v[188:189], v167 offset:34816
    ds_read_b64_tr_b16 v[190:191], v167 offset:38912
    v_mfma_f32_16x16x32_bf16 v[36:39], v[196:199], a[68:71], v[36:39]
    buffer_load_dwordx4 v215, s[56:59], s48 offen offset:3072 lds
    v_mfma_f32_16x16x32_bf16 v[40:43], v[196:199], a[124:127], v[40:43]
    v_mfma_f32_16x16x32_bf16 v[44:47], v[196:199], a[180:183], v[44:47]
    s_waitcnt vmcnt(8)
    s_waitcnt lgkmcnt(0)
    s_barrier
    v_mfma_f32_16x16x32_bf16 v[48:51], v[200:203], a[12:15], v[48:51]
    ds_read_b64_tr_b16 v[192:193], v168 offset:0
    ds_read_b64_tr_b16 v[194:195], v168 offset:4096
    v_mfma_f32_16x16x32_bf16 v[52:55], v[200:203], a[68:71], v[52:55]
    s_mov_b32 s48, 1572864
    s_add_u32 m0, s24, 34816
    v_mfma_f32_16x16x32_bf16 v[56:59], v[200:203], a[124:127], v[56:59]
    ds_read_b128 a[132:135], v217 offset:28928
    buffer_load_dwordx4 v208, s[56:59], s48 offen offset:0 lds
    v_mfma_f32_16x16x32_bf16 v[60:63], v[200:203], a[180:183], v[60:63]
    v_mfma_f32_16x16x32_bf16 v[64:67], v[176:179], a[12:15], v[64:67]
    ds_read_b64_tr_b16 v[196:197], v169 offset:0
    ds_read_b64_tr_b16 v[198:199], v169 offset:4096
    v_mfma_f32_16x16x32_bf16 v[68:71], v[176:179], a[68:71], v[68:71]
    buffer_load_dwordx4 v209, s[56:59], s48 offen offset:1024 lds
    v_mfma_f32_16x16x32_bf16 v[72:75], v[176:179], a[124:127], v[72:75]
    ds_read_b128 a[188:191], v217 offset:43264
    v_mfma_f32_16x16x32_bf16 v[76:79], v[176:179], a[180:183], v[76:79]
    v_mfma_f32_16x16x32_bf16 v[80:83], v[180:183], a[12:15], v[80:83]
    ds_read_b64_tr_b16 v[200:201], v170 offset:0
    ds_read_b64_tr_b16 v[202:203], v170 offset:4096
    v_mfma_f32_16x16x32_bf16 v[84:87], v[180:183], a[68:71], v[84:87]
    buffer_load_dwordx4 v210, s[56:59], s48 offen offset:2048 lds
    v_mfma_f32_16x16x32_bf16 v[88:91], v[180:183], a[124:127], v[88:91]
    v_mfma_f32_16x16x32_bf16 v[92:95], v[180:183], a[180:183], v[92:95]
    v_mfma_f32_16x16x32_bf16 v[96:99], v[184:187], a[12:15], v[96:99]
    ds_read_b64_tr_b16 v[176:177], v171 offset:0
    ds_read_b64_tr_b16 v[178:179], v171 offset:4096
    v_mfma_f32_16x16x32_bf16 v[100:103], v[184:187], a[68:71], v[100:103]
    ds_read_b128 a[24:27], v216 offset:384
    buffer_load_dwordx4 v211, s[56:59], s48 offen offset:3072 lds
    v_mfma_f32_16x16x32_bf16 v[104:107], v[184:187], a[124:127], v[104:107]
    v_mfma_f32_16x16x32_bf16 v[108:111], v[184:187], a[180:183], v[108:111]
    v_mfma_f32_16x16x32_bf16 v[112:115], v[188:191], a[12:15], v[112:115]
    ds_read_b64_tr_b16 v[180:181], v172 offset:0
    ds_read_b64_tr_b16 v[182:183], v172 offset:4096
    v_mfma_f32_16x16x32_bf16 v[116:119], v[188:191], a[68:71], v[116:119]
    s_add_u32 m0, s24, 38912
    v_mfma_f32_16x16x32_bf16 v[120:123], v[188:191], a[124:127], v[120:123]
    buffer_load_dwordx4 v212, s[56:59], s48 offen offset:0 lds
    ds_read_b128 a[80:83], v216 offset:14720
    v_mfma_f32_16x16x32_bf16 v[124:127], v[188:191], a[180:183], v[124:127]
    s_waitcnt lgkmcnt(9)
    v_mfma_f32_16x16x32_bf16 v[0:3], v[192:195], a[16:19], v[0:3]
    ds_read_b64_tr_b16 v[184:185], v173 offset:0
    ds_read_b64_tr_b16 v[186:187], v173 offset:4096
    v_mfma_f32_16x16x32_bf16 v[4:7], v[192:195], a[72:75], v[4:7]
    buffer_load_dwordx4 v213, s[56:59], s48 offen offset:1024 lds
    v_mfma_f32_16x16x32_bf16 v[8:11], v[192:195], a[128:131], v[8:11]
    v_mfma_f32_16x16x32_bf16 v[12:15], v[192:195], a[184:187], v[12:15]
    v_mfma_f32_16x16x32_bf16 v[16:19], v[196:199], a[16:19], v[16:19]
    ds_read_b64_tr_b16 v[188:189], v174 offset:0
    ds_read_b64_tr_b16 v[190:191], v174 offset:4096
    v_mfma_f32_16x16x32_bf16 v[20:23], v[196:199], a[72:75], v[20:23]
    ds_read_b128 a[136:139], v216 offset:29056
    buffer_load_dwordx4 v214, s[56:59], s48 offen offset:2048 lds
    v_mfma_f32_16x16x32_bf16 v[24:27], v[196:199], a[128:131], v[24:27]
    v_mfma_f32_16x16x32_bf16 v[28:31], v[196:199], a[184:187], v[28:31]
    s_waitcnt lgkmcnt(9)
    v_mfma_f32_16x16x32_bf16 v[32:35], v[200:203], a[16:19], v[32:35]
    ds_read_b64_tr_b16 v[192:193], v175 offset:0
    ds_read_b64_tr_b16 v[194:195], v175 offset:4096
    v_mfma_f32_16x16x32_bf16 v[36:39], v[200:203], a[72:75], v[36:39]
    buffer_load_dwordx4 v215, s[56:59], s48 offen offset:3072 lds
    v_mfma_f32_16x16x32_bf16 v[40:43], v[200:203], a[128:131], v[40:43]
    ds_read_b128 a[192:195], v216 offset:43392
    v_mfma_f32_16x16x32_bf16 v[44:47], v[200:203], a[184:187], v[44:47]
    s_waitcnt vmcnt(8)
    s_waitcnt lgkmcnt(1)
    s_barrier
    v_mfma_f32_16x16x32_bf16 v[48:51], v[176:179], a[16:19], v[48:51]
    ds_read_b64_tr_b16 v[196:197], v160 offset:0
    ds_read_b64_tr_b16 v[198:199], v160 offset:4096
    v_mfma_f32_16x16x32_bf16 v[52:55], v[176:179], a[72:75], v[52:55]
    s_mov_b32 s48, 1835008
    s_add_u32 m0, s24, 69632
    v_mfma_f32_16x16x32_bf16 v[56:59], v[176:179], a[128:131], v[56:59]
    buffer_load_dwordx4 v208, s[56:59], s48 offen offset:0 lds
    v_mfma_f32_16x16x32_bf16 v[60:63], v[176:179], a[184:187], v[60:63]
    v_mfma_f32_16x16x32_bf16 v[64:67], v[180:183], a[16:19], v[64:67]
    ds_read_b64_tr_b16 v[200:201], v161 offset:0
    ds_read_b64_tr_b16 v[202:203], v161 offset:4096
    v_mfma_f32_16x16x32_bf16 v[68:71], v[180:183], a[72:75], v[68:71]
    ds_read_b128 a[28:31], v217 offset:384
    buffer_load_dwordx4 v209, s[56:59], s48 offen offset:1024 lds
    v_mfma_f32_16x16x32_bf16 v[72:75], v[180:183], a[128:131], v[72:75]
    v_mfma_f32_16x16x32_bf16 v[76:79], v[180:183], a[184:187], v[76:79]
    v_mfma_f32_16x16x32_bf16 v[80:83], v[184:187], a[16:19], v[80:83]
    ds_read_b64_tr_b16 v[176:177], v162 offset:0
    ds_read_b64_tr_b16 v[178:179], v162 offset:4096
    v_mfma_f32_16x16x32_bf16 v[84:87], v[184:187], a[72:75], v[84:87]
    buffer_load_dwordx4 v210, s[56:59], s48 offen offset:2048 lds
    v_mfma_f32_16x16x32_bf16 v[88:91], v[184:187], a[128:131], v[88:91]
    ds_read_b128 a[84:87], v217 offset:14720
    v_mfma_f32_16x16x32_bf16 v[92:95], v[184:187], a[184:187], v[92:95]
    v_mfma_f32_16x16x32_bf16 v[96:99], v[188:191], a[16:19], v[96:99]
    ds_read_b64_tr_b16 v[180:181], v163 offset:0
    ds_read_b64_tr_b16 v[182:183], v163 offset:4096
    v_mfma_f32_16x16x32_bf16 v[100:103], v[188:191], a[72:75], v[100:103]
    buffer_load_dwordx4 v211, s[56:59], s48 offen offset:3072 lds
    v_mfma_f32_16x16x32_bf16 v[104:107], v[188:191], a[128:131], v[104:107]
    v_mfma_f32_16x16x32_bf16 v[108:111], v[188:191], a[184:187], v[108:111]
    v_mfma_f32_16x16x32_bf16 v[112:115], v[192:195], a[16:19], v[112:115]
    ds_read_b64_tr_b16 v[184:185], v164 offset:0
    ds_read_b64_tr_b16 v[186:187], v164 offset:4096
    v_mfma_f32_16x16x32_bf16 v[116:119], v[192:195], a[72:75], v[116:119]
    s_add_u32 m0, s24, 73728
    ds_read_b128 a[140:143], v217 offset:29056
    v_mfma_f32_16x16x32_bf16 v[120:123], v[192:195], a[128:131], v[120:123]
    buffer_load_dwordx4 v212, s[56:59], s48 offen offset:0 lds
    v_mfma_f32_16x16x32_bf16 v[124:127], v[192:195], a[184:187], v[124:127]
    s_waitcnt lgkmcnt(9)
    v_mfma_f32_16x16x32_bf16 v[0:3], v[196:199], a[20:23], v[0:3]
    ds_read_b64_tr_b16 v[188:189], v165 offset:0
    ds_read_b64_tr_b16 v[190:191], v165 offset:4096
    v_mfma_f32_16x16x32_bf16 v[4:7], v[196:199], a[76:79], v[4:7]
    buffer_load_dwordx4 v213, s[56:59], s48 offen offset:1024 lds
    v_mfma_f32_16x16x32_bf16 v[8:11], v[196:199], a[132:135], v[8:11]
    ds_read_b128 a[196:199], v217 offset:43392
    v_mfma_f32_16x16x32_bf16 v[12:15], v[196:199], a[188:191], v[12:15]
    v_mfma_f32_16x16x32_bf16 v[16:19], v[200:203], a[20:23], v[16:19]
    ds_read_b64_tr_b16 v[192:193], v166 offset:0
    ds_read_b64_tr_b16 v[194:195], v166 offset:4096
    v_mfma_f32_16x16x32_bf16 v[20:23], v[200:203], a[76:79], v[20:23]
    buffer_load_dwordx4 v214, s[56:59], s48 offen offset:2048 lds
    v_mfma_f32_16x16x32_bf16 v[24:27], v[200:203], a[132:135], v[24:27]
    v_mfma_f32_16x16x32_bf16 v[28:31], v[200:203], a[188:191], v[28:31]
    s_waitcnt lgkmcnt(8)
    v_mfma_f32_16x16x32_bf16 v[32:35], v[176:179], a[20:23], v[32:35]
    ds_read_b64_tr_b16 v[196:197], v167 offset:0
    ds_read_b64_tr_b16 v[198:199], v167 offset:4096
    v_mfma_f32_16x16x32_bf16 v[36:39], v[176:179], a[76:79], v[36:39]
    ds_read_b128 a[32:35], v216 offset:512
    buffer_load_dwordx4 v215, s[56:59], s48 offen offset:3072 lds
    v_mfma_f32_16x16x32_bf16 v[40:43], v[176:179], a[132:135], v[40:43]
    v_mfma_f32_16x16x32_bf16 v[44:47], v[176:179], a[188:191], v[44:47]
    s_waitcnt vmcnt(8)
    s_waitcnt lgkmcnt(1)
    s_barrier
    v_mfma_f32_16x16x32_bf16 v[48:51], v[180:183], a[20:23], v[48:51]
    ds_read_b64_tr_b16 v[200:201], v160 offset:34816
    ds_read_b64_tr_b16 v[202:203], v160 offset:38912
    v_mfma_f32_16x16x32_bf16 v[52:55], v[180:183], a[76:79], v[52:55]
    s_mov_b32 s48, 2097152
    s_add_u32 m0, s24, 0
    v_mfma_f32_16x16x32_bf16 v[56:59], v[180:183], a[132:135], v[56:59]
    buffer_load_dwordx4 v208, s[56:59], s48 offen offset:0 lds
    ds_read_b128 a[88:91], v216 offset:14848
    v_mfma_f32_16x16x32_bf16 v[60:63], v[180:183], a[188:191], v[60:63]
    v_mfma_f32_16x16x32_bf16 v[64:67], v[184:187], a[20:23], v[64:67]
    ds_read_b64_tr_b16 v[176:177], v161 offset:34816
    ds_read_b64_tr_b16 v[178:179], v161 offset:38912
    v_mfma_f32_16x16x32_bf16 v[68:71], v[184:187], a[76:79], v[68:71]
    buffer_load_dwordx4 v209, s[56:59], s48 offen offset:1024 lds
    v_mfma_f32_16x16x32_bf16 v[72:75], v[184:187], a[132:135], v[72:75]
    v_mfma_f32_16x16x32_bf16 v[76:79], v[184:187], a[188:191], v[76:79]
    v_mfma_f32_16x16x32_bf16 v[80:83], v[188:191], a[20:23], v[80:83]
    ds_read_b64_tr_b16 v[180:181], v162 offset:34816
    ds_read_b64_tr_b16 v[182:183], v162 offset:38912
    v_mfma_f32_16x16x32_bf16 v[84:87], v[188:191], a[76:79], v[84:87]
    ds_read_b128 a[144:147], v216 offset:29184
    buffer_load_dwordx4 v210, s[56:59], s48 offen offset:2048 lds
    v_mfma_f32_16x16x32_bf16 v[88:91], v[188:191], a[132:135], v[88:91]
    v_mfma_f32_16x16x32_bf16 v[92:95], v[188:191], a[188:191], v[92:95]
    v_mfma_f32_16x16x32_bf16 v[96:99], v[192:195], a[20:23], v[96:99]
    ds_read_b64_tr_b16 v[184:185], v163 offset:34816
    ds_read_b64_tr_b16 v[186:187], v163 offset:38912
    v_mfma_f32_16x16x32_bf16 v[100:103], v[192:195], a[76:79], v[100:103]
    buffer_load_dwordx4 v211, s[56:59], s48 offen offset:3072 lds
    v_mfma_f32_16x16x32_bf16 v[104:107], v[192:195], a[132:135], v[104:107]
    ds_read_b128 a[200:203], v216 offset:43520
    v_mfma_f32_16x16x32_bf16 v[108:111], v[192:195], a[188:191], v[108:111]
    v_mfma_f32_16x16x32_bf16 v[112:115], v[196:199], a[20:23], v[112:115]
    ds_read_b64_tr_b16 v[188:189], v164 offset:34816
    ds_read_b64_tr_b16 v[190:191], v164 offset:38912
    v_mfma_f32_16x16x32_bf16 v[116:119], v[196:199], a[76:79], v[116:119]
    s_add_u32 m0, s24, 4096
    v_mfma_f32_16x16x32_bf16 v[120:123], v[196:199], a[132:135], v[120:123]
    buffer_load_dwordx4 v212, s[56:59], s48 offen offset:0 lds
    v_mfma_f32_16x16x32_bf16 v[124:127], v[196:199], a[188:191], v[124:127]
    s_waitcnt lgkmcnt(8)
    v_mfma_f32_16x16x32_bf16 v[0:3], v[200:203], a[24:27], v[0:3]
    ds_read_b64_tr_b16 v[192:193], v165 offset:34816
    ds_read_b64_tr_b16 v[194:195], v165 offset:38912
    v_mfma_f32_16x16x32_bf16 v[4:7], v[200:203], a[80:83], v[4:7]
    ds_read_b128 a[36:39], v217 offset:512
    buffer_load_dwordx4 v213, s[56:59], s48 offen offset:1024 lds
    v_mfma_f32_16x16x32_bf16 v[8:11], v[200:203], a[136:139], v[8:11]
    v_mfma_f32_16x16x32_bf16 v[12:15], v[200:203], a[192:195], v[12:15]
    v_mfma_f32_16x16x32_bf16 v[16:19], v[176:179], a[24:27], v[16:19]
    ds_read_b64_tr_b16 v[196:197], v166 offset:34816
    ds_read_b64_tr_b16 v[198:199], v166 offset:38912
    v_mfma_f32_16x16x32_bf16 v[20:23], v[176:179], a[80:83], v[20:23]
    buffer_load_dwordx4 v214, s[56:59], s48 offen offset:2048 lds
    v_mfma_f32_16x16x32_bf16 v[24:27], v[176:179], a[136:139], v[24:27]
    ds_read_b128 a[92:95], v217 offset:14848
    v_mfma_f32_16x16x32_bf16 v[28:31], v[176:179], a[192:195], v[28:31]
    s_waitcnt lgkmcnt(9)
    v_mfma_f32_16x16x32_bf16 v[32:35], v[180:183], a[24:27], v[32:35]
    ds_read_b64_tr_b16 v[200:201], v167 offset:34816
    ds_read_b64_tr_b16 v[202:203], v167 offset:38912
    v_mfma_f32_16x16x32_bf16 v[36:39], v[180:183], a[80:83], v[36:39]
    buffer_load_dwordx4 v215, s[56:59], s48 offen offset:3072 lds
    v_mfma_f32_16x16x32_bf16 v[40:43], v[180:183], a[136:139], v[40:43]
    v_mfma_f32_16x16x32_bf16 v[44:47], v[180:183], a[192:195], v[44:47]
    s_waitcnt vmcnt(8)
    s_waitcnt lgkmcnt(0)
    s_barrier
    v_mfma_f32_16x16x32_bf16 v[48:51], v[184:187], a[24:27], v[48:51]
    ds_read_b64_tr_b16 v[176:177], v168 offset:0
    ds_read_b64_tr_b16 v[178:179], v168 offset:4096
    v_mfma_f32_16x16x32_bf16 v[52:55], v[184:187], a[80:83], v[52:55]
    s_mov_b32 s48, 2359296
    s_add_u32 m0, s24, 34816
    v_mfma_f32_16x16x32_bf16 v[56:59], v[184:187], a[136:139], v[56:59]
    ds_read_b128 a[148:151], v217 offset:29184
    buffer_load_dwordx4 v208, s[56:59], s48 offen offset:0 lds
    v_mfma_f32_16x16x32_bf16 v[60:63], v[184:187], a[192:195], v[60:63]
    v_mfma_f32_16x16x32_bf16 v[64:67], v[188:191], a[24:27], v[64:67]
    ds_read_b64_tr_b16 v[180:181], v169 offset:0
    ds_read_b64_tr_b16 v[182:183], v169 offset:4096
    v_mfma_f32_16x16x32_bf16 v[68:71], v[188:191], a[80:83], v[68:71]
    buffer_load_dwordx4 v209, s[56:59], s48 offen offset:1024 lds
    v_mfma_f32_16x16x32_bf16 v[72:75], v[188:191], a[136:139], v[72:75]
    ds_read_b128 a[204:207], v217 offset:43520
    v_mfma_f32_16x16x32_bf16 v[76:79], v[188:191], a[192:195], v[76:79]
    v_mfma_f32_16x16x32_bf16 v[80:83], v[192:195], a[24:27], v[80:83]
    ds_read_b64_tr_b16 v[184:185], v170 offset:0
    ds_read_b64_tr_b16 v[186:187], v170 offset:4096
    v_mfma_f32_16x16x32_bf16 v[84:87], v[192:195], a[80:83], v[84:87]
    buffer_load_dwordx4 v210, s[56:59], s48 offen offset:2048 lds
    v_mfma_f32_16x16x32_bf16 v[88:91], v[192:195], a[136:139], v[88:91]
    v_mfma_f32_16x16x32_bf16 v[92:95], v[192:195], a[192:195], v[92:95]
    v_mfma_f32_16x16x32_bf16 v[96:99], v[196:199], a[24:27], v[96:99]
    ds_read_b64_tr_b16 v[188:189], v171 offset:0
    ds_read_b64_tr_b16 v[190:191], v171 offset:4096
    v_mfma_f32_16x16x32_bf16 v[100:103], v[196:199], a[80:83], v[100:103]
    ds_read_b128 a[40:43], v216 offset:640
    buffer_load_dwordx4 v211, s[56:59], s48 offen offset:3072 lds
    v_mfma_f32_16x16x32_bf16 v[104:107], v[196:199], a[136:139], v[104:107]
    v_mfma_f32_16x16x32_bf16 v[108:111], v[196:199], a[192:195], v[108:111]
    v_mfma_f32_16x16x32_bf16 v[112:115], v[200:203], a[24:27], v[112:115]
    ds_read_b64_tr_b16 v[192:193], v172 offset:0
    ds_read_b64_tr_b16 v[194:195], v172 offset:4096
    v_mfma_f32_16x16x32_bf16 v[116:119], v[200:203], a[80:83], v[116:119]
    s_add_u32 m0, s24, 38912
    v_mfma_f32_16x16x32_bf16 v[120:123], v[200:203], a[136:139], v[120:123]
    buffer_load_dwordx4 v212, s[56:59], s48 offen offset:0 lds
    ds_read_b128 a[96:99], v216 offset:14976
    v_mfma_f32_16x16x32_bf16 v[124:127], v[200:203], a[192:195], v[124:127]
    s_waitcnt lgkmcnt(9)
    v_mfma_f32_16x16x32_bf16 v[0:3], v[176:179], a[28:31], v[0:3]
    ds_read_b64_tr_b16 v[196:197], v173 offset:0
    ds_read_b64_tr_b16 v[198:199], v173 offset:4096
    v_mfma_f32_16x16x32_bf16 v[4:7], v[176:179], a[84:87], v[4:7]
    buffer_load_dwordx4 v213, s[56:59], s48 offen offset:1024 lds
    v_mfma_f32_16x16x32_bf16 v[8:11], v[176:179], a[140:143], v[8:11]
    v_mfma_f32_16x16x32_bf16 v[12:15], v[176:179], a[196:199], v[12:15]
    v_mfma_f32_16x16x32_bf16 v[16:19], v[180:183], a[28:31], v[16:19]
    ds_read_b64_tr_b16 v[200:201], v174 offset:0
    ds_read_b64_tr_b16 v[202:203], v174 offset:4096
    v_mfma_f32_16x16x32_bf16 v[20:23], v[180:183], a[84:87], v[20:23]
    ds_read_b128 a[152:155], v216 offset:29312
    buffer_load_dwordx4 v214, s[56:59], s48 offen offset:2048 lds
    v_mfma_f32_16x16x32_bf16 v[24:27], v[180:183], a[140:143], v[24:27]
    v_mfma_f32_16x16x32_bf16 v[28:31], v[180:183], a[196:199], v[28:31]
    s_waitcnt lgkmcnt(9)
    v_mfma_f32_16x16x32_bf16 v[32:35], v[184:187], a[28:31], v[32:35]
    ds_read_b64_tr_b16 v[176:177], v175 offset:0
    ds_read_b64_tr_b16 v[178:179], v175 offset:4096
    v_mfma_f32_16x16x32_bf16 v[36:39], v[184:187], a[84:87], v[36:39]
    buffer_load_dwordx4 v215, s[56:59], s48 offen offset:3072 lds
    v_mfma_f32_16x16x32_bf16 v[40:43], v[184:187], a[140:143], v[40:43]
    ds_read_b128 a[208:211], v216 offset:43648
    v_mfma_f32_16x16x32_bf16 v[44:47], v[184:187], a[196:199], v[44:47]
    s_waitcnt vmcnt(8)
    s_waitcnt lgkmcnt(1)
    s_barrier
    v_mfma_f32_16x16x32_bf16 v[48:51], v[188:191], a[28:31], v[48:51]
    ds_read_b64_tr_b16 v[180:181], v160 offset:0
    ds_read_b64_tr_b16 v[182:183], v160 offset:4096
    v_mfma_f32_16x16x32_bf16 v[52:55], v[188:191], a[84:87], v[52:55]
    s_mov_b32 s48, 2621440
    s_add_u32 m0, s24, 69632
    v_mfma_f32_16x16x32_bf16 v[56:59], v[188:191], a[140:143], v[56:59]
    buffer_load_dwordx4 v208, s[56:59], s48 offen offset:0 lds
    v_mfma_f32_16x16x32_bf16 v[60:63], v[188:191], a[196:199], v[60:63]
    v_mfma_f32_16x16x32_bf16 v[64:67], v[192:195], a[28:31], v[64:67]
    ds_read_b64_tr_b16 v[184:185], v161 offset:0
    ds_read_b64_tr_b16 v[186:187], v161 offset:4096
    v_mfma_f32_16x16x32_bf16 v[68:71], v[192:195], a[84:87], v[68:71]
    ds_read_b128 a[44:47], v217 offset:640
    buffer_load_dwordx4 v209, s[56:59], s48 offen offset:1024 lds
    v_mfma_f32_16x16x32_bf16 v[72:75], v[192:195], a[140:143], v[72:75]
    v_mfma_f32_16x16x32_bf16 v[76:79], v[192:195], a[196:199], v[76:79]
    v_mfma_f32_16x16x32_bf16 v[80:83], v[196:199], a[28:31], v[80:83]
    ds_read_b64_tr_b16 v[188:189], v162 offset:0
    ds_read_b64_tr_b16 v[190:191], v162 offset:4096
    v_mfma_f32_16x16x32_bf16 v[84:87], v[196:199], a[84:87], v[84:87]
    buffer_load_dwordx4 v210, s[56:59], s48 offen offset:2048 lds
    v_mfma_f32_16x16x32_bf16 v[88:91], v[196:199], a[140:143], v[88:91]
    ds_read_b128 a[100:103], v217 offset:14976
    v_mfma_f32_16x16x32_bf16 v[92:95], v[196:199], a[196:199], v[92:95]
    v_mfma_f32_16x16x32_bf16 v[96:99], v[200:203], a[28:31], v[96:99]
    ds_read_b64_tr_b16 v[192:193], v163 offset:0
    ds_read_b64_tr_b16 v[194:195], v163 offset:4096
    v_mfma_f32_16x16x32_bf16 v[100:103], v[200:203], a[84:87], v[100:103]
    buffer_load_dwordx4 v211, s[56:59], s48 offen offset:3072 lds
    v_mfma_f32_16x16x32_bf16 v[104:107], v[200:203], a[140:143], v[104:107]
    v_mfma_f32_16x16x32_bf16 v[108:111], v[200:203], a[196:199], v[108:111]
    v_mfma_f32_16x16x32_bf16 v[112:115], v[176:179], a[28:31], v[112:115]
    ds_read_b64_tr_b16 v[196:197], v164 offset:0
    ds_read_b64_tr_b16 v[198:199], v164 offset:4096
    v_mfma_f32_16x16x32_bf16 v[116:119], v[176:179], a[84:87], v[116:119]
    s_add_u32 m0, s24, 73728
    ds_read_b128 a[156:159], v217 offset:29312
    v_mfma_f32_16x16x32_bf16 v[120:123], v[176:179], a[140:143], v[120:123]
    buffer_load_dwordx4 v212, s[56:59], s48 offen offset:0 lds
    v_mfma_f32_16x16x32_bf16 v[124:127], v[176:179], a[196:199], v[124:127]
    s_waitcnt lgkmcnt(9)
    v_mfma_f32_16x16x32_bf16 v[0:3], v[180:183], a[32:35], v[0:3]
    ds_read_b64_tr_b16 v[200:201], v165 offset:0
    ds_read_b64_tr_b16 v[202:203], v165 offset:4096
    v_mfma_f32_16x16x32_bf16 v[4:7], v[180:183], a[88:91], v[4:7]
    buffer_load_dwordx4 v213, s[56:59], s48 offen offset:1024 lds
    v_mfma_f32_16x16x32_bf16 v[8:11], v[180:183], a[144:147], v[8:11]
    ds_read_b128 a[212:215], v217 offset:43648
    v_mfma_f32_16x16x32_bf16 v[12:15], v[180:183], a[200:203], v[12:15]
    v_mfma_f32_16x16x32_bf16 v[16:19], v[184:187], a[32:35], v[16:19]
    ds_read_b64_tr_b16 v[176:177], v166 offset:0
    ds_read_b64_tr_b16 v[178:179], v166 offset:4096
    v_mfma_f32_16x16x32_bf16 v[20:23], v[184:187], a[88:91], v[20:23]
    buffer_load_dwordx4 v214, s[56:59], s48 offen offset:2048 lds
    v_mfma_f32_16x16x32_bf16 v[24:27], v[184:187], a[144:147], v[24:27]
    v_mfma_f32_16x16x32_bf16 v[28:31], v[184:187], a[200:203], v[28:31]
    s_waitcnt lgkmcnt(8)
    v_mfma_f32_16x16x32_bf16 v[32:35], v[188:191], a[32:35], v[32:35]
    ds_read_b64_tr_b16 v[180:181], v167 offset:0
    ds_read_b64_tr_b16 v[182:183], v167 offset:4096
    v_mfma_f32_16x16x32_bf16 v[36:39], v[188:191], a[88:91], v[36:39]
    ds_read_b128 a[48:51], v216 offset:768
    buffer_load_dwordx4 v215, s[56:59], s48 offen offset:3072 lds
    v_mfma_f32_16x16x32_bf16 v[40:43], v[188:191], a[144:147], v[40:43]
    v_mfma_f32_16x16x32_bf16 v[44:47], v[188:191], a[200:203], v[44:47]
    s_waitcnt vmcnt(8)
    s_waitcnt lgkmcnt(1)
    s_barrier
    v_mfma_f32_16x16x32_bf16 v[48:51], v[192:195], a[32:35], v[48:51]
    ds_read_b64_tr_b16 v[184:185], v160 offset:34816
    ds_read_b64_tr_b16 v[186:187], v160 offset:38912
    v_mfma_f32_16x16x32_bf16 v[52:55], v[192:195], a[88:91], v[52:55]
    s_mov_b32 s48, 2883584
    s_add_u32 m0, s24, 0
    v_mfma_f32_16x16x32_bf16 v[56:59], v[192:195], a[144:147], v[56:59]
    buffer_load_dwordx4 v208, s[56:59], s48 offen offset:0 lds
    ds_read_b128 a[104:107], v216 offset:15104
    v_mfma_f32_16x16x32_bf16 v[60:63], v[192:195], a[200:203], v[60:63]
    v_mfma_f32_16x16x32_bf16 v[64:67], v[196:199], a[32:35], v[64:67]
    ds_read_b64_tr_b16 v[188:189], v161 offset:34816
    ds_read_b64_tr_b16 v[190:191], v161 offset:38912
    v_mfma_f32_16x16x32_bf16 v[68:71], v[196:199], a[88:91], v[68:71]
    buffer_load_dwordx4 v209, s[56:59], s48 offen offset:1024 lds
    v_mfma_f32_16x16x32_bf16 v[72:75], v[196:199], a[144:147], v[72:75]
    v_mfma_f32_16x16x32_bf16 v[76:79], v[196:199], a[200:203], v[76:79]
    v_mfma_f32_16x16x32_bf16 v[80:83], v[200:203], a[32:35], v[80:83]
    ds_read_b64_tr_b16 v[192:193], v162 offset:34816
    ds_read_b64_tr_b16 v[194:195], v162 offset:38912
    v_mfma_f32_16x16x32_bf16 v[84:87], v[200:203], a[88:91], v[84:87]
    ds_read_b128 a[160:163], v216 offset:29440
    buffer_load_dwordx4 v210, s[56:59], s48 offen offset:2048 lds
    v_mfma_f32_16x16x32_bf16 v[88:91], v[200:203], a[144:147], v[88:91]
    v_mfma_f32_16x16x32_bf16 v[92:95], v[200:203], a[200:203], v[92:95]
    v_mfma_f32_16x16x32_bf16 v[96:99], v[176:179], a[32:35], v[96:99]
    ds_read_b64_tr_b16 v[196:197], v163 offset:34816
    ds_read_b64_tr_b16 v[198:199], v163 offset:38912
    v_mfma_f32_16x16x32_bf16 v[100:103], v[176:179], a[88:91], v[100:103]
    buffer_load_dwordx4 v211, s[56:59], s48 offen offset:3072 lds
    v_mfma_f32_16x16x32_bf16 v[104:107], v[176:179], a[144:147], v[104:107]
    ds_read_b128 a[216:219], v216 offset:43776
    v_mfma_f32_16x16x32_bf16 v[108:111], v[176:179], a[200:203], v[108:111]
    v_mfma_f32_16x16x32_bf16 v[112:115], v[180:183], a[32:35], v[112:115]
    ds_read_b64_tr_b16 v[200:201], v164 offset:34816
    ds_read_b64_tr_b16 v[202:203], v164 offset:38912
    v_mfma_f32_16x16x32_bf16 v[116:119], v[180:183], a[88:91], v[116:119]
    s_add_u32 m0, s24, 4096
    v_mfma_f32_16x16x32_bf16 v[120:123], v[180:183], a[144:147], v[120:123]
    buffer_load_dwordx4 v212, s[56:59], s48 offen offset:0 lds
    v_mfma_f32_16x16x32_bf16 v[124:127], v[180:183], a[200:203], v[124:127]
    s_waitcnt lgkmcnt(8)
    v_mfma_f32_16x16x32_bf16 v[0:3], v[184:187], a[36:39], v[0:3]
    ds_read_b64_tr_b16 v[176:177], v165 offset:34816
    ds_read_b64_tr_b16 v[178:179], v165 offset:38912
    v_mfma_f32_16x16x32_bf16 v[4:7], v[184:187], a[92:95], v[4:7]
    ds_read_b128 a[52:55], v217 offset:768
    buffer_load_dwordx4 v213, s[56:59], s48 offen offset:1024 lds
    v_mfma_f32_16x16x32_bf16 v[8:11], v[184:187], a[148:151], v[8:11]
    v_mfma_f32_16x16x32_bf16 v[12:15], v[184:187], a[204:207], v[12:15]
    v_mfma_f32_16x16x32_bf16 v[16:19], v[188:191], a[36:39], v[16:19]
    ds_read_b64_tr_b16 v[180:181], v166 offset:34816
    ds_read_b64_tr_b16 v[182:183], v166 offset:38912
    v_mfma_f32_16x16x32_bf16 v[20:23], v[188:191], a[92:95], v[20:23]
    buffer_load_dwordx4 v214, s[56:59], s48 offen offset:2048 lds
    v_mfma_f32_16x16x32_bf16 v[24:27], v[188:191], a[148:151], v[24:27]
    ds_read_b128 a[108:111], v217 offset:15104
    v_mfma_f32_16x16x32_bf16 v[28:31], v[188:191], a[204:207], v[28:31]
    s_waitcnt lgkmcnt(9)
    v_mfma_f32_16x16x32_bf16 v[32:35], v[192:195], a[36:39], v[32:35]
    ds_read_b64_tr_b16 v[184:185], v167 offset:34816
    ds_read_b64_tr_b16 v[186:187], v167 offset:38912
    v_mfma_f32_16x16x32_bf16 v[36:39], v[192:195], a[92:95], v[36:39]
    buffer_load_dwordx4 v215, s[56:59], s48 offen offset:3072 lds
    v_mfma_f32_16x16x32_bf16 v[40:43], v[192:195], a[148:151], v[40:43]
    v_mfma_f32_16x16x32_bf16 v[44:47], v[192:195], a[204:207], v[44:47]
    s_waitcnt vmcnt(8)
    s_waitcnt lgkmcnt(0)
    s_barrier
    v_mfma_f32_16x16x32_bf16 v[48:51], v[196:199], a[36:39], v[48:51]
    ds_read_b64_tr_b16 v[188:189], v168 offset:0
    ds_read_b64_tr_b16 v[190:191], v168 offset:4096
    v_mfma_f32_16x16x32_bf16 v[52:55], v[196:199], a[92:95], v[52:55]
    s_mov_b32 s48, 3145728
    s_add_u32 m0, s24, 34816
    v_mfma_f32_16x16x32_bf16 v[56:59], v[196:199], a[148:151], v[56:59]
    ds_read_b128 a[164:167], v217 offset:29440
    buffer_load_dwordx4 v208, s[56:59], s48 offen offset:0 lds
    v_mfma_f32_16x16x32_bf16 v[60:63], v[196:199], a[204:207], v[60:63]
    v_mfma_f32_16x16x32_bf16 v[64:67], v[200:203], a[36:39], v[64:67]
    ds_read_b64_tr_b16 v[192:193], v169 offset:0
    ds_read_b64_tr_b16 v[194:195], v169 offset:4096
    v_mfma_f32_16x16x32_bf16 v[68:71], v[200:203], a[92:95], v[68:71]
    buffer_load_dwordx4 v209, s[56:59], s48 offen offset:1024 lds
    v_mfma_f32_16x16x32_bf16 v[72:75], v[200:203], a[148:151], v[72:75]
    ds_read_b128 a[220:223], v217 offset:43776
    v_mfma_f32_16x16x32_bf16 v[76:79], v[200:203], a[204:207], v[76:79]
    v_mfma_f32_16x16x32_bf16 v[80:83], v[176:179], a[36:39], v[80:83]
    ds_read_b64_tr_b16 v[196:197], v170 offset:0
    ds_read_b64_tr_b16 v[198:199], v170 offset:4096
    v_mfma_f32_16x16x32_bf16 v[84:87], v[176:179], a[92:95], v[84:87]
    buffer_load_dwordx4 v210, s[56:59], s48 offen offset:2048 lds
    v_mfma_f32_16x16x32_bf16 v[88:91], v[176:179], a[148:151], v[88:91]
    v_mfma_f32_16x16x32_bf16 v[92:95], v[176:179], a[204:207], v[92:95]
    v_mfma_f32_16x16x32_bf16 v[96:99], v[180:183], a[36:39], v[96:99]
    ds_read_b64_tr_b16 v[200:201], v171 offset:0
    ds_read_b64_tr_b16 v[202:203], v171 offset:4096
    v_mfma_f32_16x16x32_bf16 v[100:103], v[180:183], a[92:95], v[100:103]
    buffer_load_dwordx4 v211, s[56:59], s48 offen offset:3072 lds
    v_mfma_f32_16x16x32_bf16 v[104:107], v[180:183], a[148:151], v[104:107]
    v_mfma_f32_16x16x32_bf16 v[108:111], v[180:183], a[204:207], v[108:111]
    v_mfma_f32_16x16x32_bf16 v[112:115], v[184:187], a[36:39], v[112:115]
    ds_read_b64_tr_b16 v[176:177], v172 offset:0
    ds_read_b64_tr_b16 v[178:179], v172 offset:4096
    v_mfma_f32_16x16x32_bf16 v[116:119], v[184:187], a[92:95], v[116:119]
    s_add_u32 m0, s24, 38912
    v_mfma_f32_16x16x32_bf16 v[120:123], v[184:187], a[148:151], v[120:123]
    buffer_load_dwordx4 v212, s[56:59], s48 offen offset:0 lds
    v_mfma_f32_16x16x32_bf16 v[124:127], v[184:187], a[204:207], v[124:127]
    s_waitcnt lgkmcnt(7)
    v_mfma_f32_16x16x32_bf16 v[0:3], v[188:191], a[40:43], v[0:3]
    ds_read_b64_tr_b16 v[180:181], v173 offset:0
    ds_read_b64_tr_b16 v[182:183], v173 offset:4096
    v_mfma_f32_16x16x32_bf16 v[4:7], v[188:191], a[96:99], v[4:7]
    buffer_load_dwordx4 v213, s[56:59], s48 offen offset:1024 lds
    v_mfma_f32_16x16x32_bf16 v[8:11], v[188:191], a[152:155], v[8:11]
    v_mfma_f32_16x16x32_bf16 v[12:15], v[188:191], a[208:211], v[12:15]
    v_mfma_f32_16x16x32_bf16 v[16:19], v[192:195], a[40:43], v[16:19]
    ds_read_b64_tr_b16 v[184:185], v174 offset:0
    ds_read_b64_tr_b16 v[186:187], v174 offset:4096
    v_mfma_f32_16x16x32_bf16 v[20:23], v[192:195], a[96:99], v[20:23]
    buffer_load_dwordx4 v214, s[56:59], s48 offen offset:2048 lds
    v_mfma_f32_16x16x32_bf16 v[24:27], v[192:195], a[152:155], v[24:27]
    v_mfma_f32_16x16x32_bf16 v[28:31], v[192:195], a[208:211], v[28:31]
    s_waitcnt lgkmcnt(6)
    v_mfma_f32_16x16x32_bf16 v[32:35], v[196:199], a[40:43], v[32:35]
    ds_read_b64_tr_b16 v[188:189], v175 offset:0
    ds_read_b64_tr_b16 v[190:191], v175 offset:4096
    v_mfma_f32_16x16x32_bf16 v[36:39], v[196:199], a[96:99], v[36:39]
    buffer_load_dwordx4 v215, s[56:59], s48 offen offset:3072 lds
    v_mfma_f32_16x16x32_bf16 v[40:43], v[196:199], a[152:155], v[40:43]
    v_mfma_f32_16x16x32_bf16 v[44:47], v[196:199], a[208:211], v[44:47]
    s_waitcnt vmcnt(8)
    s_waitcnt lgkmcnt(0)
    s_barrier
    v_mfma_f32_16x16x32_bf16 v[48:51], v[200:203], a[40:43], v[48:51]
    ds_read_b64_tr_b16 v[192:193], v160 offset:0
    ds_read_b64_tr_b16 v[194:195], v160 offset:4096
    v_mfma_f32_16x16x32_bf16 v[52:55], v[200:203], a[96:99], v[52:55]
    s_mov_b32 s48, 3407872
    s_add_u32 m0, s24, 69632
    v_mfma_f32_16x16x32_bf16 v[56:59], v[200:203], a[152:155], v[56:59]
    buffer_load_dwordx4 v208, s[56:59], s48 offen offset:0 lds
    v_mfma_f32_16x16x32_bf16 v[60:63], v[200:203], a[208:211], v[60:63]
    v_mfma_f32_16x16x32_bf16 v[64:67], v[176:179], a[40:43], v[64:67]
    ds_read_b64_tr_b16 v[196:197], v161 offset:0
    ds_read_b64_tr_b16 v[198:199], v161 offset:4096
    v_mfma_f32_16x16x32_bf16 v[68:71], v[176:179], a[96:99], v[68:71]
    buffer_load_dwordx4 v209, s[56:59], s48 offen offset:1024 lds
    v_mfma_f32_16x16x32_bf16 v[72:75], v[176:179], a[152:155], v[72:75]
    v_mfma_f32_16x16x32_bf16 v[76:79], v[176:179], a[208:211], v[76:79]
    v_mfma_f32_16x16x32_bf16 v[80:83], v[180:183], a[40:43], v[80:83]
    ds_read_b64_tr_b16 v[200:201], v162 offset:0
    ds_read_b64_tr_b16 v[202:203], v162 offset:4096
    v_mfma_f32_16x16x32_bf16 v[84:87], v[180:183], a[96:99], v[84:87]
    buffer_load_dwordx4 v210, s[56:59], s48 offen offset:2048 lds
    v_mfma_f32_16x16x32_bf16 v[88:91], v[180:183], a[152:155], v[88:91]
    v_mfma_f32_16x16x32_bf16 v[92:95], v[180:183], a[208:211], v[92:95]
    v_mfma_f32_16x16x32_bf16 v[96:99], v[184:187], a[40:43], v[96:99]
    ds_read_b64_tr_b16 v[176:177], v163 offset:0
    ds_read_b64_tr_b16 v[178:179], v163 offset:4096
    v_mfma_f32_16x16x32_bf16 v[100:103], v[184:187], a[96:99], v[100:103]
    buffer_load_dwordx4 v211, s[56:59], s48 offen offset:3072 lds
    v_mfma_f32_16x16x32_bf16 v[104:107], v[184:187], a[152:155], v[104:107]
    v_mfma_f32_16x16x32_bf16 v[108:111], v[184:187], a[208:211], v[108:111]
    v_mfma_f32_16x16x32_bf16 v[112:115], v[188:191], a[40:43], v[112:115]
    ds_read_b64_tr_b16 v[180:181], v164 offset:0
    ds_read_b64_tr_b16 v[182:183], v164 offset:4096
    v_mfma_f32_16x16x32_bf16 v[116:119], v[188:191], a[96:99], v[116:119]
    s_add_u32 m0, s24, 73728
    v_mfma_f32_16x16x32_bf16 v[120:123], v[188:191], a[152:155], v[120:123]
    buffer_load_dwordx4 v212, s[56:59], s48 offen offset:0 lds
    v_mfma_f32_16x16x32_bf16 v[124:127], v[188:191], a[208:211], v[124:127]
    s_waitcnt lgkmcnt(6)
    v_mfma_f32_16x16x32_bf16 v[0:3], v[192:195], a[44:47], v[0:3]
    ds_read_b64_tr_b16 v[184:185], v165 offset:0
    ds_read_b64_tr_b16 v[186:187], v165 offset:4096
    v_mfma_f32_16x16x32_bf16 v[4:7], v[192:195], a[100:103], v[4:7]
    buffer_load_dwordx4 v213, s[56:59], s48 offen offset:1024 lds
    v_mfma_f32_16x16x32_bf16 v[8:11], v[192:195], a[156:159], v[8:11]
    v_mfma_f32_16x16x32_bf16 v[12:15], v[192:195], a[212:215], v[12:15]
    v_mfma_f32_16x16x32_bf16 v[16:19], v[196:199], a[44:47], v[16:19]
    ds_read_b64_tr_b16 v[188:189], v166 offset:0
    ds_read_b64_tr_b16 v[190:191], v166 offset:4096
    v_mfma_f32_16x16x32_bf16 v[20:23], v[196:199], a[100:103], v[20:23]
    buffer_load_dwordx4 v214, s[56:59], s48 offen offset:2048 lds
    v_mfma_f32_16x16x32_bf16 v[24:27], v[196:199], a[156:159], v[24:27]
    v_mfma_f32_16x16x32_bf16 v[28:31], v[196:199], a[212:215], v[28:31]
    s_waitcnt lgkmcnt(6)
    v_mfma_f32_16x16x32_bf16 v[32:35], v[200:203], a[44:47], v[32:35]
    ds_read_b64_tr_b16 v[192:193], v167 offset:0
    ds_read_b64_tr_b16 v[194:195], v167 offset:4096
    v_mfma_f32_16x16x32_bf16 v[36:39], v[200:203], a[100:103], v[36:39]
    buffer_load_dwordx4 v215, s[56:59], s48 offen offset:3072 lds
    v_mfma_f32_16x16x32_bf16 v[40:43], v[200:203], a[156:159], v[40:43]
    v_mfma_f32_16x16x32_bf16 v[44:47], v[200:203], a[212:215], v[44:47]
    s_waitcnt vmcnt(8)
    s_waitcnt lgkmcnt(0)
    s_barrier
    v_mfma_f32_16x16x32_bf16 v[48:51], v[176:179], a[44:47], v[48:51]
    ds_read_b64_tr_b16 v[196:197], v160 offset:34816
    ds_read_b64_tr_b16 v[198:199], v160 offset:38912
    v_mfma_f32_16x16x32_bf16 v[52:55], v[176:179], a[100:103], v[52:55]
    s_add_u32 m0, s22, 0
    v_mfma_f32_16x16x32_bf16 v[56:59], v[176:179], a[156:159], v[56:59]
    buffer_load_dwordx4 v239, s[12:15], s52 offen offset:0 lds
    v_mfma_f32_16x16x32_bf16 v[60:63], v[176:179], a[212:215], v[60:63]
    v_mfma_f32_16x16x32_bf16 v[64:67], v[180:183], a[44:47], v[64:67]
    ds_read_b64_tr_b16 v[200:201], v161 offset:34816
    ds_read_b64_tr_b16 v[202:203], v161 offset:38912
    v_mfma_f32_16x16x32_bf16 v[68:71], v[180:183], a[100:103], v[68:71]
    s_add_u32 m0, s22, 32
    v_mfma_f32_16x16x32_bf16 v[72:75], v[180:183], a[156:159], v[72:75]
    buffer_load_dwordx4 v239, s[12:15], s52 offen offset:1024 lds
    v_mfma_f32_16x16x32_bf16 v[76:79], v[180:183], a[212:215], v[76:79]
    v_mfma_f32_16x16x32_bf16 v[80:83], v[184:187], a[44:47], v[80:83]
    ds_read_b64_tr_b16 v[176:177], v162 offset:34816
    ds_read_b64_tr_b16 v[178:179], v162 offset:38912
    v_mfma_f32_16x16x32_bf16 v[84:87], v[184:187], a[100:103], v[84:87]
    s_add_u32 m0, s22, 64
    v_mfma_f32_16x16x32_bf16 v[88:91], v[184:187], a[156:159], v[88:91]
    buffer_load_dwordx4 v239, s[12:15], s52 offen offset:2048 lds
    v_mfma_f32_16x16x32_bf16 v[92:95], v[184:187], a[212:215], v[92:95]
    v_mfma_f32_16x16x32_bf16 v[96:99], v[188:191], a[44:47], v[96:99]
    ds_read_b64_tr_b16 v[180:181], v163 offset:34816
    ds_read_b64_tr_b16 v[182:183], v163 offset:38912
    v_mfma_f32_16x16x32_bf16 v[100:103], v[188:191], a[100:103], v[100:103]
    s_add_u32 m0, s22, 96
    v_mfma_f32_16x16x32_bf16 v[104:107], v[188:191], a[156:159], v[104:107]
    buffer_load_dwordx4 v239, s[12:15], s52 offen offset:3072 lds
    v_mfma_f32_16x16x32_bf16 v[108:111], v[188:191], a[212:215], v[108:111]
    v_mfma_f32_16x16x32_bf16 v[112:115], v[192:195], a[44:47], v[112:115]
    ds_read_b64_tr_b16 v[184:185], v164 offset:34816
    ds_read_b64_tr_b16 v[186:187], v164 offset:38912
    v_mfma_f32_16x16x32_bf16 v[116:119], v[192:195], a[100:103], v[116:119]
    s_add_u32 m0, s22, 4224
    v_mfma_f32_16x16x32_bf16 v[120:123], v[192:195], a[156:159], v[120:123]
    buffer_load_dwordx4 v239, s[12:15], s53 offen offset:0 lds
    v_mfma_f32_16x16x32_bf16 v[124:127], v[192:195], a[212:215], v[124:127]
    s_waitcnt lgkmcnt(6)
    v_mfma_f32_16x16x32_bf16 v[0:3], v[196:199], a[48:51], v[0:3]
    ds_read_b64_tr_b16 v[188:189], v165 offset:34816
    ds_read_b64_tr_b16 v[190:191], v165 offset:38912
    v_mfma_f32_16x16x32_bf16 v[4:7], v[196:199], a[104:107], v[4:7]
    s_add_u32 m0, s22, 4256
    v_mfma_f32_16x16x32_bf16 v[8:11], v[196:199], a[160:163], v[8:11]
    buffer_load_dwordx4 v239, s[12:15], s53 offen offset:1024 lds
    v_mfma_f32_16x16x32_bf16 v[12:15], v[196:199], a[216:219], v[12:15]
    v_mfma_f32_16x16x32_bf16 v[16:19], v[200:203], a[48:51], v[16:19]
    ds_read_b64_tr_b16 v[192:193], v166 offset:34816
    ds_read_b64_tr_b16 v[194:195], v166 offset:38912
    v_mfma_f32_16x16x32_bf16 v[20:23], v[200:203], a[104:107], v[20:23]
    s_add_u32 m0, s22, 4288
    v_mfma_f32_16x16x32_bf16 v[24:27], v[200:203], a[160:163], v[24:27]
    buffer_load_dwordx4 v239, s[12:15], s53 offen offset:2048 lds
    v_mfma_f32_16x16x32_bf16 v[28:31], v[200:203], a[216:219], v[28:31]
    s_waitcnt lgkmcnt(6)
    v_mfma_f32_16x16x32_bf16 v[32:35], v[176:179], a[48:51], v[32:35]
    ds_read_b64_tr_b16 v[196:197], v167 offset:34816
    ds_read_b64_tr_b16 v[198:199], v167 offset:38912
    v_mfma_f32_16x16x32_bf16 v[36:39], v[176:179], a[104:107], v[36:39]
    s_add_u32 m0, s22, 4320
    v_mfma_f32_16x16x32_bf16 v[40:43], v[176:179], a[160:163], v[40:43]
    buffer_load_dwordx4 v239, s[12:15], s53 offen offset:3072 lds
    v_mfma_f32_16x16x32_bf16 v[44:47], v[176:179], a[216:219], v[44:47]
    s_waitcnt vmcnt(8)
    s_waitcnt lgkmcnt(0)
    s_barrier
    v_mfma_f32_16x16x32_bf16 v[48:51], v[180:183], a[48:51], v[48:51]
    ds_read_b64_tr_b16 v[200:201], v168 offset:0
    ds_read_b64_tr_b16 v[202:203], v168 offset:4096
    v_mfma_f32_16x16x32_bf16 v[52:55], v[180:183], a[104:107], v[52:55]
    v_mfma_f32_16x16x32_bf16 v[56:59], v[180:183], a[160:163], v[56:59]
    v_mfma_f32_16x16x32_bf16 v[60:63], v[180:183], a[216:219], v[60:63]
    v_mfma_f32_16x16x32_bf16 v[64:67], v[184:187], a[48:51], v[64:67]
    ds_read_b64_tr_b16 v[176:177], v169 offset:0
    ds_read_b64_tr_b16 v[178:179], v169 offset:4096
    v_mfma_f32_16x16x32_bf16 v[68:71], v[184:187], a[104:107], v[68:71]
    s_add_u32 s75, s74, 0
    buffer_load_dword v255, v250, s[64:67], s75 offen
    v_mfma_f32_16x16x32_bf16 v[72:75], v[184:187], a[160:163], v[72:75]
    v_mfma_f32_16x16x32_bf16 v[76:79], v[184:187], a[216:219], v[76:79]
    v_mfma_f32_16x16x32_bf16 v[80:83], v[188:191], a[48:51], v[80:83]
    ds_read_b64_tr_b16 v[180:181], v170 offset:0
    ds_read_b64_tr_b16 v[182:183], v170 offset:4096
    v_mfma_f32_16x16x32_bf16 v[84:87], v[188:191], a[104:107], v[84:87]
    v_mfma_f32_16x16x32_bf16 v[88:91], v[188:191], a[160:163], v[88:91]
    v_mfma_f32_16x16x32_bf16 v[92:95], v[188:191], a[216:219], v[92:95]
    v_mfma_f32_16x16x32_bf16 v[96:99], v[192:195], a[48:51], v[96:99]
    ds_read_b64_tr_b16 v[184:185], v171 offset:0
    ds_read_b64_tr_b16 v[186:187], v171 offset:4096
    v_mfma_f32_16x16x32_bf16 v[100:103], v[192:195], a[104:107], v[100:103]
    v_mfma_f32_16x16x32_bf16 v[104:107], v[192:195], a[160:163], v[104:107]
    v_mfma_f32_16x16x32_bf16 v[108:111], v[192:195], a[216:219], v[108:111]
    v_mfma_f32_16x16x32_bf16 v[112:115], v[196:199], a[48:51], v[112:115]
    ds_read_b64_tr_b16 v[188:189], v172 offset:0
    ds_read_b64_tr_b16 v[190:191], v172 offset:4096
    v_mfma_f32_16x16x32_bf16 v[116:119], v[196:199], a[104:107], v[116:119]
    v_mfma_f32_16x16x32_bf16 v[120:123], v[196:199], a[160:163], v[120:123]
    v_mfma_f32_16x16x32_bf16 v[124:127], v[196:199], a[216:219], v[124:127]
    s_waitcnt lgkmcnt(6)
    v_mfma_f32_16x16x32_bf16 v[0:3], v[200:203], a[52:55], v[0:3]
    ds_read_b64_tr_b16 v[192:193], v173 offset:0
    ds_read_b64_tr_b16 v[194:195], v173 offset:4096
    v_mfma_f32_16x16x32_bf16 v[4:7], v[200:203], a[108:111], v[4:7]
    v_mfma_f32_16x16x32_bf16 v[8:11], v[200:203], a[164:167], v[8:11]
    v_mfma_f32_16x16x32_bf16 v[12:15], v[200:203], a[220:223], v[12:15]
    v_mfma_f32_16x16x32_bf16 v[16:19], v[176:179], a[52:55], v[16:19]
    ds_read_b64_tr_b16 v[196:197], v174 offset:0
    ds_read_b64_tr_b16 v[198:199], v174 offset:4096
    v_mfma_f32_16x16x32_bf16 v[20:23], v[176:179], a[108:111], v[20:23]
    v_mfma_f32_16x16x32_bf16 v[24:27], v[176:179], a[164:167], v[24:27]
    v_mfma_f32_16x16x32_bf16 v[28:31], v[176:179], a[220:223], v[28:31]
    s_waitcnt lgkmcnt(6)
    v_mfma_f32_16x16x32_bf16 v[32:35], v[180:183], a[52:55], v[32:35]
    ds_read_b64_tr_b16 v[200:201], v175 offset:0
    ds_read_b64_tr_b16 v[202:203], v175 offset:4096
    v_mfma_f32_16x16x32_bf16 v[36:39], v[180:183], a[108:111], v[36:39]
    v_mfma_f32_16x16x32_bf16 v[40:43], v[180:183], a[164:167], v[40:43]
    v_mfma_f32_16x16x32_bf16 v[44:47], v[180:183], a[220:223], v[44:47]
    v_mfma_f32_16x16x32_bf16 v[48:51], v[184:187], a[52:55], v[48:51]
    v_mfma_f32_16x16x32_bf16 v[52:55], v[184:187], a[108:111], v[52:55]
    v_mfma_f32_16x16x32_bf16 v[56:59], v[184:187], a[164:167], v[56:59]
    v_mfma_f32_16x16x32_bf16 v[60:63], v[184:187], a[220:223], v[60:63]
    s_waitcnt lgkmcnt(4)
    v_mfma_f32_16x16x32_bf16 v[64:67], v[188:191], a[52:55], v[64:67]
    v_mfma_f32_16x16x32_bf16 v[68:71], v[188:191], a[108:111], v[68:71]
    v_mfma_f32_16x16x32_bf16 v[72:75], v[188:191], a[164:167], v[72:75]
    v_mfma_f32_16x16x32_bf16 v[76:79], v[188:191], a[220:223], v[76:79]
    v_mfma_f32_16x16x32_bf16 v[80:83], v[192:195], a[52:55], v[80:83]
    v_mfma_f32_16x16x32_bf16 v[84:87], v[192:195], a[108:111], v[84:87]
    v_mfma_f32_16x16x32_bf16 v[88:91], v[192:195], a[164:167], v[88:91]
    v_mfma_f32_16x16x32_bf16 v[92:95], v[192:195], a[220:223], v[92:95]
    s_waitcnt lgkmcnt(0)
    v_mfma_f32_16x16x32_bf16 v[96:99], v[196:199], a[52:55], v[96:99]
    v_mfma_f32_16x16x32_bf16 v[100:103], v[196:199], a[108:111], v[100:103]
    v_mfma_f32_16x16x32_bf16 v[104:107], v[196:199], a[164:167], v[104:107]
    v_mfma_f32_16x16x32_bf16 v[108:111], v[196:199], a[220:223], v[108:111]
    v_mfma_f32_16x16x32_bf16 v[112:115], v[200:203], a[52:55], v[112:115]
    v_mfma_f32_16x16x32_bf16 v[116:119], v[200:203], a[108:111], v[116:119]
    v_mfma_f32_16x16x32_bf16 v[120:123], v[200:203], a[164:167], v[120:123]
    v_mfma_f32_16x16x32_bf16 v[124:127], v[200:203], a[220:223], v[124:127]
    s_waitcnt lgkmcnt(0)
    s_barrier
    s_add_u32 m0, s22, 33792
    v_cvt_pk_bf16_f32 v0, v0, v1
    v_cvt_pk_bf16_f32 v1, v2, v3
    ds_write_b64 v249, v[0:1] offset:0
    v_cvt_pk_bf16_f32 v4, v4, v5
    v_cvt_pk_bf16_f32 v5, v6, v7
    ds_write_b64 v249, v[4:5] offset:8448
    v_cvt_pk_bf16_f32 v8, v8, v9
    v_cvt_pk_bf16_f32 v9, v10, v11
    ds_write_b64 v249, v[8:9] offset:16896
    v_cvt_pk_bf16_f32 v12, v12, v13
    v_cvt_pk_bf16_f32 v13, v14, v15
    ds_write_b64 v249, v[12:13] offset:25344
    buffer_load_dwordx4 v239, s[12:15], s54 offen offset:0 lds
    s_add_u32 m0, s22, 33824
    v_cvt_pk_bf16_f32 v16, v16, v17
    v_cvt_pk_bf16_f32 v17, v18, v19
    ds_write_b64 v249, v[16:17] offset:32
    v_cvt_pk_bf16_f32 v20, v20, v21
    v_cvt_pk_bf16_f32 v21, v22, v23
    ds_write_b64 v249, v[20:21] offset:8480
    v_cvt_pk_bf16_f32 v24, v24, v25
    v_cvt_pk_bf16_f32 v25, v26, v27
    ds_write_b64 v249, v[24:25] offset:16928
    v_cvt_pk_bf16_f32 v28, v28, v29
    v_cvt_pk_bf16_f32 v29, v30, v31
    ds_write_b64 v249, v[28:29] offset:25376
    buffer_load_dwordx4 v239, s[12:15], s54 offen offset:1024 lds
    s_add_u32 m0, s22, 33856
    v_cvt_pk_bf16_f32 v32, v32, v33
    v_cvt_pk_bf16_f32 v33, v34, v35
    ds_write_b64 v249, v[32:33] offset:64
    v_cvt_pk_bf16_f32 v36, v36, v37
    v_cvt_pk_bf16_f32 v37, v38, v39
    ds_write_b64 v249, v[36:37] offset:8512
    v_cvt_pk_bf16_f32 v40, v40, v41
    v_cvt_pk_bf16_f32 v41, v42, v43
    ds_write_b64 v249, v[40:41] offset:16960
    v_cvt_pk_bf16_f32 v44, v44, v45
    v_cvt_pk_bf16_f32 v45, v46, v47
    ds_write_b64 v249, v[44:45] offset:25408
    buffer_load_dwordx4 v239, s[12:15], s54 offen offset:2048 lds
    s_add_u32 m0, s22, 33888
    v_cvt_pk_bf16_f32 v48, v48, v49
    v_cvt_pk_bf16_f32 v49, v50, v51
    ds_write_b64 v249, v[48:49] offset:96
    v_cvt_pk_bf16_f32 v52, v52, v53
    v_cvt_pk_bf16_f32 v53, v54, v55
    ds_write_b64 v249, v[52:53] offset:8544
    v_cvt_pk_bf16_f32 v56, v56, v57
    v_cvt_pk_bf16_f32 v57, v58, v59
    ds_write_b64 v249, v[56:57] offset:16992
    v_cvt_pk_bf16_f32 v60, v60, v61
    v_cvt_pk_bf16_f32 v61, v62, v63
    ds_write_b64 v249, v[60:61] offset:25440
    buffer_load_dwordx4 v239, s[12:15], s54 offen offset:3072 lds
    s_add_u32 m0, s22, 38016
    v_cvt_pk_bf16_f32 v64, v64, v65
    v_cvt_pk_bf16_f32 v65, v66, v67
    ds_write_b64 v249, v[64:65] offset:128
    v_cvt_pk_bf16_f32 v68, v68, v69
    v_cvt_pk_bf16_f32 v69, v70, v71
    ds_write_b64 v249, v[68:69] offset:8576
    v_cvt_pk_bf16_f32 v72, v72, v73
    v_cvt_pk_bf16_f32 v73, v74, v75
    ds_write_b64 v249, v[72:73] offset:17024
    v_cvt_pk_bf16_f32 v76, v76, v77
    v_cvt_pk_bf16_f32 v77, v78, v79
    ds_write_b64 v249, v[76:77] offset:25472
    buffer_load_dwordx4 v239, s[12:15], s55 offen offset:0 lds
    s_add_u32 m0, s22, 38048
    v_cvt_pk_bf16_f32 v80, v80, v81
    v_cvt_pk_bf16_f32 v81, v82, v83
    ds_write_b64 v249, v[80:81] offset:160
    v_cvt_pk_bf16_f32 v84, v84, v85
    v_cvt_pk_bf16_f32 v85, v86, v87
    ds_write_b64 v249, v[84:85] offset:8608
    v_cvt_pk_bf16_f32 v88, v88, v89
    v_cvt_pk_bf16_f32 v89, v90, v91
    ds_write_b64 v249, v[88:89] offset:17056
    v_cvt_pk_bf16_f32 v92, v92, v93
    v_cvt_pk_bf16_f32 v93, v94, v95
    ds_write_b64 v249, v[92:93] offset:25504
    buffer_load_dwordx4 v239, s[12:15], s55 offen offset:1024 lds
    s_add_u32 m0, s22, 38080
    v_cvt_pk_bf16_f32 v96, v96, v97
    v_cvt_pk_bf16_f32 v97, v98, v99
    ds_write_b64 v249, v[96:97] offset:192
    v_cvt_pk_bf16_f32 v100, v100, v101
    v_cvt_pk_bf16_f32 v101, v102, v103
    ds_write_b64 v249, v[100:101] offset:8640
    v_cvt_pk_bf16_f32 v104, v104, v105
    v_cvt_pk_bf16_f32 v105, v106, v107
    ds_write_b64 v249, v[104:105] offset:17088
    v_cvt_pk_bf16_f32 v108, v108, v109
    v_cvt_pk_bf16_f32 v109, v110, v111
    ds_write_b64 v249, v[108:109] offset:25536
    buffer_load_dwordx4 v239, s[12:15], s55 offen offset:2048 lds
    s_add_u32 m0, s22, 38112
    v_cvt_pk_bf16_f32 v112, v112, v113
    v_cvt_pk_bf16_f32 v113, v114, v115
    ds_write_b64 v249, v[112:113] offset:224
    v_cvt_pk_bf16_f32 v116, v116, v117
    v_cvt_pk_bf16_f32 v117, v118, v119
    ds_write_b64 v249, v[116:117] offset:8672
    v_cvt_pk_bf16_f32 v120, v120, v121
    v_cvt_pk_bf16_f32 v121, v122, v123
    ds_write_b64 v249, v[120:121] offset:17120
    v_cvt_pk_bf16_f32 v124, v124, v125
    v_cvt_pk_bf16_f32 v125, v126, v127
    ds_write_b64 v249, v[124:125] offset:25568
    buffer_load_dwordx4 v239, s[12:15], s55 offen offset:3072 lds
    v_mov_b32 v192, 0
    v_mov_b32 v193, 0
    v_mov_b32 v194, 0
    v_mov_b32 v195, 0
    v_mov_b32 v196, 0
    v_mov_b32 v197, 0
    v_mov_b32 v198, 0
    v_mov_b32 v199, 0
    v_mov_b32 v200, 0
    v_mov_b32 v201, 0
    v_mov_b32 v202, 0
    v_mov_b32 v203, 0
    v_mov_b32 v204, 0
    v_mov_b32 v205, 0
    v_mov_b32 v206, 0
    v_mov_b32 v207, 0
    s_getpc_b64 s[56:57]
K2_pc:
    s_add_u32 s56, s56, K2_loop-K2_pc
    s_addc_u32 s57, s57, 0
    s_mov_b32 s58, CODE_END-K2_loop
    s_mov_b32 s59, 0x20000
    s_lshl_b32 s72, s41, 12
    s_lshl_b32 s73, s27, 17
    s_add_u32 s72, s72, s73
    s_waitcnt vmcnt(9)
    s_waitcnt lgkmcnt(0)
    s_barrier
    ds_read_b128 v[208:211], v236 offset:0
    ds_read_b128 v[0:3], v251 offset:0
    ds_read_b128 v[32:35], v251 offset:8448
    ds_read_b128 v[64:67], v251 offset:16896
    ds_read_b128 v[96:99], v251 offset:25344
    ds_read_b128 v[212:215], v236 offset:64
    ds_read_b128 v[4:7], v251 offset:64
    ds_read_b128 v[36:39], v251 offset:8512
    ds_read_b128 v[68:71], v251 offset:16960
    ds_read_b128 v[100:103], v251 offset:25408
    ds_read_b128 v[216:219], v236 offset:128
    ds_read_b128 v[8:11], v251 offset:128
    s_waitcnt lgkmcnt(7)
    v_mfma_f32_16x16x32_bf16 v[128:131], v[208:211], v[0:3], 0
    ds_read_b128 v[40:43], v251 offset:8576
    ds_read_b128 v[72:75], v251 offset:17024
    v_mfma_f32_16x16x32_bf16 v[136:139], v[208:211], v[32:35], 0
    ds_read_b128 v[104:107], v251 offset:25472
    ds_read_b128 v[220:223], v236 offset:192
    v_mfma_f32_16x16x32_bf16 v[144:147], v[208:211], v[64:67], 0
    ds_read_b128 v[12:15], v251 offset:192
    ds_read_b128 v[44:47], v251 offset:8640
    v_mfma_f32_16x16x32_bf16 v[152:155], v[208:211], v[96:99], 0
    ds_read_b128 v[76:79], v251 offset:17088
    s_waitcnt lgkmcnt(9)
    v_mfma_f32_16x16x32_bf16 v[128:131], v[212:215], v[4:7], v[128:131]
    ds_read_b128 v[108:111], v251 offset:25536
    ds_read_b128 v[224:227], v236 offset:256
    v_mfma_f32_16x16x32_bf16 v[136:139], v[212:215], v[36:39], v[136:139]
    ds_read_b128 v[16:19], v251 offset:256
    ds_read_b128 v[48:51], v251 offset:8704
    v_mfma_f32_16x16x32_bf16 v[144:147], v[212:215], v[68:71], v[144:147]
    ds_read_b128 v[80:83], v251 offset:17152
    ds_read_b128 v[112:115], v251 offset:25600
    v_mfma_f32_16x16x32_bf16 v[152:155], v[212:215], v[100:103], v[152:155]
    ds_read_b128 v[20:23], v251 offset:320
    s_waitcnt lgkmcnt(11)
    v_mfma_f32_16x16x32_bf16 v[128:131], v[216:219], v[8:11], v[128:131]
    ds_read_b128 v[52:55], v251 offset:8768
    ds_read_b128 v[84:87], v251 offset:17216
    v_mfma_f32_16x16x32_bf16 v[136:139], v[216:219], v[40:43], v[136:139]
    ds_read_b128 v[116:119], v251 offset:25664
    ds_read_b128 v[24:27], v251 offset:384
    v_mfma_f32_16x16x32_bf16 v[144:147], v[216:219], v[72:75], v[144:147]
    ds_read_b128 v[56:59], v251 offset:8832
    ds_read_b128 v[88:91], v251 offset:17280
    v_mfma_f32_16x16x32_bf16 v[152:155], v[216:219], v[104:107], v[152:155]
    ds_read_b128 v[120:123], v251 offset:25728
    s_waitcnt lgkmcnt(13)
    v_mfma_f32_16x16x32_bf16 v[128:131], v[220:223], v[12:15], v[128:131]
    ds_read_b128 v[28:31], v251 offset:448
    ds_read_b128 v[60:63], v251 offset:8896
    v_mfma_f32_16x16x32_bf16 v[136:139], v[220:223], v[44:47], v[136:139]
    ds_read_b128 v[92:95], v251 offset:17344
    ds_read_b128 v[124:127], v251 offset:25792
    v_mfma_f32_16x16x32_bf16 v[144:147], v[220:223], v[76:79], v[144:147]
    ds_read_b128 v[228:231], v236 offset:320
    ds_read_b128 v[232:235], v236 offset:384
    v_mfma_f32_16x16x32_bf16 v[152:155], v[220:223], v[108:111], v[152:155]
    ds_read_b128 v[208:211], v236 offset:448
    s_waitcnt lgkmcnt(15)
    v_mfma_f32_16x16x32_bf16 v[128:131], v[224:227], v[16:19], v[128:131]
    ds_read_b128 v[212:215], v236 offset:8448
    ds_read_b128 v[216:219], v236 offset:8512
    v_mfma_f32_16x16x32_bf16 v[136:139], v[224:227], v[48:51], v[136:139]
    v_mfma_f32_16x16x32_bf16 v[144:147], v[224:227], v[80:83], v[144:147]
    v_mfma_f32_16x16x32_bf16 v[152:155], v[224:227], v[112:115], v[152:155]
    s_waitcnt lgkmcnt(4)
    v_mfma_f32_16x16x32_bf16 v[128:131], v[228:231], v[20:23], v[128:131]
    ds_read_b128 v[220:223], v236 offset:8576
    v_mfma_f32_16x16x32_bf16 v[136:139], v[228:231], v[52:55], v[136:139]
    v_mfma_f32_16x16x32_bf16 v[144:147], v[228:231], v[84:87], v[144:147]
    v_mfma_f32_16x16x32_bf16 v[152:155], v[228:231], v[116:119], v[152:155]
    s_waitcnt lgkmcnt(4)
    v_mfma_f32_16x16x32_bf16 v[128:131], v[232:235], v[24:27], v[128:131]
    ds_read_b128 v[224:227], v236 offset:8640
    v_mfma_f32_16x16x32_bf16 v[136:139], v[232:235], v[56:59], v[136:139]
    v_mfma_f32_16x16x32_bf16 v[144:147], v[232:235], v[88:91], v[144:147]
    v_mfma_f32_16x16x32_bf16 v[152:155], v[232:235], v[120:123], v[152:155]
    s_waitcnt lgkmcnt(4)
    v_mfma_f32_16x16x32_bf16 v[128:131], v[208:211], v[28:31], v[128:131]
    ds_read_b128 v[228:231], v236 offset:8704
    v_mfma_f32_16x16x32_bf16 v[136:139], v[208:211], v[60:63], v[136:139]
    v_mfma_f32_16x16x32_bf16 v[144:147], v[208:211], v[92:95], v[144:147]
    v_mfma_f32_16x16x32_bf16 v[152:155], v[208:211], v[124:127], v[152:155]
    s_waitcnt lgkmcnt(4)
    v_mfma_f32_16x16x32_bf16 v[132:135], v[212:215], v[0:3], 0
    ds_read_b128 v[232:235], v236 offset:8768
    v_mfma_f32_16x16x32_bf16 v[140:143], v[212:215], v[32:35], 0
    v_mfma_f32_16x16x32_bf16 v[148:151], v[212:215], v[64:67], 0
    v_mfma_f32_16x16x32_bf16 v[156:159], v[212:215], v[96:99], 0
    s_waitcnt lgkmcnt(4)
    v_mfma_f32_16x16x32_bf16 v[132:135], v[216:219], v[4:7], v[132:135]
    ds_read_b128 v[208:211], v236 offset:8832
    v_mfma_f32_16x16x32_bf16 v[140:143], v[216:219], v[36:39], v[140:143]
    v_mfma_f32_16x16x32_bf16 v[148:151], v[216:219], v[68:71], v[148:151]
    v_mfma_f32_16x16x32_bf16 v[156:159], v[216:219], v[100:103], v[156:159]
    s_waitcnt lgkmcnt(4)
    v_mfma_f32_16x16x32_bf16 v[132:135], v[220:223], v[8:11], v[132:135]
    ds_read_b128 v[212:215], v236 offset:8896
    v_mfma_f32_16x16x32_bf16 v[140:143], v[220:223], v[40:43], v[140:143]
    v_mfma_f32_16x16x32_bf16 v[148:151], v[220:223], v[72:75], v[148:151]
    v_mfma_f32_16x16x32_bf16 v[156:159], v[220:223], v[104:107], v[156:159]
    s_waitcnt lgkmcnt(4)
    v_mfma_f32_16x16x32_bf16 v[132:135], v[224:227], v[12:15], v[132:135]
    v_mfma_f32_16x16x32_bf16 v[140:143], v[224:227], v[44:47], v[140:143]
    v_mfma_f32_16x16x32_bf16 v[148:151], v[224:227], v[76:79], v[148:151]
    s_waitcnt vmcnt(0)
    s_waitcnt lgkmcnt(0)
    s_barrier
    v_mfma_f32_16x16x32_bf16 v[156:159], v[224:227], v[108:111], v[156:159]
    s_add_u32 m0, s23, 0
    v_mfma_f32_16x16x32_bf16 v[132:135], v[228:231], v[16:19], v[132:135]
    buffer_load_dwordx4 v240, s[8:11], s52 offen offset:0 lds
    v_mfma_f32_16x16x32_bf16 v[140:143], v[228:231], v[48:51], v[140:143]
    s_add_u32 m0, s23, 64
    v_mfma_f32_16x16x32_bf16 v[148:151], v[228:231], v[80:83], v[148:151]
    buffer_load_dwordx4 v240, s[8:11], s52 offen offset:1024 lds
    v_mfma_f32_16x16x32_bf16 v[156:159], v[228:231], v[112:115], v[156:159]
    s_add_u32 m0, s23, 128
    v_mfma_f32_16x16x32_bf16 v[132:135], v[232:235], v[20:23], v[132:135]
    buffer_load_dwordx4 v240, s[8:11], s52 offen offset:2048 lds
    v_mfma_f32_16x16x32_bf16 v[140:143], v[232:235], v[52:55], v[140:143]
    s_add_u32 m0, s23, 192
    v_mfma_f32_16x16x32_bf16 v[148:151], v[232:235], v[84:87], v[148:151]
    buffer_load_dwordx4 v240, s[8:11], s52 offen offset:3072 lds
    v_mfma_f32_16x16x32_bf16 v[156:159], v[232:235], v[116:119], v[156:159]
    s_add_u32 m0, s23, 4352
    v_mfma_f32_16x16x32_bf16 v[132:135], v[208:211], v[24:27], v[132:135]
    buffer_load_dwordx4 v240, s[8:11], s53 offen offset:0 lds
    v_mfma_f32_16x16x32_bf16 v[140:143], v[208:211], v[56:59], v[140:143]
    s_add_u32 m0, s23, 4416
    v_mfma_f32_16x16x32_bf16 v[148:151], v[208:211], v[88:91], v[148:151]
    buffer_load_dwordx4 v240, s[8:11], s53 offen offset:1024 lds
    v_mfma_f32_16x16x32_bf16 v[156:159], v[208:211], v[120:123], v[156:159]
    s_add_u32 m0, s23, 4480
    v_mfma_f32_16x16x32_bf16 v[132:135], v[212:215], v[28:31], v[132:135]
    buffer_load_dwordx4 v240, s[8:11], s53 offen offset:2048 lds
    v_mfma_f32_16x16x32_bf16 v[140:143], v[212:215], v[60:63], v[140:143]
    s_add_u32 m0, s23, 4544
    v_mfma_f32_16x16x32_bf16 v[148:151], v[212:215], v[92:95], v[148:151]
    buffer_load_dwordx4 v240, s[8:11], s53 offen offset:3072 lds
    v_mfma_f32_16x16x32_bf16 v[156:159], v[212:215], v[124:127], v[156:159]
    s_mov_b32 s20, 32768
    s_mov_b32 s21, 36864
    ds_read_b128 v[208:211], v236 offset:33792
    ds_read_b128 v[212:215], v236 offset:33856
    ds_read_b128 v[216:219], v236 offset:33920
    ds_read_b128 v[220:223], v236 offset:33984
    ds_read_b128 v[224:227], v236 offset:34048
    s_nop 1
    s_add_u32 m0, s22, 0
    v_exp_f32 v128, v128
    v_exp_f32 v129, v129
    v_exp_f32 v130, v130
    buffer_load_dwordx4 v239, s[4:7], s52 offen offset:0 lds
    v_add_f32 v245, v128, v129
    s_add_u32 m0, s22, 32
    v_cvt_pk_bf16_f32 v128, v128, v129
    v_exp_f32 v131, v131
    v_add_f32 v245, v245, v130
    buffer_load_dwordx4 v239, s[4:7], s52 offen offset:1024 lds
    v_exp_f32 v132, v132
    s_add_u32 m0, s22, 64
    v_add_f32 v245, v245, v131
    v_cvt_pk_bf16_f32 v129, v130, v131
    v_exp_f32 v133, v133
    buffer_load_dwordx4 v239, s[4:7], s52 offen offset:2048 lds
    v_add_f32 v245, v245, v132
    s_add_u32 m0, s22, 96
    v_exp_f32 v134, v134
    v_add_f32 v245, v245, v133
    v_cvt_pk_bf16_f32 v130, v132, v133
    buffer_load_dwordx4 v239, s[4:7], s52 offen offset:3072 lds
    v_exp_f32 v135, v135
    s_add_u32 m0, s22, 4224
    v_add_f32 v245, v245, v134
    v_add_f32 v245, v245, v135
    v_cvt_pk_bf16_f32 v131, v134, v135
    buffer_load_dwordx4 v239, s[4:7], s53 offen offset:0 lds
    v_exp_f32 v136, v136
    s_add_u32 m0, s22, 4256
    v_exp_f32 v137, v137
    v_exp_f32 v138, v138
    v_add_f32 v246, v136, v137
    buffer_load_dwordx4 v239, s[4:7], s53 offen offset:1024 lds
    v_cvt_pk_bf16_f32 v136, v136, v137
    s_add_u32 m0, s22, 4288
    v_exp_f32 v139, v139
    v_add_f32 v246, v246, v138
    v_exp_f32 v140, v140
    buffer_load_dwordx4 v239, s[4:7], s53 offen offset:2048 lds
    v_add_f32 v246, v246, v139
    s_add_u32 m0, s22, 4320
    v_cvt_pk_bf16_f32 v137, v138, v139
    v_exp_f32 v141, v141
    v_add_f32 v246, v246, v140
    buffer_load_dwordx4 v239, s[4:7], s53 offen offset:3072 lds
    v_exp_f32 v142, v142
    v_add_f32 v246, v246, v141
    v_cvt_pk_bf16_f32 v138, v140, v141
    v_exp_f32 v143, v143
    v_add_f32 v246, v246, v142
    v_add_f32 v246, v246, v143
    v_cvt_pk_bf16_f32 v139, v142, v143
    s_waitcnt lgkmcnt(3)
    v_mfma_f32_16x16x32_bf16 v[160:163], v[208:211], v[0:3], v[192:195]
    ds_read_b128 v[228:231], v236 offset:34112
    v_mfma_f32_16x16x32_bf16 v[168:171], v[208:211], v[32:35], v[196:199]
    v_exp_f32 v144, v144
    v_mfma_f32_16x16x32_bf16 v[176:179], v[208:211], v[64:67], v[200:203]
    v_exp_f32 v145, v145
    v_mfma_f32_16x16x32_bf16 v[184:187], v[208:211], v[96:99], v[204:207]
    v_mfma_f32_16x16x32_bf16 v[160:163], v[212:215], v[4:7], v[160:163]
    ds_read_b128 v[232:235], v236 offset:34176
    v_add_f32 v243, v243, v247
    v_mfma_f32_16x16x32_bf16 v[168:171], v[212:215], v[36:39], v[168:171]
    v_exp_f32 v146, v146
    v_mfma_f32_16x16x32_bf16 v[176:179], v[212:215], v[68:71], v[176:179]
    v_mfma_f32_16x16x32_bf16 v[184:187], v[212:215], v[100:103], v[184:187]
    v_add_f32 v247, v144, v145
    s_waitcnt lgkmcnt(3)
    v_mfma_f32_16x16x32_bf16 v[160:163], v[216:219], v[8:11], v[160:163]
    ds_read_b128 v[208:211], v236 offset:34240
    v_cvt_pk_bf16_f32 v144, v144, v145
    v_mfma_f32_16x16x32_bf16 v[168:171], v[216:219], v[40:43], v[168:171]
    v_exp_f32 v147, v147
    v_mfma_f32_16x16x32_bf16 v[176:179], v[216:219], v[72:75], v[176:179]
    v_mfma_f32_16x16x32_bf16 v[184:187], v[216:219], v[104:107], v[184:187]
    v_add_f32 v247, v247, v146
    v_mfma_f32_16x16x32_bf16 v[160:163], v[220:223], v[12:15], v[160:163]
    ds_read_b128 v[212:215], v236 offset:42240
    v_mfma_f32_16x16x32_bf16 v[168:171], v[220:223], v[44:47], v[168:171]
    v_exp_f32 v148, v148
    v_mfma_f32_16x16x32_bf16 v[176:179], v[220:223], v[76:79], v[176:179]
    v_add_f32 v247, v247, v147
    v_mfma_f32_16x16x32_bf16 v[184:187], v[220:223], v[108:111], v[184:187]
    v_cvt_pk_bf16_f32 v145, v146, v147
    s_waitcnt lgkmcnt(3)
    v_mfma_f32_16x16x32_bf16 v[160:163], v[224:227], v[16:19], v[160:163]
    ds_read_b128 v[216:219], v236 offset:42304
    v_mfma_f32_16x16x32_bf16 v[168:171], v[224:227], v[48:51], v[168:171]
    v_exp_f32 v149, v149
    v_mfma_f32_16x16x32_bf16 v[176:179], v[224:227], v[80:83], v[176:179]
    v_add_f32 v247, v247, v148
    v_mfma_f32_16x16x32_bf16 v[184:187], v[224:227], v[112:115], v[184:187]
    v_exp_f32 v150, v150
    v_mfma_f32_16x16x32_bf16 v[160:163], v[228:231], v[20:23], v[160:163]
    ds_read_b128 v[220:223], v236 offset:42368
    v_mfma_f32_16x16x32_bf16 v[168:171], v[228:231], v[52:55], v[168:171]
    v_add_f32 v247, v247, v149
    v_mfma_f32_16x16x32_bf16 v[176:179], v[228:231], v[84:87], v[176:179]
    v_cvt_pk_bf16_f32 v146, v148, v149
    v_mfma_f32_16x16x32_bf16 v[184:187], v[228:231], v[116:119], v[184:187]
    s_waitcnt lgkmcnt(3)
    v_mfma_f32_16x16x32_bf16 v[160:163], v[232:235], v[24:27], v[160:163]
    v_exp_f32 v151, v151
    v_mfma_f32_16x16x32_bf16 v[168:171], v[232:235], v[56:59], v[168:171]
    ds_read_b128 v[224:227], v236 offset:42432
    v_add_f32 v247, v247, v150
    v_mfma_f32_16x16x32_bf16 v[176:179], v[232:235], v[88:91], v[176:179]
    v_add_f32 v247, v247, v151
    v_mfma_f32_16x16x32_bf16 v[184:187], v[232:235], v[120:123], v[184:187]
    v_cvt_pk_bf16_f32 v147, v150, v151
    v_mfma_f32_16x16x32_bf16 v[160:163], v[208:211], v[28:31], v[160:163]
    ds_read_b128 v[228:231], v236 offset:42496
    v_mfma_f32_16x16x32_bf16 v[168:171], v[208:211], v[60:63], v[168:171]
    v_exp_f32 v152, v152
    v_mfma_f32_16x16x32_bf16 v[176:179], v[208:211], v[92:95], v[176:179]
    v_exp_f32 v153, v153
    v_mfma_f32_16x16x32_bf16 v[184:187], v[208:211], v[124:127], v[184:187]
    s_waitcnt lgkmcnt(3)
    v_mfma_f32_16x16x32_bf16 v[164:167], v[212:215], v[0:3], v[192:195]
    ds_read_b128 v[232:235], v236 offset:42560
    v_add_f32 v244, v244, v248
    v_mfma_f32_16x16x32_bf16 v[172:175], v[212:215], v[32:35], v[196:199]
    v_exp_f32 v154, v154
    v_mfma_f32_16x16x32_bf16 v[180:183], v[212:215], v[64:67], v[200:203]
    v_mfma_f32_16x16x32_bf16 v[188:191], v[212:215], v[96:99], v[204:207]
    v_add_f32 v248, v152, v153
    v_mfma_f32_16x16x32_bf16 v[164:167], v[216:219], v[4:7], v[164:167]
    ds_read_b128 v[208:211], v236 offset:42624
    v_cvt_pk_bf16_f32 v152, v152, v153
    v_mfma_f32_16x16x32_bf16 v[172:175], v[216:219], v[36:39], v[172:175]
    v_exp_f32 v155, v155
    v_mfma_f32_16x16x32_bf16 v[180:183], v[216:219], v[68:71], v[180:183]
    v_mfma_f32_16x16x32_bf16 v[188:191], v[216:219], v[100:103], v[188:191]
    v_add_f32 v248, v248, v154
    s_waitcnt lgkmcnt(3)
    v_mfma_f32_16x16x32_bf16 v[164:167], v[220:223], v[8:11], v[164:167]
    ds_read_b128 v[212:215], v236 offset:42688
    v_mfma_f32_16x16x32_bf16 v[172:175], v[220:223], v[40:43], v[172:175]
    v_exp_f32 v156, v156
    v_mfma_f32_16x16x32_bf16 v[180:183], v[220:223], v[72:75], v[180:183]
    v_add_f32 v248, v248, v155
    v_mfma_f32_16x16x32_bf16 v[188:191], v[220:223], v[104:107], v[188:191]
    v_cvt_pk_bf16_f32 v153, v154, v155
    v_mfma_f32_16x16x32_bf16 v[164:167], v[224:227], v[12:15], v[164:167]
    v_exp_f32 v157, v157
    v_mfma_f32_16x16x32_bf16 v[172:175], v[224:227], v[44:47], v[172:175]
    v_mfma_f32_16x16x32_bf16 v[180:183], v[224:227], v[76:79], v[180:183]
    v_add_f32 v248, v248, v156
    s_waitcnt vmcnt(0) lgkmcnt(0)
    s_barrier
    v_mfma_f32_16x16x32_bf16 v[188:191], v[224:227], v[108:111], v[188:191]
    ds_read_b64_tr_b16 v[216:217], v237 offset:0
    v_mfma_f32_16x16x32_bf16 v[164:167], v[228:231], v[16:19], v[164:167]
    ds_read_b64_tr_b16 v[218:219], v237 offset:8704
    ds_read_b64_tr_b16 v[220:221], v238 offset:0
    v_mfma_f32_16x16x32_bf16 v[172:175], v[228:231], v[48:51], v[172:175]
    v_exp_f32 v158, v158
    v_mfma_f32_16x16x32_bf16 v[180:183], v[228:231], v[80:83], v[180:183]
    ds_read_b64_tr_b16 v[222:223], v238 offset:8704
    v_add_f32 v248, v248, v157
    v_mfma_f32_16x16x32_bf16 v[188:191], v[228:231], v[112:115], v[188:191]
    v_cvt_pk_bf16_f32 v154, v156, v157
    v_mfma_f32_16x16x32_bf16 v[164:167], v[232:235], v[20:23], v[164:167]
    v_exp_f32 v159, v159
    v_mfma_f32_16x16x32_bf16 v[172:175], v[232:235], v[52:55], v[172:175]
    ds_read_b64_tr_b16 v[224:225], v237 offset:64
    ds_read_b64_tr_b16 v[226:227], v237 offset:8768
    v_mfma_f32_16x16x32_bf16 v[180:183], v[232:235], v[84:87], v[180:183]
    s_add_u32 m0, s23, 34816
    v_add_f32 v248, v248, v158
    v_mfma_f32_16x16x32_bf16 v[188:191], v[232:235], v[116:119], v[188:191]
    buffer_load_dwordx4 v240, s[8:11], s20 offen offset:0 lds
    v_mfma_f32_16x16x32_bf16 v[164:167], v[208:211], v[24:27], v[164:167]
    v_add_f32 v248, v248, v159
    v_cvt_pk_bf16_f32 v155, v158, v159
    v_mfma_f32_16x16x32_bf16 v[172:175], v[208:211], v[56:59], v[172:175]
    ds_read_b64_tr_b16 v[228:229], v238 offset:64
    ds_read_b64_tr_b16 v[230:231], v238 offset:8768
    v_mfma_f32_16x16x32_bf16 v[180:183], v[208:211], v[88:91], v[180:183]
    v_min3_f32 v249, v245, v246, v247
    v_min_f32 v249, v249, v248
    v_mfma_f32_16x16x32_bf16 v[188:191], v[208:211], v[120:123], v[188:191]
    s_add_u32 m0, s23, 34880
    v_cmp_nle_f32 s[28:29], s45, v249
    v_mfma_f32_16x16x32_bf16 v[164:167], v[212:215], v[28:31], v[164:167]
    buffer_load_dwordx4 v240, s[8:11], s20 offen offset:1024 lds
    v_max3_f32 v249, v245, v246, v247
    v_mfma_f32_16x16x32_bf16 v[172:175], v[212:215], v[60:63], v[172:175]
    v_max_f32 v249, v249, v248
    ds_read_b64_tr_b16 v[208:209], v237 offset:128
    v_mfma_f32_16x16x32_bf16 v[180:183], v[212:215], v[92:95], v[180:183]
    ds_read_b64_tr_b16 v[210:211], v237 offset:8832
    v_cmp_lt_f32 vcc, s25, v249
    v_mfma_f32_16x16x32_bf16 v[188:191], v[212:215], v[124:127], v[188:191]
    s_or_b64 vcc, vcc, s[28:29]
    s_cbranch_vccnz K2_tramp_6
K2_ret_6:
    s_waitcnt lgkmcnt(6)
    v_mfma_f32_16x16x32_bf16 a[0:3], v[216:219], v[128:131], 0
    s_add_u32 m0, s23, 34944
    ds_read_b64_tr_b16 v[212:213], v238 offset:128
    v_mfma_f32_16x16x32_bf16 a[4:7], v[216:219], v[136:139], 0
    buffer_load_dwordx4 v240, s[8:11], s20 offen offset:2048 lds
    ds_read_b64_tr_b16 v[214:215], v238 offset:8832
    v_mfma_f32_16x16x32_bf16 a[8:11], v[216:219], v[144:147], 0
    s_add_u32 m0, s23, 35008
    v_mfma_f32_16x16x32_bf16 a[12:15], v[216:219], v[152:155], 0
    buffer_load_dwordx4 v240, s[8:11], s20 offen offset:3072 lds
    v_mfma_f32_16x16x32_bf16 a[16:19], v[220:223], v[128:131], 0
    ds_read_b64_tr_b16 v[216:217], v237 offset:192
    ds_read_b64_tr_b16 v[218:219], v237 offset:8896
    v_mfma_f32_16x16x32_bf16 a[20:23], v[220:223], v[136:139], 0
    v_exp_f32 v160, v160
    v_mfma_f32_16x16x32_bf16 a[24:27], v[220:223], v[144:147], 0
    v_exp_f32 v161, v161
    v_mfma_f32_16x16x32_bf16 a[28:31], v[220:223], v[152:155], 0
    s_add_u32 m0, s23, 39168
    s_waitcnt lgkmcnt(6)
    v_mfma_f32_16x16x32_bf16 a[32:35], v[224:227], v[128:131], 0
    buffer_load_dwordx4 v240, s[8:11], s21 offen offset:0 lds
    ds_read_b64_tr_b16 v[220:221], v238 offset:192
    v_mfma_f32_16x16x32_bf16 a[36:39], v[224:227], v[136:139], 0
    ds_read_b64_tr_b16 v[222:223], v238 offset:8896
    v_add_f32 v241, v241, v245
    v_mfma_f32_16x16x32_bf16 a[40:43], v[224:227], v[144:147], 0
    v_exp_f32 v162, v162
    v_mfma_f32_16x16x32_bf16 a[44:47], v[224:227], v[152:155], 0
    s_add_u32 m0, s23, 39232
    v_add_f32 v245, v160, v161
    v_mfma_f32_16x16x32_bf16 a[48:51], v[228:231], v[128:131], 0
    buffer_load_dwordx4 v240, s[8:11], s21 offen offset:1024 lds
    ds_read_b64_tr_b16 v[224:225], v237 offset:256
    v_mfma_f32_16x16x32_bf16 a[52:55], v[228:231], v[136:139], 0
    ds_read_b64_tr_b16 v[226:227], v237 offset:8960
    v_cvt_pk_bf16_f32 v160, v160, v161
    v_mfma_f32_16x16x32_bf16 a[56:59], v[228:231], v[144:147], 0
    v_exp_f32 v163, v163
    v_mfma_f32_16x16x32_bf16 a[60:63], v[228:231], v[152:155], 0
    v_add_f32 v245, v245, v162
    s_waitcnt lgkmcnt(6)
    v_mfma_f32_16x16x32_bf16 a[64:67], v[208:211], v[128:131], 0
    s_add_u32 m0, s23, 39296
    ds_read_b64_tr_b16 v[228:229], v238 offset:256
    v_mfma_f32_16x16x32_bf16 a[68:71], v[208:211], v[136:139], 0
    ds_read_b64_tr_b16 v[230:231], v238 offset:8960
    buffer_load_dwordx4 v240, s[8:11], s21 offen offset:2048 lds
    v_mfma_f32_16x16x32_bf16 a[72:75], v[208:211], v[144:147], 0
    v_exp_f32 v164, v164
    v_mfma_f32_16x16x32_bf16 a[76:79], v[208:211], v[152:155], 0
    v_add_f32 v245, v245, v163
    v_cvt_pk_bf16_f32 v161, v162, v163
    v_mfma_f32_16x16x32_bf16 a[80:83], v[212:215], v[128:131], 0
    s_add_u32 m0, s23, 39360
    ds_read_b64_tr_b16 v[208:209], v237 offset:320
    v_mfma_f32_16x16x32_bf16 a[84:87], v[212:215], v[136:139], 0
    ds_read_b64_tr_b16 v[210:211], v237 offset:9024
    buffer_load_dwordx4 v240, s[8:11], s21 offen offset:3072 lds
    v_mfma_f32_16x16x32_bf16 a[88:91], v[212:215], v[144:147], 0
    v_exp_f32 v165, v165
    v_mfma_f32_16x16x32_bf16 a[92:95], v[212:215], v[152:155], 0
    v_add_f32 v245, v245, v164
    s_waitcnt lgkmcnt(6)
    v_mfma_f32_16x16x32_bf16 a[96:99], v[216:219], v[128:131], 0
    v_exp_f32 v166, v166
    v_mfma_f32_16x16x32_bf16 a[100:103], v[216:219], v[136:139], 0
    ds_read_b64_tr_b16 v[212:213], v238 offset:320
    ds_read_b64_tr_b16 v[214:215], v238 offset:9024
    v_mfma_f32_16x16x32_bf16 a[104:107], v[216:219], v[144:147], 0
    s_add_u32 m0, s22, 33792
    v_add_f32 v245, v245, v165
    v_mfma_f32_16x16x32_bf16 a[108:111], v[216:219], v[152:155], 0
    buffer_load_dwordx4 v239, s[4:7], s20 offen offset:0 lds
    v_cvt_pk_bf16_f32 v162, v164, v165
    v_mfma_f32_16x16x32_bf16 a[112:115], v[220:223], v[128:131], 0
    v_exp_f32 v167, v167
    v_mfma_f32_16x16x32_bf16 a[116:119], v[220:223], v[136:139], 0
    ds_read_b64_tr_b16 v[216:217], v237 offset:384
    ds_read_b64_tr_b16 v[218:219], v237 offset:9088
    v_mfma_f32_16x16x32_bf16 a[120:123], v[220:223], v[144:147], 0
    s_add_u32 m0, s22, 33824
    v_add_f32 v245, v245, v166
    v_mfma_f32_16x16x32_bf16 a[124:127], v[220:223], v[152:155], 0
    buffer_load_dwordx4 v239, s[4:7], s20 offen offset:1024 lds
    s_waitcnt lgkmcnt(6)
    v_mfma_f32_16x16x32_bf16 a[128:131], v[224:227], v[128:131], 0
    v_add_f32 v245, v245, v167
    v_cvt_pk_bf16_f32 v163, v166, v167
    v_mfma_f32_16x16x32_bf16 a[132:135], v[224:227], v[136:139], 0
    ds_read_b64_tr_b16 v[220:221], v238 offset:384
    ds_read_b64_tr_b16 v[222:223], v238 offset:9088
    v_mfma_f32_16x16x32_bf16 a[136:139], v[224:227], v[144:147], 0
    v_exp_f32 v168, v168
    v_mfma_f32_16x16x32_bf16 a[140:143], v[224:227], v[152:155], 0
    s_add_u32 m0, s22, 33856
    v_mfma_f32_16x16x32_bf16 a[144:147], v[228:231], v[128:131], 0
    buffer_load_dwordx4 v239, s[4:7], s20 offen offset:2048 lds
    ds_read_b64_tr_b16 v[224:225], v237 offset:448
    v_mfma_f32_16x16x32_bf16 a[148:151], v[228:231], v[136:139], 0
    v_exp_f32 v169, v169
    v_mfma_f32_16x16x32_bf16 a[152:155], v[228:231], v[144:147], 0
    ds_read_b64_tr_b16 v[226:227], v237 offset:9152
    v_add_f32 v242, v242, v246
    v_mfma_f32_16x16x32_bf16 a[156:159], v[228:231], v[152:155], 0
    s_add_u32 m0, s22, 33888
    s_waitcnt lgkmcnt(6)
    v_mfma_f32_16x16x32_bf16 a[160:163], v[208:211], v[128:131], 0
    v_exp_f32 v170, v170
    v_mfma_f32_16x16x32_bf16 a[164:167], v[208:211], v[136:139], 0
    buffer_load_dwordx4 v239, s[4:7], s20 offen offset:3072 lds
    ds_read_b64_tr_b16 v[228:229], v238 offset:448
    v_mfma_f32_16x16x32_bf16 a[168:171], v[208:211], v[144:147], 0
    ds_read_b64_tr_b16 v[230:231], v238 offset:9152
    v_add_f32 v246, v168, v169
    v_mfma_f32_16x16x32_bf16 a[172:175], v[208:211], v[152:155], 0
    v_cvt_pk_bf16_f32 v168, v168, v169
    s_add_u32 m0, s22, 38016
    v_mfma_f32_16x16x32_bf16 a[176:179], v[212:215], v[128:131], 0
    v_exp_f32 v171, v171
    v_mfma_f32_16x16x32_bf16 a[180:183], v[212:215], v[136:139], 0
    buffer_load_dwordx4 v239, s[4:7], s21 offen offset:0 lds
    ds_read_b128 v[208:211], v236 offset:0
    v_mfma_f32_16x16x32_bf16 a[184:187], v[212:215], v[144:147], 0
    v_add_f32 v246, v246, v170
    s_add_u32 m0, s22, 38048
    v_mfma_f32_16x16x32_bf16 a[188:191], v[212:215], v[152:155], 0
    buffer_load_dwordx4 v239, s[4:7], s21 offen offset:1024 lds
    s_waitcnt lgkmcnt(5)
    v_mfma_f32_16x16x32_bf16 a[192:195], v[216:219], v[128:131], 0
    v_exp_f32 v172, v172
    v_mfma_f32_16x16x32_bf16 a[196:199], v[216:219], v[136:139], 0
    v_add_f32 v246, v246, v171
    ds_read_b128 v[212:215], v236 offset:64
    v_mfma_f32_16x16x32_bf16 a[200:203], v[216:219], v[144:147], 0
    v_cvt_pk_bf16_f32 v169, v170, v171
    v_mfma_f32_16x16x32_bf16 a[204:207], v[216:219], v[152:155], 0
    v_exp_f32 v173, v173
    v_mfma_f32_16x16x32_bf16 a[208:211], v[220:223], v[128:131], 0
    v_add_f32 v246, v246, v172
    s_add_u32 m0, s22, 38080
    v_mfma_f32_16x16x32_bf16 a[212:215], v[220:223], v[136:139], 0
    ds_read_b128 v[216:219], v236 offset:128
    buffer_load_dwordx4 v239, s[4:7], s21 offen offset:2048 lds
    v_mfma_f32_16x16x32_bf16 a[216:219], v[220:223], v[144:147], 0
    v_exp_f32 v174, v174
    v_mfma_f32_16x16x32_bf16 a[220:223], v[220:223], v[152:155], 0
    v_add_f32 v246, v246, v173
    s_waitcnt lgkmcnt(3)
    v_mfma_f32_16x16x32_bf16 a[224:227], v[224:227], v[128:131], 0
    v_cvt_pk_bf16_f32 v170, v172, v173
    s_add_u32 m0, s22, 38112
    v_mfma_f32_16x16x32_bf16 a[228:231], v[224:227], v[136:139], 0
    ds_read_b128 v[220:223], v236 offset:192
    buffer_load_dwordx4 v239, s[4:7], s21 offen offset:3072 lds
    v_mfma_f32_16x16x32_bf16 a[232:235], v[224:227], v[144:147], 0
    v_exp_f32 v175, v175
    v_mfma_f32_16x16x32_bf16 a[236:239], v[224:227], v[152:155], 0
    v_add_f32 v246, v246, v174
    v_add_f32 v246, v246, v175
    v_mfma_f32_16x16x32_bf16 a[240:243], v[228:231], v[128:131], 0
    ds_read_b128 v[224:227], v236 offset:256
    v_cvt_pk_bf16_f32 v171, v174, v175
    v_mfma_f32_16x16x32_bf16 a[244:247], v[228:231], v[136:139], 0
    s_add_u32 s20, s20, 32768
    s_add_u32 s21, s21, 32768
    v_mfma_f32_16x16x32_bf16 a[248:251], v[228:231], v[144:147], 0
    s_add_u32 s75, s74, 262144
    buffer_load_dword v255, v250, s[64:67], s75 offen
    v_mfma_f32_16x16x32_bf16 a[252:255], v[228:231], v[152:155], 0
    s_waitcnt lgkmcnt(3)
    v_mfma_f32_16x16x32_bf16 v[128:131], v[208:211], v[0:3], v[192:195]
    ds_read_b128 v[228:231], v236 offset:320
    v_mfma_f32_16x16x32_bf16 v[136:139], v[208:211], v[32:35], v[196:199]
    v_exp_f32 v176, v176
    v_mfma_f32_16x16x32_bf16 v[144:147], v[208:211], v[64:67], v[200:203]
    v_exp_f32 v177, v177
    v_mfma_f32_16x16x32_bf16 v[152:155], v[208:211], v[96:99], v[204:207]
    v_mfma_f32_16x16x32_bf16 v[128:131], v[212:215], v[4:7], v[128:131]
    ds_read_b128 v[232:235], v236 offset:384
    v_add_f32 v243, v243, v247
    v_mfma_f32_16x16x32_bf16 v[136:139], v[212:215], v[36:39], v[136:139]
    v_exp_f32 v178, v178
    v_mfma_f32_16x16x32_bf16 v[144:147], v[212:215], v[68:71], v[144:147]
    v_mfma_f32_16x16x32_bf16 v[152:155], v[212:215], v[100:103], v[152:155]
    v_add_f32 v247, v176, v177
    s_waitcnt lgkmcnt(3)
    v_mfma_f32_16x16x32_bf16 v[128:131], v[216:219], v[8:11], v[128:131]
    ds_read_b128 v[208:211], v236 offset:448
    v_cvt_pk_bf16_f32 v176, v176, v177
    v_mfma_f32_16x16x32_bf16 v[136:139], v[216:219], v[40:43], v[136:139]
    v_exp_f32 v179, v179
    v_mfma_f32_16x16x32_bf16 v[144:147], v[216:219], v[72:75], v[144:147]
    v_mfma_f32_16x16x32_bf16 v[152:155], v[216:219], v[104:107], v[152:155]
    v_add_f32 v247, v247, v178
    v_mfma_f32_16x16x32_bf16 v[128:131], v[220:223], v[12:15], v[128:131]
    ds_read_b128 v[212:215], v236 offset:8448
    v_mfma_f32_16x16x32_bf16 v[136:139], v[220:223], v[44:47], v[136:139]
    v_exp_f32 v180, v180
    v_mfma_f32_16x16x32_bf16 v[144:147], v[220:223], v[76:79], v[144:147]
    v_add_f32 v247, v247, v179
    v_mfma_f32_16x16x32_bf16 v[152:155], v[220:223], v[108:111], v[152:155]
    v_cvt_pk_bf16_f32 v177, v178, v179
    s_waitcnt lgkmcnt(3)
    v_mfma_f32_16x16x32_bf16 v[128:131], v[224:227], v[16:19], v[128:131]
    ds_read_b128 v[216:219], v236 offset:8512
    v_mfma_f32_16x16x32_bf16 v[136:139], v[224:227], v[48:51], v[136:139]
    v_exp_f32 v181, v181
    v_mfma_f32_16x16x32_bf16 v[144:147], v[224:227], v[80:83], v[144:147]
    v_add_f32 v247, v247, v180
    v_mfma_f32_16x16x32_bf16 v[152:155], v[224:227], v[112:115], v[152:155]
    v_exp_f32 v182, v182
    v_mfma_f32_16x16x32_bf16 v[128:131], v[228:231], v[20:23], v[128:131]
    ds_read_b128 v[220:223], v236 offset:8576
    v_mfma_f32_16x16x32_bf16 v[136:139], v[228:231], v[52:55], v[136:139]
    v_add_f32 v247, v247, v181
    v_mfma_f32_16x16x32_bf16 v[144:147], v[228:231], v[84:87], v[144:147]
    v_cvt_pk_bf16_f32 v178, v180, v181
    v_mfma_f32_16x16x32_bf16 v[152:155], v[228:231], v[116:119], v[152:155]
    s_waitcnt lgkmcnt(3)
    v_mfma_f32_16x16x32_bf16 v[128:131], v[232:235], v[24:27], v[128:131]
    v_exp_f32 v183, v183
    v_mfma_f32_16x16x32_bf16 v[136:139], v[232:235], v[56:59], v[136:139]
    ds_read_b128 v[224:227], v236 offset:8640
    v_add_f32 v247, v247, v182
    v_mfma_f32_16x16x32_bf16 v[144:147], v[232:235], v[88:91], v[144:147]
    v_add_f32 v247, v247, v183
    v_mfma_f32_16x16x32_bf16 v[152:155], v[232:235], v[120:123], v[152:155]
    v_cvt_pk_bf16_f32 v179, v182, v183
    v_mfma_f32_16x16x32_bf16 v[128:131], v[208:211], v[28:31], v[128:131]
    ds_read_b128 v[228:231], v236 offset:8704
    v_mfma_f32_16x16x32_bf16 v[136:139], v[208:211], v[60:63], v[136:139]
    v_exp_f32 v184, v184
    v_mfma_f32_16x16x32_bf16 v[144:147], v[208:211], v[92:95], v[144:147]
    v_mfma_f32_16x16x32_bf16 v[152:155], v[208:211], v[124:127], v[152:155]
    s_waitcnt lgkmcnt(3)
    v_mfma_f32_16x16x32_bf16 v[132:135], v[212:215], v[0:3], v[192:195]
    v_exp_f32 v185, v185
    v_mfma_f32_16x16x32_bf16 v[140:143], v[212:215], v[32:35], v[196:199]
    ds_read_b128 v[232:235], v236 offset:8768
    v_add_f32 v244, v244, v248
    v_mfma_f32_16x16x32_bf16 v[148:151], v[212:215], v[64:67], v[200:203]
    v_exp_f32 v186, v186
    v_mfma_f32_16x16x32_bf16 v[156:159], v[212:215], v[96:99], v[204:207]
    v_mfma_f32_16x16x32_bf16 v[132:135], v[216:219], v[4:7], v[132:135]
    ds_read_b128 v[208:211], v236 offset:8832
    v_add_f32 v248, v184, v185
    v_mfma_f32_16x16x32_bf16 v[140:143], v[216:219], v[36:39], v[140:143]
    v_cvt_pk_bf16_f32 v184, v184, v185
    v_mfma_f32_16x16x32_bf16 v[148:151], v[216:219], v[68:71], v[148:151]
    v_exp_f32 v187, v187
    v_mfma_f32_16x16x32_bf16 v[156:159], v[216:219], v[100:103], v[156:159]
    s_waitcnt lgkmcnt(3)
    v_mfma_f32_16x16x32_bf16 v[132:135], v[220:223], v[8:11], v[132:135]
    ds_read_b128 v[212:215], v236 offset:8896
    v_add_f32 v248, v248, v186
    v_mfma_f32_16x16x32_bf16 v[140:143], v[220:223], v[40:43], v[140:143]
    v_exp_f32 v188, v188
    v_mfma_f32_16x16x32_bf16 v[148:151], v[220:223], v[72:75], v[148:151]
    v_mfma_f32_16x16x32_bf16 v[156:159], v[220:223], v[104:107], v[156:159]
    v_add_f32 v248, v248, v187
    v_mfma_f32_16x16x32_bf16 v[132:135], v[224:227], v[12:15], v[132:135]
    v_cvt_pk_bf16_f32 v185, v186, v187
    v_mfma_f32_16x16x32_bf16 v[140:143], v[224:227], v[44:47], v[140:143]
    v_exp_f32 v189, v189
    v_mfma_f32_16x16x32_bf16 v[148:151], v[224:227], v[76:79], v[148:151]
    s_waitcnt vmcnt(1) lgkmcnt(0)
    s_barrier
    v_mfma_f32_16x16x32_bf16 v[156:159], v[224:227], v[108:111], v[156:159]
    ds_read_b64_tr_b16 v[216:217], v237 offset:34816
    v_mfma_f32_16x16x32_bf16 v[132:135], v[228:231], v[16:19], v[132:135]
    ds_read_b64_tr_b16 v[218:219], v237 offset:43520
    v_add_f32 v248, v248, v188
    v_mfma_f32_16x16x32_bf16 v[140:143], v[228:231], v[48:51], v[140:143]
    ds_read_b64_tr_b16 v[220:221], v238 offset:34816
    ds_read_b64_tr_b16 v[222:223], v238 offset:43520
    v_mfma_f32_16x16x32_bf16 v[148:151], v[228:231], v[80:83], v[148:151]
    v_exp_f32 v190, v190
    v_mfma_f32_16x16x32_bf16 v[156:159], v[228:231], v[112:115], v[156:159]
    v_add_f32 v248, v248, v189
    v_cvt_pk_bf16_f32 v186, v188, v189
    v_mfma_f32_16x16x32_bf16 v[132:135], v[232:235], v[20:23], v[132:135]
    ds_read_b64_tr_b16 v[224:225], v237 offset:34880
    ds_read_b64_tr_b16 v[226:227], v237 offset:43584
    v_mfma_f32_16x16x32_bf16 v[140:143], v[232:235], v[52:55], v[140:143]
    v_exp_f32 v191, v191
    v_mfma_f32_16x16x32_bf16 v[148:151], v[232:235], v[84:87], v[148:151]
    s_add_u32 m0, s23, 0
    v_add_f32 v248, v248, v190
    v_mfma_f32_16x16x32_bf16 v[156:159], v[232:235], v[116:119], v[156:159]
    buffer_load_dwordx4 v240, s[8:11], s20 offen offset:0 lds
    v_mfma_f32_16x16x32_bf16 v[132:135], v[208:211], v[24:27], v[132:135]
    v_add_f32 v248, v248, v191
    ds_read_b64_tr_b16 v[228:229], v238 offset:34880
    v_mfma_f32_16x16x32_bf16 v[140:143], v[208:211], v[56:59], v[140:143]
    ds_read_b64_tr_b16 v[230:231], v238 offset:43584
    v_cvt_pk_bf16_f32 v187, v190, v191
    v_mfma_f32_16x16x32_bf16 v[148:151], v[208:211], v[88:91], v[148:151]
    s_add_u32 m0, s23, 64
    v_max3_f32 v249, v245, v246, v247
    v_mfma_f32_16x16x32_bf16 v[156:159], v[208:211], v[120:123], v[156:159]
    buffer_load_dwordx4 v240, s[8:11], s20 offen offset:1024 lds
    v_max_f32 v249, v249, v248
    v_mfma_f32_16x16x32_bf16 v[132:135], v[212:215], v[28:31], v[132:135]
    ds_read_b64_tr_b16 v[208:209], v237 offset:34944
    ds_read_b64_tr_b16 v[210:211], v237 offset:43648
    v_mfma_f32_16x16x32_bf16 v[140:143], v[212:215], v[60:63], v[140:143]
    v_cmp_lt_f32 vcc, s25, v249
    s_add_u32 m0, s23, 128
    v_mfma_f32_16x16x32_bf16 v[148:151], v[212:215], v[92:95], v[148:151]
    buffer_load_dwordx4 v240, s[8:11], s20 offen offset:2048 lds
    v_mfma_f32_16x16x32_bf16 v[156:159], v[212:215], v[124:127], v[156:159]
    s_cbranch_vccnz K2_tramp_7
K2_ret_7:
    s_waitcnt lgkmcnt(6)
    v_mfma_f32_16x16x32_bf16 a[0:3], v[216:219], v[160:163], a[0:3]
    ds_read_b64_tr_b16 v[212:213], v238 offset:34944
    ds_read_b64_tr_b16 v[214:215], v238 offset:43648
    v_mfma_f32_16x16x32_bf16 a[4:7], v[216:219], v[168:171], a[4:7]
    s_add_u32 m0, s23, 192
    v_mfma_f32_16x16x32_bf16 a[8:11], v[216:219], v[176:179], a[8:11]
    buffer_load_dwordx4 v240, s[8:11], s20 offen offset:3072 lds
    v_mfma_f32_16x16x32_bf16 a[12:15], v[216:219], v[184:187], a[12:15]
    v_mfma_f32_16x16x32_bf16 a[16:19], v[220:223], v[160:163], a[16:19]
    ds_read_b64_tr_b16 v[216:217], v237 offset:35008
    ds_read_b64_tr_b16 v[218:219], v237 offset:43712
    v_mfma_f32_16x16x32_bf16 a[20:23], v[220:223], v[168:171], a[20:23]
    v_exp_f32 v128, v128
    v_mfma_f32_16x16x32_bf16 a[24:27], v[220:223], v[176:179], a[24:27]
    v_exp_f32 v129, v129
    v_mfma_f32_16x16x32_bf16 a[28:31], v[220:223], v[184:187], a[28:31]
    s_add_u32 m0, s23, 4352
    s_waitcnt lgkmcnt(6)
    v_mfma_f32_16x16x32_bf16 a[32:35], v[224:227], v[160:163], a[32:35]
    buffer_load_dwordx4 v240, s[8:11], s21 offen offset:0 lds
    ds_read_b64_tr_b16 v[220:221], v238 offset:35008
    v_mfma_f32_16x16x32_bf16 a[36:39], v[224:227], v[168:171], a[36:39]
    ds_read_b64_tr_b16 v[222:223], v238 offset:43712
    v_add_f32 v241, v241, v245
    v_mfma_f32_16x16x32_bf16 a[40:43], v[224:227], v[176:179], a[40:43]
    v_exp_f32 v130, v130
    v_mfma_f32_16x16x32_bf16 a[44:47], v[224:227], v[184:187], a[44:47]
    s_add_u32 m0, s23, 4416
    v_add_f32 v245, v128, v129
    v_mfma_f32_16x16x32_bf16 a[48:51], v[228:231], v[160:163], a[48:51]
    buffer_load_dwordx4 v240, s[8:11], s21 offen offset:1024 lds
    ds_read_b64_tr_b16 v[224:225], v237 offset:35072
    v_mfma_f32_16x16x32_bf16 a[52:55], v[228:231], v[168:171], a[52:55]
    ds_read_b64_tr_b16 v[226:227], v237 offset:43776
    v_cvt_pk_bf16_f32 v128, v128, v129
    v_mfma_f32_16x16x32_bf16 a[56:59], v[228:231], v[176:179], a[56:59]
    v_exp_f32 v131, v131
    v_mfma_f32_16x16x32_bf16 a[60:63], v[228:231], v[184:187], a[60:63]
    v_add_f32 v245, v245, v130
    s_waitcnt lgkmcnt(6)
    v_mfma_f32_16x16x32_bf16 a[64:67], v[208:211], v[160:163], a[64:67]
    s_add_u32 m0, s23, 4480
    ds_read_b64_tr_b16 v[228:229], v238 offset:35072
    v_mfma_f32_16x16x32_bf16 a[68:71], v[208:211], v[168:171], a[68:71]
    ds_read_b64_tr_b16 v[230:231], v238 offset:43776
    buffer_load_dwordx4 v240, s[8:11], s21 offen offset:2048 lds
    v_mfma_f32_16x16x32_bf16 a[72:75], v[208:211], v[176:179], a[72:75]
    v_exp_f32 v132, v132
    v_mfma_f32_16x16x32_bf16 a[76:79], v[208:211], v[184:187], a[76:79]
    v_add_f32 v245, v245, v131
    v_cvt_pk_bf16_f32 v129, v130, v131
    v_mfma_f32_16x16x32_bf16 a[80:83], v[212:215], v[160:163], a[80:83]
    s_add_u32 m0, s23, 4544
    ds_read_b64_tr_b16 v[208:209], v237 offset:35136
    v_mfma_f32_16x16x32_bf16 a[84:87], v[212:215], v[168:171], a[84:87]
    ds_read_b64_tr_b16 v[210:211], v237 offset:43840
    buffer_load_dwordx4 v240, s[8:11], s21 offen offset:3072 lds
    v_mfma_f32_16x16x32_bf16 a[88:91], v[212:215], v[176:179], a[88:91]
    v_exp_f32 v133, v133
    v_mfma_f32_16x16x32_bf16 a[92:95], v[212:215], v[184:187], a[92:95]
    v_add_f32 v245, v245, v132
    s_waitcnt lgkmcnt(6)
    v_mfma_f32_16x16x32_bf16 a[96:99], v[216:219], v[160:163], a[96:99]
    v_exp_f32 v134, v134
    v_mfma_f32_16x16x32_bf16 a[100:103], v[216:219], v[168:171], a[100:103]
    ds_read_b64_tr_b16 v[212:213], v238 offset:35136
    ds_read_b64_tr_b16 v[214:215], v238 offset:43840
    v_mfma_f32_16x16x32_bf16 a[104:107], v[216:219], v[176:179], a[104:107]
    s_add_u32 m0, s22, 0
    v_add_f32 v245, v245, v133
    v_mfma_f32_16x16x32_bf16 a[108:111], v[216:219], v[184:187], a[108:111]
    buffer_load_dwordx4 v239, s[4:7], s20 offen offset:0 lds
    v_cvt_pk_bf16_f32 v130, v132, v133
    v_mfma_f32_16x16x32_bf16 a[112:115], v[220:223], v[160:163], a[112:115]
    v_exp_f32 v135, v135
    v_mfma_f32_16x16x32_bf16 a[116:119], v[220:223], v[168:171], a[116:119]
    ds_read_b64_tr_b16 v[216:217], v237 offset:35200
    ds_read_b64_tr_b16 v[218:219], v237 offset:43904
    v_mfma_f32_16x16x32_bf16 a[120:123], v[220:223], v[176:179], a[120:123]
    s_add_u32 m0, s22, 32
    v_add_f32 v245, v245, v134
    v_mfma_f32_16x16x32_bf16 a[124:127], v[220:223], v[184:187], a[124:127]
    buffer_load_dwordx4 v239, s[4:7], s20 offen offset:1024 lds
    s_waitcnt lgkmcnt(6)
    v_mfma_f32_16x16x32_bf16 a[128:131], v[224:227], v[160:163], a[128:131]
    v_add_f32 v245, v245, v135
    v_cvt_pk_bf16_f32 v131, v134, v135
    v_mfma_f32_16x16x32_bf16 a[132:135], v[224:227], v[168:171], a[132:135]
    ds_read_b64_tr_b16 v[220:221], v238 offset:35200
    ds_read_b64_tr_b16 v[222:223], v238 offset:43904
    v_mfma_f32_16x16x32_bf16 a[136:139], v[224:227], v[176:179], a[136:139]
    v_exp_f32 v136, v136
    v_mfma_f32_16x16x32_bf16 a[140:143], v[224:227], v[184:187], a[140:143]
    s_add_u32 m0, s22, 64
    v_mfma_f32_16x16x32_bf16 a[144:147], v[228:231], v[160:163], a[144:147]
    buffer_load_dwordx4 v239, s[4:7], s20 offen offset:2048 lds
    ds_read_b64_tr_b16 v[224:225], v237 offset:35264
    v_mfma_f32_16x16x32_bf16 a[148:151], v[228:231], v[168:171], a[148:151]
    v_exp_f32 v137, v137
    v_mfma_f32_16x16x32_bf16 a[152:155], v[228:231], v[176:179], a[152:155]
    ds_read_b64_tr_b16 v[226:227], v237 offset:43968
    v_add_f32 v242, v242, v246
    v_mfma_f32_16x16x32_bf16 a[156:159], v[228:231], v[184:187], a[156:159]
    s_add_u32 m0, s22, 96
    s_waitcnt lgkmcnt(6)
    v_mfma_f32_16x16x32_bf16 a[160:163], v[208:211], v[160:163], a[160:163]
    v_exp_f32 v138, v138
    v_mfma_f32_16x16x32_bf16 a[164:167], v[208:211], v[168:171], a[164:167]
    buffer_load_dwordx4 v239, s[4:7], s20 offen offset:3072 lds
    ds_read_b64_tr_b16 v[228:229], v238 offset:35264
    v_mfma_f32_16x16x32_bf16 a[168:171], v[208:211], v[176:179], a[168:171]
    ds_read_b64_tr_b16 v[230:231], v238 offset:43968
    v_add_f32 v246, v136, v137
    v_mfma_f32_16x16x32_bf16 a[172:175], v[208:211], v[184:187], a[172:175]
    v_cvt_pk_bf16_f32 v136, v136, v137
    s_add_u32 m0, s22, 4224
    v_mfma_f32_16x16x32_bf16 a[176:179], v[212:215], v[160:163], a[176:179]
    v_exp_f32 v139, v139
    v_mfma_f32_16x16x32_bf16 a[180:183], v[212:215], v[168:171], a[180:183]
    buffer_load_dwordx4 v239, s[4:7], s21 offen offset:0 lds
    ds_read_b128 v[208:211], v236 offset:33792
    v_mfma_f32_16x16x32_bf16 a[184:187], v[212:215], v[176:179], a[184:187]
    v_add_f32 v246, v246, v138
    s_add_u32 m0, s22, 4256
    v_mfma_f32_16x16x32_bf16 a[188:191], v[212:215], v[184:187], a[188:191]
    buffer_load_dwordx4 v239, s[4:7], s21 offen offset:1024 lds
    s_waitcnt lgkmcnt(5)
    v_mfma_f32_16x16x32_bf16 a[192:195], v[216:219], v[160:163], a[192:195]
    v_exp_f32 v140, v140
    v_mfma_f32_16x16x32_bf16 a[196:199], v[216:219], v[168:171], a[196:199]
    v_add_f32 v246, v246, v139
    ds_read_b128 v[212:215], v236 offset:33856
    v_mfma_f32_16x16x32_bf16 a[200:203], v[216:219], v[176:179], a[200:203]
    v_cvt_pk_bf16_f32 v137, v138, v139
    v_mfma_f32_16x16x32_bf16 a[204:207], v[216:219], v[184:187], a[204:207]
    v_exp_f32 v141, v141
    v_mfma_f32_16x16x32_bf16 a[208:211], v[220:223], v[160:163], a[208:211]
    v_add_f32 v246, v246, v140
    s_add_u32 m0, s22, 4288
    v_mfma_f32_16x16x32_bf16 a[212:215], v[220:223], v[168:171], a[212:215]
    ds_read_b128 v[216:219], v236 offset:33920
    buffer_load_dwordx4 v239, s[4:7], s21 offen offset:2048 lds
    v_mfma_f32_16x16x32_bf16 a[216:219], v[220:223], v[176:179], a[216:219]
    v_exp_f32 v142, v142
    v_mfma_f32_16x16x32_bf16 a[220:223], v[220:223], v[184:187], a[220:223]
    v_add_f32 v246, v246, v141
    s_waitcnt lgkmcnt(3)
    v_mfma_f32_16x16x32_bf16 a[224:227], v[224:227], v[160:163], a[224:227]
    v_cvt_pk_bf16_f32 v138, v140, v141
    s_add_u32 m0, s22, 4320
    v_mfma_f32_16x16x32_bf16 a[228:231], v[224:227], v[168:171], a[228:231]
    ds_read_b128 v[220:223], v236 offset:33984
    buffer_load_dwordx4 v239, s[4:7], s21 offen offset:3072 lds
    v_mfma_f32_16x16x32_bf16 a[232:235], v[224:227], v[176:179], a[232:235]
    v_exp_f32 v143, v143
    v_mfma_f32_16x16x32_bf16 a[236:239], v[224:227], v[184:187], a[236:239]
    v_add_f32 v246, v246, v142
    v_add_f32 v246, v246, v143
    v_mfma_f32_16x16x32_bf16 a[240:243], v[228:231], v[160:163], a[240:243]
    ds_read_b128 v[224:227], v236 offset:34048
    v_cvt_pk_bf16_f32 v139, v142, v143
    v_mfma_f32_16x16x32_bf16 a[244:247], v[228:231], v[168:171], a[244:247]
    s_add_u32 s20, s20, 32768
    s_add_u32 s21, s21, 32768
    v_mfma_f32_16x16x32_bf16 a[248:251], v[228:231], v[176:179], a[248:251]
    s_add_u32 s75, s74, 524288
    buffer_load_dword v255, v250, s[64:67], s75 offen
    v_mfma_f32_16x16x32_bf16 a[252:255], v[228:231], v[184:187], a[252:255]
    s_waitcnt lgkmcnt(3)
    v_mfma_f32_16x16x32_bf16 v[160:163], v[208:211], v[0:3], v[192:195]
    ds_read_b128 v[228:231], v236 offset:34112
    v_mfma_f32_16x16x32_bf16 v[168:171], v[208:211], v[32:35], v[196:199]
    v_exp_f32 v144, v144
    v_mfma_f32_16x16x32_bf16 v[176:179], v[208:211], v[64:67], v[200:203]
    v_exp_f32 v145, v145
    v_mfma_f32_16x16x32_bf16 v[184:187], v[208:211], v[96:99], v[204:207]
    v_mfma_f32_16x16x32_bf16 v[160:163], v[212:215], v[4:7], v[160:163]
    ds_read_b128 v[232:235], v236 offset:34176
    v_add_f32 v243, v243, v247
    v_mfma_f32_16x16x32_bf16 v[168:171], v[212:215], v[36:39], v[168:171]
    v_exp_f32 v146, v146
    v_mfma_f32_16x16x32_bf16 v[176:179], v[212:215], v[68:71], v[176:179]
    v_mfma_f32_16x16x32_bf16 v[184:187], v[212:215], v[100:103], v[184:187]
    v_add_f32 v247, v144, v145
    s_waitcnt lgkmcnt(3)
    v_mfma_f32_16x16x32_bf16 v[160:163], v[216:219], v[8:11], v[160:163]
    ds_read_b128 v[208:211], v236 offset:34240
    v_cvt_pk_bf16_f32 v144, v144, v145
    v_mfma_f32_16x16x32_bf16 v[168:171], v[216:219], v[40:43], v[168:171]
    v_exp_f32 v147, v147
    v_mfma_f32_16x16x32_bf16 v[176:179], v[216:219], v[72:75], v[176:179]
    v_mfma_f32_16x16x32_bf16 v[184:187], v[216:219], v[104:107], v[184:187]
    v_add_f32 v247, v247, v146
    v_mfma_f32_16x16x32_bf16 v[160:163], v[220:223], v[12:15], v[160:163]
    ds_read_b128 v[212:215], v236 offset:42240
    v_mfma_f32_16x16x32_bf16 v[168:171], v[220:223], v[44:47], v[168:171]
    v_exp_f32 v148, v148
    v_mfma_f32_16x16x32_bf16 v[176:179], v[220:223], v[76:79], v[176:179]
    v_add_f32 v247, v247, v147
    v_mfma_f32_16x16x32_bf16 v[184:187], v[220:223], v[108:111], v[184:187]
    v_cvt_pk_bf16_f32 v145, v146, v147
    s_waitcnt lgkmcnt(3)
    v_mfma_f32_16x16x32_bf16 v[160:163], v[224:227], v[16:19], v[160:163]
    ds_read_b128 v[216:219], v236 offset:42304
    v_mfma_f32_16x16x32_bf16 v[168:171], v[224:227], v[48:51], v[168:171]
    v_exp_f32 v149, v149
    v_mfma_f32_16x16x32_bf16 v[176:179], v[224:227], v[80:83], v[176:179]
    v_add_f32 v247, v247, v148
    v_mfma_f32_16x16x32_bf16 v[184:187], v[224:227], v[112:115], v[184:187]
    v_exp_f32 v150, v150
    v_mfma_f32_16x16x32_bf16 v[160:163], v[228:231], v[20:23], v[160:163]
    ds_read_b128 v[220:223], v236 offset:42368
    v_mfma_f32_16x16x32_bf16 v[168:171], v[228:231], v[52:55], v[168:171]
    v_add_f32 v247, v247, v149
    v_mfma_f32_16x16x32_bf16 v[176:179], v[228:231], v[84:87], v[176:179]
    v_cvt_pk_bf16_f32 v146, v148, v149
    v_mfma_f32_16x16x32_bf16 v[184:187], v[228:231], v[116:119], v[184:187]
    s_waitcnt lgkmcnt(3)
    v_mfma_f32_16x16x32_bf16 v[160:163], v[232:235], v[24:27], v[160:163]
    v_exp_f32 v151, v151
    v_mfma_f32_16x16x32_bf16 v[168:171], v[232:235], v[56:59], v[168:171]
    ds_read_b128 v[224:227], v236 offset:42432
    v_add_f32 v247, v247, v150
    v_mfma_f32_16x16x32_bf16 v[176:179], v[232:235], v[88:91], v[176:179]
    v_add_f32 v247, v247, v151
    v_mfma_f32_16x16x32_bf16 v[184:187], v[232:235], v[120:123], v[184:187]
    v_cvt_pk_bf16_f32 v147, v150, v151
    v_mfma_f32_16x16x32_bf16 v[160:163], v[208:211], v[28:31], v[160:163]
    ds_read_b128 v[228:231], v236 offset:42496
    v_mfma_f32_16x16x32_bf16 v[168:171], v[208:211], v[60:63], v[168:171]
    v_exp_f32 v152, v152
    v_mfma_f32_16x16x32_bf16 v[176:179], v[208:211], v[92:95], v[176:179]
    v_mfma_f32_16x16x32_bf16 v[184:187], v[208:211], v[124:127], v[184:187]
    s_waitcnt lgkmcnt(3)
    v_mfma_f32_16x16x32_bf16 v[164:167], v[212:215], v[0:3], v[192:195]
    v_exp_f32 v153, v153
    v_mfma_f32_16x16x32_bf16 v[172:175], v[212:215], v[32:35], v[196:199]
    ds_read_b128 v[232:235], v236 offset:42560
    v_add_f32 v244, v244, v248
    v_mfma_f32_16x16x32_bf16 v[180:183], v[212:215], v[64:67], v[200:203]
    v_exp_f32 v154, v154
    v_mfma_f32_16x16x32_bf16 v[188:191], v[212:215], v[96:99], v[204:207]
    v_mfma_f32_16x16x32_bf16 v[164:167], v[216:219], v[4:7], v[164:167]
    ds_read_b128 v[208:211], v236 offset:42624
    v_add_f32 v248, v152, v153
    v_mfma_f32_16x16x32_bf16 v[172:175], v[216:219], v[36:39], v[172:175]
    v_cvt_pk_bf16_f32 v152, v152, v153
    v_mfma_f32_16x16x32_bf16 v[180:183], v[216:219], v[68:71], v[180:183]
    v_exp_f32 v155, v155
    v_mfma_f32_16x16x32_bf16 v[188:191], v[216:219], v[100:103], v[188:191]
    s_waitcnt lgkmcnt(3)
    v_mfma_f32_16x16x32_bf16 v[164:167], v[220:223], v[8:11], v[164:167]
    ds_read_b128 v[212:215], v236 offset:42688
    v_add_f32 v248, v248, v154
    v_mfma_f32_16x16x32_bf16 v[172:175], v[220:223], v[40:43], v[172:175]
    v_exp_f32 v156, v156
    v_mfma_f32_16x16x32_bf16 v[180:183], v[220:223], v[72:75], v[180:183]
    v_mfma_f32_16x16x32_bf16 v[188:191], v[220:223], v[104:107], v[188:191]
    v_add_f32 v248, v248, v155
    v_mfma_f32_16x16x32_bf16 v[164:167], v[224:227], v[12:15], v[164:167]
    v_cvt_pk_bf16_f32 v153, v154, v155
    v_mfma_f32_16x16x32_bf16 v[172:175], v[224:227], v[44:47], v[172:175]
    v_exp_f32 v157, v157
    v_mfma_f32_16x16x32_bf16 v[180:183], v[224:227], v[76:79], v[180:183]
    s_waitcnt vmcnt(1) lgkmcnt(0)
    s_barrier
    v_mfma_f32_16x16x32_bf16 v[188:191], v[224:227], v[108:111], v[188:191]
    ds_read_b64_tr_b16 v[216:217], v237 offset:0
    v_mfma_f32_16x16x32_bf16 v[164:167], v[228:231], v[16:19], v[164:167]
    ds_read_b64_tr_b16 v[218:219], v237 offset:8704
    v_add_f32 v248, v248, v156
    v_mfma_f32_16x16x32_bf16 v[172:175], v[228:231], v[48:51], v[172:175]
    ds_read_b64_tr_b16 v[220:221], v238 offset:0
    ds_read_b64_tr_b16 v[222:223], v238 offset:8704
    v_mfma_f32_16x16x32_bf16 v[180:183], v[228:231], v[80:83], v[180:183]
    v_exp_f32 v158, v158
    v_mfma_f32_16x16x32_bf16 v[188:191], v[228:231], v[112:115], v[188:191]
    v_add_f32 v248, v248, v157
    v_cvt_pk_bf16_f32 v154, v156, v157
    v_mfma_f32_16x16x32_bf16 v[164:167], v[232:235], v[20:23], v[164:167]
    ds_read_b64_tr_b16 v[224:225], v237 offset:64
    ds_read_b64_tr_b16 v[226:227], v237 offset:8768
    v_mfma_f32_16x16x32_bf16 v[172:175], v[232:235], v[52:55], v[172:175]
    v_exp_f32 v159, v159
    v_mfma_f32_16x16x32_bf16 v[180:183], v[232:235], v[84:87], v[180:183]
    s_add_u32 m0, s23, 34816
    v_add_f32 v248, v248, v158
    v_mfma_f32_16x16x32_bf16 v[188:191], v[232:235], v[116:119], v[188:191]
    buffer_load_dwordx4 v240, s[8:11], s20 offen offset:0 lds
    v_mfma_f32_16x16x32_bf16 v[164:167], v[208:211], v[24:27], v[164:167]
    v_add_f32 v248, v248, v159
    ds_read_b64_tr_b16 v[228:229], v238 offset:64
    v_mfma_f32_16x16x32_bf16 v[172:175], v[208:211], v[56:59], v[172:175]
    ds_read_b64_tr_b16 v[230:231], v238 offset:8768
    v_cvt_pk_bf16_f32 v155, v158, v159
    v_mfma_f32_16x16x32_bf16 v[180:183], v[208:211], v[88:91], v[180:183]
    s_add_u32 m0, s23, 34880
    v_max3_f32 v249, v245, v246, v247
    v_mfma_f32_16x16x32_bf16 v[188:191], v[208:211], v[120:123], v[188:191]
    buffer_load_dwordx4 v240, s[8:11], s20 offen offset:1024 lds
    v_max_f32 v249, v249, v248
    v_mfma_f32_16x16x32_bf16 v[164:167], v[212:215], v[28:31], v[164:167]
    ds_read_b64_tr_b16 v[208:209], v237 offset:128
    ds_read_b64_tr_b16 v[210:211], v237 offset:8832
    v_mfma_f32_16x16x32_bf16 v[172:175], v[212:215], v[60:63], v[172:175]
    v_cmp_lt_f32 vcc, s25, v249
    s_add_u32 m0, s23, 34944
    v_mfma_f32_16x16x32_bf16 v[180:183], v[212:215], v[92:95], v[180:183]
    buffer_load_dwordx4 v240, s[8:11], s20 offen offset:2048 lds
    v_mfma_f32_16x16x32_bf16 v[188:191], v[212:215], v[124:127], v[188:191]
    s_cbranch_vccnz K2_tramp_8
K2_ret_8:
    s_waitcnt lgkmcnt(6)
    v_mfma_f32_16x16x32_bf16 a[0:3], v[216:219], v[128:131], a[0:3]
    ds_read_b64_tr_b16 v[212:213], v238 offset:128
    ds_read_b64_tr_b16 v[214:215], v238 offset:8832
    v_mfma_f32_16x16x32_bf16 a[4:7], v[216:219], v[136:139], a[4:7]
    s_add_u32 m0, s23, 35008
    v_mfma_f32_16x16x32_bf16 a[8:11], v[216:219], v[144:147], a[8:11]
    buffer_load_dwordx4 v240, s[8:11], s20 offen offset:3072 lds
    v_mfma_f32_16x16x32_bf16 a[12:15], v[216:219], v[152:155], a[12:15]
    v_mfma_f32_16x16x32_bf16 a[16:19], v[220:223], v[128:131], a[16:19]
    ds_read_b64_tr_b16 v[216:217], v237 offset:192
    ds_read_b64_tr_b16 v[218:219], v237 offset:8896
    v_mfma_f32_16x16x32_bf16 a[20:23], v[220:223], v[136:139], a[20:23]
    v_exp_f32 v160, v160
    v_mfma_f32_16x16x32_bf16 a[24:27], v[220:223], v[144:147], a[24:27]
    v_exp_f32 v161, v161
    v_mfma_f32_16x16x32_bf16 a[28:31], v[220:223], v[152:155], a[28:31]
    s_add_u32 m0, s23, 39168
    s_waitcnt lgkmcnt(6)
    v_mfma_f32_16x16x32_bf16 a[32:35], v[224:227], v[128:131], a[32:35]
    buffer_load_dwordx4 v240, s[8:11], s21 offen offset:0 lds
    ds_read_b64_tr_b16 v[220:221], v238 offset:192
    v_mfma_f32_16x16x32_bf16 a[36:39], v[224:227], v[136:139], a[36:39]
    ds_read_b64_tr_b16 v[222:223], v238 offset:8896
    v_add_f32 v241, v241, v245
    v_mfma_f32_16x16x32_bf16 a[40:43], v[224:227], v[144:147], a[40:43]
    v_exp_f32 v162, v162
    v_mfma_f32_16x16x32_bf16 a[44:47], v[224:227], v[152:155], a[44:47]
    s_add_u32 m0, s23, 39232
    v_add_f32 v245, v160, v161
    v_mfma_f32_16x16x32_bf16 a[48:51], v[228:231], v[128:131], a[48:51]
    buffer_load_dwordx4 v240, s[8:11], s21 offen offset:1024 lds
    ds_read_b64_tr_b16 v[224:225], v237 offset:256
    v_mfma_f32_16x16x32_bf16 a[52:55], v[228:231], v[136:139], a[52:55]
    ds_read_b64_tr_b16 v[226:227], v237 offset:8960
    v_cvt_pk_bf16_f32 v160, v160, v161
    v_mfma_f32_16x16x32_bf16 a[56:59], v[228:231], v[144:147], a[56:59]
    v_exp_f32 v163, v163
    v_mfma_f32_16x16x32_bf16 a[60:63], v[228:231], v[152:155], a[60:63]
    v_add_f32 v245, v245, v162
    s_waitcnt lgkmcnt(6)
    v_mfma_f32_16x16x32_bf16 a[64:67], v[208:211], v[128:131], a[64:67]
    s_add_u32 m0, s23, 39296
    ds_read_b64_tr_b16 v[228:229], v238 offset:256
    v_mfma_f32_16x16x32_bf16 a[68:71], v[208:211], v[136:139], a[68:71]
    ds_read_b64_tr_b16 v[230:231], v238 offset:8960
    buffer_load_dwordx4 v240, s[8:11], s21 offen offset:2048 lds
    v_mfma_f32_16x16x32_bf16 a[72:75], v[208:211], v[144:147], a[72:75]
    v_exp_f32 v164, v164
    v_mfma_f32_16x16x32_bf16 a[76:79], v[208:211], v[152:155], a[76:79]
    v_add_f32 v245, v245, v163
    v_cvt_pk_bf16_f32 v161, v162, v163
    v_mfma_f32_16x16x32_bf16 a[80:83], v[212:215], v[128:131], a[80:83]
    s_add_u32 m0, s23, 39360
    ds_read_b64_tr_b16 v[208:209], v237 offset:320
    v_mfma_f32_16x16x32_bf16 a[84:87], v[212:215], v[136:139], a[84:87]
    ds_read_b64_tr_b16 v[210:211], v237 offset:9024
    buffer_load_dwordx4 v240, s[8:11], s21 offen offset:3072 lds
    v_mfma_f32_16x16x32_bf16 a[88:91], v[212:215], v[144:147], a[88:91]
    v_exp_f32 v165, v165
    v_mfma_f32_16x16x32_bf16 a[92:95], v[212:215], v[152:155], a[92:95]
    v_add_f32 v245, v245, v164
    s_waitcnt lgkmcnt(6)
    v_mfma_f32_16x16x32_bf16 a[96:99], v[216:219], v[128:131], a[96:99]
    v_exp_f32 v166, v166
    v_mfma_f32_16x16x32_bf16 a[100:103], v[216:219], v[136:139], a[100:103]
    ds_read_b64_tr_b16 v[212:213], v238 offset:320
    ds_read_b64_tr_b16 v[214:215], v238 offset:9024
    v_mfma_f32_16x16x32_bf16 a[104:107], v[216:219], v[144:147], a[104:107]
    s_add_u32 m0, s22, 33792
    v_add_f32 v245, v245, v165
    v_mfma_f32_16x16x32_bf16 a[108:111], v[216:219], v[152:155], a[108:111]
    buffer_load_dwordx4 v239, s[4:7], s20 offen offset:0 lds
    v_cvt_pk_bf16_f32 v162, v164, v165
    v_mfma_f32_16x16x32_bf16 a[112:115], v[220:223], v[128:131], a[112:115]
    v_exp_f32 v167, v167
    v_mfma_f32_16x16x32_bf16 a[116:119], v[220:223], v[136:139], a[116:119]
    ds_read_b64_tr_b16 v[216:217], v237 offset:384
    ds_read_b64_tr_b16 v[218:219], v237 offset:9088
    v_mfma_f32_16x16x32_bf16 a[120:123], v[220:223], v[144:147], a[120:123]
    s_add_u32 m0, s22, 33824
    v_add_f32 v245, v245, v166
    v_mfma_f32_16x16x32_bf16 a[124:127], v[220:223], v[152:155], a[124:127]
    buffer_load_dwordx4 v239, s[4:7], s20 offen offset:1024 lds
    s_waitcnt lgkmcnt(6)
    v_mfma_f32_16x16x32_bf16 a[128:131], v[224:227], v[128:131], a[128:131]
    v_add_f32 v245, v245, v167
    v_cvt_pk_bf16_f32 v163, v166, v167
    v_mfma_f32_16x16x32_bf16 a[132:135], v[224:227], v[136:139], a[132:135]
    ds_read_b64_tr_b16 v[220:221], v238 offset:384
    ds_read_b64_tr_b16 v[222:223], v238 offset:9088
    v_mfma_f32_16x16x32_bf16 a[136:139], v[224:227], v[144:147], a[136:139]
    v_exp_f32 v168, v168
    v_mfma_f32_16x16x32_bf16 a[140:143], v[224:227], v[152:155], a[140:143]
    s_add_u32 m0, s22, 33856
    v_mfma_f32_16x16x32_bf16 a[144:147], v[228:231], v[128:131], a[144:147]
    buffer_load_dwordx4 v239, s[4:7], s20 offen offset:2048 lds
    ds_read_b64_tr_b16 v[224:225], v237 offset:448
    v_mfma_f32_16x16x32_bf16 a[148:151], v[228:231], v[136:139], a[148:151]
    v_exp_f32 v169, v169
    v_mfma_f32_16x16x32_bf16 a[152:155], v[228:231], v[144:147], a[152:155]
    ds_read_b64_tr_b16 v[226:227], v237 offset:9152
    v_add_f32 v242, v242, v246
    v_mfma_f32_16x16x32_bf16 a[156:159], v[228:231], v[152:155], a[156:159]
    s_add_u32 m0, s22, 33888
    s_waitcnt lgkmcnt(6)
    v_mfma_f32_16x16x32_bf16 a[160:163], v[208:211], v[128:131], a[160:163]
    v_exp_f32 v170, v170
    v_mfma_f32_16x16x32_bf16 a[164:167], v[208:211], v[136:139], a[164:167]
    buffer_load_dwordx4 v239, s[4:7], s20 offen offset:3072 lds
    ds_read_b64_tr_b16 v[228:229], v238 offset:448
    v_mfma_f32_16x16x32_bf16 a[168:171], v[208:211], v[144:147], a[168:171]
    ds_read_b64_tr_b16 v[230:231], v238 offset:9152
    v_add_f32 v246, v168, v169
    v_mfma_f32_16x16x32_bf16 a[172:175], v[208:211], v[152:155], a[172:175]
    v_cvt_pk_bf16_f32 v168, v168, v169
    s_add_u32 m0, s22, 38016
    v_mfma_f32_16x16x32_bf16 a[176:179], v[212:215], v[128:131], a[176:179]
    v_exp_f32 v171, v171
    v_mfma_f32_16x16x32_bf16 a[180:183], v[212:215], v[136:139], a[180:183]
    buffer_load_dwordx4 v239, s[4:7], s21 offen offset:0 lds
    ds_read_b128 v[208:211], v236 offset:0
    v_mfma_f32_16x16x32_bf16 a[184:187], v[212:215], v[144:147], a[184:187]
    v_add_f32 v246, v246, v170
    s_add_u32 m0, s22, 38048
    v_mfma_f32_16x16x32_bf16 a[188:191], v[212:215], v[152:155], a[188:191]
    buffer_load_dwordx4 v239, s[4:7], s21 offen offset:1024 lds
    s_waitcnt lgkmcnt(5)
    v_mfma_f32_16x16x32_bf16 a[192:195], v[216:219], v[128:131], a[192:195]
    v_exp_f32 v172, v172
    v_mfma_f32_16x16x32_bf16 a[196:199], v[216:219], v[136:139], a[196:199]
    v_add_f32 v246, v246, v171
    ds_read_b128 v[212:215], v236 offset:64
    v_mfma_f32_16x16x32_bf16 a[200:203], v[216:219], v[144:147], a[200:203]
    v_cvt_pk_bf16_f32 v169, v170, v171
    v_mfma_f32_16x16x32_bf16 a[204:207], v[216:219], v[152:155], a[204:207]
    v_exp_f32 v173, v173
    v_mfma_f32_16x16x32_bf16 a[208:211], v[220:223], v[128:131], a[208:211]
    v_add_f32 v246, v246, v172
    s_add_u32 m0, s22, 38080
    v_mfma_f32_16x16x32_bf16 a[212:215], v[220:223], v[136:139], a[212:215]
    ds_read_b128 v[216:219], v236 offset:128
    buffer_load_dwordx4 v239, s[4:7], s21 offen offset:2048 lds
    v_mfma_f32_16x16x32_bf16 a[216:219], v[220:223], v[144:147], a[216:219]
    v_exp_f32 v174, v174
    v_mfma_f32_16x16x32_bf16 a[220:223], v[220:223], v[152:155], a[220:223]
    v_add_f32 v246, v246, v173
    s_waitcnt lgkmcnt(3)
    v_mfma_f32_16x16x32_bf16 a[224:227], v[224:227], v[128:131], a[224:227]
    v_cvt_pk_bf16_f32 v170, v172, v173
    s_add_u32 m0, s22, 38112
    v_mfma_f32_16x16x32_bf16 a[228:231], v[224:227], v[136:139], a[228:231]
    ds_read_b128 v[220:223], v236 offset:192
    buffer_load_dwordx4 v239, s[4:7], s21 offen offset:3072 lds
    v_mfma_f32_16x16x32_bf16 a[232:235], v[224:227], v[144:147], a[232:235]
    v_exp_f32 v175, v175
    v_mfma_f32_16x16x32_bf16 a[236:239], v[224:227], v[152:155], a[236:239]
    v_add_f32 v246, v246, v174
    v_add_f32 v246, v246, v175
    v_mfma_f32_16x16x32_bf16 a[240:243], v[228:231], v[128:131], a[240:243]
    ds_read_b128 v[224:227], v236 offset:256
    v_cvt_pk_bf16_f32 v171, v174, v175
    v_mfma_f32_16x16x32_bf16 a[244:247], v[228:231], v[136:139], a[244:247]
    s_add_u32 s75, s74, 786432
    s_add_u32 s20, s20, 32768
    v_mfma_f32_16x16x32_bf16 a[248:251], v[228:231], v[144:147], a[248:251]
    s_add_u32 s21, s21, 32768
    buffer_load_dword v255, v250, s[64:67], s75 offen
    v_mfma_f32_16x16x32_bf16 a[252:255], v[228:231], v[152:155], a[252:255]
    buffer_load_dword v255, v250, s[56:59], s72 offen
    s_waitcnt lgkmcnt(3)
    v_mfma_f32_16x16x32_bf16 v[128:131], v[208:211], v[0:3], v[192:195]
    ds_read_b128 v[228:231], v236 offset:320
    v_mfma_f32_16x16x32_bf16 v[136:139], v[208:211], v[32:35], v[196:199]
    v_exp_f32 v176, v176
    v_mfma_f32_16x16x32_bf16 v[144:147], v[208:211], v[64:67], v[200:203]
    v_exp_f32 v177, v177
    v_mfma_f32_16x16x32_bf16 v[152:155], v[208:211], v[96:99], v[204:207]
    v_mfma_f32_16x16x32_bf16 v[128:131], v[212:215], v[4:7], v[128:131]
    ds_read_b128 v[232:235], v236 offset:384
    v_add_f32 v243, v243, v247
    v_mfma_f32_16x16x32_bf16 v[136:139], v[212:215], v[36:39], v[136:139]
    v_exp_f32 v178, v178
    v_mfma_f32_16x16x32_bf16 v[144:147], v[212:215], v[68:71], v[144:147]
    v_mfma_f32_16x16x32_bf16 v[152:155], v[212:215], v[100:103], v[152:155]
    v_add_f32 v247, v176, v177
    s_waitcnt lgkmcnt(3)
    v_mfma_f32_16x16x32_bf16 v[128:131], v[216:219], v[8:11], v[128:131]
    ds_read_b128 v[208:211], v236 offset:448
    v_cvt_pk_bf16_f32 v176, v176, v177
    v_mfma_f32_16x16x32_bf16 v[136:139], v[216:219], v[40:43], v[136:139]
    v_exp_f32 v179, v179
    v_mfma_f32_16x16x32_bf16 v[144:147], v[216:219], v[72:75], v[144:147]
    v_mfma_f32_16x16x32_bf16 v[152:155], v[216:219], v[104:107], v[152:155]
    v_add_f32 v247, v247, v178
    v_mfma_f32_16x16x32_bf16 v[128:131], v[220:223], v[12:15], v[128:131]
    ds_read_b128 v[212:215], v236 offset:8448
    v_mfma_f32_16x16x32_bf16 v[136:139], v[220:223], v[44:47], v[136:139]
    v_exp_f32 v180, v180
    v_mfma_f32_16x16x32_bf16 v[144:147], v[220:223], v[76:79], v[144:147]
    v_add_f32 v247, v247, v179
    v_mfma_f32_16x16x32_bf16 v[152:155], v[220:223], v[108:111], v[152:155]
    v_cvt_pk_bf16_f32 v177, v178, v179
    s_waitcnt lgkmcnt(3)
    v_mfma_f32_16x16x32_bf16 v[128:131], v[224:227], v[16:19], v[128:131]
    ds_read_b128 v[216:219], v236 offset:8512
    v_mfma_f32_16x16x32_bf16 v[136:139], v[224:227], v[48:51], v[136:139]
    v_exp_f32 v181, v181
    v_mfma_f32_16x16x32_bf16 v[144:147], v[224:227], v[80:83], v[144:147]
    v_add_f32 v247, v247, v180
    v_mfma_f32_16x16x32_bf16 v[152:155], v[224:227], v[112:115], v[152:155]
    v_exp_f32 v182, v182
    v_mfma_f32_16x16x32_bf16 v[128:131], v[228:231], v[20:23], v[128:131]
    ds_read_b128 v[220:223], v236 offset:8576
    v_mfma_f32_16x16x32_bf16 v[136:139], v[228:231], v[52:55], v[136:139]
    v_add_f32 v247, v247, v181
    v_mfma_f32_16x16x32_bf16 v[144:147], v[228:231], v[84:87], v[144:147]
    v_cvt_pk_bf16_f32 v178, v180, v181
    v_mfma_f32_16x16x32_bf16 v[152:155], v[228:231], v[116:119], v[152:155]
    s_waitcnt lgkmcnt(3)
    v_mfma_f32_16x16x32_bf16 v[128:131], v[232:235], v[24:27], v[128:131]
    v_exp_f32 v183, v183
    v_mfma_f32_16x16x32_bf16 v[136:139], v[232:235], v[56:59], v[136:139]
    ds_read_b128 v[224:227], v236 offset:8640
    v_add_f32 v247, v247, v182
    v_mfma_f32_16x16x32_bf16 v[144:147], v[232:235], v[88:91], v[144:147]
    v_add_f32 v247, v247, v183
    v_mfma_f32_16x16x32_bf16 v[152:155], v[232:235], v[120:123], v[152:155]
    v_cvt_pk_bf16_f32 v179, v182, v183
    v_mfma_f32_16x16x32_bf16 v[128:131], v[208:211], v[28:31], v[128:131]
    ds_read_b128 v[228:231], v236 offset:8704
    v_mfma_f32_16x16x32_bf16 v[136:139], v[208:211], v[60:63], v[136:139]
    v_exp_f32 v184, v184
    v_mfma_f32_16x16x32_bf16 v[144:147], v[208:211], v[92:95], v[144:147]
    v_mfma_f32_16x16x32_bf16 v[152:155], v[208:211], v[124:127], v[152:155]
    s_waitcnt lgkmcnt(3)
    v_mfma_f32_16x16x32_bf16 v[132:135], v[212:215], v[0:3], v[192:195]
    v_exp_f32 v185, v185
    v_mfma_f32_16x16x32_bf16 v[140:143], v[212:215], v[32:35], v[196:199]
    ds_read_b128 v[232:235], v236 offset:8768
    v_add_f32 v244, v244, v248
    v_mfma_f32_16x16x32_bf16 v[148:151], v[212:215], v[64:67], v[200:203]
    v_exp_f32 v186, v186
    v_mfma_f32_16x16x32_bf16 v[156:159], v[212:215], v[96:99], v[204:207]
    v_mfma_f32_16x16x32_bf16 v[132:135], v[216:219], v[4:7], v[132:135]
    ds_read_b128 v[208:211], v236 offset:8832
    v_add_f32 v248, v184, v185
    v_mfma_f32_16x16x32_bf16 v[140:143], v[216:219], v[36:39], v[140:143]
    v_cvt_pk_bf16_f32 v184, v184, v185
    v_mfma_f32_16x16x32_bf16 v[148:151], v[216:219], v[68:71], v[148:151]
    v_exp_f32 v187, v187
    v_mfma_f32_16x16x32_bf16 v[156:159], v[216:219], v[100:103], v[156:159]
    s_waitcnt lgkmcnt(3)
    v_mfma_f32_16x16x32_bf16 v[132:135], v[220:223], v[8:11], v[132:135]
    ds_read_b128 v[212:215], v236 offset:8896
    v_add_f32 v248, v248, v186
    v_mfma_f32_16x16x32_bf16 v[140:143], v[220:223], v[40:43], v[140:143]
    v_exp_f32 v188, v188
    v_mfma_f32_16x16x32_bf16 v[148:151], v[220:223], v[72:75], v[148:151]
    v_mfma_f32_16x16x32_bf16 v[156:159], v[220:223], v[104:107], v[156:159]
    v_add_f32 v248, v248, v187
    v_mfma_f32_16x16x32_bf16 v[132:135], v[224:227], v[12:15], v[132:135]
    v_cvt_pk_bf16_f32 v185, v186, v187
    v_mfma_f32_16x16x32_bf16 v[140:143], v[224:227], v[44:47], v[140:143]
    v_exp_f32 v189, v189
    v_mfma_f32_16x16x32_bf16 v[148:151], v[224:227], v[76:79], v[148:151]
    s_waitcnt vmcnt(2) lgkmcnt(0)
    s_barrier
    v_mfma_f32_16x16x32_bf16 v[156:159], v[224:227], v[108:111], v[156:159]
    ds_read_b64_tr_b16 v[216:217], v237 offset:34816
    v_mfma_f32_16x16x32_bf16 v[132:135], v[228:231], v[16:19], v[132:135]
    ds_read_b64_tr_b16 v[218:219], v237 offset:43520
    v_add_f32 v248, v248, v188
    v_mfma_f32_16x16x32_bf16 v[140:143], v[228:231], v[48:51], v[140:143]
    ds_read_b64_tr_b16 v[220:221], v238 offset:34816
    ds_read_b64_tr_b16 v[222:223], v238 offset:43520
    v_mfma_f32_16x16x32_bf16 v[148:151], v[228:231], v[80:83], v[148:151]
    v_exp_f32 v190, v190
    v_mfma_f32_16x16x32_bf16 v[156:159], v[228:231], v[112:115], v[156:159]
    v_add_f32 v248, v248, v189
    v_cvt_pk_bf16_f32 v186, v188, v189
    v_mfma_f32_16x16x32_bf16 v[132:135], v[232:235], v[20:23], v[132:135]
    ds_read_b64_tr_b16 v[224:225], v237 offset:34880
    ds_read_b64_tr_b16 v[226:227], v237 offset:43584
    v_mfma_f32_16x16x32_bf16 v[140:143], v[232:235], v[52:55], v[140:143]
    v_exp_f32 v191, v191
    v_mfma_f32_16x16x32_bf16 v[148:151], v[232:235], v[84:87], v[148:151]
    s_add_u32 m0, s23, 0
    v_add_f32 v248, v248, v190
    v_mfma_f32_16x16x32_bf16 v[156:159], v[232:235], v[116:119], v[156:159]
    buffer_load_dwordx4 v240, s[8:11], s20 offen offset:0 lds
    v_mfma_f32_16x16x32_bf16 v[132:135], v[208:211], v[24:27], v[132:135]
    v_add_f32 v248, v248, v191
    ds_read_b64_tr_b16 v[228:229], v238 offset:34880
    v_mfma_f32_16x16x32_bf16 v[140:143], v[208:211], v[56:59], v[140:143]
    ds_read_b64_tr_b16 v[230:231], v238 offset:43584
    v_cvt_pk_bf16_f32 v187, v190, v191
    v_mfma_f32_16x16x32_bf16 v[148:151], v[208:211], v[88:91], v[148:151]
    s_add_u32 m0, s23, 64
    v_max3_f32 v249, v245, v246, v247
    v_mfma_f32_16x16x32_bf16 v[156:159], v[208:211], v[120:123], v[156:159]
    buffer_load_dwordx4 v240, s[8:11], s20 offen offset:1024 lds
    v_max_f32 v249, v249, v248
    v_mfma_f32_16x16x32_bf16 v[132:135], v[212:215], v[28:31], v[132:135]
    ds_read_b64_tr_b16 v[208:209], v237 offset:34944
    ds_read_b64_tr_b16 v[210:211], v237 offset:43648
    v_mfma_f32_16x16x32_bf16 v[140:143], v[212:215], v[60:63], v[140:143]
    v_cmp_lt_f32 vcc, s25, v249
    s_add_u32 m0, s23, 128
    v_mfma_f32_16x16x32_bf16 v[148:151], v[212:215], v[92:95], v[148:151]
    buffer_load_dwordx4 v240, s[8:11], s20 offen offset:2048 lds
    v_mfma_f32_16x16x32_bf16 v[156:159], v[212:215], v[124:127], v[156:159]
    s_cbranch_vccnz K2_tramp_9
K2_ret_9:
    s_waitcnt lgkmcnt(6)
    v_mfma_f32_16x16x32_bf16 a[0:3], v[216:219], v[160:163], a[0:3]
    ds_read_b64_tr_b16 v[212:213], v238 offset:34944
    ds_read_b64_tr_b16 v[214:215], v238 offset:43648
    v_mfma_f32_16x16x32_bf16 a[4:7], v[216:219], v[168:171], a[4:7]
    s_add_u32 m0, s23, 192
    v_mfma_f32_16x16x32_bf16 a[8:11], v[216:219], v[176:179], a[8:11]
    buffer_load_dwordx4 v240, s[8:11], s20 offen offset:3072 lds
    v_mfma_f32_16x16x32_bf16 a[12:15], v[216:219], v[184:187], a[12:15]
    v_mfma_f32_16x16x32_bf16 a[16:19], v[220:223], v[160:163], a[16:19]
    ds_read_b64_tr_b16 v[216:217], v237 offset:35008
    ds_read_b64_tr_b16 v[218:219], v237 offset:43712
    v_mfma_f32_16x16x32_bf16 a[20:23], v[220:223], v[168:171], a[20:23]
    v_exp_f32 v128, v128
    v_mfma_f32_16x16x32_bf16 a[24:27], v[220:223], v[176:179], a[24:27]
    v_exp_f32 v129, v129
    v_mfma_f32_16x16x32_bf16 a[28:31], v[220:223], v[184:187], a[28:31]
    s_add_u32 m0, s23, 4352
    s_waitcnt lgkmcnt(6)
    v_mfma_f32_16x16x32_bf16 a[32:35], v[224:227], v[160:163], a[32:35]
    buffer_load_dwordx4 v240, s[8:11], s21 offen offset:0 lds
    ds_read_b64_tr_b16 v[220:221], v238 offset:35008
    v_mfma_f32_16x16x32_bf16 a[36:39], v[224:227], v[168:171], a[36:39]
    ds_read_b64_tr_b16 v[222:223], v238 offset:43712
    v_add_f32 v241, v241, v245
    v_mfma_f32_16x16x32_bf16 a[40:43], v[224:227], v[176:179], a[40:43]
    v_exp_f32 v130, v130
    v_mfma_f32_16x16x32_bf16 a[44:47], v[224:227], v[184:187], a[44:47]
    s_add_u32 m0, s23, 4416
    v_add_f32 v245, v128, v129
    v_mfma_f32_16x16x32_bf16 a[48:51], v[228:231], v[160:163], a[48:51]
    buffer_load_dwordx4 v240, s[8:11], s21 offen offset:1024 lds
    ds_read_b64_tr_b16 v[224:225], v237 offset:35072
    v_mfma_f32_16x16x32_bf16 a[52:55], v[228:231], v[168:171], a[52:55]
    ds_read_b64_tr_b16 v[226:227], v237 offset:43776
    v_cvt_pk_bf16_f32 v128, v128, v129
    v_mfma_f32_16x16x32_bf16 a[56:59], v[228:231], v[176:179], a[56:59]
    v_exp_f32 v131, v131
    v_mfma_f32_16x16x32_bf16 a[60:63], v[228:231], v[184:187], a[60:63]
    v_add_f32 v245, v245, v130
    s_waitcnt lgkmcnt(6)
    v_mfma_f32_16x16x32_bf16 a[64:67], v[208:211], v[160:163], a[64:67]
    s_add_u32 m0, s23, 4480
    ds_read_b64_tr_b16 v[228:229], v238 offset:35072
    v_mfma_f32_16x16x32_bf16 a[68:71], v[208:211], v[168:171], a[68:71]
    ds_read_b64_tr_b16 v[230:231], v238 offset:43776
    buffer_load_dwordx4 v240, s[8:11], s21 offen offset:2048 lds
    v_mfma_f32_16x16x32_bf16 a[72:75], v[208:211], v[176:179], a[72:75]
    v_exp_f32 v132, v132
    v_mfma_f32_16x16x32_bf16 a[76:79], v[208:211], v[184:187], a[76:79]
    v_add_f32 v245, v245, v131
    v_cvt_pk_bf16_f32 v129, v130, v131
    v_mfma_f32_16x16x32_bf16 a[80:83], v[212:215], v[160:163], a[80:83]
    s_add_u32 m0, s23, 4544
    ds_read_b64_tr_b16 v[208:209], v237 offset:35136
    v_mfma_f32_16x16x32_bf16 a[84:87], v[212:215], v[168:171], a[84:87]
    ds_read_b64_tr_b16 v[210:211], v237 offset:43840
    buffer_load_dwordx4 v240, s[8:11], s21 offen offset:3072 lds
    v_mfma_f32_16x16x32_bf16 a[88:91], v[212:215], v[176:179], a[88:91]
    v_exp_f32 v133, v133
    v_mfma_f32_16x16x32_bf16 a[92:95], v[212:215], v[184:187], a[92:95]
    v_add_f32 v245, v245, v132
    s_waitcnt lgkmcnt(6)
    v_mfma_f32_16x16x32_bf16 a[96:99], v[216:219], v[160:163], a[96:99]
    v_exp_f32 v134, v134
    v_mfma_f32_16x16x32_bf16 a[100:103], v[216:219], v[168:171], a[100:103]
    ds_read_b64_tr_b16 v[212:213], v238 offset:35136
    ds_read_b64_tr_b16 v[214:215], v238 offset:43840
    v_mfma_f32_16x16x32_bf16 a[104:107], v[216:219], v[176:179], a[104:107]
    s_add_u32 m0, s22, 0
    v_add_f32 v245, v245, v133
    v_mfma_f32_16x16x32_bf16 a[108:111], v[216:219], v[184:187], a[108:111]
    buffer_load_dwordx4 v239, s[4:7], s20 offen offset:0 lds
    v_cvt_pk_bf16_f32 v130, v132, v133
    v_mfma_f32_16x16x32_bf16 a[112:115], v[220:223], v[160:163], a[112:115]
    v_exp_f32 v135, v135
    v_mfma_f32_16x16x32_bf16 a[116:119], v[220:223], v[168:171], a[116:119]
    ds_read_b64_tr_b16 v[216:217], v237 offset:35200
    ds_read_b64_tr_b16 v[218:219], v237 offset:43904
    v_mfma_f32_16x16x32_bf16 a[120:123], v[220:223], v[176:179], a[120:123]
    s_add_u32 m0, s22, 32
    v_add_f32 v245, v245, v134
    v_mfma_f32_16x16x32_bf16 a[124:127], v[220:223], v[184:187], a[124:127]
    buffer_load_dwordx4 v239, s[4:7], s20 offen offset:1024 lds
    s_waitcnt lgkmcnt(6)
    v_mfma_f32_16x16x32_bf16 a[128:131], v[224:227], v[160:163], a[128:131]
    v_add_f32 v245, v245, v135
    v_cvt_pk_bf16_f32 v131, v134, v135
    v_mfma_f32_16x16x32_bf16 a[132:135], v[224:227], v[168:171], a[132:135]
    ds_read_b64_tr_b16 v[220:221], v238 offset:35200
    ds_read_b64_tr_b16 v[222:223], v238 offset:43904
    v_mfma_f32_16x16x32_bf16 a[136:139], v[224:227], v[176:179], a[136:139]
    v_exp_f32 v136, v136
    v_mfma_f32_16x16x32_bf16 a[140:143], v[224:227], v[184:187], a[140:143]
    s_add_u32 m0, s22, 64
    v_mfma_f32_16x16x32_bf16 a[144:147], v[228:231], v[160:163], a[144:147]
    buffer_load_dwordx4 v239, s[4:7], s20 offen offset:2048 lds
    ds_read_b64_tr_b16 v[224:225], v237 offset:35264
    v_mfma_f32_16x16x32_bf16 a[148:151], v[228:231], v[168:171], a[148:151]
    v_exp_f32 v137, v137
    v_mfma_f32_16x16x32_bf16 a[152:155], v[228:231], v[176:179], a[152:155]
    ds_read_b64_tr_b16 v[226:227], v237 offset:43968
    v_add_f32 v242, v242, v246
    v_mfma_f32_16x16x32_bf16 a[156:159], v[228:231], v[184:187], a[156:159]
    s_add_u32 m0, s22, 96
    s_waitcnt lgkmcnt(6)
    v_mfma_f32_16x16x32_bf16 a[160:163], v[208:211], v[160:163], a[160:163]
    v_exp_f32 v138, v138
    v_mfma_f32_16x16x32_bf16 a[164:167], v[208:211], v[168:171], a[164:167]
    buffer_load_dwordx4 v239, s[4:7], s20 offen offset:3072 lds
    ds_read_b64_tr_b16 v[228:229], v238 offset:35264
    v_mfma_f32_16x16x32_bf16 a[168:171], v[208:211], v[176:179], a[168:171]
    ds_read_b64_tr_b16 v[230:231], v238 offset:43968
    v_add_f32 v246, v136, v137
    v_mfma_f32_16x16x32_bf16 a[172:175], v[208:211], v[184:187], a[172:175]
    v_cvt_pk_bf16_f32 v136, v136, v137
    s_add_u32 m0, s22, 4224
    v_mfma_f32_16x16x32_bf16 a[176:179], v[212:215], v[160:163], a[176:179]
    v_exp_f32 v139, v139
    v_mfma_f32_16x16x32_bf16 a[180:183], v[212:215], v[168:171], a[180:183]
    buffer_load_dwordx4 v239, s[4:7], s21 offen offset:0 lds
    ds_read_b128 v[208:211], v236 offset:33792
    v_mfma_f32_16x16x32_bf16 a[184:187], v[212:215], v[176:179], a[184:187]
    v_add_f32 v246, v246, v138
    s_add_u32 m0, s22, 4256
    v_mfma_f32_16x16x32_bf16 a[188:191], v[212:215], v[184:187], a[188:191]
    buffer_load_dwordx4 v239, s[4:7], s21 offen offset:1024 lds
    s_waitcnt lgkmcnt(5)
    v_mfma_f32_16x16x32_bf16 a[192:195], v[216:219], v[160:163], a[192:195]
    v_exp_f32 v140, v140
    v_mfma_f32_16x16x32_bf16 a[196:199], v[216:219], v[168:171], a[196:199]
    v_add_f32 v246, v246, v139
    ds_read_b128 v[212:215], v236 offset:33856
    v_mfma_f32_16x16x32_bf16 a[200:203], v[216:219], v[176:179], a[200:203]
    v_cvt_pk_bf16_f32 v137, v138, v139
    v_mfma_f32_16x16x32_bf16 a[204:207], v[216:219], v[184:187], a[204:207]
    v_exp_f32 v141, v141
    v_mfma_f32_16x16x32_bf16 a[208:211], v[220:223], v[160:163], a[208:211]
    v_add_f32 v246, v246, v140
    s_add_u32 m0, s22, 4288
    v_mfma_f32_16x16x32_bf16 a[212:215], v[220:223], v[168:171], a[212:215]
    ds_read_b128 v[216:219], v236 offset:33920
    buffer_load_dwordx4 v239, s[4:7], s21 offen offset:2048 lds
    v_mfma_f32_16x16x32_bf16 a[216:219], v[220:223], v[176:179], a[216:219]
    v_exp_f32 v142, v142
    v_mfma_f32_16x16x32_bf16 a[220:223], v[220:223], v[184:187], a[220:223]
    v_add_f32 v246, v246, v141
    s_waitcnt lgkmcnt(3)
    v_mfma_f32_16x16x32_bf16 a[224:227], v[224:227], v[160:163], a[224:227]
    v_cvt_pk_bf16_f32 v138, v140, v141
    s_add_u32 m0, s22, 4320
    v_mfma_f32_16x16x32_bf16 a[228:231], v[224:227], v[168:171], a[228:231]
    ds_read_b128 v[220:223], v236 offset:33984
    buffer_load_dwordx4 v239, s[4:7], s21 offen offset:3072 lds
    v_mfma_f32_16x16x32_bf16 a[232:235], v[224:227], v[176:179], a[232:235]
    v_exp_f32 v143, v143
    v_mfma_f32_16x16x32_bf16 a[236:239], v[224:227], v[184:187], a[236:239]
    v_add_f32 v246, v246, v142
    v_add_f32 v246, v246, v143
    v_mfma_f32_16x16x32_bf16 a[240:243], v[228:231], v[160:163], a[240:243]
    ds_read_b128 v[224:227], v236 offset:34048
    v_cvt_pk_bf16_f32 v139, v142, v143
    v_mfma_f32_16x16x32_bf16 a[244:247], v[228:231], v[168:171], a[244:247]
    s_add_u32 s20, s20, 32768
    s_add_u32 s21, s21, 32768
    v_mfma_f32_16x16x32_bf16 a[248:251], v[228:231], v[176:179], a[248:251]
    v_mfma_f32_16x16x32_bf16 a[252:255], v[228:231], v[184:187], a[252:255]
    s_mov_b32 s26, 12
.p2align 6
K2_loop:
    s_waitcnt lgkmcnt(3)
    v_mfma_f32_16x16x32_bf16 v[160:163], v[208:211], v[0:3], v[192:195]
    ds_read_b128 v[228:231], v236 offset:34112
    v_mfma_f32_16x16x32_bf16 v[168:171], v[208:211], v[32:35], v[196:199]
    v_exp_f32 v144, v144
    v_mfma_f32_16x16x32_bf16 v[176:179], v[208:211], v[64:67], v[200:203]
    v_exp_f32 v145, v145
    v_mfma_f32_16x16x32_bf16 v[184:187], v[208:211], v[96:99], v[204:207]
    v_mfma_f32_16x16x32_bf16 v[160:163], v[212:215], v[4:7], v[160:163]
    ds_read_b128 v[232:235], v236 offset:34176
    v_add_f32 v243, v243, v247
    v_mfma_f32_16x16x32_bf16 v[168:171], v[212:215], v[36:39], v[168:171]
    v_exp_f32 v146, v146
    v_mfma_f32_16x16x32_bf16 v[176:179], v[212:215], v[68:71], v[176:179]
    v_mfma_f32_16x16x32_bf16 v[184:187], v[212:215], v[100:103], v[184:187]
    v_add_f32 v247, v144, v145
    s_waitcnt lgkmcnt(3)
    v_mfma_f32_16x16x32_bf16 v[160:163], v[216:219], v[8:11], v[160:163]
    ds_read_b128 v[208:211], v236 offset:34240
    v_cvt_pk_bf16_f32 v144, v144, v145
    v_mfma_f32_16x16x32_bf16 v[168:171], v[216:219], v[40:43], v[168:171]
    v_exp_f32 v147, v147
    v_mfma_f32_16x16x32_bf16 v[176:179], v[216:219], v[72:75], v[176:179]
    v_mfma_f32_16x16x32_bf16 v[184:187], v[216:219], v[104:107], v[184:187]
    v_add_f32 v247, v247, v146
    v_mfma_f32_16x16x32_bf16 v[160:163], v[220:223], v[12:15], v[160:163]
    ds_read_b128 v[212:215], v236 offset:42240
    v_mfma_f32_16x16x32_bf16 v[168:171], v[220:223], v[44:47], v[168:171]
    v_exp_f32 v148, v148
    v_mfma_f32_16x16x32_bf16 v[176:179], v[220:223], v[76:79], v[176:179]
    v_add_f32 v247, v247, v147
    v_mfma_f32_16x16x32_bf16 v[184:187], v[220:223], v[108:111], v[184:187]
    v_cvt_pk_bf16_f32 v145, v146, v147
    s_waitcnt lgkmcnt(3)
    v_mfma_f32_16x16x32_bf16 v[160:163], v[224:227], v[16:19], v[160:163]
    ds_read_b128 v[216:219], v236 offset:42304
    v_mfma_f32_16x16x32_bf16 v[168:171], v[224:227], v[48:51], v[168:171]
    v_exp_f32 v149, v149
    v_mfma_f32_16x16x32_bf16 v[176:179], v[224:227], v[80:83], v[176:179]
    v_add_f32 v247, v247, v148
    v_mfma_f32_16x16x32_bf16 v[184:187], v[224:227], v[112:115], v[184:187]
    v_exp_f32 v150, v150
    v_mfma_f32_16x16x32_bf16 v[160:163], v[228:231], v[20:23], v[160:163]
    ds_read_b128 v[220:223], v236 offset:42368
    v_mfma_f32_16x16x32_bf16 v[168:171], v[228:231], v[52:55], v[168:171]
    v_add_f32 v247, v247, v149
    v_mfma_f32_16x16x32_bf16 v[176:179], v[228:231], v[84:87], v[176:179]
    v_cvt_pk_bf16_f32 v146, v148, v149
    v_mfma_f32_16x16x32_bf16 v[184:187], v[228:231], v[116:119], v[184:187]
    s_waitcnt lgkmcnt(3)
    v_mfma_f32_16x16x32_bf16 v[160:163], v[232:235], v[24:27], v[160:163]
    v_exp_f32 v151, v151
    v_mfma_f32_16x16x32_bf16 v[168:171], v[232:235], v[56:59], v[168:171]
    ds_read_b128 v[224:227], v236 offset:42432
    v_add_f32 v247, v247, v150
    v_mfma_f32_16x16x32_bf16 v[176:179], v[232:235], v[88:91], v[176:179]
    v_add_f32 v247, v247, v151
    v_mfma_f32_16x16x32_bf16 v[184:187], v[232:235], v[120:123], v[184:187]
    v_cvt_pk_bf16_f32 v147, v150, v151
    v_mfma_f32_16x16x32_bf16 v[160:163], v[208:211], v[28:31], v[160:163]
    ds_read_b128 v[228:231], v236 offset:42496
    v_mfma_f32_16x16x32_bf16 v[168:171], v[208:211], v[60:63], v[168:171]
    v_exp_f32 v152, v152
    v_mfma_f32_16x16x32_bf16 v[176:179], v[208:211], v[92:95], v[176:179]
    v_mfma_f32_16x16x32_bf16 v[184:187], v[208:211], v[124:127], v[184:187]
    s_waitcnt lgkmcnt(3)
    v_mfma_f32_16x16x32_bf16 v[164:167], v[212:215], v[0:3], v[192:195]
    v_exp_f32 v153, v153
    v_mfma_f32_16x16x32_bf16 v[172:175], v[212:215], v[32:35], v[196:199]
    ds_read_b128 v[232:235], v236 offset:42560
    v_add_f32 v244, v244, v248
    v_mfma_f32_16x16x32_bf16 v[180:183], v[212:215], v[64:67], v[200:203]
    v_exp_f32 v154, v154
    v_mfma_f32_16x16x32_bf16 v[188:191], v[212:215], v[96:99], v[204:207]
    v_mfma_f32_16x16x32_bf16 v[164:167], v[216:219], v[4:7], v[164:167]
    ds_read_b128 v[208:211], v236 offset:42624
    v_add_f32 v248, v152, v153
    v_mfma_f32_16x16x32_bf16 v[172:175], v[216:219], v[36:39], v[172:175]
    v_cvt_pk_bf16_f32 v152, v152, v153
    v_mfma_f32_16x16x32_bf16 v[180:183], v[216:219], v[68:71], v[180:183]
    v_exp_f32 v155, v155
    v_mfma_f32_16x16x32_bf16 v[188:191], v[216:219], v[100:103], v[188:191]
    s_waitcnt lgkmcnt(3)
    v_mfma_f32_16x16x32_bf16 v[164:167], v[220:223], v[8:11], v[164:167]
    ds_read_b128 v[212:215], v236 offset:42688
    v_add_f32 v248, v248, v154
    v_mfma_f32_16x16x32_bf16 v[172:175], v[220:223], v[40:43], v[172:175]
    v_exp_f32 v156, v156
    v_mfma_f32_16x16x32_bf16 v[180:183], v[220:223], v[72:75], v[180:183]
    v_mfma_f32_16x16x32_bf16 v[188:191], v[220:223], v[104:107], v[188:191]
    v_add_f32 v248, v248, v155
    v_mfma_f32_16x16x32_bf16 v[164:167], v[224:227], v[12:15], v[164:167]
    v_cvt_pk_bf16_f32 v153, v154, v155
    v_mfma_f32_16x16x32_bf16 v[172:175], v[224:227], v[44:47], v[172:175]
    v_exp_f32 v157, v157
    v_mfma_f32_16x16x32_bf16 v[180:183], v[224:227], v[76:79], v[180:183]
    s_waitcnt vmcnt(0) lgkmcnt(0)
    s_barrier
    v_mfma_f32_16x16x32_bf16 v[188:191], v[224:227], v[108:111], v[188:191]
    ds_read_b64_tr_b16 v[216:217], v237 offset:0
    v_mfma_f32_16x16x32_bf16 v[164:167], v[228:231], v[16:19], v[164:167]
    ds_read_b64_tr_b16 v[218:219], v237 offset:8704
    v_add_f32 v248, v248, v156
    v_mfma_f32_16x16x32_bf16 v[172:175], v[228:231], v[48:51], v[172:175]
    ds_read_b64_tr_b16 v[220:221], v238 offset:0
    ds_read_b64_tr_b16 v[222:223], v238 offset:8704
    v_mfma_f32_16x16x32_bf16 v[180:183], v[228:231], v[80:83], v[180:183]
    v_exp_f32 v158, v158
    v_mfma_f32_16x16x32_bf16 v[188:191], v[228:231], v[112:115], v[188:191]
    v_add_f32 v248, v248, v157
    v_cvt_pk_bf16_f32 v154, v156, v157
    v_mfma_f32_16x16x32_bf16 v[164:167], v[232:235], v[20:23], v[164:167]
    ds_read_b64_tr_b16 v[224:225], v237 offset:64
    ds_read_b64_tr_b16 v[226:227], v237 offset:8768
    v_mfma_f32_16x16x32_bf16 v[172:175], v[232:235], v[52:55], v[172:175]
    v_exp_f32 v159, v159
    v_mfma_f32_16x16x32_bf16 v[180:183], v[232:235], v[84:87], v[180:183]
    s_add_u32 m0, s23, 34816
    v_add_f32 v248, v248, v158
    v_mfma_f32_16x16x32_bf16 v[188:191], v[232:235], v[116:119], v[188:191]
    buffer_load_dwordx4 v240, s[8:11], s20 offen offset:0 lds
    v_mfma_f32_16x16x32_bf16 v[164:167], v[208:211], v[24:27], v[164:167]
    v_add_f32 v248, v248, v159
    ds_read_b64_tr_b16 v[228:229], v238 offset:64
    v_mfma_f32_16x16x32_bf16 v[172:175], v[208:211], v[56:59], v[172:175]
    ds_read_b64_tr_b16 v[230:231], v238 offset:8768
    v_cvt_pk_bf16_f32 v155, v158, v159
    v_mfma_f32_16x16x32_bf16 v[180:183], v[208:211], v[88:91], v[180:183]
    s_add_u32 m0, s23, 34880
    v_max3_f32 v249, v245, v246, v247
    v_mfma_f32_16x16x32_bf16 v[188:191], v[208:211], v[120:123], v[188:191]
    buffer_load_dwordx4 v240, s[8:11], s20 offen offset:1024 lds
    v_max_f32 v249, v249, v248
    v_mfma_f32_16x16x32_bf16 v[164:167], v[212:215], v[28:31], v[164:167]
    ds_read_b64_tr_b16 v[208:209], v237 offset:128
    ds_read_b64_tr_b16 v[210:211], v237 offset:8832
    v_mfma_f32_16x16x32_bf16 v[172:175], v[212:215], v[60:63], v[172:175]
    v_cmp_lt_f32 vcc, s25, v249
    s_add_u32 m0, s23, 34944
    v_mfma_f32_16x16x32_bf16 v[180:183], v[212:215], v[92:95], v[180:183]
    buffer_load_dwordx4 v240, s[8:11], s20 offen offset:2048 lds
    v_mfma_f32_16x16x32_bf16 v[188:191], v[212:215], v[124:127], v[188:191]
    s_cbranch_vccnz K2_tramp_0
K2_ret_0:
    s_waitcnt lgkmcnt(6)
    v_mfma_f32_16x16x32_bf16 a[0:3], v[216:219], v[128:131], a[0:3]
    ds_read_b64_tr_b16 v[212:213], v238 offset:128
    ds_read_b64_tr_b16 v[214:215], v238 offset:8832
    v_mfma_f32_16x16x32_bf16 a[4:7], v[216:219], v[136:139], a[4:7]
    s_add_u32 m0, s23, 35008
    v_mfma_f32_16x16x32_bf16 a[8:11], v[216:219], v[144:147], a[8:11]
    buffer_load_dwordx4 v240, s[8:11], s20 offen offset:3072 lds
    v_mfma_f32_16x16x32_bf16 a[12:15], v[216:219], v[152:155], a[12:15]
    v_mfma_f32_16x16x32_bf16 a[16:19], v[220:223], v[128:131], a[16:19]
    ds_read_b64_tr_b16 v[216:217], v237 offset:192
    ds_read_b64_tr_b16 v[218:219], v237 offset:8896
    v_mfma_f32_16x16x32_bf16 a[20:23], v[220:223], v[136:139], a[20:23]
    v_exp_f32 v160, v160
    v_mfma_f32_16x16x32_bf16 a[24:27], v[220:223], v[144:147], a[24:27]
    v_exp_f32 v161, v161
    v_mfma_f32_16x16x32_bf16 a[28:31], v[220:223], v[152:155], a[28:31]
    s_add_u32 m0, s23, 39168
    s_waitcnt lgkmcnt(6)
    v_mfma_f32_16x16x32_bf16 a[32:35], v[224:227], v[128:131], a[32:35]
    buffer_load_dwordx4 v240, s[8:11], s21 offen offset:0 lds
    ds_read_b64_tr_b16 v[220:221], v238 offset:192
    v_mfma_f32_16x16x32_bf16 a[36:39], v[224:227], v[136:139], a[36:39]
    ds_read_b64_tr_b16 v[222:223], v238 offset:8896
    v_add_f32 v241, v241, v245
    v_mfma_f32_16x16x32_bf16 a[40:43], v[224:227], v[144:147], a[40:43]
    v_exp_f32 v162, v162
    v_mfma_f32_16x16x32_bf16 a[44:47], v[224:227], v[152:155], a[44:47]
    s_add_u32 m0, s23, 39232
    v_add_f32 v245, v160, v161
    v_mfma_f32_16x16x32_bf16 a[48:51], v[228:231], v[128:131], a[48:51]
    buffer_load_dwordx4 v240, s[8:11], s21 offen offset:1024 lds
    ds_read_b64_tr_b16 v[224:225], v237 offset:256
    v_mfma_f32_16x16x32_bf16 a[52:55], v[228:231], v[136:139], a[52:55]
    ds_read_b64_tr_b16 v[226:227], v237 offset:8960
    v_cvt_pk_bf16_f32 v160, v160, v161
    v_mfma_f32_16x16x32_bf16 a[56:59], v[228:231], v[144:147], a[56:59]
    v_exp_f32 v163, v163
    v_mfma_f32_16x16x32_bf16 a[60:63], v[228:231], v[152:155], a[60:63]
    v_add_f32 v245, v245, v162
    s_waitcnt lgkmcnt(6)
    v_mfma_f32_16x16x32_bf16 a[64:67], v[208:211], v[128:131], a[64:67]
    s_add_u32 m0, s23, 39296
    ds_read_b64_tr_b16 v[228:229], v238 offset:256
    v_mfma_f32_16x16x32_bf16 a[68:71], v[208:211], v[136:139], a[68:71]
    ds_read_b64_tr_b16 v[230:231], v238 offset:8960
    buffer_load_dwordx4 v240, s[8:11], s21 offen offset:2048 lds
    v_mfma_f32_16x16x32_bf16 a[72:75], v[208:211], v[144:147], a[72:75]
    v_exp_f32 v164, v164
    v_mfma_f32_16x16x32_bf16 a[76:79], v[208:211], v[152:155], a[76:79]
    v_add_f32 v245, v245, v163
    v_cvt_pk_bf16_f32 v161, v162, v163
    v_mfma_f32_16x16x32_bf16 a[80:83], v[212:215], v[128:131], a[80:83]
    s_add_u32 m0, s23, 39360
    ds_read_b64_tr_b16 v[208:209], v237 offset:320
    v_mfma_f32_16x16x32_bf16 a[84:87], v[212:215], v[136:139], a[84:87]
    ds_read_b64_tr_b16 v[210:211], v237 offset:9024
    buffer_load_dwordx4 v240, s[8:11], s21 offen offset:3072 lds
    v_mfma_f32_16x16x32_bf16 a[88:91], v[212:215], v[144:147], a[88:91]
    v_exp_f32 v165, v165
    v_mfma_f32_16x16x32_bf16 a[92:95], v[212:215], v[152:155], a[92:95]
    v_add_f32 v245, v245, v164
    s_waitcnt lgkmcnt(6)
    v_mfma_f32_16x16x32_bf16 a[96:99], v[216:219], v[128:131], a[96:99]
    v_exp_f32 v166, v166
    v_mfma_f32_16x16x32_bf16 a[100:103], v[216:219], v[136:139], a[100:103]
    ds_read_b64_tr_b16 v[212:213], v238 offset:320
    ds_read_b64_tr_b16 v[214:215], v238 offset:9024
    v_mfma_f32_16x16x32_bf16 a[104:107], v[216:219], v[144:147], a[104:107]
    s_add_u32 m0, s22, 33792
    v_add_f32 v245, v245, v165
    v_mfma_f32_16x16x32_bf16 a[108:111], v[216:219], v[152:155], a[108:111]
    buffer_load_dwordx4 v239, s[4:7], s20 offen offset:0 lds
    v_cvt_pk_bf16_f32 v162, v164, v165
    v_mfma_f32_16x16x32_bf16 a[112:115], v[220:223], v[128:131], a[112:115]
    v_exp_f32 v167, v167
    v_mfma_f32_16x16x32_bf16 a[116:119], v[220:223], v[136:139], a[116:119]
    ds_read_b64_tr_b16 v[216:217], v237 offset:384
    ds_read_b64_tr_b16 v[218:219], v237 offset:9088
    v_mfma_f32_16x16x32_bf16 a[120:123], v[220:223], v[144:147], a[120:123]
    s_add_u32 m0, s22, 33824
    v_add_f32 v245, v245, v166
    v_mfma_f32_16x16x32_bf16 a[124:127], v[220:223], v[152:155], a[124:127]
    buffer_load_dwordx4 v239, s[4:7], s20 offen offset:1024 lds
    s_waitcnt lgkmcnt(6)
    v_mfma_f32_16x16x32_bf16 a[128:131], v[224:227], v[128:131], a[128:131]
    v_add_f32 v245, v245, v167
    v_cvt_pk_bf16_f32 v163, v166, v167
    v_mfma_f32_16x16x32_bf16 a[132:135], v[224:227], v[136:139], a[132:135]
    ds_read_b64_tr_b16 v[220:221], v238 offset:384
    ds_read_b64_tr_b16 v[222:223], v238 offset:9088
    v_mfma_f32_16x16x32_bf16 a[136:139], v[224:227], v[144:147], a[136:139]
    v_exp_f32 v168, v168
    v_mfma_f32_16x16x32_bf16 a[140:143], v[224:227], v[152:155], a[140:143]
    s_add_u32 m0, s22, 33856
    v_mfma_f32_16x16x32_bf16 a[144:147], v[228:231], v[128:131], a[144:147]
    buffer_load_dwordx4 v239, s[4:7], s20 offen offset:2048 lds
    ds_read_b64_tr_b16 v[224:225], v237 offset:448
    v_mfma_f32_16x16x32_bf16 a[148:151], v[228:231], v[136:139], a[148:151]
    v_exp_f32 v169, v169
    v_mfma_f32_16x16x32_bf16 a[152:155], v[228:231], v[144:147], a[152:155]
    ds_read_b64_tr_b16 v[226:227], v237 offset:9152
    v_add_f32 v242, v242, v246
    v_mfma_f32_16x16x32_bf16 a[156:159], v[228:231], v[152:155], a[156:159]
    s_add_u32 m0, s22, 33888
    s_waitcnt lgkmcnt(6)
    v_mfma_f32_16x16x32_bf16 a[160:163], v[208:211], v[128:131], a[160:163]
    v_exp_f32 v170, v170
    v_mfma_f32_16x16x32_bf16 a[164:167], v[208:211], v[136:139], a[164:167]
    buffer_load_dwordx4 v239, s[4:7], s20 offen offset:3072 lds
    ds_read_b64_tr_b16 v[228:229], v238 offset:448
    v_mfma_f32_16x16x32_bf16 a[168:171], v[208:211], v[144:147], a[168:171]
    ds_read_b64_tr_b16 v[230:231], v238 offset:9152
    v_add_f32 v246, v168, v169
    v_mfma_f32_16x16x32_bf16 a[172:175], v[208:211], v[152:155], a[172:175]
    v_cvt_pk_bf16_f32 v168, v168, v169
    s_add_u32 m0, s22, 38016
    v_mfma_f32_16x16x32_bf16 a[176:179], v[212:215], v[128:131], a[176:179]
    v_exp_f32 v171, v171
    v_mfma_f32_16x16x32_bf16 a[180:183], v[212:215], v[136:139], a[180:183]
    buffer_load_dwordx4 v239, s[4:7], s21 offen offset:0 lds
    ds_read_b128 v[208:211], v236 offset:0
    v_mfma_f32_16x16x32_bf16 a[184:187], v[212:215], v[144:147], a[184:187]
    v_add_f32 v246, v246, v170
    s_add_u32 m0, s22, 38048
    v_mfma_f32_16x16x32_bf16 a[188:191], v[212:215], v[152:155], a[188:191]
    buffer_load_dwordx4 v239, s[4:7], s21 offen offset:1024 lds
    s_waitcnt lgkmcnt(5)
    v_mfma_f32_16x16x32_bf16 a[192:195], v[216:219], v[128:131], a[192:195]
    v_exp_f32 v172, v172
    v_mfma_f32_16x16x32_bf16 a[196:199], v[216:219], v[136:139], a[196:199]
    v_add_f32 v246, v246, v171
    ds_read_b128 v[212:215], v236 offset:64
    v_mfma_f32_16x16x32_bf16 a[200:203], v[216:219], v[144:147], a[200:203]
    v_cvt_pk_bf16_f32 v169, v170, v171
    v_mfma_f32_16x16x32_bf16 a[204:207], v[216:219], v[152:155], a[204:207]
    v_exp_f32 v173, v173
    v_mfma_f32_16x16x32_bf16 a[208:211], v[220:223], v[128:131], a[208:211]
    v_add_f32 v246, v246, v172
    s_add_u32 m0, s22, 38080
    v_mfma_f32_16x16x32_bf16 a[212:215], v[220:223], v[136:139], a[212:215]
    ds_read_b128 v[216:219], v236 offset:128
    buffer_load_dwordx4 v239, s[4:7], s21 offen offset:2048 lds
    v_mfma_f32_16x16x32_bf16 a[216:219], v[220:223], v[144:147], a[216:219]
    v_exp_f32 v174, v174
    v_mfma_f32_16x16x32_bf16 a[220:223], v[220:223], v[152:155], a[220:223]
    v_add_f32 v246, v246, v173
    s_waitcnt lgkmcnt(3)
    v_mfma_f32_16x16x32_bf16 a[224:227], v[224:227], v[128:131], a[224:227]
    v_cvt_pk_bf16_f32 v170, v172, v173
    s_add_u32 m0, s22, 38112
    v_mfma_f32_16x16x32_bf16 a[228:231], v[224:227], v[136:139], a[228:231]
    ds_read_b128 v[220:223], v236 offset:192
    buffer_load_dwordx4 v239, s[4:7], s21 offen offset:3072 lds
    v_mfma_f32_16x16x32_bf16 a[232:235], v[224:227], v[144:147], a[232:235]
    v_exp_f32 v175, v175
    v_mfma_f32_16x16x32_bf16 a[236:239], v[224:227], v[152:155], a[236:239]
    v_add_f32 v246, v246, v174
    v_add_f32 v246, v246, v175
    v_mfma_f32_16x16x32_bf16 a[240:243], v[228:231], v[128:131], a[240:243]
    ds_read_b128 v[224:227], v236 offset:256
    v_cvt_pk_bf16_f32 v171, v174, v175
    v_mfma_f32_16x16x32_bf16 a[244:247], v[228:231], v[136:139], a[244:247]
    s_add_u32 s20, s20, 32768
    s_add_u32 s21, s21, 32768
    v_mfma_f32_16x16x32_bf16 a[248:251], v[228:231], v[144:147], a[248:251]
    v_mfma_f32_16x16x32_bf16 a[252:255], v[228:231], v[152:155], a[252:255]
    s_waitcnt lgkmcnt(3)
    v_mfma_f32_16x16x32_bf16 v[128:131], v[208:211], v[0:3], v[192:195]
    ds_read_b128 v[228:231], v236 offset:320
    v_mfma_f32_16x16x32_bf16 v[136:139], v[208:211], v[32:35], v[196:199]
    v_exp_f32 v176, v176
    v_mfma_f32_16x16x32_bf16 v[144:147], v[208:211], v[64:67], v[200:203]
    v_exp_f32 v177, v177
    v_mfma_f32_16x16x32_bf16 v[152:155], v[208:211], v[96:99], v[204:207]
    v_mfma_f32_16x16x32_bf16 v[128:131], v[212:215], v[4:7], v[128:131]
    ds_read_b128 v[232:235], v236 offset:384
    v_add_f32 v243, v243, v247
    v_mfma_f32_16x16x32_bf16 v[136:139], v[212:215], v[36:39], v[136:139]
    v_exp_f32 v178, v178
    v_mfma_f32_16x16x32_bf16 v[144:147], v[212:215], v[68:71], v[144:147]
    v_mfma_f32_16x16x32_bf16 v[152:155], v[212:215], v[100:103], v[152:155]
    v_add_f32 v247, v176, v177
    s_waitcnt lgkmcnt(3)
    v_mfma_f32_16x16x32_bf16 v[128:131], v[216:219], v[8:11], v[128:131]
    ds_read_b128 v[208:211], v236 offset:448
    v_cvt_pk_bf16_f32 v176, v176, v177
    v_mfma_f32_16x16x32_bf16 v[136:139], v[216:219], v[40:43], v[136:139]
    v_exp_f32 v179, v179
    v_mfma_f32_16x16x32_bf16 v[144:147], v[216:219], v[72:75], v[144:147]
    v_mfma_f32_16x16x32_bf16 v[152:155], v[216:219], v[104:107], v[152:155]
    v_add_f32 v247, v247, v178
    v_mfma_f32_16x16x32_bf16 v[128:131], v[220:223], v[12:15], v[128:131]
    ds_read_b128 v[212:215], v236 offset:8448
    v_mfma_f32_16x16x32_bf16 v[136:139], v[220:223], v[44:47], v[136:139]
    v_exp_f32 v180, v180
    v_mfma_f32_16x16x32_bf16 v[144:147], v[220:223], v[76:79], v[144:147]
    v_add_f32 v247, v247, v179
    v_mfma_f32_16x16x32_bf16 v[152:155], v[220:223], v[108:111], v[152:155]
    v_cvt_pk_bf16_f32 v177, v178, v179
    s_waitcnt lgkmcnt(3)
    v_mfma_f32_16x16x32_bf16 v[128:131], v[224:227], v[16:19], v[128:131]
    ds_read_b128 v[216:219], v236 offset:8512
    v_mfma_f32_16x16x32_bf16 v[136:139], v[224:227], v[48:51], v[136:139]
    v_exp_f32 v181, v181
    v_mfma_f32_16x16x32_bf16 v[144:147], v[224:227], v[80:83], v[144:147]
    v_add_f32 v247, v247, v180
    v_mfma_f32_16x16x32_bf16 v[152:155], v[224:227], v[112:115], v[152:155]
    v_exp_f32 v182, v182
    v_mfma_f32_16x16x32_bf16 v[128:131], v[228:231], v[20:23], v[128:131]
    ds_read_b128 v[220:223], v236 offset:8576
    v_mfma_f32_16x16x32_bf16 v[136:139], v[228:231], v[52:55], v[136:139]
    v_add_f32 v247, v247, v181
    v_mfma_f32_16x16x32_bf16 v[144:147], v[228:231], v[84:87], v[144:147]
    v_cvt_pk_bf16_f32 v178, v180, v181
    v_mfma_f32_16x16x32_bf16 v[152:155], v[228:231], v[116:119], v[152:155]
    s_waitcnt lgkmcnt(3)
    v_mfma_f32_16x16x32_bf16 v[128:131], v[232:235], v[24:27], v[128:131]
    v_exp_f32 v183, v183
    v_mfma_f32_16x16x32_bf16 v[136:139], v[232:235], v[56:59], v[136:139]
    ds_read_b128 v[224:227], v236 offset:8640
    v_add_f32 v247, v247, v182
    v_mfma_f32_16x16x32_bf16 v[144:147], v[232:235], v[88:91], v[144:147]
    v_add_f32 v247, v247, v183
    v_mfma_f32_16x16x32_bf16 v[152:155], v[232:235], v[120:123], v[152:155]
    v_cvt_pk_bf16_f32 v179, v182, v183
    v_mfma_f32_16x16x32_bf16 v[128:131], v[208:211], v[28:31], v[128:131]
    ds_read_b128 v[228:231], v236 offset:8704
    v_mfma_f32_16x16x32_bf16 v[136:139], v[208:211], v[60:63], v[136:139]
    v_exp_f32 v184, v184
    v_mfma_f32_16x16x32_bf16 v[144:147], v[208:211], v[92:95], v[144:147]
    v_mfma_f32_16x16x32_bf16 v[152:155], v[208:211], v[124:127], v[152:155]
    s_waitcnt lgkmcnt(3)
    v_mfma_f32_16x16x32_bf16 v[132:135], v[212:215], v[0:3], v[192:195]
    v_exp_f32 v185, v185
    v_mfma_f32_16x16x32_bf16 v[140:143], v[212:215], v[32:35], v[196:199]
    ds_read_b128 v[232:235], v236 offset:8768
    v_add_f32 v244, v244, v248
    v_mfma_f32_16x16x32_bf16 v[148:151], v[212:215], v[64:67], v[200:203]
    v_exp_f32 v186, v186
    v_mfma_f32_16x16x32_bf16 v[156:159], v[212:215], v[96:99], v[204:207]
    v_mfma_f32_16x16x32_bf16 v[132:135], v[216:219], v[4:7], v[132:135]
    ds_read_b128 v[208:211], v236 offset:8832
    v_add_f32 v248, v184, v185
    v_mfma_f32_16x16x32_bf16 v[140:143], v[216:219], v[36:39], v[140:143]
    v_cvt_pk_bf16_f32 v184, v184, v185
    v_mfma_f32_16x16x32_bf16 v[148:151], v[216:219], v[68:71], v[148:151]
    v_exp_f32 v187, v187
    v_mfma_f32_16x16x32_bf16 v[156:159], v[216:219], v[100:103], v[156:159]
    s_waitcnt lgkmcnt(3)
    v_mfma_f32_16x16x32_bf16 v[132:135], v[220:223], v[8:11], v[132:135]
    ds_read_b128 v[212:215], v236 offset:8896
    v_add_f32 v248, v248, v186
    v_mfma_f32_16x16x32_bf16 v[140:143], v[220:223], v[40:43], v[140:143]
    v_exp_f32 v188, v188
    v_mfma_f32_16x16x32_bf16 v[148:151], v[220:223], v[72:75], v[148:151]
    v_mfma_f32_16x16x32_bf16 v[156:159], v[220:223], v[104:107], v[156:159]
    v_add_f32 v248, v248, v187
    v_mfma_f32_16x16x32_bf16 v[132:135], v[224:227], v[12:15], v[132:135]
    v_cvt_pk_bf16_f32 v185, v186, v187
    v_mfma_f32_16x16x32_bf16 v[140:143], v[224:227], v[44:47], v[140:143]
    v_exp_f32 v189, v189
    v_mfma_f32_16x16x32_bf16 v[148:151], v[224:227], v[76:79], v[148:151]
    s_waitcnt vmcnt(0) lgkmcnt(0)
    s_barrier
    v_mfma_f32_16x16x32_bf16 v[156:159], v[224:227], v[108:111], v[156:159]
    ds_read_b64_tr_b16 v[216:217], v237 offset:34816
    v_mfma_f32_16x16x32_bf16 v[132:135], v[228:231], v[16:19], v[132:135]
    ds_read_b64_tr_b16 v[218:219], v237 offset:43520
    v_add_f32 v248, v248, v188
    v_mfma_f32_16x16x32_bf16 v[140:143], v[228:231], v[48:51], v[140:143]
    ds_read_b64_tr_b16 v[220:221], v238 offset:34816
    ds_read_b64_tr_b16 v[222:223], v238 offset:43520
    v_mfma_f32_16x16x32_bf16 v[148:151], v[228:231], v[80:83], v[148:151]
    v_exp_f32 v190, v190
    v_mfma_f32_16x16x32_bf16 v[156:159], v[228:231], v[112:115], v[156:159]
    v_add_f32 v248, v248, v189
    v_cvt_pk_bf16_f32 v186, v188, v189
    v_mfma_f32_16x16x32_bf16 v[132:135], v[232:235], v[20:23], v[132:135]
    ds_read_b64_tr_b16 v[224:225], v237 offset:34880
    ds_read_b64_tr_b16 v[226:227], v237 offset:43584
    v_mfma_f32_16x16x32_bf16 v[140:143], v[232:235], v[52:55], v[140:143]
    v_exp_f32 v191, v191
    v_mfma_f32_16x16x32_bf16 v[148:151], v[232:235], v[84:87], v[148:151]
    s_add_u32 m0, s23, 0
    v_add_f32 v248, v248, v190
    v_mfma_f32_16x16x32_bf16 v[156:159], v[232:235], v[116:119], v[156:159]
    buffer_load_dwordx4 v240, s[8:11], s20 offen offset:0 lds
    v_mfma_f32_16x16x32_bf16 v[132:135], v[208:211], v[24:27], v[132:135]
    v_add_f32 v248, v248, v191
    ds_read_b64_tr_b16 v[228:229], v238 offset:34880
    v_mfma_f32_16x16x32_bf16 v[140:143], v[208:211], v[56:59], v[140:143]
    ds_read_b64_tr_b16 v[230:231], v238 offset:43584
    v_cvt_pk_bf16_f32 v187, v190, v191
    v_mfma_f32_16x16x32_bf16 v[148:151], v[208:211], v[88:91], v[148:151]
    s_add_u32 m0, s23, 64
    v_max3_f32 v249, v245, v246, v247
    v_mfma_f32_16x16x32_bf16 v[156:159], v[208:211], v[120:123], v[156:159]
    buffer_load_dwordx4 v240, s[8:11], s20 offen offset:1024 lds
    v_max_f32 v249, v249, v248
    v_mfma_f32_16x16x32_bf16 v[132:135], v[212:215], v[28:31], v[132:135]
    ds_read_b64_tr_b16 v[208:209], v237 offset:34944
    ds_read_b64_tr_b16 v[210:211], v237 offset:43648
    v_mfma_f32_16x16x32_bf16 v[140:143], v[212:215], v[60:63], v[140:143]
    v_cmp_lt_f32 vcc, s25, v249
    s_add_u32 m0, s23, 128
    v_mfma_f32_16x16x32_bf16 v[148:151], v[212:215], v[92:95], v[148:151]
    buffer_load_dwordx4 v240, s[8:11], s20 offen offset:2048 lds
    v_mfma_f32_16x16x32_bf16 v[156:159], v[212:215], v[124:127], v[156:159]
    s_cbranch_vccnz K2_tramp_1
K2_ret_1:
    s_waitcnt lgkmcnt(6)
    v_mfma_f32_16x16x32_bf16 a[0:3], v[216:219], v[160:163], a[0:3]
    ds_read_b64_tr_b16 v[212:213], v238 offset:34944
    ds_read_b64_tr_b16 v[214:215], v238 offset:43648
    v_mfma_f32_16x16x32_bf16 a[4:7], v[216:219], v[168:171], a[4:7]
    s_add_u32 m0, s23, 192
    v_mfma_f32_16x16x32_bf16 a[8:11], v[216:219], v[176:179], a[8:11]
    buffer_load_dwordx4 v240, s[8:11], s20 offen offset:3072 lds
    v_mfma_f32_16x16x32_bf16 a[12:15], v[216:219], v[184:187], a[12:15]
    v_mfma_f32_16x16x32_bf16 a[16:19], v[220:223], v[160:163], a[16:19]
    ds_read_b64_tr_b16 v[216:217], v237 offset:35008
    ds_read_b64_tr_b16 v[218:219], v237 offset:43712
    v_mfma_f32_16x16x32_bf16 a[20:23], v[220:223], v[168:171], a[20:23]
    v_exp_f32 v128, v128
    v_mfma_f32_16x16x32_bf16 a[24:27], v[220:223], v[176:179], a[24:27]
    v_exp_f32 v129, v129
    v_mfma_f32_16x16x32_bf16 a[28:31], v[220:223], v[184:187], a[28:31]
    s_add_u32 m0, s23, 4352
    s_waitcnt lgkmcnt(6)
    v_mfma_f32_16x16x32_bf16 a[32:35], v[224:227], v[160:163], a[32:35]
    buffer_load_dwordx4 v240, s[8:11], s21 offen offset:0 lds
    ds_read_b64_tr_b16 v[220:221], v238 offset:35008
    v_mfma_f32_16x16x32_bf16 a[36:39], v[224:227], v[168:171], a[36:39]
    ds_read_b64_tr_b16 v[222:223], v238 offset:43712
    v_add_f32 v241, v241, v245
    v_mfma_f32_16x16x32_bf16 a[40:43], v[224:227], v[176:179], a[40:43]
    v_exp_f32 v130, v130
    v_mfma_f32_16x16x32_bf16 a[44:47], v[224:227], v[184:187], a[44:47]
    s_add_u32 m0, s23, 4416
    v_add_f32 v245, v128, v129
    v_mfma_f32_16x16x32_bf16 a[48:51], v[228:231], v[160:163], a[48:51]
    buffer_load_dwordx4 v240, s[8:11], s21 offen offset:1024 lds
    ds_read_b64_tr_b16 v[224:225], v237 offset:35072
    v_mfma_f32_16x16x32_bf16 a[52:55], v[228:231], v[168:171], a[52:55]
    ds_read_b64_tr_b16 v[226:227], v237 offset:43776
    v_cvt_pk_bf16_f32 v128, v128, v129
    v_mfma_f32_16x16x32_bf16 a[56:59], v[228:231], v[176:179], a[56:59]
    v_exp_f32 v131, v131
    v_mfma_f32_16x16x32_bf16 a[60:63], v[228:231], v[184:187], a[60:63]
    v_add_f32 v245, v245, v130
    s_waitcnt lgkmcnt(6)
    v_mfma_f32_16x16x32_bf16 a[64:67], v[208:211], v[160:163], a[64:67]
    s_add_u32 m0, s23, 4480
    ds_read_b64_tr_b16 v[228:229], v238 offset:35072
    v_mfma_f32_16x16x32_bf16 a[68:71], v[208:211], v[168:171], a[68:71]
    ds_read_b64_tr_b16 v[230:231], v238 offset:43776
    buffer_load_dwordx4 v240, s[8:11], s21 offen offset:2048 lds
    v_mfma_f32_16x16x32_bf16 a[72:75], v[208:211], v[176:179], a[72:75]
    v_exp_f32 v132, v132
    v_mfma_f32_16x16x32_bf16 a[76:79], v[208:211], v[184:187], a[76:79]
    v_add_f32 v245, v245, v131
    v_cvt_pk_bf16_f32 v129, v130, v131
    v_mfma_f32_16x16x32_bf16 a[80:83], v[212:215], v[160:163], a[80:83]
    s_add_u32 m0, s23, 4544
    ds_read_b64_tr_b16 v[208:209], v237 offset:35136
    v_mfma_f32_16x16x32_bf16 a[84:87], v[212:215], v[168:171], a[84:87]
    ds_read_b64_tr_b16 v[210:211], v237 offset:43840
    buffer_load_dwordx4 v240, s[8:11], s21 offen offset:3072 lds
    v_mfma_f32_16x16x32_bf16 a[88:91], v[212:215], v[176:179], a[88:91]
    v_exp_f32 v133, v133
    v_mfma_f32_16x16x32_bf16 a[92:95], v[212:215], v[184:187], a[92:95]
    v_add_f32 v245, v245, v132
    s_waitcnt lgkmcnt(6)
    v_mfma_f32_16x16x32_bf16 a[96:99], v[216:219], v[160:163], a[96:99]
    v_exp_f32 v134, v134
    v_mfma_f32_16x16x32_bf16 a[100:103], v[216:219], v[168:171], a[100:103]
    ds_read_b64_tr_b16 v[212:213], v238 offset:35136
    ds_read_b64_tr_b16 v[214:215], v238 offset:43840
    v_mfma_f32_16x16x32_bf16 a[104:107], v[216:219], v[176:179], a[104:107]
    s_add_u32 m0, s22, 0
    v_add_f32 v245, v245, v133
    v_mfma_f32_16x16x32_bf16 a[108:111], v[216:219], v[184:187], a[108:111]
    buffer_load_dwordx4 v239, s[4:7], s20 offen offset:0 lds
    v_cvt_pk_bf16_f32 v130, v132, v133
    v_mfma_f32_16x16x32_bf16 a[112:115], v[220:223], v[160:163], a[112:115]
    v_exp_f32 v135, v135
    v_mfma_f32_16x16x32_bf16 a[116:119], v[220:223], v[168:171], a[116:119]
    ds_read_b64_tr_b16 v[216:217], v237 offset:35200
    ds_read_b64_tr_b16 v[218:219], v237 offset:43904
    v_mfma_f32_16x16x32_bf16 a[120:123], v[220:223], v[176:179], a[120:123]
    s_add_u32 m0, s22, 32
    v_add_f32 v245, v245, v134
    v_mfma_f32_16x16x32_bf16 a[124:127], v[220:223], v[184:187], a[124:127]
    buffer_load_dwordx4 v239, s[4:7], s20 offen offset:1024 lds
    s_waitcnt lgkmcnt(6)
    v_mfma_f32_16x16x32_bf16 a[128:131], v[224:227], v[160:163], a[128:131]
    v_add_f32 v245, v245, v135
    v_cvt_pk_bf16_f32 v131, v134, v135
    v_mfma_f32_16x16x32_bf16 a[132:135], v[224:227], v[168:171], a[132:135]
    ds_read_b64_tr_b16 v[220:221], v238 offset:35200
    ds_read_b64_tr_b16 v[222:223], v238 offset:43904
    v_mfma_f32_16x16x32_bf16 a[136:139], v[224:227], v[176:179], a[136:139]
    v_exp_f32 v136, v136
    v_mfma_f32_16x16x32_bf16 a[140:143], v[224:227], v[184:187], a[140:143]
    s_add_u32 m0, s22, 64
    v_mfma_f32_16x16x32_bf16 a[144:147], v[228:231], v[160:163], a[144:147]
    buffer_load_dwordx4 v239, s[4:7], s20 offen offset:2048 lds
    ds_read_b64_tr_b16 v[224:225], v237 offset:35264
    v_mfma_f32_16x16x32_bf16 a[148:151], v[228:231], v[168:171], a[148:151]
    v_exp_f32 v137, v137
    v_mfma_f32_16x16x32_bf16 a[152:155], v[228:231], v[176:179], a[152:155]
    ds_read_b64_tr_b16 v[226:227], v237 offset:43968
    v_add_f32 v242, v242, v246
    v_mfma_f32_16x16x32_bf16 a[156:159], v[228:231], v[184:187], a[156:159]
    s_add_u32 m0, s22, 96
    s_waitcnt lgkmcnt(6)
    v_mfma_f32_16x16x32_bf16 a[160:163], v[208:211], v[160:163], a[160:163]
    v_exp_f32 v138, v138
    v_mfma_f32_16x16x32_bf16 a[164:167], v[208:211], v[168:171], a[164:167]
    buffer_load_dwordx4 v239, s[4:7], s20 offen offset:3072 lds
    ds_read_b64_tr_b16 v[228:229], v238 offset:35264
    v_mfma_f32_16x16x32_bf16 a[168:171], v[208:211], v[176:179], a[168:171]
    ds_read_b64_tr_b16 v[230:231], v238 offset:43968
    v_add_f32 v246, v136, v137
    v_mfma_f32_16x16x32_bf16 a[172:175], v[208:211], v[184:187], a[172:175]
    v_cvt_pk_bf16_f32 v136, v136, v137
    s_add_u32 m0, s22, 4224
    v_mfma_f32_16x16x32_bf16 a[176:179], v[212:215], v[160:163], a[176:179]
    v_exp_f32 v139, v139
    v_mfma_f32_16x16x32_bf16 a[180:183], v[212:215], v[168:171], a[180:183]
    buffer_load_dwordx4 v239, s[4:7], s21 offen offset:0 lds
    ds_read_b128 v[208:211], v236 offset:33792
    v_mfma_f32_16x16x32_bf16 a[184:187], v[212:215], v[176:179], a[184:187]
    v_add_f32 v246, v246, v138
    s_add_u32 m0, s22, 4256
    v_mfma_f32_16x16x32_bf16 a[188:191], v[212:215], v[184:187], a[188:191]
    buffer_load_dwordx4 v239, s[4:7], s21 offen offset:1024 lds
    s_waitcnt lgkmcnt(5)
    v_mfma_f32_16x16x32_bf16 a[192:195], v[216:219], v[160:163], a[192:195]
    v_exp_f32 v140, v140
    v_mfma_f32_16x16x32_bf16 a[196:199], v[216:219], v[168:171], a[196:199]
    v_add_f32 v246, v246, v139
    ds_read_b128 v[212:215], v236 offset:33856
    v_mfma_f32_16x16x32_bf16 a[200:203], v[216:219], v[176:179], a[200:203]
    v_cvt_pk_bf16_f32 v137, v138, v139
    v_mfma_f32_16x16x32_bf16 a[204:207], v[216:219], v[184:187], a[204:207]
    v_exp_f32 v141, v141
    v_mfma_f32_16x16x32_bf16 a[208:211], v[220:223], v[160:163], a[208:211]
    v_add_f32 v246, v246, v140
    s_add_u32 m0, s22, 4288
    v_mfma_f32_16x16x32_bf16 a[212:215], v[220:223], v[168:171], a[212:215]
    ds_read_b128 v[216:219], v236 offset:33920
    buffer_load_dwordx4 v239, s[4:7], s21 offen offset:2048 lds
    v_mfma_f32_16x16x32_bf16 a[216:219], v[220:223], v[176:179], a[216:219]
    v_exp_f32 v142, v142
    v_mfma_f32_16x16x32_bf16 a[220:223], v[220:223], v[184:187], a[220:223]
    v_add_f32 v246, v246, v141
    s_waitcnt lgkmcnt(3)
    v_mfma_f32_16x16x32_bf16 a[224:227], v[224:227], v[160:163], a[224:227]
    v_cvt_pk_bf16_f32 v138, v140, v141
    s_add_u32 m0, s22, 4320
    v_mfma_f32_16x16x32_bf16 a[228:231], v[224:227], v[168:171], a[228:231]
    ds_read_b128 v[220:223], v236 offset:33984
    buffer_load_dwordx4 v239, s[4:7], s21 offen offset:3072 lds
    v_mfma_f32_16x16x32_bf16 a[232:235], v[224:227], v[176:179], a[232:235]
    v_exp_f32 v143, v143
    v_mfma_f32_16x16x32_bf16 a[236:239], v[224:227], v[184:187], a[236:239]
    v_add_f32 v246, v246, v142
    v_add_f32 v246, v246, v143
    v_mfma_f32_16x16x32_bf16 a[240:243], v[228:231], v[160:163], a[240:243]
    ds_read_b128 v[224:227], v236 offset:34048
    v_cvt_pk_bf16_f32 v139, v142, v143
    v_mfma_f32_16x16x32_bf16 a[244:247], v[228:231], v[168:171], a[244:247]
    s_add_u32 s20, s20, 32768
    s_add_u32 s21, s21, 32768
    v_mfma_f32_16x16x32_bf16 a[248:251], v[228:231], v[176:179], a[248:251]
    v_mfma_f32_16x16x32_bf16 a[252:255], v[228:231], v[184:187], a[252:255]
    s_sub_u32 s26, s26, 1
    s_cmp_lg_u32 s26, 0
    s_cbranch_scc1 K2_loop
    s_mov_b32 s60, s92
    s_mov_b32 s61, s93
    s_mov_b32 s62, 0x188000
    s_mov_b32 s63, 0x20000
    s_mov_b32 s64, s94
    s_mov_b32 s65, s95
    s_mov_b32 s66, 0x188000
    s_mov_b32 s67, 0x20000
    s_lshl_b32 s49, s27, 12
    s_mul_i32 s50, s41, 14336
    s_add_u32 s50, s50, s49
    s_mul_i32 s51, s41, 50176
    s_add_u32 s51, s51, s49
    s_waitcnt lgkmcnt(3)
    v_mfma_f32_16x16x32_bf16 v[160:163], v[208:211], v[0:3], v[192:195]
    ds_read_b128 v[228:231], v236 offset:34112
    v_mfma_f32_16x16x32_bf16 v[168:171], v[208:211], v[32:35], v[196:199]
    v_exp_f32 v144, v144
    v_mfma_f32_16x16x32_bf16 v[176:179], v[208:211], v[64:67], v[200:203]
    v_exp_f32 v145, v145
    v_mfma_f32_16x16x32_bf16 v[184:187], v[208:211], v[96:99], v[204:207]
    v_mfma_f32_16x16x32_bf16 v[160:163], v[212:215], v[4:7], v[160:163]
    ds_read_b128 v[232:235], v236 offset:34176
    v_add_f32 v243, v243, v247
    v_mfma_f32_16x16x32_bf16 v[168:171], v[212:215], v[36:39], v[168:171]
    v_exp_f32 v146, v146
    v_mfma_f32_16x16x32_bf16 v[176:179], v[212:215], v[68:71], v[176:179]
    v_mfma_f32_16x16x32_bf16 v[184:187], v[212:215], v[100:103], v[184:187]
    v_add_f32 v247, v144, v145
    s_waitcnt lgkmcnt(3)
    v_mfma_f32_16x16x32_bf16 v[160:163], v[216:219], v[8:11], v[160:163]
    ds_read_b128 v[208:211], v236 offset:34240
    v_cvt_pk_bf16_f32 v144, v144, v145
    v_mfma_f32_16x16x32_bf16 v[168:171], v[216:219], v[40:43], v[168:171]
    v_exp_f32 v147, v147
    v_mfma_f32_16x16x32_bf16 v[176:179], v[216:219], v[72:75], v[176:179]
    v_mfma_f32_16x16x32_bf16 v[184:187], v[216:219], v[104:107], v[184:187]
    v_add_f32 v247, v247, v146
    v_mfma_f32_16x16x32_bf16 v[160:163], v[220:223], v[12:15], v[160:163]
    ds_read_b128 v[212:215], v236 offset:42240
    v_mfma_f32_16x16x32_bf16 v[168:171], v[220:223], v[44:47], v[168:171]
    v_exp_f32 v148, v148
    v_mfma_f32_16x16x32_bf16 v[176:179], v[220:223], v[76:79], v[176:179]
    v_add_f32 v247, v247, v147
    v_mfma_f32_16x16x32_bf16 v[184:187], v[220:223], v[108:111], v[184:187]
    v_cvt_pk_bf16_f32 v145, v146, v147
    s_waitcnt lgkmcnt(3)
    v_mfma_f32_16x16x32_bf16 v[160:163], v[224:227], v[16:19], v[160:163]
    ds_read_b128 v[216:219], v236 offset:42304
    v_mfma_f32_16x16x32_bf16 v[168:171], v[224:227], v[48:51], v[168:171]
    v_exp_f32 v149, v149
    v_mfma_f32_16x16x32_bf16 v[176:179], v[224:227], v[80:83], v[176:179]
    v_add_f32 v247, v247, v148
    v_mfma_f32_16x16x32_bf16 v[184:187], v[224:227], v[112:115], v[184:187]
    v_exp_f32 v150, v150
    v_mfma_f32_16x16x32_bf16 v[160:163], v[228:231], v[20:23], v[160:163]
    ds_read_b128 v[220:223], v236 offset:42368
    v_mfma_f32_16x16x32_bf16 v[168:171], v[228:231], v[52:55], v[168:171]
    v_add_f32 v247, v247, v149
    v_mfma_f32_16x16x32_bf16 v[176:179], v[228:231], v[84:87], v[176:179]
    v_cvt_pk_bf16_f32 v146, v148, v149
    v_mfma_f32_16x16x32_bf16 v[184:187], v[228:231], v[116:119], v[184:187]
    s_waitcnt lgkmcnt(3)
    v_mfma_f32_16x16x32_bf16 v[160:163], v[232:235], v[24:27], v[160:163]
    v_exp_f32 v151, v151
    v_mfma_f32_16x16x32_bf16 v[168:171], v[232:235], v[56:59], v[168:171]
    ds_read_b128 v[224:227], v236 offset:42432
    v_add_f32 v247, v247, v150
    v_mfma_f32_16x16x32_bf16 v[176:179], v[232:235], v[88:91], v[176:179]
    v_add_f32 v247, v247, v151
    v_mfma_f32_16x16x32_bf16 v[184:187], v[232:235], v[120:123], v[184:187]
    v_cvt_pk_bf16_f32 v147, v150, v151
    v_mfma_f32_16x16x32_bf16 v[160:163], v[208:211], v[28:31], v[160:163]
    ds_read_b128 v[228:231], v236 offset:42496
    v_mfma_f32_16x16x32_bf16 v[168:171], v[208:211], v[60:63], v[168:171]
    v_exp_f32 v152, v152
    v_mfma_f32_16x16x32_bf16 v[176:179], v[208:211], v[92:95], v[176:179]
    v_mfma_f32_16x16x32_bf16 v[184:187], v[208:211], v[124:127], v[184:187]
    s_waitcnt lgkmcnt(3)
    v_mfma_f32_16x16x32_bf16 v[164:167], v[212:215], v[0:3], v[192:195]
    v_exp_f32 v153, v153
    v_mfma_f32_16x16x32_bf16 v[172:175], v[212:215], v[32:35], v[196:199]
    ds_read_b128 v[232:235], v236 offset:42560
    v_add_f32 v244, v244, v248
    v_mfma_f32_16x16x32_bf16 v[180:183], v[212:215], v[64:67], v[200:203]
    v_exp_f32 v154, v154
    v_mfma_f32_16x16x32_bf16 v[188:191], v[212:215], v[96:99], v[204:207]
    v_mfma_f32_16x16x32_bf16 v[164:167], v[216:219], v[4:7], v[164:167]
    ds_read_b128 v[208:211], v236 offset:42624
    v_add_f32 v248, v152, v153
    v_mfma_f32_16x16x32_bf16 v[172:175], v[216:219], v[36:39], v[172:175]
    v_cvt_pk_bf16_f32 v152, v152, v153
    v_mfma_f32_16x16x32_bf16 v[180:183], v[216:219], v[68:71], v[180:183]
    v_exp_f32 v155, v155
    v_mfma_f32_16x16x32_bf16 v[188:191], v[216:219], v[100:103], v[188:191]
    s_waitcnt lgkmcnt(3)
    v_mfma_f32_16x16x32_bf16 v[164:167], v[220:223], v[8:11], v[164:167]
    ds_read_b128 v[212:215], v236 offset:42688
    v_add_f32 v248, v248, v154
    v_mfma_f32_16x16x32_bf16 v[172:175], v[220:223], v[40:43], v[172:175]
    v_exp_f32 v156, v156
    v_mfma_f32_16x16x32_bf16 v[180:183], v[220:223], v[72:75], v[180:183]
    v_mfma_f32_16x16x32_bf16 v[188:191], v[220:223], v[104:107], v[188:191]
    v_add_f32 v248, v248, v155
    v_mfma_f32_16x16x32_bf16 v[164:167], v[224:227], v[12:15], v[164:167]
    v_cvt_pk_bf16_f32 v153, v154, v155
    v_mfma_f32_16x16x32_bf16 v[172:175], v[224:227], v[44:47], v[172:175]
    v_exp_f32 v157, v157
    v_mfma_f32_16x16x32_bf16 v[180:183], v[224:227], v[76:79], v[180:183]
    s_waitcnt vmcnt(0) lgkmcnt(0)
    s_barrier
    v_mfma_f32_16x16x32_bf16 v[188:191], v[224:227], v[108:111], v[188:191]
    ds_read_b64_tr_b16 v[216:217], v237 offset:0
    v_mfma_f32_16x16x32_bf16 v[164:167], v[228:231], v[16:19], v[164:167]
    ds_read_b64_tr_b16 v[218:219], v237 offset:8704
    v_add_f32 v248, v248, v156
    v_mfma_f32_16x16x32_bf16 v[172:175], v[228:231], v[48:51], v[172:175]
    ds_read_b64_tr_b16 v[220:221], v238 offset:0
    ds_read_b64_tr_b16 v[222:223], v238 offset:8704
    v_mfma_f32_16x16x32_bf16 v[180:183], v[228:231], v[80:83], v[180:183]
    v_exp_f32 v158, v158
    v_mfma_f32_16x16x32_bf16 v[188:191], v[228:231], v[112:115], v[188:191]
    v_add_f32 v248, v248, v157
    v_cvt_pk_bf16_f32 v154, v156, v157
    v_mfma_f32_16x16x32_bf16 v[164:167], v[232:235], v[20:23], v[164:167]
    ds_read_b64_tr_b16 v[224:225], v237 offset:64
    ds_read_b64_tr_b16 v[226:227], v237 offset:8768
    v_mfma_f32_16x16x32_bf16 v[172:175], v[232:235], v[52:55], v[172:175]
    v_exp_f32 v159, v159
    v_mfma_f32_16x16x32_bf16 v[180:183], v[232:235], v[84:87], v[180:183]
    s_add_u32 m0, s23, 34816
    v_add_f32 v248, v248, v158
    v_mfma_f32_16x16x32_bf16 v[188:191], v[232:235], v[116:119], v[188:191]
    buffer_load_dwordx4 v240, s[8:11], s20 offen offset:0 lds
    v_mfma_f32_16x16x32_bf16 v[164:167], v[208:211], v[24:27], v[164:167]
    v_add_f32 v248, v248, v159
    ds_read_b64_tr_b16 v[228:229], v238 offset:64
    v_mfma_f32_16x16x32_bf16 v[172:175], v[208:211], v[56:59], v[172:175]
    ds_read_b64_tr_b16 v[230:231], v238 offset:8768
    v_cvt_pk_bf16_f32 v155, v158, v159
    v_mfma_f32_16x16x32_bf16 v[180:183], v[208:211], v[88:91], v[180:183]
    s_add_u32 m0, s23, 34880
    v_max3_f32 v249, v245, v246, v247
    v_mfma_f32_16x16x32_bf16 v[188:191], v[208:211], v[120:123], v[188:191]
    buffer_load_dwordx4 v240, s[8:11], s20 offen offset:1024 lds
    v_max_f32 v249, v249, v248
    v_mfma_f32_16x16x32_bf16 v[164:167], v[212:215], v[28:31], v[164:167]
    ds_read_b64_tr_b16 v[208:209], v237 offset:128
    ds_read_b64_tr_b16 v[210:211], v237 offset:8832
    v_mfma_f32_16x16x32_bf16 v[172:175], v[212:215], v[60:63], v[172:175]
    v_cmp_lt_f32 vcc, s25, v249
    s_add_u32 m0, s23, 34944
    v_mfma_f32_16x16x32_bf16 v[180:183], v[212:215], v[92:95], v[180:183]
    buffer_load_dwordx4 v240, s[8:11], s20 offen offset:2048 lds
    v_mfma_f32_16x16x32_bf16 v[188:191], v[212:215], v[124:127], v[188:191]
    s_cbranch_vccnz K2_tramp_2
K2_ret_2:
    s_waitcnt lgkmcnt(6)
    v_mfma_f32_16x16x32_bf16 a[0:3], v[216:219], v[128:131], a[0:3]
    ds_read_b64_tr_b16 v[212:213], v238 offset:128
    ds_read_b64_tr_b16 v[214:215], v238 offset:8832
    v_mfma_f32_16x16x32_bf16 a[4:7], v[216:219], v[136:139], a[4:7]
    s_add_u32 m0, s23, 35008
    v_mfma_f32_16x16x32_bf16 a[8:11], v[216:219], v[144:147], a[8:11]
    buffer_load_dwordx4 v240, s[8:11], s20 offen offset:3072 lds
    v_mfma_f32_16x16x32_bf16 a[12:15], v[216:219], v[152:155], a[12:15]
    v_mfma_f32_16x16x32_bf16 a[16:19], v[220:223], v[128:131], a[16:19]
    ds_read_b64_tr_b16 v[216:217], v237 offset:192
    ds_read_b64_tr_b16 v[218:219], v237 offset:8896
    v_mfma_f32_16x16x32_bf16 a[20:23], v[220:223], v[136:139], a[20:23]
    v_exp_f32 v160, v160
    v_mfma_f32_16x16x32_bf16 a[24:27], v[220:223], v[144:147], a[24:27]
    v_exp_f32 v161, v161
    v_mfma_f32_16x16x32_bf16 a[28:31], v[220:223], v[152:155], a[28:31]
    s_add_u32 m0, s23, 39168
    s_waitcnt lgkmcnt(6)
    v_mfma_f32_16x16x32_bf16 a[32:35], v[224:227], v[128:131], a[32:35]
    buffer_load_dwordx4 v240, s[8:11], s21 offen offset:0 lds
    ds_read_b64_tr_b16 v[220:221], v238 offset:192
    v_mfma_f32_16x16x32_bf16 a[36:39], v[224:227], v[136:139], a[36:39]
    ds_read_b64_tr_b16 v[222:223], v238 offset:8896
    v_add_f32 v241, v241, v245
    v_mfma_f32_16x16x32_bf16 a[40:43], v[224:227], v[144:147], a[40:43]
    v_exp_f32 v162, v162
    v_mfma_f32_16x16x32_bf16 a[44:47], v[224:227], v[152:155], a[44:47]
    s_add_u32 m0, s23, 39232
    v_add_f32 v245, v160, v161
    v_mfma_f32_16x16x32_bf16 a[48:51], v[228:231], v[128:131], a[48:51]
    buffer_load_dwordx4 v240, s[8:11], s21 offen offset:1024 lds
    ds_read_b64_tr_b16 v[224:225], v237 offset:256
    v_mfma_f32_16x16x32_bf16 a[52:55], v[228:231], v[136:139], a[52:55]
    ds_read_b64_tr_b16 v[226:227], v237 offset:8960
    v_cvt_pk_bf16_f32 v160, v160, v161
    v_mfma_f32_16x16x32_bf16 a[56:59], v[228:231], v[144:147], a[56:59]
    v_exp_f32 v163, v163
    v_mfma_f32_16x16x32_bf16 a[60:63], v[228:231], v[152:155], a[60:63]
    v_add_f32 v245, v245, v162
    s_waitcnt lgkmcnt(6)
    v_mfma_f32_16x16x32_bf16 a[64:67], v[208:211], v[128:131], a[64:67]
    s_add_u32 m0, s23, 39296
    ds_read_b64_tr_b16 v[228:229], v238 offset:256
    v_mfma_f32_16x16x32_bf16 a[68:71], v[208:211], v[136:139], a[68:71]
    ds_read_b64_tr_b16 v[230:231], v238 offset:8960
    buffer_load_dwordx4 v240, s[8:11], s21 offen offset:2048 lds
    v_mfma_f32_16x16x32_bf16 a[72:75], v[208:211], v[144:147], a[72:75]
    v_exp_f32 v164, v164
    v_mfma_f32_16x16x32_bf16 a[76:79], v[208:211], v[152:155], a[76:79]
    v_add_f32 v245, v245, v163
    v_cvt_pk_bf16_f32 v161, v162, v163
    v_mfma_f32_16x16x32_bf16 a[80:83], v[212:215], v[128:131], a[80:83]
    s_add_u32 m0, s23, 39360
    ds_read_b64_tr_b16 v[208:209], v237 offset:320
    v_mfma_f32_16x16x32_bf16 a[84:87], v[212:215], v[136:139], a[84:87]
    ds_read_b64_tr_b16 v[210:211], v237 offset:9024
    buffer_load_dwordx4 v240, s[8:11], s21 offen offset:3072 lds
    v_mfma_f32_16x16x32_bf16 a[88:91], v[212:215], v[144:147], a[88:91]
    v_exp_f32 v165, v165
    v_mfma_f32_16x16x32_bf16 a[92:95], v[212:215], v[152:155], a[92:95]
    v_add_f32 v245, v245, v164
    s_waitcnt lgkmcnt(6)
    v_mfma_f32_16x16x32_bf16 a[96:99], v[216:219], v[128:131], a[96:99]
    v_exp_f32 v166, v166
    v_mfma_f32_16x16x32_bf16 a[100:103], v[216:219], v[136:139], a[100:103]
    ds_read_b64_tr_b16 v[212:213], v238 offset:320
    ds_read_b64_tr_b16 v[214:215], v238 offset:9024
    v_mfma_f32_16x16x32_bf16 a[104:107], v[216:219], v[144:147], a[104:107]
    s_add_u32 m0, s22, 33792
    v_add_f32 v245, v245, v165
    v_mfma_f32_16x16x32_bf16 a[108:111], v[216:219], v[152:155], a[108:111]
    buffer_load_dwordx4 v239, s[4:7], s20 offen offset:0 lds
    v_cvt_pk_bf16_f32 v162, v164, v165
    v_mfma_f32_16x16x32_bf16 a[112:115], v[220:223], v[128:131], a[112:115]
    v_exp_f32 v167, v167
    v_mfma_f32_16x16x32_bf16 a[116:119], v[220:223], v[136:139], a[116:119]
    ds_read_b64_tr_b16 v[216:217], v237 offset:384
    ds_read_b64_tr_b16 v[218:219], v237 offset:9088
    v_mfma_f32_16x16x32_bf16 a[120:123], v[220:223], v[144:147], a[120:123]
    s_add_u32 m0, s22, 33824
    v_add_f32 v245, v245, v166
    v_mfma_f32_16x16x32_bf16 a[124:127], v[220:223], v[152:155], a[124:127]
    buffer_load_dwordx4 v239, s[4:7], s20 offen offset:1024 lds
    s_waitcnt lgkmcnt(6)
    v_mfma_f32_16x16x32_bf16 a[128:131], v[224:227], v[128:131], a[128:131]
    v_add_f32 v245, v245, v167
    v_cvt_pk_bf16_f32 v163, v166, v167
    v_mfma_f32_16x16x32_bf16 a[132:135], v[224:227], v[136:139], a[132:135]
    ds_read_b64_tr_b16 v[220:221], v238 offset:384
    ds_read_b64_tr_b16 v[222:223], v238 offset:9088
    v_mfma_f32_16x16x32_bf16 a[136:139], v[224:227], v[144:147], a[136:139]
    v_exp_f32 v168, v168
    v_mfma_f32_16x16x32_bf16 a[140:143], v[224:227], v[152:155], a[140:143]
    s_add_u32 m0, s22, 33856
    v_mfma_f32_16x16x32_bf16 a[144:147], v[228:231], v[128:131], a[144:147]
    buffer_load_dwordx4 v239, s[4:7], s20 offen offset:2048 lds
    ds_read_b64_tr_b16 v[224:225], v237 offset:448
    v_mfma_f32_16x16x32_bf16 a[148:151], v[228:231], v[136:139], a[148:151]
    v_exp_f32 v169, v169
    v_mfma_f32_16x16x32_bf16 a[152:155], v[228:231], v[144:147], a[152:155]
    ds_read_b64_tr_b16 v[226:227], v237 offset:9152
    v_add_f32 v242, v242, v246
    v_mfma_f32_16x16x32_bf16 a[156:159], v[228:231], v[152:155], a[156:159]
    s_add_u32 m0, s22, 33888
    s_waitcnt lgkmcnt(6)
    v_mfma_f32_16x16x32_bf16 a[160:163], v[208:211], v[128:131], a[160:163]
    v_exp_f32 v170, v170
    v_mfma_f32_16x16x32_bf16 a[164:167], v[208:211], v[136:139], a[164:167]
    buffer_load_dwordx4 v239, s[4:7], s20 offen offset:3072 lds
    ds_read_b64_tr_b16 v[228:229], v238 offset:448
    v_mfma_f32_16x16x32_bf16 a[168:171], v[208:211], v[144:147], a[168:171]
    ds_read_b64_tr_b16 v[230:231], v238 offset:9152
    v_add_f32 v246, v168, v169
    v_mfma_f32_16x16x32_bf16 a[172:175], v[208:211], v[152:155], a[172:175]
    v_cvt_pk_bf16_f32 v168, v168, v169
    s_add_u32 m0, s22, 38016
    v_mfma_f32_16x16x32_bf16 a[176:179], v[212:215], v[128:131], a[176:179]
    v_exp_f32 v171, v171
    v_mfma_f32_16x16x32_bf16 a[180:183], v[212:215], v[136:139], a[180:183]
    buffer_load_dwordx4 v239, s[4:7], s21 offen offset:0 lds
    ds_read_b128 v[208:211], v236 offset:0
    v_mfma_f32_16x16x32_bf16 a[184:187], v[212:215], v[144:147], a[184:187]
    v_add_f32 v246, v246, v170
    s_add_u32 m0, s22, 38048
    v_mfma_f32_16x16x32_bf16 a[188:191], v[212:215], v[152:155], a[188:191]
    buffer_load_dwordx4 v239, s[4:7], s21 offen offset:1024 lds
    s_waitcnt lgkmcnt(5)
    v_mfma_f32_16x16x32_bf16 a[192:195], v[216:219], v[128:131], a[192:195]
    v_exp_f32 v172, v172
    v_mfma_f32_16x16x32_bf16 a[196:199], v[216:219], v[136:139], a[196:199]
    v_add_f32 v246, v246, v171
    ds_read_b128 v[212:215], v236 offset:64
    v_mfma_f32_16x16x32_bf16 a[200:203], v[216:219], v[144:147], a[200:203]
    v_cvt_pk_bf16_f32 v169, v170, v171
    v_mfma_f32_16x16x32_bf16 a[204:207], v[216:219], v[152:155], a[204:207]
    v_exp_f32 v173, v173
    v_mfma_f32_16x16x32_bf16 a[208:211], v[220:223], v[128:131], a[208:211]
    v_add_f32 v246, v246, v172
    s_add_u32 m0, s22, 38080
    v_mfma_f32_16x16x32_bf16 a[212:215], v[220:223], v[136:139], a[212:215]
    ds_read_b128 v[216:219], v236 offset:128
    buffer_load_dwordx4 v239, s[4:7], s21 offen offset:2048 lds
    v_mfma_f32_16x16x32_bf16 a[216:219], v[220:223], v[144:147], a[216:219]
    v_exp_f32 v174, v174
    v_mfma_f32_16x16x32_bf16 a[220:223], v[220:223], v[152:155], a[220:223]
    v_add_f32 v246, v246, v173
    s_waitcnt lgkmcnt(3)
    v_mfma_f32_16x16x32_bf16 a[224:227], v[224:227], v[128:131], a[224:227]
    v_cvt_pk_bf16_f32 v170, v172, v173
    s_add_u32 m0, s22, 38112
    v_mfma_f32_16x16x32_bf16 a[228:231], v[224:227], v[136:139], a[228:231]
    ds_read_b128 v[220:223], v236 offset:192
    buffer_load_dwordx4 v239, s[4:7], s21 offen offset:3072 lds
    v_mfma_f32_16x16x32_bf16 a[232:235], v[224:227], v[144:147], a[232:235]
    v_exp_f32 v175, v175
    v_mfma_f32_16x16x32_bf16 a[236:239], v[224:227], v[152:155], a[236:239]
    v_add_f32 v246, v246, v174
    v_add_f32 v246, v246, v175
    v_mfma_f32_16x16x32_bf16 a[240:243], v[228:231], v[128:131], a[240:243]
    ds_read_b128 v[224:227], v236 offset:256
    v_cvt_pk_bf16_f32 v171, v174, v175
    v_mfma_f32_16x16x32_bf16 a[244:247], v[228:231], v[136:139], a[244:247]
    s_add_u32 s20, s20, 32768
    s_add_u32 s21, s21, 32768
    v_mfma_f32_16x16x32_bf16 a[248:251], v[228:231], v[144:147], a[248:251]
    s_add_u32 s49, s50, 0
    buffer_load_dword v255, v250, s[68:71], s49 offen
    v_mfma_f32_16x16x32_bf16 a[252:255], v[228:231], v[152:155], a[252:255]
    s_waitcnt lgkmcnt(3)
    v_mfma_f32_16x16x32_bf16 v[128:131], v[208:211], v[0:3], v[192:195]
    ds_read_b128 v[228:231], v236 offset:320
    v_mfma_f32_16x16x32_bf16 v[136:139], v[208:211], v[32:35], v[196:199]
    v_exp_f32 v176, v176
    v_mfma_f32_16x16x32_bf16 v[144:147], v[208:211], v[64:67], v[200:203]
    v_exp_f32 v177, v177
    v_mfma_f32_16x16x32_bf16 v[152:155], v[208:211], v[96:99], v[204:207]
    v_mfma_f32_16x16x32_bf16 v[128:131], v[212:215], v[4:7], v[128:131]
    ds_read_b128 v[232:235], v236 offset:384
    v_add_f32 v243, v243, v247
    v_mfma_f32_16x16x32_bf16 v[136:139], v[212:215], v[36:39], v[136:139]
    v_exp_f32 v178, v178
    v_mfma_f32_16x16x32_bf16 v[144:147], v[212:215], v[68:71], v[144:147]
    v_mfma_f32_16x16x32_bf16 v[152:155], v[212:215], v[100:103], v[152:155]
    v_add_f32 v247, v176, v177
    s_waitcnt lgkmcnt(3)
    v_mfma_f32_16x16x32_bf16 v[128:131], v[216:219], v[8:11], v[128:131]
    ds_read_b128 v[208:211], v236 offset:448
    v_cvt_pk_bf16_f32 v176, v176, v177
    v_mfma_f32_16x16x32_bf16 v[136:139], v[216:219], v[40:43], v[136:139]
    v_exp_f32 v179, v179
    v_mfma_f32_16x16x32_bf16 v[144:147], v[216:219], v[72:75], v[144:147]
    v_mfma_f32_16x16x32_bf16 v[152:155], v[216:219], v[104:107], v[152:155]
    v_add_f32 v247, v247, v178
    v_mfma_f32_16x16x32_bf16 v[128:131], v[220:223], v[12:15], v[128:131]
    ds_read_b128 v[212:215], v236 offset:8448
    v_mfma_f32_16x16x32_bf16 v[136:139], v[220:223], v[44:47], v[136:139]
    v_exp_f32 v180, v180
    v_mfma_f32_16x16x32_bf16 v[144:147], v[220:223], v[76:79], v[144:147]
    v_add_f32 v247, v247, v179
    v_mfma_f32_16x16x32_bf16 v[152:155], v[220:223], v[108:111], v[152:155]
    v_cvt_pk_bf16_f32 v177, v178, v179
    s_waitcnt lgkmcnt(3)
    v_mfma_f32_16x16x32_bf16 v[128:131], v[224:227], v[16:19], v[128:131]
    ds_read_b128 v[216:219], v236 offset:8512
    v_mfma_f32_16x16x32_bf16 v[136:139], v[224:227], v[48:51], v[136:139]
    v_exp_f32 v181, v181
    v_mfma_f32_16x16x32_bf16 v[144:147], v[224:227], v[80:83], v[144:147]
    v_add_f32 v247, v247, v180
    v_mfma_f32_16x16x32_bf16 v[152:155], v[224:227], v[112:115], v[152:155]
    v_exp_f32 v182, v182
    v_mfma_f32_16x16x32_bf16 v[128:131], v[228:231], v[20:23], v[128:131]
    ds_read_b128 v[220:223], v236 offset:8576
    v_mfma_f32_16x16x32_bf16 v[136:139], v[228:231], v[52:55], v[136:139]
    v_add_f32 v247, v247, v181
    v_mfma_f32_16x16x32_bf16 v[144:147], v[228:231], v[84:87], v[144:147]
    v_cvt_pk_bf16_f32 v178, v180, v181
    v_mfma_f32_16x16x32_bf16 v[152:155], v[228:231], v[116:119], v[152:155]
    s_waitcnt lgkmcnt(3)
    v_mfma_f32_16x16x32_bf16 v[128:131], v[232:235], v[24:27], v[128:131]
    v_exp_f32 v183, v183
    v_mfma_f32_16x16x32_bf16 v[136:139], v[232:235], v[56:59], v[136:139]
    ds_read_b128 v[224:227], v236 offset:8640
    v_add_f32 v247, v247, v182
    v_mfma_f32_16x16x32_bf16 v[144:147], v[232:235], v[88:91], v[144:147]
    v_add_f32 v247, v247, v183
    v_mfma_f32_16x16x32_bf16 v[152:155], v[232:235], v[120:123], v[152:155]
    v_cvt_pk_bf16_f32 v179, v182, v183
    v_mfma_f32_16x16x32_bf16 v[128:131], v[208:211], v[28:31], v[128:131]
    ds_read_b128 v[228:231], v236 offset:8704
    v_mfma_f32_16x16x32_bf16 v[136:139], v[208:211], v[60:63], v[136:139]
    v_exp_f32 v184, v184
    v_mfma_f32_16x16x32_bf16 v[144:147], v[208:211], v[92:95], v[144:147]
    v_mfma_f32_16x16x32_bf16 v[152:155], v[208:211], v[124:127], v[152:155]
    s_waitcnt lgkmcnt(3)
    v_mfma_f32_16x16x32_bf16 v[132:135], v[212:215], v[0:3], v[192:195]
    v_exp_f32 v185, v185
    v_mfma_f32_16x16x32_bf16 v[140:143], v[212:215], v[32:35], v[196:199]
    ds_read_b128 v[232:235], v236 offset:8768
    v_add_f32 v244, v244, v248
    v_mfma_f32_16x16x32_bf16 v[148:151], v[212:215], v[64:67], v[200:203]
    v_exp_f32 v186, v186
    v_mfma_f32_16x16x32_bf16 v[156:159], v[212:215], v[96:99], v[204:207]
    v_mfma_f32_16x16x32_bf16 v[132:135], v[216:219], v[4:7], v[132:135]
    ds_read_b128 v[208:211], v236 offset:8832
    v_add_f32 v248, v184, v185
    v_mfma_f32_16x16x32_bf16 v[140:143], v[216:219], v[36:39], v[140:143]
    v_cvt_pk_bf16_f32 v184, v184, v185
    v_mfma_f32_16x16x32_bf16 v[148:151], v[216:219], v[68:71], v[148:151]
    v_exp_f32 v187, v187
    v_mfma_f32_16x16x32_bf16 v[156:159], v[216:219], v[100:103], v[156:159]
    s_waitcnt lgkmcnt(3)
    v_mfma_f32_16x16x32_bf16 v[132:135], v[220:223], v[8:11], v[132:135]
    ds_read_b128 v[212:215], v236 offset:8896
    v_add_f32 v248, v248, v186
    v_mfma_f32_16x16x32_bf16 v[140:143], v[220:223], v[40:43], v[140:143]
    v_exp_f32 v188, v188
    v_mfma_f32_16x16x32_bf16 v[148:151], v[220:223], v[72:75], v[148:151]
    v_mfma_f32_16x16x32_bf16 v[156:159], v[220:223], v[104:107], v[156:159]
    v_add_f32 v248, v248, v187
    v_mfma_f32_16x16x32_bf16 v[132:135], v[224:227], v[12:15], v[132:135]
    v_cvt_pk_bf16_f32 v185, v186, v187
    v_mfma_f32_16x16x32_bf16 v[140:143], v[224:227], v[44:47], v[140:143]
    v_exp_f32 v189, v189
    v_mfma_f32_16x16x32_bf16 v[148:151], v[224:227], v[76:79], v[148:151]
    s_waitcnt vmcnt(1) lgkmcnt(0)
    s_barrier
    v_mfma_f32_16x16x32_bf16 v[156:159], v[224:227], v[108:111], v[156:159]
    ds_read_b64_tr_b16 v[216:217], v237 offset:34816
    v_mfma_f32_16x16x32_bf16 v[132:135], v[228:231], v[16:19], v[132:135]
    ds_read_b64_tr_b16 v[218:219], v237 offset:43520
    v_add_f32 v248, v248, v188
    v_mfma_f32_16x16x32_bf16 v[140:143], v[228:231], v[48:51], v[140:143]
    ds_read_b64_tr_b16 v[220:221], v238 offset:34816
    ds_read_b64_tr_b16 v[222:223], v238 offset:43520
    v_mfma_f32_16x16x32_bf16 v[148:151], v[228:231], v[80:83], v[148:151]
    v_exp_f32 v190, v190
    v_mfma_f32_16x16x32_bf16 v[156:159], v[228:231], v[112:115], v[156:159]
    v_add_f32 v248, v248, v189
    v_cvt_pk_bf16_f32 v186, v188, v189
    v_mfma_f32_16x16x32_bf16 v[132:135], v[232:235], v[20:23], v[132:135]
    ds_read_b64_tr_b16 v[224:225], v237 offset:34880
    ds_read_b64_tr_b16 v[226:227], v237 offset:43584
    v_mfma_f32_16x16x32_bf16 v[140:143], v[232:235], v[52:55], v[140:143]
    v_exp_f32 v191, v191
    v_mfma_f32_16x16x32_bf16 v[148:151], v[232:235], v[84:87], v[148:151]
    s_add_u32 m0, s23, 0
    v_add_f32 v248, v248, v190
    v_mfma_f32_16x16x32_bf16 v[156:159], v[232:235], v[116:119], v[156:159]
    buffer_load_dwordx4 v240, s[8:11], s20 offen offset:0 lds
    v_mfma_f32_16x16x32_bf16 v[132:135], v[208:211], v[24:27], v[132:135]
    v_add_f32 v248, v248, v191
    ds_read_b64_tr_b16 v[228:229], v238 offset:34880
    v_mfma_f32_16x16x32_bf16 v[140:143], v[208:211], v[56:59], v[140:143]
    ds_read_b64_tr_b16 v[230:231], v238 offset:43584
    v_cvt_pk_bf16_f32 v187, v190, v191
    v_mfma_f32_16x16x32_bf16 v[148:151], v[208:211], v[88:91], v[148:151]
    s_add_u32 m0, s23, 64
    v_max3_f32 v249, v245, v246, v247
    v_mfma_f32_16x16x32_bf16 v[156:159], v[208:211], v[120:123], v[156:159]
    buffer_load_dwordx4 v240, s[8:11], s20 offen offset:1024 lds
    v_max_f32 v249, v249, v248
    v_mfma_f32_16x16x32_bf16 v[132:135], v[212:215], v[28:31], v[132:135]
    ds_read_b64_tr_b16 v[208:209], v237 offset:34944
    ds_read_b64_tr_b16 v[210:211], v237 offset:43648
    v_mfma_f32_16x16x32_bf16 v[140:143], v[212:215], v[60:63], v[140:143]
    v_cmp_lt_f32 vcc, s25, v249
    s_add_u32 m0, s23, 128
    v_mfma_f32_16x16x32_bf16 v[148:151], v[212:215], v[92:95], v[148:151]
    buffer_load_dwordx4 v240, s[8:11], s20 offen offset:2048 lds
    v_mfma_f32_16x16x32_bf16 v[156:159], v[212:215], v[124:127], v[156:159]
    s_cbranch_vccnz K2_tramp_3
K2_ret_3:
    s_waitcnt lgkmcnt(6)
    v_mfma_f32_16x16x32_bf16 a[0:3], v[216:219], v[160:163], a[0:3]
    ds_read_b64_tr_b16 v[212:213], v238 offset:34944
    ds_read_b64_tr_b16 v[214:215], v238 offset:43648
    v_mfma_f32_16x16x32_bf16 a[4:7], v[216:219], v[168:171], a[4:7]
    s_add_u32 m0, s23, 192
    v_mfma_f32_16x16x32_bf16 a[8:11], v[216:219], v[176:179], a[8:11]
    buffer_load_dwordx4 v240, s[8:11], s20 offen offset:3072 lds
    v_mfma_f32_16x16x32_bf16 a[12:15], v[216:219], v[184:187], a[12:15]
    v_mfma_f32_16x16x32_bf16 a[16:19], v[220:223], v[160:163], a[16:19]
    ds_read_b64_tr_b16 v[216:217], v237 offset:35008
    ds_read_b64_tr_b16 v[218:219], v237 offset:43712
    v_mfma_f32_16x16x32_bf16 a[20:23], v[220:223], v[168:171], a[20:23]
    v_exp_f32 v128, v128
    v_mfma_f32_16x16x32_bf16 a[24:27], v[220:223], v[176:179], a[24:27]
    v_exp_f32 v129, v129
    v_mfma_f32_16x16x32_bf16 a[28:31], v[220:223], v[184:187], a[28:31]
    s_add_u32 m0, s23, 4352
    s_waitcnt lgkmcnt(6)
    v_mfma_f32_16x16x32_bf16 a[32:35], v[224:227], v[160:163], a[32:35]
    buffer_load_dwordx4 v240, s[8:11], s21 offen offset:0 lds
    ds_read_b64_tr_b16 v[220:221], v238 offset:35008
    v_mfma_f32_16x16x32_bf16 a[36:39], v[224:227], v[168:171], a[36:39]
    ds_read_b64_tr_b16 v[222:223], v238 offset:43712
    v_add_f32 v241, v241, v245
    v_mfma_f32_16x16x32_bf16 a[40:43], v[224:227], v[176:179], a[40:43]
    v_exp_f32 v130, v130
    v_mfma_f32_16x16x32_bf16 a[44:47], v[224:227], v[184:187], a[44:47]
    s_add_u32 m0, s23, 4416
    v_add_f32 v245, v128, v129
    v_mfma_f32_16x16x32_bf16 a[48:51], v[228:231], v[160:163], a[48:51]
    buffer_load_dwordx4 v240, s[8:11], s21 offen offset:1024 lds
    ds_read_b64_tr_b16 v[224:225], v237 offset:35072
    v_mfma_f32_16x16x32_bf16 a[52:55], v[228:231], v[168:171], a[52:55]
    ds_read_b64_tr_b16 v[226:227], v237 offset:43776
    v_cvt_pk_bf16_f32 v128, v128, v129
    v_mfma_f32_16x16x32_bf16 a[56:59], v[228:231], v[176:179], a[56:59]
    v_exp_f32 v131, v131
    v_mfma_f32_16x16x32_bf16 a[60:63], v[228:231], v[184:187], a[60:63]
    v_add_f32 v245, v245, v130
    s_waitcnt lgkmcnt(6)
    v_mfma_f32_16x16x32_bf16 a[64:67], v[208:211], v[160:163], a[64:67]
    s_add_u32 m0, s23, 4480
    ds_read_b64_tr_b16 v[228:229], v238 offset:35072
    v_mfma_f32_16x16x32_bf16 a[68:71], v[208:211], v[168:171], a[68:71]
    ds_read_b64_tr_b16 v[230:231], v238 offset:43776
    buffer_load_dwordx4 v240, s[8:11], s21 offen offset:2048 lds
    v_mfma_f32_16x16x32_bf16 a[72:75], v[208:211], v[176:179], a[72:75]
    v_exp_f32 v132, v132
    v_mfma_f32_16x16x32_bf16 a[76:79], v[208:211], v[184:187], a[76:79]
    v_add_f32 v245, v245, v131
    v_cvt_pk_bf16_f32 v129, v130, v131
    v_mfma_f32_16x16x32_bf16 a[80:83], v[212:215], v[160:163], a[80:83]
    s_add_u32 m0, s23, 4544
    ds_read_b64_tr_b16 v[208:209], v237 offset:35136
    v_mfma_f32_16x16x32_bf16 a[84:87], v[212:215], v[168:171], a[84:87]
    ds_read_b64_tr_b16 v[210:211], v237 offset:43840
    buffer_load_dwordx4 v240, s[8:11], s21 offen offset:3072 lds
    v_mfma_f32_16x16x32_bf16 a[88:91], v[212:215], v[176:179], a[88:91]
    v_exp_f32 v133, v133
    v_mfma_f32_16x16x32_bf16 a[92:95], v[212:215], v[184:187], a[92:95]
    v_add_f32 v245, v245, v132
    s_waitcnt lgkmcnt(6)
    v_mfma_f32_16x16x32_bf16 a[96:99], v[216:219], v[160:163], a[96:99]
    v_exp_f32 v134, v134
    v_mfma_f32_16x16x32_bf16 a[100:103], v[216:219], v[168:171], a[100:103]
    ds_read_b64_tr_b16 v[212:213], v238 offset:35136
    ds_read_b64_tr_b16 v[214:215], v238 offset:43840
    v_mfma_f32_16x16x32_bf16 a[104:107], v[216:219], v[176:179], a[104:107]
    v_add_f32 v245, v245, v133
    v_cvt_pk_bf16_f32 v130, v132, v133
    v_mfma_f32_16x16x32_bf16 a[108:111], v[216:219], v[184:187], a[108:111]
    v_exp_f32 v135, v135
    v_mfma_f32_16x16x32_bf16 a[112:115], v[220:223], v[160:163], a[112:115]
    ds_read_b64_tr_b16 v[216:217], v237 offset:35200
    ds_read_b64_tr_b16 v[218:219], v237 offset:43904
    v_mfma_f32_16x16x32_bf16 a[116:119], v[220:223], v[168:171], a[116:119]
    v_add_f32 v245, v245, v134
    v_mfma_f32_16x16x32_bf16 a[120:123], v[220:223], v[176:179], a[120:123]
    v_add_f32 v245, v245, v135
    v_mfma_f32_16x16x32_bf16 a[124:127], v[220:223], v[184:187], a[124:127]
    v_cvt_pk_bf16_f32 v131, v134, v135
    s_waitcnt lgkmcnt(6)
    v_mfma_f32_16x16x32_bf16 a[128:131], v[224:227], v[160:163], a[128:131]
    ds_read_b64_tr_b16 v[220:221], v238 offset:35200
    ds_read_b64_tr_b16 v[222:223], v238 offset:43904
    v_mfma_f32_16x16x32_bf16 a[132:135], v[224:227], v[168:171], a[132:135]
    s_add_u32 s49, s51, 0
    buffer_load_dword v255, v250, s[64:67], s49 offen
    v_mfma_f32_16x16x32_bf16 a[136:139], v[224:227], v[176:179], a[136:139]
    v_exp_f32 v136, v136
    v_mfma_f32_16x16x32_bf16 a[140:143], v[224:227], v[184:187], a[140:143]
    v_exp_f32 v137, v137
    v_mfma_f32_16x16x32_bf16 a[144:147], v[228:231], v[160:163], a[144:147]
    ds_read_b64_tr_b16 v[224:225], v237 offset:35264
    ds_read_b64_tr_b16 v[226:227], v237 offset:43968
    v_mfma_f32_16x16x32_bf16 a[148:151], v[228:231], v[168:171], a[148:151]
    v_add_f32 v242, v242, v246
    v_mfma_f32_16x16x32_bf16 a[152:155], v[228:231], v[176:179], a[152:155]
    v_exp_f32 v138, v138
    v_mfma_f32_16x16x32_bf16 a[156:159], v[228:231], v[184:187], a[156:159]
    s_add_u32 s49, s51, 16384
    s_waitcnt lgkmcnt(6)
    v_mfma_f32_16x16x32_bf16 a[160:163], v[208:211], v[160:163], a[160:163]
    buffer_load_dword v255, v250, s[64:67], s49 offen
    ds_read_b64_tr_b16 v[228:229], v238 offset:35264
    v_mfma_f32_16x16x32_bf16 a[164:167], v[208:211], v[168:171], a[164:167]
    ds_read_b64_tr_b16 v[230:231], v238 offset:43968
    v_add_f32 v246, v136, v137
    v_mfma_f32_16x16x32_bf16 a[168:171], v[208:211], v[176:179], a[168:171]
    v_cvt_pk_bf16_f32 v136, v136, v137
    v_mfma_f32_16x16x32_bf16 a[172:175], v[208:211], v[184:187], a[172:175]
    v_exp_f32 v139, v139
    v_mfma_f32_16x16x32_bf16 a[176:179], v[212:215], v[160:163], a[176:179]
    ds_read_b128 v[208:211], v236 offset:33792
    v_add_f32 v246, v246, v138
    v_mfma_f32_16x16x32_bf16 a[180:183], v[212:215], v[168:171], a[180:183]
    s_add_u32 s49, s51, 32768
    buffer_load_dword v255, v250, s[64:67], s49 offen
    v_mfma_f32_16x16x32_bf16 a[184:187], v[212:215], v[176:179], a[184:187]
    v_exp_f32 v140, v140
    v_mfma_f32_16x16x32_bf16 a[188:191], v[212:215], v[184:187], a[188:191]
    v_add_f32 v246, v246, v139
    s_waitcnt lgkmcnt(5)
    v_mfma_f32_16x16x32_bf16 a[192:195], v[216:219], v[160:163], a[192:195]
    ds_read_b128 v[212:215], v236 offset:33856
    v_cvt_pk_bf16_f32 v137, v138, v139
    v_mfma_f32_16x16x32_bf16 a[196:199], v[216:219], v[168:171], a[196:199]
    v_exp_f32 v141, v141
    v_mfma_f32_16x16x32_bf16 a[200:203], v[216:219], v[176:179], a[200:203]
    s_add_u32 s49, s51, 49152
    v_mfma_f32_16x16x32_bf16 a[204:207], v[216:219], v[184:187], a[204:207]
    v_add_f32 v246, v246, v140
    buffer_load_dword v255, v250, s[64:67], s49 offen
    v_mfma_f32_16x16x32_bf16 a[208:211], v[220:223], v[160:163], a[208:211]
    ds_read_b128 v[216:219], v236 offset:33920
    v_mfma_f32_16x16x32_bf16 a[212:215], v[220:223], v[168:171], a[212:215]
    v_exp_f32 v142, v142
    v_mfma_f32_16x16x32_bf16 a[216:219], v[220:223], v[176:179], a[216:219]
    v_add_f32 v246, v246, v141
    v_mfma_f32_16x16x32_bf16 a[220:223], v[220:223], v[184:187], a[220:223]
    v_cvt_pk_bf16_f32 v138, v140, v141
    s_waitcnt lgkmcnt(3)
    v_mfma_f32_16x16x32_bf16 a[224:227], v[224:227], v[160:163], a[224:227]
    ds_read_b128 v[220:223], v236 offset:33984
    v_mfma_f32_16x16x32_bf16 a[228:231], v[224:227], v[168:171], a[228:231]
    v_exp_f32 v143, v143
    v_mfma_f32_16x16x32_bf16 a[232:235], v[224:227], v[176:179], a[232:235]
    v_add_f32 v246, v246, v142
    v_mfma_f32_16x16x32_bf16 a[236:239], v[224:227], v[184:187], a[236:239]
    v_add_f32 v246, v246, v143
    v_mfma_f32_16x16x32_bf16 a[240:243], v[228:231], v[160:163], a[240:243]
    ds_read_b128 v[224:227], v236 offset:34048
    v_cvt_pk_bf16_f32 v139, v142, v143
    v_mfma_f32_16x16x32_bf16 a[244:247], v[228:231], v[168:171], a[244:247]
    s_add_u32 s20, s20, 32768
    s_add_u32 s21, s21, 32768
    v_mfma_f32_16x16x32_bf16 a[248:251], v[228:231], v[176:179], a[248:251]
    v_mfma_f32_16x16x32_bf16 a[252:255], v[228:231], v[184:187], a[252:255]
    s_waitcnt lgkmcnt(3)
    v_mfma_f32_16x16x32_bf16 v[160:163], v[208:211], v[0:3], v[192:195]
    ds_read_b128 v[228:231], v236 offset:34112
    v_mfma_f32_16x16x32_bf16 v[168:171], v[208:211], v[32:35], v[196:199]
    v_exp_f32 v144, v144
    v_mfma_f32_16x16x32_bf16 v[176:179], v[208:211], v[64:67], v[200:203]
    v_exp_f32 v145, v145
    v_mfma_f32_16x16x32_bf16 v[184:187], v[208:211], v[96:99], v[204:207]
    v_mfma_f32_16x16x32_bf16 v[160:163], v[212:215], v[4:7], v[160:163]
    ds_read_b128 v[232:235], v236 offset:34176
    v_add_f32 v243, v243, v247
    v_mfma_f32_16x16x32_bf16 v[168:171], v[212:215], v[36:39], v[168:171]
    v_exp_f32 v146, v146
    v_mfma_f32_16x16x32_bf16 v[176:179], v[212:215], v[68:71], v[176:179]
    v_mfma_f32_16x16x32_bf16 v[184:187], v[212:215], v[100:103], v[184:187]
    v_add_f32 v247, v144, v145
    s_waitcnt lgkmcnt(3)
    v_mfma_f32_16x16x32_bf16 v[160:163], v[216:219], v[8:11], v[160:163]
    ds_read_b128 v[208:211], v236 offset:34240
    v_cvt_pk_bf16_f32 v144, v144, v145
    v_mfma_f32_16x16x32_bf16 v[168:171], v[216:219], v[40:43], v[168:171]
    v_exp_f32 v147, v147
    v_mfma_f32_16x16x32_bf16 v[176:179], v[216:219], v[72:75], v[176:179]
    v_mfma_f32_16x16x32_bf16 v[184:187], v[216:219], v[104:107], v[184:187]
    v_add_f32 v247, v247, v146
    v_mfma_f32_16x16x32_bf16 v[160:163], v[220:223], v[12:15], v[160:163]
    ds_read_b128 v[212:215], v236 offset:42240
    v_mfma_f32_16x16x32_bf16 v[168:171], v[220:223], v[44:47], v[168:171]
    v_exp_f32 v148, v148
    v_mfma_f32_16x16x32_bf16 v[176:179], v[220:223], v[76:79], v[176:179]
    v_add_f32 v247, v247, v147
    v_mfma_f32_16x16x32_bf16 v[184:187], v[220:223], v[108:111], v[184:187]
    v_cvt_pk_bf16_f32 v145, v146, v147
    s_waitcnt lgkmcnt(3)
    v_mfma_f32_16x16x32_bf16 v[160:163], v[224:227], v[16:19], v[160:163]
    ds_read_b128 v[216:219], v236 offset:42304
    v_mfma_f32_16x16x32_bf16 v[168:171], v[224:227], v[48:51], v[168:171]
    v_exp_f32 v149, v149
    v_mfma_f32_16x16x32_bf16 v[176:179], v[224:227], v[80:83], v[176:179]
    v_add_f32 v247, v247, v148
    v_mfma_f32_16x16x32_bf16 v[184:187], v[224:227], v[112:115], v[184:187]
    v_exp_f32 v150, v150
    v_mfma_f32_16x16x32_bf16 v[160:163], v[228:231], v[20:23], v[160:163]
    ds_read_b128 v[220:223], v236 offset:42368
    v_mfma_f32_16x16x32_bf16 v[168:171], v[228:231], v[52:55], v[168:171]
    v_add_f32 v247, v247, v149
    v_mfma_f32_16x16x32_bf16 v[176:179], v[228:231], v[84:87], v[176:179]
    v_cvt_pk_bf16_f32 v146, v148, v149
    v_mfma_f32_16x16x32_bf16 v[184:187], v[228:231], v[116:119], v[184:187]
    s_waitcnt lgkmcnt(3)
    v_mfma_f32_16x16x32_bf16 v[160:163], v[232:235], v[24:27], v[160:163]
    v_exp_f32 v151, v151
    v_mfma_f32_16x16x32_bf16 v[168:171], v[232:235], v[56:59], v[168:171]
    ds_read_b128 v[224:227], v236 offset:42432
    v_add_f32 v247, v247, v150
    v_mfma_f32_16x16x32_bf16 v[176:179], v[232:235], v[88:91], v[176:179]
    v_add_f32 v247, v247, v151
    v_mfma_f32_16x16x32_bf16 v[184:187], v[232:235], v[120:123], v[184:187]
    v_cvt_pk_bf16_f32 v147, v150, v151
    v_mfma_f32_16x16x32_bf16 v[160:163], v[208:211], v[28:31], v[160:163]
    ds_read_b128 v[228:231], v236 offset:42496
    v_mfma_f32_16x16x32_bf16 v[168:171], v[208:211], v[60:63], v[168:171]
    v_exp_f32 v152, v152
    v_mfma_f32_16x16x32_bf16 v[176:179], v[208:211], v[92:95], v[176:179]
    v_mfma_f32_16x16x32_bf16 v[184:187], v[208:211], v[124:127], v[184:187]
    s_waitcnt lgkmcnt(3)
    v_mfma_f32_16x16x32_bf16 v[164:167], v[212:215], v[0:3], v[192:195]
    v_exp_f32 v153, v153
    v_mfma_f32_16x16x32_bf16 v[172:175], v[212:215], v[32:35], v[196:199]
    ds_read_b128 v[232:235], v236 offset:42560
    v_add_f32 v244, v244, v248
    v_mfma_f32_16x16x32_bf16 v[180:183], v[212:215], v[64:67], v[200:203]
    v_exp_f32 v154, v154
    v_mfma_f32_16x16x32_bf16 v[188:191], v[212:215], v[96:99], v[204:207]
    v_mfma_f32_16x16x32_bf16 v[164:167], v[216:219], v[4:7], v[164:167]
    ds_read_b128 v[208:211], v236 offset:42624
    v_add_f32 v248, v152, v153
    v_mfma_f32_16x16x32_bf16 v[172:175], v[216:219], v[36:39], v[172:175]
    v_cvt_pk_bf16_f32 v152, v152, v153
    v_mfma_f32_16x16x32_bf16 v[180:183], v[216:219], v[68:71], v[180:183]
    v_exp_f32 v155, v155
    v_mfma_f32_16x16x32_bf16 v[188:191], v[216:219], v[100:103], v[188:191]
    s_waitcnt lgkmcnt(3)
    v_mfma_f32_16x16x32_bf16 v[164:167], v[220:223], v[8:11], v[164:167]
    ds_read_b128 v[212:215], v236 offset:42688
    v_add_f32 v248, v248, v154
    v_mfma_f32_16x16x32_bf16 v[172:175], v[220:223], v[40:43], v[172:175]
    v_exp_f32 v156, v156
    v_mfma_f32_16x16x32_bf16 v[180:183], v[220:223], v[72:75], v[180:183]
    v_mfma_f32_16x16x32_bf16 v[188:191], v[220:223], v[104:107], v[188:191]
    v_add_f32 v248, v248, v155
    v_mfma_f32_16x16x32_bf16 v[164:167], v[224:227], v[12:15], v[164:167]
    v_cvt_pk_bf16_f32 v153, v154, v155
    v_mfma_f32_16x16x32_bf16 v[172:175], v[224:227], v[44:47], v[172:175]
    v_exp_f32 v157, v157
    v_mfma_f32_16x16x32_bf16 v[180:183], v[224:227], v[76:79], v[180:183]
    s_waitcnt vmcnt(4) lgkmcnt(0)
    s_barrier
    v_mfma_f32_16x16x32_bf16 v[188:191], v[224:227], v[108:111], v[188:191]
    ds_read_b64_tr_b16 v[216:217], v237 offset:0
    v_mfma_f32_16x16x32_bf16 v[164:167], v[228:231], v[16:19], v[164:167]
    ds_read_b64_tr_b16 v[218:219], v237 offset:8704
    v_add_f32 v248, v248, v156
    v_mfma_f32_16x16x32_bf16 v[172:175], v[228:231], v[48:51], v[172:175]
    ds_read_b64_tr_b16 v[220:221], v238 offset:0
    ds_read_b64_tr_b16 v[222:223], v238 offset:8704
    v_mfma_f32_16x16x32_bf16 v[180:183], v[228:231], v[80:83], v[180:183]
    v_exp_f32 v158, v158
    v_mfma_f32_16x16x32_bf16 v[188:191], v[228:231], v[112:115], v[188:191]
    v_add_f32 v248, v248, v157
    v_cvt_pk_bf16_f32 v154, v156, v157
    v_mfma_f32_16x16x32_bf16 v[164:167], v[232:235], v[20:23], v[164:167]
    ds_read_b64_tr_b16 v[224:225], v237 offset:64
    ds_read_b64_tr_b16 v[226:227], v237 offset:8768
    v_mfma_f32_16x16x32_bf16 v[172:175], v[232:235], v[52:55], v[172:175]
    v_exp_f32 v159, v159
    v_mfma_f32_16x16x32_bf16 v[180:183], v[232:235], v[84:87], v[180:183]
    s_add_u32 m0, s23, 34816
    v_add_f32 v248, v248, v158
    v_mfma_f32_16x16x32_bf16 v[188:191], v[232:235], v[116:119], v[188:191]
    buffer_load_dwordx4 v240, s[8:11], s20 offen offset:0 lds
    v_mfma_f32_16x16x32_bf16 v[164:167], v[208:211], v[24:27], v[164:167]
    v_add_f32 v248, v248, v159
    ds_read_b64_tr_b16 v[228:229], v238 offset:64
    v_mfma_f32_16x16x32_bf16 v[172:175], v[208:211], v[56:59], v[172:175]
    ds_read_b64_tr_b16 v[230:231], v238 offset:8768
    v_cvt_pk_bf16_f32 v155, v158, v159
    v_mfma_f32_16x16x32_bf16 v[180:183], v[208:211], v[88:91], v[180:183]
    s_add_u32 m0, s23, 34880
    v_max3_f32 v249, v245, v246, v247
    v_mfma_f32_16x16x32_bf16 v[188:191], v[208:211], v[120:123], v[188:191]
    buffer_load_dwordx4 v240, s[8:11], s20 offen offset:1024 lds
    v_max_f32 v249, v249, v248
    v_mfma_f32_16x16x32_bf16 v[164:167], v[212:215], v[28:31], v[164:167]
    ds_read_b64_tr_b16 v[208:209], v237 offset:128
    ds_read_b64_tr_b16 v[210:211], v237 offset:8832
    v_mfma_f32_16x16x32_bf16 v[172:175], v[212:215], v[60:63], v[172:175]
    v_cmp_lt_f32 vcc, s25, v249
    s_add_u32 m0, s23, 34944
    v_mfma_f32_16x16x32_bf16 v[180:183], v[212:215], v[92:95], v[180:183]
    buffer_load_dwordx4 v240, s[8:11], s20 offen offset:2048 lds
    v_mfma_f32_16x16x32_bf16 v[188:191], v[212:215], v[124:127], v[188:191]
    s_cbranch_vccnz K2_tramp_4
K2_ret_4:
    s_waitcnt lgkmcnt(6)
    v_mfma_f32_16x16x32_bf16 a[0:3], v[216:219], v[128:131], a[0:3]
    ds_read_b64_tr_b16 v[212:213], v238 offset:128
    ds_read_b64_tr_b16 v[214:215], v238 offset:8832
    v_mfma_f32_16x16x32_bf16 a[4:7], v[216:219], v[136:139], a[4:7]
    s_add_u32 m0, s23, 35008
    v_mfma_f32_16x16x32_bf16 a[8:11], v[216:219], v[144:147], a[8:11]
    buffer_load_dwordx4 v240, s[8:11], s20 offen offset:3072 lds
    v_mfma_f32_16x16x32_bf16 a[12:15], v[216:219], v[152:155], a[12:15]
    v_mfma_f32_16x16x32_bf16 a[16:19], v[220:223], v[128:131], a[16:19]
    ds_read_b64_tr_b16 v[216:217], v237 offset:192
    ds_read_b64_tr_b16 v[218:219], v237 offset:8896
    v_mfma_f32_16x16x32_bf16 a[20:23], v[220:223], v[136:139], a[20:23]
    v_exp_f32 v160, v160
    v_mfma_f32_16x16x32_bf16 a[24:27], v[220:223], v[144:147], a[24:27]
    v_exp_f32 v161, v161
    v_mfma_f32_16x16x32_bf16 a[28:31], v[220:223], v[152:155], a[28:31]
    s_add_u32 m0, s23, 39168
    s_waitcnt lgkmcnt(6)
    v_mfma_f32_16x16x32_bf16 a[32:35], v[224:227], v[128:131], a[32:35]
    buffer_load_dwordx4 v240, s[8:11], s21 offen offset:0 lds
    ds_read_b64_tr_b16 v[220:221], v238 offset:192
    v_mfma_f32_16x16x32_bf16 a[36:39], v[224:227], v[136:139], a[36:39]
    ds_read_b64_tr_b16 v[222:223], v238 offset:8896
    v_add_f32 v241, v241, v245
    v_mfma_f32_16x16x32_bf16 a[40:43], v[224:227], v[144:147], a[40:43]
    v_exp_f32 v162, v162
    v_mfma_f32_16x16x32_bf16 a[44:47], v[224:227], v[152:155], a[44:47]
    s_add_u32 m0, s23, 39232
    v_add_f32 v245, v160, v161
    v_mfma_f32_16x16x32_bf16 a[48:51], v[228:231], v[128:131], a[48:51]
    buffer_load_dwordx4 v240, s[8:11], s21 offen offset:1024 lds
    ds_read_b64_tr_b16 v[224:225], v237 offset:256
    v_mfma_f32_16x16x32_bf16 a[52:55], v[228:231], v[136:139], a[52:55]
    ds_read_b64_tr_b16 v[226:227], v237 offset:8960
    v_cvt_pk_bf16_f32 v160, v160, v161
    v_mfma_f32_16x16x32_bf16 a[56:59], v[228:231], v[144:147], a[56:59]
    v_exp_f32 v163, v163
    v_mfma_f32_16x16x32_bf16 a[60:63], v[228:231], v[152:155], a[60:63]
    v_add_f32 v245, v245, v162
    s_waitcnt lgkmcnt(6)
    v_mfma_f32_16x16x32_bf16 a[64:67], v[208:211], v[128:131], a[64:67]
    s_add_u32 m0, s23, 39296
    ds_read_b64_tr_b16 v[228:229], v238 offset:256
    v_mfma_f32_16x16x32_bf16 a[68:71], v[208:211], v[136:139], a[68:71]
    ds_read_b64_tr_b16 v[230:231], v238 offset:8960
    buffer_load_dwordx4 v240, s[8:11], s21 offen offset:2048 lds
    v_mfma_f32_16x16x32_bf16 a[72:75], v[208:211], v[144:147], a[72:75]
    v_exp_f32 v164, v164
    v_mfma_f32_16x16x32_bf16 a[76:79], v[208:211], v[152:155], a[76:79]
    v_add_f32 v245, v245, v163
    v_cvt_pk_bf16_f32 v161, v162, v163
    v_mfma_f32_16x16x32_bf16 a[80:83], v[212:215], v[128:131], a[80:83]
    s_add_u32 m0, s23, 39360
    ds_read_b64_tr_b16 v[208:209], v237 offset:320
    v_mfma_f32_16x16x32_bf16 a[84:87], v[212:215], v[136:139], a[84:87]
    ds_read_b64_tr_b16 v[210:211], v237 offset:9024
    buffer_load_dwordx4 v240, s[8:11], s21 offen offset:3072 lds
    v_mfma_f32_16x16x32_bf16 a[88:91], v[212:215], v[144:147], a[88:91]
    v_exp_f32 v165, v165
    v_mfma_f32_16x16x32_bf16 a[92:95], v[212:215], v[152:155], a[92:95]
    v_add_f32 v245, v245, v164
    s_waitcnt lgkmcnt(6)
    v_mfma_f32_16x16x32_bf16 a[96:99], v[216:219], v[128:131], a[96:99]
    v_exp_f32 v166, v166
    v_mfma_f32_16x16x32_bf16 a[100:103], v[216:219], v[136:139], a[100:103]
    ds_read_b64_tr_b16 v[212:213], v238 offset:320
    ds_read_b64_tr_b16 v[214:215], v238 offset:9024
    v_mfma_f32_16x16x32_bf16 a[104:107], v[216:219], v[144:147], a[104:107]
    v_add_f32 v245, v245, v165
    v_cvt_pk_bf16_f32 v162, v164, v165
    v_mfma_f32_16x16x32_bf16 a[108:111], v[216:219], v[152:155], a[108:111]
    v_exp_f32 v167, v167
    v_mfma_f32_16x16x32_bf16 a[112:115], v[220:223], v[128:131], a[112:115]
    ds_read_b64_tr_b16 v[216:217], v237 offset:384
    ds_read_b64_tr_b16 v[218:219], v237 offset:9088
    v_mfma_f32_16x16x32_bf16 a[116:119], v[220:223], v[136:139], a[116:119]
    v_add_f32 v245, v245, v166
    v_mfma_f32_16x16x32_bf16 a[120:123], v[220:223], v[144:147], a[120:123]
    v_add_f32 v245, v245, v167
    v_mfma_f32_16x16x32_bf16 a[124:127], v[220:223], v[152:155], a[124:127]
    v_cvt_pk_bf16_f32 v163, v166, v167
    s_waitcnt lgkmcnt(6)
    v_mfma_f32_16x16x32_bf16 a[128:131], v[224:227], v[128:131], a[128:131]
    ds_read_b64_tr_b16 v[220:221], v238 offset:384
    ds_read_b64_tr_b16 v[222:223], v238 offset:9088
    v_mfma_f32_16x16x32_bf16 a[132:135], v[224:227], v[136:139], a[132:135]
    s_add_u32 s49, s51, 0
    buffer_load_dword v255, v250, s[60:63], s49 offen
    v_mfma_f32_16x16x32_bf16 a[136:139], v[224:227], v[144:147], a[136:139]
    v_exp_f32 v168, v168
    v_mfma_f32_16x16x32_bf16 a[140:143], v[224:227], v[152:155], a[140:143]
    v_exp_f32 v169, v169
    v_mfma_f32_16x16x32_bf16 a[144:147], v[228:231], v[128:131], a[144:147]
    ds_read_b64_tr_b16 v[224:225], v237 offset:448
    ds_read_b64_tr_b16 v[226:227], v237 offset:9152
    v_mfma_f32_16x16x32_bf16 a[148:151], v[228:231], v[136:139], a[148:151]
    v_add_f32 v242, v242, v246
    v_mfma_f32_16x16x32_bf16 a[152:155], v[228:231], v[144:147], a[152:155]
    v_exp_f32 v170, v170
    v_mfma_f32_16x16x32_bf16 a[156:159], v[228:231], v[152:155], a[156:159]
    s_add_u32 s49, s51, 16384
    s_waitcnt lgkmcnt(6)
    v_mfma_f32_16x16x32_bf16 a[160:163], v[208:211], v[128:131], a[160:163]
    buffer_load_dword v255, v250, s[60:63], s49 offen
    ds_read_b64_tr_b16 v[228:229], v238 offset:448
    v_mfma_f32_16x16x32_bf16 a[164:167], v[208:211], v[136:139], a[164:167]
    ds_read_b64_tr_b16 v[230:231], v238 offset:9152
    v_add_f32 v246, v168, v169
    v_mfma_f32_16x16x32_bf16 a[168:171], v[208:211], v[144:147], a[168:171]
    v_cvt_pk_bf16_f32 v168, v168, v169
    v_mfma_f32_16x16x32_bf16 a[172:175], v[208:211], v[152:155], a[172:175]
    v_exp_f32 v171, v171
    v_mfma_f32_16x16x32_bf16 a[176:179], v[212:215], v[128:131], a[176:179]
    v_add_f32 v246, v246, v170
    s_add_u32 s49, s51, 32768
    v_mfma_f32_16x16x32_bf16 a[180:183], v[212:215], v[136:139], a[180:183]
    v_exp_f32 v172, v172
    v_mfma_f32_16x16x32_bf16 a[184:187], v[212:215], v[144:147], a[184:187]
    buffer_load_dword v255, v250, s[60:63], s49 offen
    v_mfma_f32_16x16x32_bf16 a[188:191], v[212:215], v[152:155], a[188:191]
    v_add_f32 v246, v246, v171
    s_waitcnt lgkmcnt(4)
    v_mfma_f32_16x16x32_bf16 a[192:195], v[216:219], v[128:131], a[192:195]
    v_cvt_pk_bf16_f32 v169, v170, v171
    v_mfma_f32_16x16x32_bf16 a[196:199], v[216:219], v[136:139], a[196:199]
    v_exp_f32 v173, v173
    v_mfma_f32_16x16x32_bf16 a[200:203], v[216:219], v[144:147], a[200:203]
    s_add_u32 s49, s51, 49152
    v_mfma_f32_16x16x32_bf16 a[204:207], v[216:219], v[152:155], a[204:207]
    v_add_f32 v246, v246, v172
    buffer_load_dword v255, v250, s[60:63], s49 offen
    v_mfma_f32_16x16x32_bf16 a[208:211], v[220:223], v[128:131], a[208:211]
    v_exp_f32 v174, v174
    v_mfma_f32_16x16x32_bf16 a[212:215], v[220:223], v[136:139], a[212:215]
    v_mfma_f32_16x16x32_bf16 a[216:219], v[220:223], v[144:147], a[216:219]
    v_add_f32 v246, v246, v173
    v_mfma_f32_16x16x32_bf16 a[220:223], v[220:223], v[152:155], a[220:223]
    v_cvt_pk_bf16_f32 v170, v172, v173
    s_waitcnt lgkmcnt(0)
    v_mfma_f32_16x16x32_bf16 a[224:227], v[224:227], v[128:131], a[224:227]
    v_exp_f32 v175, v175
    v_mfma_f32_16x16x32_bf16 a[228:231], v[224:227], v[136:139], a[228:231]
    v_mfma_f32_16x16x32_bf16 a[232:235], v[224:227], v[144:147], a[232:235]
    v_add_f32 v246, v246, v174
    buffer_load_dword v255, v250, s[56:59], s72 offen
    v_mfma_f32_16x16x32_bf16 a[236:239], v[224:227], v[152:155], a[236:239]
    v_add_f32 v246, v246, v175
    v_mfma_f32_16x16x32_bf16 a[240:243], v[228:231], v[128:131], a[240:243]
    v_cvt_pk_bf16_f32 v171, v174, v175
    v_mfma_f32_16x16x32_bf16 a[244:247], v[228:231], v[136:139], a[244:247]
    s_add_u32 s20, s20, 32768
    s_add_u32 s21, s21, 32768
    v_mfma_f32_16x16x32_bf16 a[248:251], v[228:231], v[144:147], a[248:251]
    v_mfma_f32_16x16x32_bf16 a[252:255], v[228:231], v[152:155], a[252:255]
    v_lshrrev_b32 v251, 2, v250
    s_xor_b32 s49, s27, 2
    s_lshl_b32 s49, s49, 11
    s_add_u32 s49, s49, 139264
    v_add_u32 v236, s49, v251
    s_lshl_b32 s49, s27, 11
    s_add_u32 s49, s49, 139264
    v_add_u32 v239, s49, v251
    v_exp_f32 v176, v176
    v_exp_f32 v177, v177
    v_add_f32 v243, v243, v247
    v_exp_f32 v178, v178
    v_add_f32 v247, v176, v177
    v_cvt_pk_bf16_f32 v176, v176, v177
    v_exp_f32 v179, v179
    v_add_f32 v247, v247, v178
    v_exp_f32 v180, v180
    v_add_f32 v247, v247, v179
    v_cvt_pk_bf16_f32 v177, v178, v179
    v_exp_f32 v181, v181
    v_add_f32 v247, v247, v180
    v_exp_f32 v182, v182
    v_add_f32 v247, v247, v181
    v_cvt_pk_bf16_f32 v178, v180, v181
    v_exp_f32 v183, v183
    v_add_f32 v247, v247, v182
    v_add_f32 v247, v247, v183
    v_cvt_pk_bf16_f32 v179, v182, v183
    v_exp_f32 v184, v184
    v_exp_f32 v185, v185
    v_add_f32 v244, v244, v248
    v_exp_f32 v186, v186
    v_add_f32 v248, v184, v185
    v_cvt_pk_bf16_f32 v184, v184, v185
    v_exp_f32 v187, v187
    v_add_f32 v248, v248, v186
    v_exp_f32 v188, v188
    v_add_f32 v248, v248, v187
    v_cvt_pk_bf16_f32 v185, v186, v187
    v_exp_f32 v189, v189
    s_waitcnt vmcnt(5) lgkmcnt(0)
    s_barrier
    ds_read_b64_tr_b16 v[216:217], v237 offset:34816
    ds_read_b64_tr_b16 v[218:219], v237 offset:43520
    v_add_f32 v248, v248, v188
    ds_read_b64_tr_b16 v[220:221], v238 offset:34816
    ds_read_b64_tr_b16 v[222:223], v238 offset:43520
    v_exp_f32 v190, v190
    v_add_f32 v248, v248, v189
    v_cvt_pk_bf16_f32 v186, v188, v189
    ds_read_b64_tr_b16 v[224:225], v237 offset:34880
    ds_read_b64_tr_b16 v[226:227], v237 offset:43584
    v_exp_f32 v191, v191
    v_add_f32 v248, v248, v190
    v_add_f32 v248, v248, v191
    ds_read_b64_tr_b16 v[228:229], v238 offset:34880
    ds_read_b64_tr_b16 v[230:231], v238 offset:43584
    v_cvt_pk_bf16_f32 v187, v190, v191
    v_max3_f32 v249, v245, v246, v247
    v_max_f32 v249, v249, v248
    ds_read_b64_tr_b16 v[208:209], v237 offset:34944
    ds_read_b64_tr_b16 v[210:211], v237 offset:43648
    v_cmp_lt_f32 vcc, s25, v249
    s_cbranch_vccnz K2_tramp_5
K2_ret_5:
    s_waitcnt lgkmcnt(6)
    v_mfma_f32_16x16x32_bf16 a[0:3], v[216:219], v[160:163], a[0:3]
    ds_read_b64_tr_b16 v[212:213], v238 offset:34944
    ds_read_b64_tr_b16 v[214:215], v238 offset:43648
    v_mfma_f32_16x16x32_bf16 a[4:7], v[216:219], v[168:171], a[4:7]
    v_add_f32 v132, v241, v245
    v_mfma_f32_16x16x32_bf16 a[8:11], v[216:219], v[176:179], a[8:11]
    v_add_f32 v133, v242, v246
    v_mfma_f32_16x16x32_bf16 a[12:15], v[216:219], v[184:187], a[12:15]
    v_add_f32 v134, v243, v247
    v_mfma_f32_16x16x32_bf16 a[16:19], v[220:223], v[160:163], a[16:19]
    ds_read_b64_tr_b16 v[216:217], v237 offset:35008
    ds_read_b64_tr_b16 v[218:219], v237 offset:43712
    v_mfma_f32_16x16x32_bf16 a[20:23], v[220:223], v[168:171], a[20:23]
    v_add_f32 v135, v244, v248
    v_mov_b32 v136, v132
    v_mfma_f32_16x16x32_bf16 a[24:27], v[220:223], v[176:179], a[24:27]
    v_mov_b32 v137, v133
    v_mfma_f32_16x16x32_bf16 a[28:31], v[220:223], v[184:187], a[28:31]
    v_mov_b32 v138, v134
    s_waitcnt lgkmcnt(6)
    v_mfma_f32_16x16x32_bf16 a[32:35], v[224:227], v[160:163], a[32:35]
    ds_read_b64_tr_b16 v[220:221], v238 offset:35008
    ds_read_b64_tr_b16 v[222:223], v238 offset:43712
    v_mfma_f32_16x16x32_bf16 a[36:39], v[224:227], v[168:171], a[36:39]
    v_mov_b32 v139, v135
    v_mfma_f32_16x16x32_bf16 a[40:43], v[224:227], v[176:179], a[40:43]
    v_permlane16_swap_b32 v132, v136
    v_mfma_f32_16x16x32_bf16 a[44:47], v[224:227], v[184:187], a[44:47]
    v_permlane16_swap_b32 v133, v137
    v_mfma_f32_16x16x32_bf16 a[48:51], v[228:231], v[160:163], a[48:51]
    ds_read_b64_tr_b16 v[224:225], v237 offset:35072
    ds_read_b64_tr_b16 v[226:227], v237 offset:43776
    v_mfma_f32_16x16x32_bf16 a[52:55], v[228:231], v[168:171], a[52:55]
    v_permlane16_swap_b32 v134, v138
    v_permlane16_swap_b32 v135, v139
    v_mfma_f32_16x16x32_bf16 a[56:59], v[228:231], v[176:179], a[56:59]
    v_add_f32 v132, v132, v136
    v_mfma_f32_16x16x32_bf16 a[60:63], v[228:231], v[184:187], a[60:63]
    v_add_f32 v133, v133, v137
    s_waitcnt lgkmcnt(6)
    v_mfma_f32_16x16x32_bf16 a[64:67], v[208:211], v[160:163], a[64:67]
    ds_read_b64_tr_b16 v[228:229], v238 offset:35072
    ds_read_b64_tr_b16 v[230:231], v238 offset:43776
    v_mfma_f32_16x16x32_bf16 a[68:71], v[208:211], v[168:171], a[68:71]
    v_add_f32 v134, v134, v138
    v_add_f32 v135, v135, v139
    v_mfma_f32_16x16x32_bf16 a[72:75], v[208:211], v[176:179], a[72:75]
    v_mov_b32 v136, v132
    v_mov_b32 v137, v133
    v_mfma_f32_16x16x32_bf16 a[76:79], v[208:211], v[184:187], a[76:79]
    v_mov_b32 v138, v134
    v_mov_b32 v139, v135
    v_mfma_f32_16x16x32_bf16 a[80:83], v[212:215], v[160:163], a[80:83]
    v_permlane32_swap_b32 v132, v136
    ds_read_b64_tr_b16 v[208:209], v237 offset:35136
    v_mfma_f32_16x16x32_bf16 a[84:87], v[212:215], v[168:171], a[84:87]
    ds_read_b64_tr_b16 v[210:211], v237 offset:43840
    v_permlane32_swap_b32 v133, v137
    v_mfma_f32_16x16x32_bf16 a[88:91], v[212:215], v[176:179], a[88:91]
    v_permlane32_swap_b32 v134, v138
    v_permlane32_swap_b32 v135, v139
    v_mfma_f32_16x16x32_bf16 a[92:95], v[212:215], v[184:187], a[92:95]
    v_add_f32 v132, v132, v136
    s_waitcnt lgkmcnt(6)
    v_mfma_f32_16x16x32_bf16 a[96:99], v[216:219], v[160:163], a[96:99]
    ds_read_b64_tr_b16 v[212:213], v238 offset:35136
    ds_read_b64_tr_b16 v[214:215], v238 offset:43840
    v_mfma_f32_16x16x32_bf16 a[100:103], v[216:219], v[168:171], a[100:103]
    v_add_f32 v133, v133, v137
    v_add_f32 v134, v134, v138
    v_mfma_f32_16x16x32_bf16 a[104:107], v[216:219], v[176:179], a[104:107]
    v_add_f32 v135, v135, v139
    v_mov_b32 v128, v192
    v_mfma_f32_16x16x32_bf16 a[108:111], v[216:219], v[184:187], a[108:111]
    v_mov_b32 v129, v196
    v_mov_b32 v130, v200
    v_mfma_f32_16x16x32_bf16 a[112:115], v[220:223], v[160:163], a[112:115]
    v_mov_b32 v131, v204
    ds_write_b128 v236, v[128:131]
    v_mfma_f32_16x16x32_bf16 a[116:119], v[220:223], v[168:171], a[116:119]
    ds_write_b128 v236, v[132:135] offset:1024
    ds_read_b64_tr_b16 v[216:217], v237 offset:35200
    v_mfma_f32_16x16x32_bf16 a[120:123], v[220:223], v[176:179], a[120:123]
    ds_read_b64_tr_b16 v[218:219], v237 offset:43904
    v_mfma_f32_16x16x32_bf16 a[124:127], v[220:223], v[184:187], a[124:127]
    s_waitcnt lgkmcnt(8)
    v_mfma_f32_16x16x32_bf16 a[128:131], v[224:227], v[160:163], a[128:131]
    ds_read_b64_tr_b16 v[220:221], v238 offset:35200
    ds_read_b64_tr_b16 v[222:223], v238 offset:43904
    v_mfma_f32_16x16x32_bf16 a[132:135], v[224:227], v[168:171], a[132:135]
    v_mfma_f32_16x16x32_bf16 a[136:139], v[224:227], v[176:179], a[136:139]
    v_mfma_f32_16x16x32_bf16 a[140:143], v[224:227], v[184:187], a[140:143]
    v_mfma_f32_16x16x32_bf16 a[144:147], v[228:231], v[160:163], a[144:147]
    ds_read_b64_tr_b16 v[224:225], v237 offset:35264
    s_waitcnt lgkmcnt(5)
    s_barrier
    v_mfma_f32_16x16x32_bf16 a[148:151], v[228:231], v[168:171], a[148:151]
    ds_read_b64_tr_b16 v[226:227], v237 offset:43968
    ds_read_b128 v[136:139], v239
    v_mfma_f32_16x16x32_bf16 a[152:155], v[228:231], v[176:179], a[152:155]
    ds_read_b128 v[140:143], v239 offset:1024
    v_mfma_f32_16x16x32_bf16 a[156:159], v[228:231], v[184:187], a[156:159]
    v_mfma_f32_16x16x32_bf16 a[160:163], v[208:211], v[160:163], a[160:163]
    ds_read_b64_tr_b16 v[228:229], v238 offset:35264
    ds_read_b64_tr_b16 v[230:231], v238 offset:43968
    v_mfma_f32_16x16x32_bf16 a[164:167], v[208:211], v[168:171], a[164:167]
    v_mfma_f32_16x16x32_bf16 a[168:171], v[208:211], v[176:179], a[168:171]
    v_mfma_f32_16x16x32_bf16 a[172:175], v[208:211], v[184:187], a[172:175]
    s_waitcnt lgkmcnt(2)
    v_min_f32 v252, v128, v136
    v_mfma_f32_16x16x32_bf16 a[176:179], v[212:215], v[160:163], a[176:179]
    v_sub_f32 v253, v252, v128
    v_sub_f32 v254, v252, v136
    v_mfma_f32_16x16x32_bf16 a[180:183], v[212:215], v[168:171], a[180:183]
    v_exp_f32 v253, v253
    v_mfma_f32_16x16x32_bf16 a[184:187], v[212:215], v[176:179], a[184:187]
    v_exp_f32 v254, v254
    v_mfma_f32_16x16x32_bf16 a[188:191], v[212:215], v[184:187], a[188:191]
    v_mul_f32 v252, v253, v132
    v_mfma_f32_16x16x32_bf16 a[192:195], v[216:219], v[160:163], a[192:195]
    s_nop 0
    v_fmac_f32 v252, v254, v140
    v_mfma_f32_16x16x32_bf16 a[196:199], v[216:219], v[168:171], a[196:199]
    v_rcp_f32 v252, v252
    v_mfma_f32_16x16x32_bf16 a[200:203], v[216:219], v[176:179], a[200:203]
    s_nop 0
    v_mul_f32 v144, v253, v252
    v_mfma_f32_16x16x32_bf16 a[204:207], v[216:219], v[184:187], a[204:207]
    v_mul_f32 v145, v253, v252
    v_mul_f32 v152, v254, v252
    v_mfma_f32_16x16x32_bf16 a[208:211], v[220:223], v[160:163], a[208:211]
    v_mul_f32 v153, v254, v252
    v_min_f32 v252, v129, v137
    v_mfma_f32_16x16x32_bf16 a[212:215], v[220:223], v[168:171], a[212:215]
    v_sub_f32 v253, v252, v129
    v_sub_f32 v254, v252, v137
    v_mfma_f32_16x16x32_bf16 a[216:219], v[220:223], v[176:179], a[216:219]
    v_exp_f32 v253, v253
    v_mfma_f32_16x16x32_bf16 a[220:223], v[220:223], v[184:187], a[220:223]
    s_waitcnt lgkmcnt(0)
    v_mfma_f32_16x16x32_bf16 a[224:227], v[224:227], v[160:163], a[224:227]
    v_exp_f32 v254, v254
    v_mfma_f32_16x16x32_bf16 a[228:231], v[224:227], v[168:171], a[228:231]
    v_mul_f32 v252, v253, v133
    s_nop 0
    v_mfma_f32_16x16x32_bf16 a[232:235], v[224:227], v[176:179], a[232:235]
    v_fmac_f32 v252, v254, v141
    v_mfma_f32_16x16x32_bf16 a[236:239], v[224:227], v[184:187], a[236:239]
    v_rcp_f32 v252, v252
    v_mfma_f32_16x16x32_bf16 a[240:243], v[228:231], v[160:163], a[240:243]
    s_nop 0
    v_mul_f32 v146, v253, v252
    v_mfma_f32_16x16x32_bf16 a[244:247], v[228:231], v[168:171], a[244:247]
    v_mul_f32 v147, v253, v252
    v_mul_f32 v154, v254, v252
    v_mfma_f32_16x16x32_bf16 a[248:251], v[228:231], v[176:179], a[248:251]
    v_mul_f32 v155, v254, v252
    v_min_f32 v252, v130, v138
    v_mfma_f32_16x16x32_bf16 a[252:255], v[228:231], v[184:187], a[252:255]
    v_sub_f32 v253, v252, v130
    v_sub_f32 v254, v252, v138
    v_exp_f32 v253, v253
    v_exp_f32 v254, v254
    v_mul_f32 v252, v253, v134
    s_nop 0
    v_fmac_f32 v252, v254, v142
    v_rcp_f32 v252, v252
    s_nop 0
    v_mul_f32 v148, v253, v252
    v_mul_f32 v149, v253, v252
    v_mul_f32 v156, v254, v252
    v_mul_f32 v157, v254, v252
    v_min_f32 v252, v131, v139
    v_sub_f32 v253, v252, v131
    v_sub_f32 v254, v252, v139
    v_exp_f32 v253, v253
    v_exp_f32 v254, v254
    v_mul_f32 v252, v253, v135
    s_nop 0
    v_fmac_f32 v252, v254, v143
    v_rcp_f32 v252, v252
    s_nop 0
    v_mul_f32 v150, v253, v252
    v_mul_f32 v151, v253, v252
    v_mul_f32 v158, v254, v252
    v_mul_f32 v159, v254, v252
    s_add_u32 s20, s20, 32768
    s_add_u32 s21, s21, 32768
    v_lshrrev_b32 v240, 6, v250
    v_lshrrev_b32 v244, 2, v250
    s_xor_b32 s49, s27, 2
    s_lshl_b32 s49, s49, 15
    v_add_u32 v236, s49, v244
    s_lshl_b32 s49, s27, 15
    v_add_u32 v237, s49, v244
    s_mul_i32 s47, s27, 7168
    s_waitcnt lgkmcnt(0)
    s_barrier
    s_cmp_eq_u32 s43, 0
    s_cbranch_scc1 K2_send0
    ds_write_b128 v236, a[0:3] offset:0
    v_add_u32 v245, 0, v240
    v_mul_u32_u24 v246, 0x925, v245
    v_lshrrev_b32 v246, 17, v246
    v_and_b32 v246, 6, v246
    ds_write_b128 v236, a[4:7] offset:1024
    v_xor_b32 v245, v245, v246
    v_lshlrev_b32 v245, 4, v245
    v_subrev_u32 v245, 0, v245
    v_add_u32 v204, s47, v245
    ds_write_b128 v236, a[8:11] offset:2048
    v_add_u32 v245, 64, v240
    v_mul_u32_u24 v246, 0x925, v245
    v_lshrrev_b32 v246, 17, v246
    v_and_b32 v246, 6, v246
    ds_write_b128 v236, a[12:15] offset:3072
    v_xor_b32 v245, v245, v246
    v_lshlrev_b32 v245, 4, v245
    v_subrev_u32 v245, 1024, v245
    v_add_u32 v205, s47, v245
    ds_write_b128 v236, a[16:19] offset:4096
    v_add_u32 v245, 128, v240
    v_mul_u32_u24 v246, 0x925, v245
    v_lshrrev_b32 v246, 17, v246
    v_and_b32 v246, 6, v246
    ds_write_b128 v236, a[20:23] offset:5120
    v_xor_b32 v245, v245, v246
    v_lshlrev_b32 v245, 4, v245
    v_subrev_u32 v245, 2048, v245
    v_add_u32 v206, s47, v245
    ds_write_b128 v236, a[24:27] offset:6144
    v_add_u32 v245, 192, v240
    v_mul_u32_u24 v246, 0x925, v245
    v_lshrrev_b32 v246, 17, v246
    v_and_b32 v246, 6, v246
    ds_write_b128 v236, a[28:31] offset:7168
    v_xor_b32 v245, v245, v246
    v_lshlrev_b32 v245, 4, v245
    v_subrev_u32 v245, 3072, v245
    v_add_u32 v207, s47, v245
    ds_write_b128 v236, a[32:35] offset:8192
    v_add_u32 v245, 256, v240
    v_mul_u32_u24 v246, 0x925, v245
    v_lshrrev_b32 v246, 17, v246
    v_and_b32 v246, 6, v246
    ds_write_b128 v236, a[36:39] offset:9216
    v_xor_b32 v245, v245, v246
    v_lshlrev_b32 v245, 4, v245
    v_subrev_u32 v245, 0, v245
    v_add_u32 v208, s47, v245
    ds_write_b128 v236, a[40:43] offset:10240
    v_add_u32 v245, 320, v240
    v_mul_u32_u24 v246, 0x925, v245
    v_lshrrev_b32 v246, 17, v246
    v_and_b32 v246, 6, v246
    ds_write_b128 v236, a[44:47] offset:11264
    v_xor_b32 v245, v245, v246
    v_lshlrev_b32 v245, 4, v245
    v_subrev_u32 v245, 1024, v245
    v_add_u32 v209, s47, v245
    ds_write_b128 v236, a[48:51] offset:12288
    v_add_u32 v245, 384, v240
    v_mul_u32_u24 v246, 0x925, v245
    v_lshrrev_b32 v246, 17, v246
    v_and_b32 v246, 6, v246
    ds_write_b128 v236, a[52:55] offset:13312
    v_xor_b32 v245, v245, v246
    v_lshlrev_b32 v245, 4, v245
    v_subrev_u32 v245, 2048, v245
    v_add_u32 v210, s47, v245
    ds_write_b128 v236, a[56:59] offset:14336
    s_mov_b32 s48, 0
    s_add_u32 m0, s47, 135168
    s_nop 0
    buffer_load_dwordx4 v204, s[68:71], s48 offen offset:0 lds
    ds_write_b128 v236, a[60:63] offset:15360
    buffer_load_dwordx4 v205, s[68:71], s48 offen offset:1024 lds
    buffer_load_dwordx4 v206, s[68:71], s48 offen offset:2048 lds
    buffer_load_dwordx4 v207, s[68:71], s48 offen offset:3072 lds
    s_add_u32 m0, s47, 139264
    ds_write_b128 v236, a[64:67] offset:16384
    s_nop 0
    buffer_load_dwordx4 v208, s[68:71], s48 offen offset:0 lds
    buffer_load_dwordx4 v209, s[68:71], s48 offen offset:1024 lds
    buffer_load_dwordx4 v210, s[68:71], s48 offen offset:2048 lds
    ds_write_b128 v236, a[68:71] offset:17408
    v_lshrrev_b32 v241, 4, v240
    v_bfe_u32 v242, v240, 2, 2
    v_and_b32 v243, 3, v240
    v_lshl_add_u32 v245, v241, 2, v242
    ds_write_b128 v236, a[72:75] offset:18432
    v_bfe_u32 v246, v245, 1, 2
    v_mul_u32_u24 v245, 896, v245
    v_lshl_add_u32 v245, v243, 3, v245
    s_mul_i32 s49, s27, 7
    ds_write_b128 v236, a[76:79] offset:19456
    s_add_u32 s50, s49, 0
    v_xor_b32 v238, s50, v246
    v_lshl_add_u32 v211, v238, 5, v245
    v_add_u32 v218, 135168, v211
    ds_write_b128 v236, a[80:83] offset:20480
    s_add_u32 s50, s49, 1
    v_xor_b32 v238, s50, v246
    v_lshl_add_u32 v212, v238, 5, v245
    v_add_u32 v219, 135168, v212
    ds_write_b128 v236, a[84:87] offset:21504
    s_add_u32 s50, s49, 2
    v_xor_b32 v238, s50, v246
    v_lshl_add_u32 v213, v238, 5, v245
    v_add_u32 v220, 135168, v213
    ds_write_b128 v236, a[88:91] offset:22528
    s_add_u32 s50, s49, 3
    v_xor_b32 v238, s50, v246
    v_lshl_add_u32 v214, v238, 5, v245
    v_add_u32 v221, 135168, v214
    ds_write_b128 v236, a[92:95] offset:23552
    s_add_u32 s50, s49, 4
    v_xor_b32 v238, s50, v246
    v_lshl_add_u32 v215, v238, 5, v245
    v_add_u32 v222, 135168, v215
    ds_write_b128 v236, a[96:99] offset:24576
    s_add_u32 s50, s49, 5
    v_xor_b32 v238, s50, v246
    v_lshl_add_u32 v216, v238, 5, v245
    v_add_u32 v223, 135168, v216
    ds_write_b128 v236, a[100:103] offset:25600
    s_add_u32 s50, s49, 6
    v_xor_b32 v238, s50, v246
    v_lshl_add_u32 v217, v238, 5, v245
    v_add_u32 v224, 135168, v217
    ds_write_b128 v236, a[104:107] offset:26624
    s_lshl_b32 s49, s42, 15
    s_lshl_b32 s50, s43, 14
    s_add_u32 s49, s49, s50
    s_add_u32 s49, s49, 65536
    ds_write_b128 v236, a[108:111] offset:27648
    v_add_u32 v238, s49, v244
    v_add_u32 v239, 65536, v244
    ds_write_b128 v236, a[112:115] offset:28672
    ds_write_b128 v236, a[116:119] offset:29696
    ds_write_b128 v236, a[120:123] offset:30720
    ds_write_b128 v236, a[124:127] offset:31744
    s_branch K2_sent
K2_send0:
    ds_write_b128 v236, a[128:131] offset:0
    v_add_u32 v245, 0, v240
    v_mul_u32_u24 v246, 0x925, v245
    v_lshrrev_b32 v246, 17, v246
    v_and_b32 v246, 6, v246
    ds_write_b128 v236, a[132:135] offset:1024
    v_xor_b32 v245, v245, v246
    v_lshlrev_b32 v245, 4, v245
    v_subrev_u32 v245, 0, v245
    v_add_u32 v204, s47, v245
    ds_write_b128 v236, a[136:139] offset:2048
    v_add_u32 v245, 64, v240
    v_mul_u32_u24 v246, 0x925, v245
    v_lshrrev_b32 v246, 17, v246
    v_and_b32 v246, 6, v246
    ds_write_b128 v236, a[140:143] offset:3072
    v_xor_b32 v245, v245, v246
    v_lshlrev_b32 v245, 4, v245
    v_subrev_u32 v245, 1024, v245
    v_add_u32 v205, s47, v245
    ds_write_b128 v236, a[144:147] offset:4096
    v_add_u32 v245, 128, v240
    v_mul_u32_u24 v246, 0x925, v245
    v_lshrrev_b32 v246, 17, v246
    v_and_b32 v246, 6, v246
    ds_write_b128 v236, a[148:151] offset:5120
    v_xor_b32 v245, v245, v246
    v_lshlrev_b32 v245, 4, v245
    v_subrev_u32 v245, 2048, v245
    v_add_u32 v206, s47, v245
    ds_write_b128 v236, a[152:155] offset:6144
    v_add_u32 v245, 192, v240
    v_mul_u32_u24 v246, 0x925, v245
    v_lshrrev_b32 v246, 17, v246
    v_and_b32 v246, 6, v246
    ds_write_b128 v236, a[156:159] offset:7168
    v_xor_b32 v245, v245, v246
    v_lshlrev_b32 v245, 4, v245
    v_subrev_u32 v245, 3072, v245
    v_add_u32 v207, s47, v245
    ds_write_b128 v236, a[160:163] offset:8192
    v_add_u32 v245, 256, v240
    v_mul_u32_u24 v246, 0x925, v245
    v_lshrrev_b32 v246, 17, v246
    v_and_b32 v246, 6, v246
    ds_write_b128 v236, a[164:167] offset:9216
    v_xor_b32 v245, v245, v246
    v_lshlrev_b32 v245, 4, v245
    v_subrev_u32 v245, 0, v245
    v_add_u32 v208, s47, v245
    ds_write_b128 v236, a[168:171] offset:10240
    v_add_u32 v245, 320, v240
    v_mul_u32_u24 v246, 0x925, v245
    v_lshrrev_b32 v246, 17, v246
    v_and_b32 v246, 6, v246
    ds_write_b128 v236, a[172:175] offset:11264
    v_xor_b32 v245, v245, v246
    v_lshlrev_b32 v245, 4, v245
    v_subrev_u32 v245, 1024, v245
    v_add_u32 v209, s47, v245
    ds_write_b128 v236, a[176:179] offset:12288
    v_add_u32 v245, 384, v240
    v_mul_u32_u24 v246, 0x925, v245
    v_lshrrev_b32 v246, 17, v246
    v_and_b32 v246, 6, v246
    ds_write_b128 v236, a[180:183] offset:13312
    v_xor_b32 v245, v245, v246
    v_lshlrev_b32 v245, 4, v245
    v_subrev_u32 v245, 2048, v245
    v_add_u32 v210, s47, v245
    ds_write_b128 v236, a[184:187] offset:14336
    s_mov_b32 s48, 0
    s_add_u32 m0, s47, 135168
    s_nop 0
    buffer_load_dwordx4 v204, s[68:71], s48 offen offset:0 lds
    ds_write_b128 v236, a[188:191] offset:15360
    buffer_load_dwordx4 v205, s[68:71], s48 offen offset:1024 lds
    buffer_load_dwordx4 v206, s[68:71], s48 offen offset:2048 lds
    buffer_load_dwordx4 v207, s[68:71], s48 offen offset:3072 lds
    s_add_u32 m0, s47, 139264
    ds_write_b128 v236, a[192:195] offset:16384
    s_nop 0
    buffer_load_dwordx4 v208, s[68:71], s48 offen offset:0 lds
    buffer_load_dwordx4 v209, s[68:71], s48 offen offset:1024 lds
    buffer_load_dwordx4 v210, s[68:71], s48 offen offset:2048 lds
    ds_write_b128 v236, a[196:199] offset:17408
    v_lshrrev_b32 v241, 4, v240
    v_bfe_u32 v242, v240, 2, 2
    v_and_b32 v243, 3, v240
    v_lshl_add_u32 v245, v241, 2, v242
    ds_write_b128 v236, a[200:203] offset:18432
    v_bfe_u32 v246, v245, 1, 2
    v_mul_u32_u24 v245, 896, v245
    v_lshl_add_u32 v245, v243, 3, v245
    s_mul_i32 s49, s27, 7
    ds_write_b128 v236, a[204:207] offset:19456
    s_add_u32 s50, s49, 0
    v_xor_b32 v238, s50, v246
    v_lshl_add_u32 v211, v238, 5, v245
    v_add_u32 v218, 135168, v211
    ds_write_b128 v236, a[208:211] offset:20480
    s_add_u32 s50, s49, 1
    v_xor_b32 v238, s50, v246
    v_lshl_add_u32 v212, v238, 5, v245
    v_add_u32 v219, 135168, v212
    ds_write_b128 v236, a[212:215] offset:21504
    s_add_u32 s50, s49, 2
    v_xor_b32 v238, s50, v246
    v_lshl_add_u32 v213, v238, 5, v245
    v_add_u32 v220, 135168, v213
    ds_write_b128 v236, a[216:219] offset:22528
    s_add_u32 s50, s49, 3
    v_xor_b32 v238, s50, v246
    v_lshl_add_u32 v214, v238, 5, v245
    v_add_u32 v221, 135168, v214
    ds_write_b128 v236, a[220:223] offset:23552
    s_add_u32 s50, s49, 4
    v_xor_b32 v238, s50, v246
    v_lshl_add_u32 v215, v238, 5, v245
    v_add_u32 v222, 135168, v215
    ds_write_b128 v236, a[224:227] offset:24576
    s_add_u32 s50, s49, 5
    v_xor_b32 v238, s50, v246
    v_lshl_add_u32 v216, v238, 5, v245
    v_add_u32 v223, 135168, v216
    ds_write_b128 v236, a[228:231] offset:25600
    s_add_u32 s50, s49, 6
    v_xor_b32 v238, s50, v246
    v_lshl_add_u32 v217, v238, 5, v245
    v_add_u32 v224, 135168, v217
    ds_write_b128 v236, a[232:235] offset:26624
    s_lshl_b32 s49, s42, 15
    s_lshl_b32 s50, s43, 14
    s_add_u32 s49, s49, s50
    s_add_u32 s49, s49, 65536
    ds_write_b128 v236, a[236:239] offset:27648
    v_add_u32 v238, s49, v244
    v_add_u32 v239, 65536, v244
    ds_write_b128 v236, a[240:243] offset:28672
    ds_write_b128 v236, a[244:247] offset:29696
    ds_write_b128 v236, a[248:251] offset:30720
    ds_write_b128 v236, a[252:255] offset:31744
K2_sent:
    s_waitcnt lgkmcnt(0)
    s_barrier
    s_cmp_eq_u32 s43, 0
    s_cbranch_scc1 K2_comb0
    ds_read_b128 v[0:3], v237 offset:0
    ds_read_b128 v[16:19], v237 offset:4096
    ds_read_b128 v[4:7], v237 offset:1024
    ds_read_b128 v[20:23], v237 offset:5120
    ds_read_b128 v[8:11], v237 offset:2048
    ds_read_b128 v[24:27], v237 offset:6144
    ds_read_b128 v[12:15], v237 offset:3072
    ds_read_b128 v[28:31], v237 offset:7168
    ds_read_b128 v[32:35], v237 offset:8192
    ds_read_b128 v[48:51], v237 offset:12288
    ds_read_b128 v[36:39], v237 offset:9216
    ds_read_b128 v[52:55], v237 offset:13312
    v_accvgpr_read_b32 v160, a128
    v_accvgpr_read_b32 v161, a129
    v_accvgpr_read_b32 v162, a130
    v_accvgpr_read_b32 v163, a131
    v_pk_mul_f32 v[160:161], v[160:161], v[144:145]
    v_pk_mul_f32 v[162:163], v[162:163], v[144:145]
    s_waitcnt lgkmcnt(11)
    ds_read_b128 v[40:43], v237 offset:10240
    ds_read_b128 v[56:59], v237 offset:14336
    ds_read_b128 v[44:47], v237 offset:11264
    v_pk_fma_f32 v[160:161], v[0:1], v[152:153], v[160:161]
    v_pk_fma_f32 v[162:163], v[2:3], v[152:153], v[162:163]
    v_cvt_pk_bf16_f32 v0, v160, v161
    v_cvt_pk_bf16_f32 v1, v162, v163
    v_accvgpr_read_b32 v164, a144
    v_accvgpr_read_b32 v165, a145
    v_accvgpr_read_b32 v166, a146
    v_accvgpr_read_b32 v167, a147
    v_pk_mul_f32 v[164:165], v[164:165], v[144:145]
    v_pk_mul_f32 v[166:167], v[166:167], v[144:145]
    s_waitcnt lgkmcnt(13)
    ds_read_b128 v[60:63], v237 offset:15360
    ds_read_b128 v[64:67], v237 offset:16384
    ds_read_b128 v[80:83], v237 offset:20480
    v_pk_fma_f32 v[164:165], v[16:17], v[152:153], v[164:165]
    v_pk_fma_f32 v[166:167], v[18:19], v[152:153], v[166:167]
    v_cvt_pk_bf16_f32 v2, v164, v165
    v_cvt_pk_bf16_f32 v3, v166, v167
    v_accvgpr_read_b32 v160, a132
    v_accvgpr_read_b32 v161, a133
    v_accvgpr_read_b32 v162, a134
    v_accvgpr_read_b32 v163, a135
    v_pk_mul_f32 v[160:161], v[160:161], v[146:147]
    v_pk_mul_f32 v[162:163], v[162:163], v[146:147]
    s_waitcnt lgkmcnt(15)
    ds_read_b128 v[68:71], v237 offset:17408
    ds_read_b128 v[84:87], v237 offset:21504
    ds_read_b128 v[72:75], v237 offset:18432
    v_pk_fma_f32 v[160:161], v[4:5], v[154:155], v[160:161]
    v_pk_fma_f32 v[162:163], v[6:7], v[154:155], v[162:163]
    v_cvt_pk_bf16_f32 v4, v160, v161
    v_cvt_pk_bf16_f32 v5, v162, v163
    v_accvgpr_read_b32 v164, a148
    v_accvgpr_read_b32 v165, a149
    v_accvgpr_read_b32 v166, a150
    v_accvgpr_read_b32 v167, a151
    v_pk_mul_f32 v[164:165], v[164:165], v[146:147]
    v_pk_mul_f32 v[166:167], v[166:167], v[146:147]
    s_waitcnt lgkmcnt(15)
    ds_read_b128 v[88:91], v237 offset:22528
    ds_read_b128 v[76:79], v237 offset:19456
    ds_read_b128 v[92:95], v237 offset:23552
    v_pk_fma_f32 v[164:165], v[20:21], v[154:155], v[164:165]
    v_pk_fma_f32 v[166:167], v[22:23], v[154:155], v[166:167]
    v_cvt_pk_bf16_f32 v6, v164, v165
    v_cvt_pk_bf16_f32 v7, v166, v167
    v_accvgpr_read_b32 v160, a136
    v_accvgpr_read_b32 v161, a137
    v_accvgpr_read_b32 v162, a138
    v_accvgpr_read_b32 v163, a139
    v_pk_mul_f32 v[160:161], v[160:161], v[148:149]
    v_pk_mul_f32 v[162:163], v[162:163], v[148:149]
    ds_read_b128 v[96:99], v237 offset:24576
    ds_read_b128 v[112:115], v237 offset:28672
    ds_read_b128 v[100:103], v237 offset:25600
    v_pk_fma_f32 v[160:161], v[8:9], v[156:157], v[160:161]
    v_pk_fma_f32 v[162:163], v[10:11], v[156:157], v[162:163]
    v_cvt_pk_bf16_f32 v8, v160, v161
    v_cvt_pk_bf16_f32 v9, v162, v163
    v_accvgpr_read_b32 v164, a152
    v_accvgpr_read_b32 v165, a153
    v_accvgpr_read_b32 v166, a154
    v_accvgpr_read_b32 v167, a155
    v_pk_mul_f32 v[164:165], v[164:165], v[148:149]
    v_pk_mul_f32 v[166:167], v[166:167], v[148:149]
    ds_read_b128 v[116:119], v237 offset:29696
    ds_read_b128 v[104:107], v237 offset:26624
    ds_read_b128 v[120:123], v237 offset:30720
    v_pk_fma_f32 v[164:165], v[24:25], v[156:157], v[164:165]
    v_pk_fma_f32 v[166:167], v[26:27], v[156:157], v[166:167]
    v_cvt_pk_bf16_f32 v10, v164, v165
    v_cvt_pk_bf16_f32 v11, v166, v167
    v_accvgpr_read_b32 v160, a140
    v_accvgpr_read_b32 v161, a141
    v_accvgpr_read_b32 v162, a142
    v_accvgpr_read_b32 v163, a143
    v_pk_mul_f32 v[160:161], v[160:161], v[150:151]
    v_pk_mul_f32 v[162:163], v[162:163], v[150:151]
    s_waitcnt lgkmcnt(15)
    ds_read_b128 v[108:111], v237 offset:27648
    ds_read_b128 v[124:127], v237 offset:31744
    v_pk_fma_f32 v[160:161], v[12:13], v[158:159], v[160:161]
    v_pk_fma_f32 v[162:163], v[14:15], v[158:159], v[162:163]
    v_cvt_pk_bf16_f32 v12, v160, v161
    v_cvt_pk_bf16_f32 v13, v162, v163
    v_accvgpr_read_b32 v164, a156
    v_accvgpr_read_b32 v165, a157
    v_accvgpr_read_b32 v166, a158
    v_accvgpr_read_b32 v167, a159
    v_pk_mul_f32 v[164:165], v[164:165], v[150:151]
    v_pk_mul_f32 v[166:167], v[166:167], v[150:151]
    v_pk_fma_f32 v[164:165], v[28:29], v[158:159], v[164:165]
    v_pk_fma_f32 v[166:167], v[30:31], v[158:159], v[166:167]
    v_cvt_pk_bf16_f32 v14, v164, v165
    v_cvt_pk_bf16_f32 v15, v166, v167
    v_accvgpr_read_b32 v160, a160
    v_accvgpr_read_b32 v161, a161
    v_accvgpr_read_b32 v162, a162
    v_accvgpr_read_b32 v163, a163
    v_pk_mul_f32 v[160:161], v[160:161], v[144:145]
    v_pk_mul_f32 v[162:163], v[162:163], v[144:145]
    v_pk_fma_f32 v[160:161], v[32:33], v[152:153], v[160:161]
    v_pk_fma_f32 v[162:163], v[34:35], v[152:153], v[162:163]
    v_cvt_pk_bf16_f32 v32, v160, v161
    v_cvt_pk_bf16_f32 v33, v162, v163
    v_accvgpr_read_b32 v164, a176
    v_accvgpr_read_b32 v165, a177
    v_accvgpr_read_b32 v166, a178
    v_accvgpr_read_b32 v167, a179
    v_pk_mul_f32 v[164:165], v[164:165], v[144:145]
    v_pk_mul_f32 v[166:167], v[166:167], v[144:145]
    v_pk_fma_f32 v[164:165], v[48:49], v[152:153], v[164:165]
    v_pk_fma_f32 v[166:167], v[50:51], v[152:153], v[166:167]
    v_cvt_pk_bf16_f32 v34, v164, v165
    v_cvt_pk_bf16_f32 v35, v166, v167
    s_waitcnt lgkmcnt(0)
    s_barrier
    v_accvgpr_read_b32 v160, a164
    v_accvgpr_read_b32 v161, a165
    v_accvgpr_read_b32 v162, a166
    v_accvgpr_read_b32 v163, a167
    v_pk_mul_f32 v[160:161], v[160:161], v[146:147]
    v_pk_mul_f32 v[162:163], v[162:163], v[146:147]
    v_pk_fma_f32 v[160:161], v[36:37], v[154:155], v[160:161]
    v_pk_fma_f32 v[162:163], v[38:39], v[154:155], v[162:163]
    v_cvt_pk_bf16_f32 v36, v160, v161
    v_cvt_pk_bf16_f32 v37, v162, v163
    ds_write_b128 v238, v[0:3] offset:0
    s_mov_b32 s48, 28672
    s_add_u32 m0, s47, 0
    s_nop 0
    buffer_load_dwordx4 v204, s[68:71], s48 offen offset:0 lds
    v_accvgpr_read_b32 v164, a180
    v_accvgpr_read_b32 v165, a181
    v_accvgpr_read_b32 v166, a182
    v_accvgpr_read_b32 v167, a183
    v_pk_mul_f32 v[164:165], v[164:165], v[146:147]
    v_pk_mul_f32 v[166:167], v[166:167], v[146:147]
    v_pk_fma_f32 v[164:165], v[52:53], v[154:155], v[164:165]
    v_pk_fma_f32 v[166:167], v[54:55], v[154:155], v[166:167]
    v_cvt_pk_bf16_f32 v38, v164, v165
    v_cvt_pk_bf16_f32 v39, v166, v167
    ds_write_b128 v238, v[4:7] offset:1024
    buffer_load_dwordx4 v205, s[68:71], s48 offen offset:1024 lds
    v_accvgpr_read_b32 v160, a168
    v_accvgpr_read_b32 v161, a169
    v_accvgpr_read_b32 v162, a170
    v_accvgpr_read_b32 v163, a171
    v_pk_mul_f32 v[160:161], v[160:161], v[148:149]
    v_pk_mul_f32 v[162:163], v[162:163], v[148:149]
    v_pk_fma_f32 v[160:161], v[40:41], v[156:157], v[160:161]
    v_pk_fma_f32 v[162:163], v[42:43], v[156:157], v[162:163]
    v_cvt_pk_bf16_f32 v40, v160, v161
    v_cvt_pk_bf16_f32 v41, v162, v163
    ds_write_b128 v238, v[8:11] offset:2048
    buffer_load_dwordx4 v206, s[68:71], s48 offen offset:2048 lds
    v_accvgpr_read_b32 v164, a184
    v_accvgpr_read_b32 v165, a185
    v_accvgpr_read_b32 v166, a186
    v_accvgpr_read_b32 v167, a187
    v_pk_mul_f32 v[164:165], v[164:165], v[148:149]
    v_pk_mul_f32 v[166:167], v[166:167], v[148:149]
    v_pk_fma_f32 v[164:165], v[56:57], v[156:157], v[164:165]
    v_pk_fma_f32 v[166:167], v[58:59], v[156:157], v[166:167]
    v_cvt_pk_bf16_f32 v42, v164, v165
    v_cvt_pk_bf16_f32 v43, v166, v167
    ds_write_b128 v238, v[12:15] offset:3072
    buffer_load_dwordx4 v207, s[68:71], s48 offen offset:3072 lds
    v_accvgpr_read_b32 v160, a172
    v_accvgpr_read_b32 v161, a173
    v_accvgpr_read_b32 v162, a174
    v_accvgpr_read_b32 v163, a175
    v_pk_mul_f32 v[160:161], v[160:161], v[150:151]
    v_pk_mul_f32 v[162:163], v[162:163], v[150:151]
    v_pk_fma_f32 v[160:161], v[44:45], v[158:159], v[160:161]
    v_pk_fma_f32 v[162:163], v[46:47], v[158:159], v[162:163]
    v_cvt_pk_bf16_f32 v44, v160, v161
    v_cvt_pk_bf16_f32 v45, v162, v163
    ds_write_b128 v238, v[32:35] offset:4096
    s_add_u32 m0, s47, 4096
    s_nop 0
    buffer_load_dwordx4 v208, s[68:71], s48 offen offset:0 lds
    v_accvgpr_read_b32 v164, a188
    v_accvgpr_read_b32 v165, a189
    v_accvgpr_read_b32 v166, a190
    v_accvgpr_read_b32 v167, a191
    v_pk_mul_f32 v[164:165], v[164:165], v[150:151]
    v_pk_mul_f32 v[166:167], v[166:167], v[150:151]
    v_pk_fma_f32 v[164:165], v[60:61], v[158:159], v[164:165]
    v_pk_fma_f32 v[166:167], v[62:63], v[158:159], v[166:167]
    v_cvt_pk_bf16_f32 v46, v164, v165
    v_cvt_pk_bf16_f32 v47, v166, v167
    ds_write_b128 v238, v[36:39] offset:5120
    buffer_load_dwordx4 v209, s[68:71], s48 offen offset:1024 lds
    v_accvgpr_read_b32 v160, a192
    v_accvgpr_read_b32 v161, a193
    v_accvgpr_read_b32 v162, a194
    v_accvgpr_read_b32 v163, a195
    v_pk_mul_f32 v[160:161], v[160:161], v[144:145]
    v_pk_mul_f32 v[162:163], v[162:163], v[144:145]
    v_pk_fma_f32 v[160:161], v[64:65], v[152:153], v[160:161]
    v_pk_fma_f32 v[162:163], v[66:67], v[152:153], v[162:163]
    v_cvt_pk_bf16_f32 v64, v160, v161
    v_cvt_pk_bf16_f32 v65, v162, v163
    ds_write_b128 v238, v[40:43] offset:6144
    buffer_load_dwordx4 v210, s[68:71], s48 offen offset:2048 lds
    v_accvgpr_read_b32 v164, a208
    v_accvgpr_read_b32 v165, a209
    v_accvgpr_read_b32 v166, a210
    v_accvgpr_read_b32 v167, a211
    v_pk_mul_f32 v[164:165], v[164:165], v[144:145]
    v_pk_mul_f32 v[166:167], v[166:167], v[144:145]
    v_pk_fma_f32 v[164:165], v[80:81], v[152:153], v[164:165]
    v_pk_fma_f32 v[166:167], v[82:83], v[152:153], v[166:167]
    v_cvt_pk_bf16_f32 v66, v164, v165
    v_cvt_pk_bf16_f32 v67, v166, v167
    ds_write_b128 v238, v[44:47] offset:7168
    s_mov_b32 s48, 57344
    s_add_u32 m0, s47, 28672
    s_nop 0
    buffer_load_dwordx4 v204, s[68:71], s48 offen offset:0 lds
    v_accvgpr_read_b32 v160, a196
    v_accvgpr_read_b32 v161, a197
    v_accvgpr_read_b32 v162, a198
    v_accvgpr_read_b32 v163, a199
    v_pk_mul_f32 v[160:161], v[160:161], v[146:147]
    v_pk_mul_f32 v[162:163], v[162:163], v[146:147]
    v_pk_fma_f32 v[160:161], v[68:69], v[154:155], v[160:161]
    v_pk_fma_f32 v[162:163], v[70:71], v[154:155], v[162:163]
    v_cvt_pk_bf16_f32 v68, v160, v161
    v_cvt_pk_bf16_f32 v69, v162, v163
    ds_write_b128 v238, v[64:67] offset:8192
    buffer_load_dwordx4 v205, s[68:71], s48 offen offset:1024 lds
    v_accvgpr_read_b32 v164, a212
    v_accvgpr_read_b32 v165, a213
    v_accvgpr_read_b32 v166, a214
    v_accvgpr_read_b32 v167, a215
    v_pk_mul_f32 v[164:165], v[164:165], v[146:147]
    v_pk_mul_f32 v[166:167], v[166:167], v[146:147]
    v_pk_fma_f32 v[164:165], v[84:85], v[154:155], v[164:165]
    v_pk_fma_f32 v[166:167], v[86:87], v[154:155], v[166:167]
    v_cvt_pk_bf16_f32 v70, v164, v165
    v_cvt_pk_bf16_f32 v71, v166, v167
    ds_write_b128 v238, v[68:71] offset:9216
    buffer_load_dwordx4 v206, s[68:71], s48 offen offset:2048 lds
    v_accvgpr_read_b32 v160, a200
    v_accvgpr_read_b32 v161, a201
    v_accvgpr_read_b32 v162, a202
    v_accvgpr_read_b32 v163, a203
    v_pk_mul_f32 v[160:161], v[160:161], v[148:149]
    v_pk_mul_f32 v[162:163], v[162:163], v[148:149]
    v_pk_fma_f32 v[160:161], v[72:73], v[156:157], v[160:161]
    v_pk_fma_f32 v[162:163], v[74:75], v[156:157], v[162:163]
    v_cvt_pk_bf16_f32 v72, v160, v161
    v_cvt_pk_bf16_f32 v73, v162, v163
    buffer_load_dwordx4 v207, s[68:71], s48 offen offset:3072 lds
    v_accvgpr_read_b32 v164, a216
    v_accvgpr_read_b32 v165, a217
    v_accvgpr_read_b32 v166, a218
    v_accvgpr_read_b32 v167, a219
    v_pk_mul_f32 v[164:165], v[164:165], v[148:149]
    v_pk_mul_f32 v[166:167], v[166:167], v[148:149]
    v_pk_fma_f32 v[164:165], v[88:89], v[156:157], v[164:165]
    v_pk_fma_f32 v[166:167], v[90:91], v[156:157], v[166:167]
    v_cvt_pk_bf16_f32 v74, v164, v165
    v_cvt_pk_bf16_f32 v75, v166, v167
    ds_write_b128 v238, v[72:75] offset:10240
    s_add_u32 m0, s47, 32768
    s_nop 0
    buffer_load_dwordx4 v208, s[68:71], s48 offen offset:0 lds
    v_accvgpr_read_b32 v160, a204
    v_accvgpr_read_b32 v161, a205
    v_accvgpr_read_b32 v162, a206
    v_accvgpr_read_b32 v163, a207
    v_pk_mul_f32 v[160:161], v[160:161], v[150:151]
    v_pk_mul_f32 v[162:163], v[162:163], v[150:151]
    v_pk_fma_f32 v[160:161], v[76:77], v[158:159], v[160:161]
    v_pk_fma_f32 v[162:163], v[78:79], v[158:159], v[162:163]
    v_cvt_pk_bf16_f32 v76, v160, v161
    v_cvt_pk_bf16_f32 v77, v162, v163
    buffer_load_dwordx4 v209, s[68:71], s48 offen offset:1024 lds
    v_accvgpr_read_b32 v164, a220
    v_accvgpr_read_b32 v165, a221
    v_accvgpr_read_b32 v166, a222
    v_accvgpr_read_b32 v167, a223
    v_pk_mul_f32 v[164:165], v[164:165], v[150:151]
    v_pk_mul_f32 v[166:167], v[166:167], v[150:151]
    v_pk_fma_f32 v[164:165], v[92:93], v[158:159], v[164:165]
    v_pk_fma_f32 v[166:167], v[94:95], v[158:159], v[166:167]
    v_cvt_pk_bf16_f32 v78, v164, v165
    v_cvt_pk_bf16_f32 v79, v166, v167
    ds_write_b128 v238, v[76:79] offset:11264
    buffer_load_dwordx4 v210, s[68:71], s48 offen offset:2048 lds
    v_accvgpr_read_b32 v160, a224
    v_accvgpr_read_b32 v161, a225
    v_accvgpr_read_b32 v162, a226
    v_accvgpr_read_b32 v163, a227
    v_pk_mul_f32 v[160:161], v[160:161], v[144:145]
    v_pk_mul_f32 v[162:163], v[162:163], v[144:145]
    v_pk_fma_f32 v[160:161], v[96:97], v[152:153], v[160:161]
    v_pk_fma_f32 v[162:163], v[98:99], v[152:153], v[162:163]
    v_cvt_pk_bf16_f32 v96, v160, v161
    v_cvt_pk_bf16_f32 v97, v162, v163
    v_accvgpr_read_b32 v164, a240
    v_accvgpr_read_b32 v165, a241
    v_accvgpr_read_b32 v166, a242
    v_accvgpr_read_b32 v167, a243
    v_pk_mul_f32 v[164:165], v[164:165], v[144:145]
    v_pk_mul_f32 v[166:167], v[166:167], v[144:145]
    v_pk_fma_f32 v[164:165], v[112:113], v[152:153], v[164:165]
    v_pk_fma_f32 v[166:167], v[114:115], v[152:153], v[166:167]
    v_cvt_pk_bf16_f32 v98, v164, v165
    v_cvt_pk_bf16_f32 v99, v166, v167
    ds_write_b128 v238, v[96:99] offset:12288
    v_accvgpr_read_b32 v160, a228
    v_accvgpr_read_b32 v161, a229
    v_accvgpr_read_b32 v162, a230
    v_accvgpr_read_b32 v163, a231
    v_pk_mul_f32 v[160:161], v[160:161], v[146:147]
    v_pk_mul_f32 v[162:163], v[162:163], v[146:147]
    v_pk_fma_f32 v[160:161], v[100:101], v[154:155], v[160:161]
    v_pk_fma_f32 v[162:163], v[102:103], v[154:155], v[162:163]
    v_cvt_pk_bf16_f32 v100, v160, v161
    v_cvt_pk_bf16_f32 v101, v162, v163
    v_accvgpr_read_b32 v164, a244
    v_accvgpr_read_b32 v165, a245
    v_accvgpr_read_b32 v166, a246
    v_accvgpr_read_b32 v167, a247
    v_pk_mul_f32 v[164:165], v[164:165], v[146:147]
    v_pk_mul_f32 v[166:167], v[166:167], v[146:147]
    v_pk_fma_f32 v[164:165], v[116:117], v[154:155], v[164:165]
    v_pk_fma_f32 v[166:167], v[118:119], v[154:155], v[166:167]
    v_cvt_pk_bf16_f32 v102, v164, v165
    v_cvt_pk_bf16_f32 v103, v166, v167
    ds_write_b128 v238, v[100:103] offset:13312
    v_accvgpr_read_b32 v160, a232
    v_accvgpr_read_b32 v161, a233
    v_accvgpr_read_b32 v162, a234
    v_accvgpr_read_b32 v163, a235
    v_pk_mul_f32 v[160:161], v[160:161], v[148:149]
    v_pk_mul_f32 v[162:163], v[162:163], v[148:149]
    v_pk_fma_f32 v[160:161], v[104:105], v[156:157], v[160:161]
    v_pk_fma_f32 v[162:163], v[106:107], v[156:157], v[162:163]
    v_cvt_pk_bf16_f32 v104, v160, v161
    v_cvt_pk_bf16_f32 v105, v162, v163
    v_accvgpr_read_b32 v164, a248
    v_accvgpr_read_b32 v165, a249
    v_accvgpr_read_b32 v166, a250
    v_accvgpr_read_b32 v167, a251
    v_pk_mul_f32 v[164:165], v[164:165], v[148:149]
    v_pk_mul_f32 v[166:167], v[166:167], v[148:149]
    v_pk_fma_f32 v[164:165], v[120:121], v[156:157], v[164:165]
    v_pk_fma_f32 v[166:167], v[122:123], v[156:157], v[166:167]
    v_cvt_pk_bf16_f32 v106, v164, v165
    v_cvt_pk_bf16_f32 v107, v166, v167
    ds_write_b128 v238, v[104:107] offset:14336
    v_accvgpr_read_b32 v160, a236
    v_accvgpr_read_b32 v161, a237
    v_accvgpr_read_b32 v162, a238
    v_accvgpr_read_b32 v163, a239
    v_pk_mul_f32 v[160:161], v[160:161], v[150:151]
    v_pk_mul_f32 v[162:163], v[162:163], v[150:151]
    v_pk_fma_f32 v[160:161], v[108:109], v[158:159], v[160:161]
    v_pk_fma_f32 v[162:163], v[110:111], v[158:159], v[162:163]
    v_cvt_pk_bf16_f32 v108, v160, v161
    v_cvt_pk_bf16_f32 v109, v162, v163
    v_accvgpr_read_b32 v164, a252
    v_accvgpr_read_b32 v165, a253
    v_accvgpr_read_b32 v166, a254
    v_accvgpr_read_b32 v167, a255
    v_pk_mul_f32 v[164:165], v[164:165], v[150:151]
    v_pk_mul_f32 v[166:167], v[166:167], v[150:151]
    v_pk_fma_f32 v[164:165], v[124:125], v[158:159], v[164:165]
    v_pk_fma_f32 v[166:167], v[126:127], v[158:159], v[166:167]
    v_cvt_pk_bf16_f32 v110, v164, v165
    v_cvt_pk_bf16_f32 v111, v166, v167
    ds_write_b128 v238, v[108:111] offset:15360
    s_branch K2_combd
K2_comb0:
    ds_read_b128 v[0:3], v237 offset:0
    ds_read_b128 v[16:19], v237 offset:4096
    ds_read_b128 v[4:7], v237 offset:1024
    ds_read_b128 v[20:23], v237 offset:5120
    ds_read_b128 v[8:11], v237 offset:2048
    ds_read_b128 v[24:27], v237 offset:6144
    ds_read_b128 v[12:15], v237 offset:3072
    ds_read_b128 v[28:31], v237 offset:7168
    ds_read_b128 v[32:35], v237 offset:8192
    ds_read_b128 v[48:51], v237 offset:12288
    ds_read_b128 v[36:39], v237 offset:9216
    ds_read_b128 v[52:55], v237 offset:13312
    v_accvgpr_read_b32 v160, a0
    v_accvgpr_read_b32 v161, a1
    v_accvgpr_read_b32 v162, a2
    v_accvgpr_read_b32 v163, a3
    v_pk_mul_f32 v[160:161], v[160:161], v[144:145]
    v_pk_mul_f32 v[162:163], v[162:163], v[144:145]
    s_waitcnt lgkmcnt(11)
    ds_read_b128 v[40:43], v237 offset:10240
    ds_read_b128 v[56:59], v237 offset:14336
    ds_read_b128 v[44:47], v237 offset:11264
    v_pk_fma_f32 v[160:161], v[0:1], v[152:153], v[160:161]
    v_pk_fma_f32 v[162:163], v[2:3], v[152:153], v[162:163]
    v_cvt_pk_bf16_f32 v0, v160, v161
    v_cvt_pk_bf16_f32 v1, v162, v163
    v_accvgpr_read_b32 v164, a16
    v_accvgpr_read_b32 v165, a17
    v_accvgpr_read_b32 v166, a18
    v_accvgpr_read_b32 v167, a19
    v_pk_mul_f32 v[164:165], v[164:165], v[144:145]
    v_pk_mul_f32 v[166:167], v[166:167], v[144:145]
    s_waitcnt lgkmcnt(13)
    ds_read_b128 v[60:63], v237 offset:15360
    ds_read_b128 v[64:67], v237 offset:16384
    ds_read_b128 v[80:83], v237 offset:20480
    v_pk_fma_f32 v[164:165], v[16:17], v[152:153], v[164:165]
    v_pk_fma_f32 v[166:167], v[18:19], v[152:153], v[166:167]
    v_cvt_pk_bf16_f32 v2, v164, v165
    v_cvt_pk_bf16_f32 v3, v166, v167
    v_accvgpr_read_b32 v160, a4
    v_accvgpr_read_b32 v161, a5
    v_accvgpr_read_b32 v162, a6
    v_accvgpr_read_b32 v163, a7
    v_pk_mul_f32 v[160:161], v[160:161], v[146:147]
    v_pk_mul_f32 v[162:163], v[162:163], v[146:147]
    s_waitcnt lgkmcnt(15)
    ds_read_b128 v[68:71], v237 offset:17408
    ds_read_b128 v[84:87], v237 offset:21504
    ds_read_b128 v[72:75], v237 offset:18432
    v_pk_fma_f32 v[160:161], v[4:5], v[154:155], v[160:161]
    v_pk_fma_f32 v[162:163], v[6:7], v[154:155], v[162:163]
    v_cvt_pk_bf16_f32 v4, v160, v161
    v_cvt_pk_bf16_f32 v5, v162, v163
    v_accvgpr_read_b32 v164, a20
    v_accvgpr_read_b32 v165, a21
    v_accvgpr_read_b32 v166, a22
    v_accvgpr_read_b32 v167, a23
    v_pk_mul_f32 v[164:165], v[164:165], v[146:147]
    v_pk_mul_f32 v[166:167], v[166:167], v[146:147]
    s_waitcnt lgkmcnt(15)
    ds_read_b128 v[88:91], v237 offset:22528
    ds_read_b128 v[76:79], v237 offset:19456
    ds_read_b128 v[92:95], v237 offset:23552
    v_pk_fma_f32 v[164:165], v[20:21], v[154:155], v[164:165]
    v_pk_fma_f32 v[166:167], v[22:23], v[154:155], v[166:167]
    v_cvt_pk_bf16_f32 v6, v164, v165
    v_cvt_pk_bf16_f32 v7, v166, v167
    v_accvgpr_read_b32 v160, a8
    v_accvgpr_read_b32 v161, a9
    v_accvgpr_read_b32 v162, a10
    v_accvgpr_read_b32 v163, a11
    v_pk_mul_f32 v[160:161], v[160:161], v[148:149]
    v_pk_mul_f32 v[162:163], v[162:163], v[148:149]
    ds_read_b128 v[96:99], v237 offset:24576
    ds_read_b128 v[112:115], v237 offset:28672
    ds_read_b128 v[100:103], v237 offset:25600
    v_pk_fma_f32 v[160:161], v[8:9], v[156:157], v[160:161]
    v_pk_fma_f32 v[162:163], v[10:11], v[156:157], v[162:163]
    v_cvt_pk_bf16_f32 v8, v160, v161
    v_cvt_pk_bf16_f32 v9, v162, v163
    v_accvgpr_read_b32 v164, a24
    v_accvgpr_read_b32 v165, a25
    v_accvgpr_read_b32 v166, a26
    v_accvgpr_read_b32 v167, a27
    v_pk_mul_f32 v[164:165], v[164:165], v[148:149]
    v_pk_mul_f32 v[166:167], v[166:167], v[148:149]
    ds_read_b128 v[116:119], v237 offset:29696
    ds_read_b128 v[104:107], v237 offset:26624
    ds_read_b128 v[120:123], v237 offset:30720
    v_pk_fma_f32 v[164:165], v[24:25], v[156:157], v[164:165]
    v_pk_fma_f32 v[166:167], v[26:27], v[156:157], v[166:167]
    v_cvt_pk_bf16_f32 v10, v164, v165
    v_cvt_pk_bf16_f32 v11, v166, v167
    v_accvgpr_read_b32 v160, a12
    v_accvgpr_read_b32 v161, a13
    v_accvgpr_read_b32 v162, a14
    v_accvgpr_read_b32 v163, a15
    v_pk_mul_f32 v[160:161], v[160:161], v[150:151]
    v_pk_mul_f32 v[162:163], v[162:163], v[150:151]
    s_waitcnt lgkmcnt(15)
    ds_read_b128 v[108:111], v237 offset:27648
    ds_read_b128 v[124:127], v237 offset:31744
    v_pk_fma_f32 v[160:161], v[12:13], v[158:159], v[160:161]
    v_pk_fma_f32 v[162:163], v[14:15], v[158:159], v[162:163]
    v_cvt_pk_bf16_f32 v12, v160, v161
    v_cvt_pk_bf16_f32 v13, v162, v163
    v_accvgpr_read_b32 v164, a28
    v_accvgpr_read_b32 v165, a29
    v_accvgpr_read_b32 v166, a30
    v_accvgpr_read_b32 v167, a31
    v_pk_mul_f32 v[164:165], v[164:165], v[150:151]
    v_pk_mul_f32 v[166:167], v[166:167], v[150:151]
    v_pk_fma_f32 v[164:165], v[28:29], v[158:159], v[164:165]
    v_pk_fma_f32 v[166:167], v[30:31], v[158:159], v[166:167]
    v_cvt_pk_bf16_f32 v14, v164, v165
    v_cvt_pk_bf16_f32 v15, v166, v167
    v_accvgpr_read_b32 v160, a32
    v_accvgpr_read_b32 v161, a33
    v_accvgpr_read_b32 v162, a34
    v_accvgpr_read_b32 v163, a35
    v_pk_mul_f32 v[160:161], v[160:161], v[144:145]
    v_pk_mul_f32 v[162:163], v[162:163], v[144:145]
    v_pk_fma_f32 v[160:161], v[32:33], v[152:153], v[160:161]
    v_pk_fma_f32 v[162:163], v[34:35], v[152:153], v[162:163]
    v_cvt_pk_bf16_f32 v32, v160, v161
    v_cvt_pk_bf16_f32 v33, v162, v163
    v_accvgpr_read_b32 v164, a48
    v_accvgpr_read_b32 v165, a49
    v_accvgpr_read_b32 v166, a50
    v_accvgpr_read_b32 v167, a51
    v_pk_mul_f32 v[164:165], v[164:165], v[144:145]
    v_pk_mul_f32 v[166:167], v[166:167], v[144:145]
    v_pk_fma_f32 v[164:165], v[48:49], v[152:153], v[164:165]
    v_pk_fma_f32 v[166:167], v[50:51], v[152:153], v[166:167]
    v_cvt_pk_bf16_f32 v34, v164, v165
    v_cvt_pk_bf16_f32 v35, v166, v167
    s_waitcnt lgkmcnt(0)
    s_barrier
    v_accvgpr_read_b32 v160, a36
    v_accvgpr_read_b32 v161, a37
    v_accvgpr_read_b32 v162, a38
    v_accvgpr_read_b32 v163, a39
    v_pk_mul_f32 v[160:161], v[160:161], v[146:147]
    v_pk_mul_f32 v[162:163], v[162:163], v[146:147]
    v_pk_fma_f32 v[160:161], v[36:37], v[154:155], v[160:161]
    v_pk_fma_f32 v[162:163], v[38:39], v[154:155], v[162:163]
    v_cvt_pk_bf16_f32 v36, v160, v161
    v_cvt_pk_bf16_f32 v37, v162, v163
    ds_write_b128 v238, v[0:3] offset:0
    s_mov_b32 s48, 28672
    s_add_u32 m0, s47, 0
    s_nop 0
    buffer_load_dwordx4 v204, s[68:71], s48 offen offset:0 lds
    v_accvgpr_read_b32 v164, a52
    v_accvgpr_read_b32 v165, a53
    v_accvgpr_read_b32 v166, a54
    v_accvgpr_read_b32 v167, a55
    v_pk_mul_f32 v[164:165], v[164:165], v[146:147]
    v_pk_mul_f32 v[166:167], v[166:167], v[146:147]
    v_pk_fma_f32 v[164:165], v[52:53], v[154:155], v[164:165]
    v_pk_fma_f32 v[166:167], v[54:55], v[154:155], v[166:167]
    v_cvt_pk_bf16_f32 v38, v164, v165
    v_cvt_pk_bf16_f32 v39, v166, v167
    ds_write_b128 v238, v[4:7] offset:1024
    buffer_load_dwordx4 v205, s[68:71], s48 offen offset:1024 lds
    v_accvgpr_read_b32 v160, a40
    v_accvgpr_read_b32 v161, a41
    v_accvgpr_read_b32 v162, a42
    v_accvgpr_read_b32 v163, a43
    v_pk_mul_f32 v[160:161], v[160:161], v[148:149]
    v_pk_mul_f32 v[162:163], v[162:163], v[148:149]
    v_pk_fma_f32 v[160:161], v[40:41], v[156:157], v[160:161]
    v_pk_fma_f32 v[162:163], v[42:43], v[156:157], v[162:163]
    v_cvt_pk_bf16_f32 v40, v160, v161
    v_cvt_pk_bf16_f32 v41, v162, v163
    ds_write_b128 v238, v[8:11] offset:2048
    buffer_load_dwordx4 v206, s[68:71], s48 offen offset:2048 lds
    v_accvgpr_read_b32 v164, a56
    v_accvgpr_read_b32 v165, a57
    v_accvgpr_read_b32 v166, a58
    v_accvgpr_read_b32 v167, a59
    v_pk_mul_f32 v[164:165], v[164:165], v[148:149]
    v_pk_mul_f32 v[166:167], v[166:167], v[148:149]
    v_pk_fma_f32 v[164:165], v[56:57], v[156:157], v[164:165]
    v_pk_fma_f32 v[166:167], v[58:59], v[156:157], v[166:167]
    v_cvt_pk_bf16_f32 v42, v164, v165
    v_cvt_pk_bf16_f32 v43, v166, v167
    ds_write_b128 v238, v[12:15] offset:3072
    buffer_load_dwordx4 v207, s[68:71], s48 offen offset:3072 lds
    v_accvgpr_read_b32 v160, a44
    v_accvgpr_read_b32 v161, a45
    v_accvgpr_read_b32 v162, a46
    v_accvgpr_read_b32 v163, a47
    v_pk_mul_f32 v[160:161], v[160:161], v[150:151]
    v_pk_mul_f32 v[162:163], v[162:163], v[150:151]
    v_pk_fma_f32 v[160:161], v[44:45], v[158:159], v[160:161]
    v_pk_fma_f32 v[162:163], v[46:47], v[158:159], v[162:163]
    v_cvt_pk_bf16_f32 v44, v160, v161
    v_cvt_pk_bf16_f32 v45, v162, v163
    ds_write_b128 v238, v[32:35] offset:4096
    s_add_u32 m0, s47, 4096
    s_nop 0
    buffer_load_dwordx4 v208, s[68:71], s48 offen offset:0 lds
    v_accvgpr_read_b32 v164, a60
    v_accvgpr_read_b32 v165, a61
    v_accvgpr_read_b32 v166, a62
    v_accvgpr_read_b32 v167, a63
    v_pk_mul_f32 v[164:165], v[164:165], v[150:151]
    v_pk_mul_f32 v[166:167], v[166:167], v[150:151]
    v_pk_fma_f32 v[164:165], v[60:61], v[158:159], v[164:165]
    v_pk_fma_f32 v[166:167], v[62:63], v[158:159], v[166:167]
    v_cvt_pk_bf16_f32 v46, v164, v165
    v_cvt_pk_bf16_f32 v47, v166, v167
    ds_write_b128 v238, v[36:39] offset:5120
    buffer_load_dwordx4 v209, s[68:71], s48 offen offset:1024 lds
    v_accvgpr_read_b32 v160, a64
    v_accvgpr_read_b32 v161, a65
    v_accvgpr_read_b32 v162, a66
    v_accvgpr_read_b32 v163, a67
    v_pk_mul_f32 v[160:161], v[160:161], v[144:145]
    v_pk_mul_f32 v[162:163], v[162:163], v[144:145]
    v_pk_fma_f32 v[160:161], v[64:65], v[152:153], v[160:161]
    v_pk_fma_f32 v[162:163], v[66:67], v[152:153], v[162:163]
    v_cvt_pk_bf16_f32 v64, v160, v161
    v_cvt_pk_bf16_f32 v65, v162, v163
    ds_write_b128 v238, v[40:43] offset:6144
    buffer_load_dwordx4 v210, s[68:71], s48 offen offset:2048 lds
    v_accvgpr_read_b32 v164, a80
    v_accvgpr_read_b32 v165, a81
    v_accvgpr_read_b32 v166, a82
    v_accvgpr_read_b32 v167, a83
    v_pk_mul_f32 v[164:165], v[164:165], v[144:145]
    v_pk_mul_f32 v[166:167], v[166:167], v[144:145]
    v_pk_fma_f32 v[164:165], v[80:81], v[152:153], v[164:165]
    v_pk_fma_f32 v[166:167], v[82:83], v[152:153], v[166:167]
    v_cvt_pk_bf16_f32 v66, v164, v165
    v_cvt_pk_bf16_f32 v67, v166, v167
    ds_write_b128 v238, v[44:47] offset:7168
    s_mov_b32 s48, 57344
    s_add_u32 m0, s47, 28672
    s_nop 0
    buffer_load_dwordx4 v204, s[68:71], s48 offen offset:0 lds
    v_accvgpr_read_b32 v160, a68
    v_accvgpr_read_b32 v161, a69
    v_accvgpr_read_b32 v162, a70
    v_accvgpr_read_b32 v163, a71
    v_pk_mul_f32 v[160:161], v[160:161], v[146:147]
    v_pk_mul_f32 v[162:163], v[162:163], v[146:147]
    v_pk_fma_f32 v[160:161], v[68:69], v[154:155], v[160:161]
    v_pk_fma_f32 v[162:163], v[70:71], v[154:155], v[162:163]
    v_cvt_pk_bf16_f32 v68, v160, v161
    v_cvt_pk_bf16_f32 v69, v162, v163
    ds_write_b128 v238, v[64:67] offset:8192
    buffer_load_dwordx4 v205, s[68:71], s48 offen offset:1024 lds
    v_accvgpr_read_b32 v164, a84
    v_accvgpr_read_b32 v165, a85
    v_accvgpr_read_b32 v166, a86
    v_accvgpr_read_b32 v167, a87
    v_pk_mul_f32 v[164:165], v[164:165], v[146:147]
    v_pk_mul_f32 v[166:167], v[166:167], v[146:147]
    v_pk_fma_f32 v[164:165], v[84:85], v[154:155], v[164:165]
    v_pk_fma_f32 v[166:167], v[86:87], v[154:155], v[166:167]
    v_cvt_pk_bf16_f32 v70, v164, v165
    v_cvt_pk_bf16_f32 v71, v166, v167
    ds_write_b128 v238, v[68:71] offset:9216
    buffer_load_dwordx4 v206, s[68:71], s48 offen offset:2048 lds
    v_accvgpr_read_b32 v160, a72
    v_accvgpr_read_b32 v161, a73
    v_accvgpr_read_b32 v162, a74
    v_accvgpr_read_b32 v163, a75
    v_pk_mul_f32 v[160:161], v[160:161], v[148:149]
    v_pk_mul_f32 v[162:163], v[162:163], v[148:149]
    v_pk_fma_f32 v[160:161], v[72:73], v[156:157], v[160:161]
    v_pk_fma_f32 v[162:163], v[74:75], v[156:157], v[162:163]
    v_cvt_pk_bf16_f32 v72, v160, v161
    v_cvt_pk_bf16_f32 v73, v162, v163
    buffer_load_dwordx4 v207, s[68:71], s48 offen offset:3072 lds
    v_accvgpr_read_b32 v164, a88
    v_accvgpr_read_b32 v165, a89
    v_accvgpr_read_b32 v166, a90
    v_accvgpr_read_b32 v167, a91
    v_pk_mul_f32 v[164:165], v[164:165], v[148:149]
    v_pk_mul_f32 v[166:167], v[166:167], v[148:149]
    v_pk_fma_f32 v[164:165], v[88:89], v[156:157], v[164:165]
    v_pk_fma_f32 v[166:167], v[90:91], v[156:157], v[166:167]
    v_cvt_pk_bf16_f32 v74, v164, v165
    v_cvt_pk_bf16_f32 v75, v166, v167
    ds_write_b128 v238, v[72:75] offset:10240
    s_add_u32 m0, s47, 32768
    s_nop 0
    buffer_load_dwordx4 v208, s[68:71], s48 offen offset:0 lds
    v_accvgpr_read_b32 v160, a76
    v_accvgpr_read_b32 v161, a77
    v_accvgpr_read_b32 v162, a78
    v_accvgpr_read_b32 v163, a79
    v_pk_mul_f32 v[160:161], v[160:161], v[150:151]
    v_pk_mul_f32 v[162:163], v[162:163], v[150:151]
    v_pk_fma_f32 v[160:161], v[76:77], v[158:159], v[160:161]
    v_pk_fma_f32 v[162:163], v[78:79], v[158:159], v[162:163]
    v_cvt_pk_bf16_f32 v76, v160, v161
    v_cvt_pk_bf16_f32 v77, v162, v163
    buffer_load_dwordx4 v209, s[68:71], s48 offen offset:1024 lds
    v_accvgpr_read_b32 v164, a92
    v_accvgpr_read_b32 v165, a93
    v_accvgpr_read_b32 v166, a94
    v_accvgpr_read_b32 v167, a95
    v_pk_mul_f32 v[164:165], v[164:165], v[150:151]
    v_pk_mul_f32 v[166:167], v[166:167], v[150:151]
    v_pk_fma_f32 v[164:165], v[92:93], v[158:159], v[164:165]
    v_pk_fma_f32 v[166:167], v[94:95], v[158:159], v[166:167]
    v_cvt_pk_bf16_f32 v78, v164, v165
    v_cvt_pk_bf16_f32 v79, v166, v167
    ds_write_b128 v238, v[76:79] offset:11264
    buffer_load_dwordx4 v210, s[68:71], s48 offen offset:2048 lds
    v_accvgpr_read_b32 v160, a96
    v_accvgpr_read_b32 v161, a97
    v_accvgpr_read_b32 v162, a98
    v_accvgpr_read_b32 v163, a99
    v_pk_mul_f32 v[160:161], v[160:161], v[144:145]
    v_pk_mul_f32 v[162:163], v[162:163], v[144:145]
    v_pk_fma_f32 v[160:161], v[96:97], v[152:153], v[160:161]
    v_pk_fma_f32 v[162:163], v[98:99], v[152:153], v[162:163]
    v_cvt_pk_bf16_f32 v96, v160, v161
    v_cvt_pk_bf16_f32 v97, v162, v163
    v_accvgpr_read_b32 v164, a112
    v_accvgpr_read_b32 v165, a113
    v_accvgpr_read_b32 v166, a114
    v_accvgpr_read_b32 v167, a115
    v_pk_mul_f32 v[164:165], v[164:165], v[144:145]
    v_pk_mul_f32 v[166:167], v[166:167], v[144:145]
    v_pk_fma_f32 v[164:165], v[112:113], v[152:153], v[164:165]
    v_pk_fma_f32 v[166:167], v[114:115], v[152:153], v[166:167]
    v_cvt_pk_bf16_f32 v98, v164, v165
    v_cvt_pk_bf16_f32 v99, v166, v167
    ds_write_b128 v238, v[96:99] offset:12288
    v_accvgpr_read_b32 v160, a100
    v_accvgpr_read_b32 v161, a101
    v_accvgpr_read_b32 v162, a102
    v_accvgpr_read_b32 v163, a103
    v_pk_mul_f32 v[160:161], v[160:161], v[146:147]
    v_pk_mul_f32 v[162:163], v[162:163], v[146:147]
    v_pk_fma_f32 v[160:161], v[100:101], v[154:155], v[160:161]
    v_pk_fma_f32 v[162:163], v[102:103], v[154:155], v[162:163]
    v_cvt_pk_bf16_f32 v100, v160, v161
    v_cvt_pk_bf16_f32 v101, v162, v163
    v_accvgpr_read_b32 v164, a116
    v_accvgpr_read_b32 v165, a117
    v_accvgpr_read_b32 v166, a118
    v_accvgpr_read_b32 v167, a119
    v_pk_mul_f32 v[164:165], v[164:165], v[146:147]
    v_pk_mul_f32 v[166:167], v[166:167], v[146:147]
    v_pk_fma_f32 v[164:165], v[116:117], v[154:155], v[164:165]
    v_pk_fma_f32 v[166:167], v[118:119], v[154:155], v[166:167]
    v_cvt_pk_bf16_f32 v102, v164, v165
    v_cvt_pk_bf16_f32 v103, v166, v167
    ds_write_b128 v238, v[100:103] offset:13312
    v_accvgpr_read_b32 v160, a104
    v_accvgpr_read_b32 v161, a105
    v_accvgpr_read_b32 v162, a106
    v_accvgpr_read_b32 v163, a107
    v_pk_mul_f32 v[160:161], v[160:161], v[148:149]
    v_pk_mul_f32 v[162:163], v[162:163], v[148:149]
    v_pk_fma_f32 v[160:161], v[104:105], v[156:157], v[160:161]
    v_pk_fma_f32 v[162:163], v[106:107], v[156:157], v[162:163]
    v_cvt_pk_bf16_f32 v104, v160, v161
    v_cvt_pk_bf16_f32 v105, v162, v163
    v_accvgpr_read_b32 v164, a120
    v_accvgpr_read_b32 v165, a121
    v_accvgpr_read_b32 v166, a122
    v_accvgpr_read_b32 v167, a123
    v_pk_mul_f32 v[164:165], v[164:165], v[148:149]
    v_pk_mul_f32 v[166:167], v[166:167], v[148:149]
    v_pk_fma_f32 v[164:165], v[120:121], v[156:157], v[164:165]
    v_pk_fma_f32 v[166:167], v[122:123], v[156:157], v[166:167]
    v_cvt_pk_bf16_f32 v106, v164, v165
    v_cvt_pk_bf16_f32 v107, v166, v167
    ds_write_b128 v238, v[104:107] offset:14336
    v_accvgpr_read_b32 v160, a108
    v_accvgpr_read_b32 v161, a109
    v_accvgpr_read_b32 v162, a110
    v_accvgpr_read_b32 v163, a111
    v_pk_mul_f32 v[160:161], v[160:161], v[150:151]
    v_pk_mul_f32 v[162:163], v[162:163], v[150:151]
    v_pk_fma_f32 v[160:161], v[108:109], v[158:159], v[160:161]
    v_pk_fma_f32 v[162:163], v[110:111], v[158:159], v[162:163]
    v_cvt_pk_bf16_f32 v108, v160, v161
    v_cvt_pk_bf16_f32 v109, v162, v163
    v_accvgpr_read_b32 v164, a124
    v_accvgpr_read_b32 v165, a125
    v_accvgpr_read_b32 v166, a126
    v_accvgpr_read_b32 v167, a127
    v_pk_mul_f32 v[164:165], v[164:165], v[150:151]
    v_pk_mul_f32 v[166:167], v[166:167], v[150:151]
    v_pk_fma_f32 v[164:165], v[124:125], v[158:159], v[164:165]
    v_pk_fma_f32 v[166:167], v[126:127], v[158:159], v[166:167]
    v_cvt_pk_bf16_f32 v110, v164, v165
    v_cvt_pk_bf16_f32 v111, v166, v167
    ds_write_b128 v238, v[108:111] offset:15360
K2_combd:
    s_waitcnt vmcnt(14)
    s_waitcnt lgkmcnt(0)
    s_barrier
    s_mul_i32 s50, s40, 1835008
    s_mul_i32 s51, s41, 57344
    s_add_u32 s50, s50, s51
    s_mul_i32 s51, s27, 7168
    s_add_u32 s50, s50, s51
    s_add_u32 s50, s50, 4194304
    s_add_u32 s51, s50, 4096
    s_add_u32 s52, s50, 28672
    s_add_u32 s53, s51, 28672
    ds_read_b128 a[0:3], v239 offset:0
    ds_read_b128 a[4:7], v239 offset:1024
    ds_read_b128 a[8:11], v239 offset:2048
    ds_read_b128 a[12:15], v239 offset:3072
    ds_read_b64_tr_b16 v[176:177], v218 offset:0
    ds_read_b64_tr_b16 v[178:179], v218 offset:14336
    ds_read_b64_tr_b16 v[180:181], v219 offset:0
    ds_read_b64_tr_b16 v[182:183], v219 offset:14336
    ds_read_b64_tr_b16 v[184:185], v220 offset:0
    ds_read_b64_tr_b16 v[186:187], v220 offset:14336
    ds_read_b64_tr_b16 v[188:189], v221 offset:0
    ds_read_b64_tr_b16 v[190:191], v221 offset:14336
    ds_read_b64_tr_b16 v[192:193], v222 offset:0
    ds_read_b64_tr_b16 v[194:195], v222 offset:14336
    s_waitcnt lgkmcnt(6)
    v_mfma_f32_16x16x32_bf16 v[0:3], v[176:179], a[0:3], 0
    ds_read_b64_tr_b16 v[196:197], v223 offset:0
    ds_read_b64_tr_b16 v[198:199], v223 offset:14336
    v_mfma_f32_16x16x32_bf16 v[4:7], v[176:179], a[4:7], 0
    ds_read_b128 a[16:19], v239 offset:4096
    v_mfma_f32_16x16x32_bf16 v[8:11], v[176:179], a[8:11], 0
    v_mfma_f32_16x16x32_bf16 v[12:15], v[176:179], a[12:15], 0
    v_mfma_f32_16x16x32_bf16 v[16:19], v[180:183], a[0:3], 0
    ds_read_b64_tr_b16 v[200:201], v224 offset:0
    ds_read_b64_tr_b16 v[202:203], v224 offset:14336
    v_mfma_f32_16x16x32_bf16 v[20:23], v[180:183], a[4:7], 0
    ds_read_b128 a[20:23], v239 offset:5120
    v_mfma_f32_16x16x32_bf16 v[24:27], v[180:183], a[8:11], 0
    v_mfma_f32_16x16x32_bf16 v[28:31], v[180:183], a[12:15], 0
    s_waitcnt vmcnt(7)
    s_waitcnt lgkmcnt(1)
    s_barrier
    v_mfma_f32_16x16x32_bf16 v[32:35], v[184:187], a[0:3], 0
    ds_read_b64_tr_b16 v[176:177], v211 offset:0
    ds_read_b64_tr_b16 v[178:179], v211 offset:14336
    v_mfma_f32_16x16x32_bf16 v[36:39], v[184:187], a[4:7], 0
    s_mov_b32 s48, 86016
    s_add_u32 m0, s47, 135168
    v_mfma_f32_16x16x32_bf16 v[40:43], v[184:187], a[8:11], 0
    ds_read_b128 a[24:27], v239 offset:6144
    buffer_load_dwordx4 v204, s[68:71], s48 offen offset:0 lds
    v_mfma_f32_16x16x32_bf16 v[44:47], v[184:187], a[12:15], 0
    v_mfma_f32_16x16x32_bf16 v[48:51], v[188:191], a[0:3], 0
    ds_read_b64_tr_b16 v[180:181], v212 offset:0
    ds_read_b64_tr_b16 v[182:183], v212 offset:14336
    v_mfma_f32_16x16x32_bf16 v[52:55], v[188:191], a[4:7], 0
    ds_read_b128 a[28:31], v239 offset:7168
    buffer_load_dwordx4 v205, s[68:71], s48 offen offset:1024 lds
    v_mfma_f32_16x16x32_bf16 v[56:59], v[188:191], a[8:11], 0
    v_mfma_f32_16x16x32_bf16 v[60:63], v[188:191], a[12:15], 0
    v_mfma_f32_16x16x32_bf16 v[64:67], v[192:195], a[0:3], 0
    ds_read_b64_tr_b16 v[184:185], v213 offset:0
    ds_read_b64_tr_b16 v[186:187], v213 offset:14336
    v_mfma_f32_16x16x32_bf16 v[68:71], v[192:195], a[4:7], 0
    ds_read_b128 a[32:35], v239 offset:8192
    buffer_load_dwordx4 v206, s[68:71], s48 offen offset:2048 lds
    v_mfma_f32_16x16x32_bf16 v[72:75], v[192:195], a[8:11], 0
    v_mfma_f32_16x16x32_bf16 v[76:79], v[192:195], a[12:15], 0
    v_mfma_f32_16x16x32_bf16 v[80:83], v[196:199], a[0:3], 0
    ds_read_b64_tr_b16 v[188:189], v214 offset:0
    ds_read_b64_tr_b16 v[190:191], v214 offset:14336
    v_mfma_f32_16x16x32_bf16 v[84:87], v[196:199], a[4:7], 0
    ds_read_b128 a[36:39], v239 offset:9216
    buffer_load_dwordx4 v207, s[68:71], s48 offen offset:3072 lds
    v_mfma_f32_16x16x32_bf16 v[88:91], v[196:199], a[8:11], 0
    v_mfma_f32_16x16x32_bf16 v[92:95], v[196:199], a[12:15], 0
    s_waitcnt lgkmcnt(10)
    v_mfma_f32_16x16x32_bf16 v[96:99], v[200:203], a[0:3], 0
    ds_read_b64_tr_b16 v[192:193], v215 offset:0
    ds_read_b64_tr_b16 v[194:195], v215 offset:14336
    v_mfma_f32_16x16x32_bf16 v[100:103], v[200:203], a[4:7], 0
    s_add_u32 m0, s47, 139264
    ds_read_b128 a[40:43], v239 offset:10240
    v_mfma_f32_16x16x32_bf16 v[104:107], v[200:203], a[8:11], 0
    buffer_load_dwordx4 v208, s[68:71], s48 offen offset:0 lds
    v_mfma_f32_16x16x32_bf16 v[108:111], v[200:203], a[12:15], 0
    s_waitcnt lgkmcnt(9)
    v_mfma_f32_16x16x32_bf16 v[0:3], v[176:179], a[16:19], v[0:3]
    ds_read_b64_tr_b16 v[196:197], v216 offset:0
    ds_read_b64_tr_b16 v[198:199], v216 offset:14336
    v_mfma_f32_16x16x32_bf16 v[4:7], v[176:179], a[20:23], v[4:7]
    ds_read_b128 a[44:47], v239 offset:11264
    buffer_load_dwordx4 v209, s[68:71], s48 offen offset:1024 lds
    v_mfma_f32_16x16x32_bf16 v[8:11], v[176:179], a[24:27], v[8:11]
    v_mfma_f32_16x16x32_bf16 v[12:15], v[176:179], a[28:31], v[12:15]
    s_waitcnt lgkmcnt(10)
    v_mfma_f32_16x16x32_bf16 v[16:19], v[180:183], a[16:19], v[16:19]
    ds_read_b64_tr_b16 v[200:201], v217 offset:0
    ds_read_b64_tr_b16 v[202:203], v217 offset:14336
    v_mfma_f32_16x16x32_bf16 v[20:23], v[180:183], a[20:23], v[20:23]
    ds_read_b128 a[48:51], v239 offset:12288
    buffer_load_dwordx4 v210, s[68:71], s48 offen offset:2048 lds
    v_mfma_f32_16x16x32_bf16 v[24:27], v[180:183], a[24:27], v[24:27]
    v_mfma_f32_16x16x32_bf16 v[28:31], v[180:183], a[28:31], v[28:31]
    s_waitcnt vmcnt(7)
    s_waitcnt lgkmcnt(1)
    s_barrier
    v_mfma_f32_16x16x32_bf16 v[32:35], v[184:187], a[16:19], v[32:35]
    ds_read_b64_tr_b16 v[176:177], v211 offset:28672
    ds_read_b64_tr_b16 v[178:179], v211 offset:43008
    v_mfma_f32_16x16x32_bf16 v[36:39], v[184:187], a[20:23], v[36:39]
    s_mov_b32 s48, 114688
    s_add_u32 m0, s47, 0
    v_mfma_f32_16x16x32_bf16 v[40:43], v[184:187], a[24:27], v[40:43]
    ds_read_b128 a[52:55], v239 offset:13312
    buffer_load_dwordx4 v204, s[68:71], s48 offen offset:0 lds
    v_mfma_f32_16x16x32_bf16 v[44:47], v[184:187], a[28:31], v[44:47]
    v_mfma_f32_16x16x32_bf16 v[48:51], v[188:191], a[16:19], v[48:51]
    ds_read_b64_tr_b16 v[180:181], v212 offset:28672
    ds_read_b64_tr_b16 v[182:183], v212 offset:43008
    v_mfma_f32_16x16x32_bf16 v[52:55], v[188:191], a[20:23], v[52:55]
    ds_read_b128 a[56:59], v239 offset:14336
    buffer_load_dwordx4 v205, s[68:71], s48 offen offset:1024 lds
    v_mfma_f32_16x16x32_bf16 v[56:59], v[188:191], a[24:27], v[56:59]
    v_mfma_f32_16x16x32_bf16 v[60:63], v[188:191], a[28:31], v[60:63]
    v_mfma_f32_16x16x32_bf16 v[64:67], v[192:195], a[16:19], v[64:67]
    ds_read_b64_tr_b16 v[184:185], v213 offset:28672
    ds_read_b64_tr_b16 v[186:187], v213 offset:43008
    v_mfma_f32_16x16x32_bf16 v[68:71], v[192:195], a[20:23], v[68:71]
    ds_read_b128 a[60:63], v239 offset:15360
    buffer_load_dwordx4 v206, s[68:71], s48 offen offset:2048 lds
    v_mfma_f32_16x16x32_bf16 v[72:75], v[192:195], a[24:27], v[72:75]
    v_mfma_f32_16x16x32_bf16 v[76:79], v[192:195], a[28:31], v[76:79]
    v_mfma_f32_16x16x32_bf16 v[80:83], v[196:199], a[16:19], v[80:83]
    ds_read_b64_tr_b16 v[188:189], v214 offset:28672
    ds_read_b64_tr_b16 v[190:191], v214 offset:43008
    v_mfma_f32_16x16x32_bf16 v[84:87], v[196:199], a[20:23], v[84:87]
    ds_read_b128 a[64:67], v239 offset:16384
    buffer_load_dwordx4 v207, s[68:71], s48 offen offset:3072 lds
    v_mfma_f32_16x16x32_bf16 v[88:91], v[196:199], a[24:27], v[88:91]
    v_mfma_f32_16x16x32_bf16 v[92:95], v[196:199], a[28:31], v[92:95]
    v_mfma_f32_16x16x32_bf16 v[96:99], v[200:203], a[16:19], v[96:99]
    ds_read_b64_tr_b16 v[192:193], v215 offset:28672
    ds_read_b64_tr_b16 v[194:195], v215 offset:43008
    v_mfma_f32_16x16x32_bf16 v[100:103], v[200:203], a[20:23], v[100:103]
    s_add_u32 m0, s47, 4096
    ds_read_b128 a[68:71], v239 offset:17408
    v_mfma_f32_16x16x32_bf16 v[104:107], v[200:203], a[24:27], v[104:107]
    buffer_load_dwordx4 v208, s[68:71], s48 offen offset:0 lds
    v_mfma_f32_16x16x32_bf16 v[108:111], v[200:203], a[28:31], v[108:111]
    s_waitcnt lgkmcnt(10)
    v_mfma_f32_16x16x32_bf16 v[0:3], v[176:179], a[32:35], v[0:3]
    ds_read_b64_tr_b16 v[196:197], v216 offset:28672
    ds_read_b64_tr_b16 v[198:199], v216 offset:43008
    v_mfma_f32_16x16x32_bf16 v[4:7], v[176:179], a[36:39], v[4:7]
    ds_read_b128 a[72:75], v239 offset:18432
    buffer_load_dwordx4 v209, s[68:71], s48 offen offset:1024 lds
    v_mfma_f32_16x16x32_bf16 v[8:11], v[176:179], a[40:43], v[8:11]
    v_mfma_f32_16x16x32_bf16 v[12:15], v[176:179], a[44:47], v[12:15]
    v_mfma_f32_16x16x32_bf16 v[16:19], v[180:183], a[32:35], v[16:19]
    ds_read_b64_tr_b16 v[200:201], v217 offset:28672
    ds_read_b64_tr_b16 v[202:203], v217 offset:43008
    v_mfma_f32_16x16x32_bf16 v[20:23], v[180:183], a[36:39], v[20:23]
    ds_read_b128 a[76:79], v239 offset:19456
    buffer_load_dwordx4 v210, s[68:71], s48 offen offset:2048 lds
    v_mfma_f32_16x16x32_bf16 v[24:27], v[180:183], a[40:43], v[24:27]
    v_mfma_f32_16x16x32_bf16 v[28:31], v[180:183], a[44:47], v[28:31]
    s_waitcnt vmcnt(7)
    s_waitcnt lgkmcnt(1)
    s_barrier
    v_mfma_f32_16x16x32_bf16 v[32:35], v[184:187], a[32:35], v[32:35]
    ds_read_b64_tr_b16 v[176:177], v218 offset:0
    ds_read_b64_tr_b16 v[178:179], v218 offset:14336
    v_mfma_f32_16x16x32_bf16 v[36:39], v[184:187], a[36:39], v[36:39]
    s_mov_b32 s48, 143360
    s_add_u32 m0, s47, 28672
    v_mfma_f32_16x16x32_bf16 v[40:43], v[184:187], a[40:43], v[40:43]
    ds_read_b128 a[80:83], v239 offset:20480
    buffer_load_dwordx4 v204, s[68:71], s48 offen offset:0 lds
    v_mfma_f32_16x16x32_bf16 v[44:47], v[184:187], a[44:47], v[44:47]
    v_mfma_f32_16x16x32_bf16 v[48:51], v[188:191], a[32:35], v[48:51]
    ds_read_b64_tr_b16 v[180:181], v219 offset:0
    ds_read_b64_tr_b16 v[182:183], v219 offset:14336
    v_mfma_f32_16x16x32_bf16 v[52:55], v[188:191], a[36:39], v[52:55]
    ds_read_b128 a[84:87], v239 offset:21504
    buffer_load_dwordx4 v205, s[68:71], s48 offen offset:1024 lds
    v_mfma_f32_16x16x32_bf16 v[56:59], v[188:191], a[40:43], v[56:59]
    v_mfma_f32_16x16x32_bf16 v[60:63], v[188:191], a[44:47], v[60:63]
    v_mfma_f32_16x16x32_bf16 v[64:67], v[192:195], a[32:35], v[64:67]
    ds_read_b64_tr_b16 v[184:185], v220 offset:0
    ds_read_b64_tr_b16 v[186:187], v220 offset:14336
    v_mfma_f32_16x16x32_bf16 v[68:71], v[192:195], a[36:39], v[68:71]
    ds_read_b128 a[88:91], v239 offset:22528
    buffer_load_dwordx4 v206, s[68:71], s48 offen offset:2048 lds
    v_mfma_f32_16x16x32_bf16 v[72:75], v[192:195], a[40:43], v[72:75]
    v_mfma_f32_16x16x32_bf16 v[76:79], v[192:195], a[44:47], v[76:79]
    v_mfma_f32_16x16x32_bf16 v[80:83], v[196:199], a[32:35], v[80:83]
    ds_read_b64_tr_b16 v[188:189], v221 offset:0
    ds_read_b64_tr_b16 v[190:191], v221 offset:14336
    v_mfma_f32_16x16x32_bf16 v[84:87], v[196:199], a[36:39], v[84:87]
    ds_read_b128 a[92:95], v239 offset:23552
    buffer_load_dwordx4 v207, s[68:71], s48 offen offset:3072 lds
    v_mfma_f32_16x16x32_bf16 v[88:91], v[196:199], a[40:43], v[88:91]
    v_mfma_f32_16x16x32_bf16 v[92:95], v[196:199], a[44:47], v[92:95]
    s_waitcnt lgkmcnt(10)
    v_mfma_f32_16x16x32_bf16 v[96:99], v[200:203], a[32:35], v[96:99]
    ds_read_b64_tr_b16 v[192:193], v222 offset:0
    ds_read_b64_tr_b16 v[194:195], v222 offset:14336
    v_mfma_f32_16x16x32_bf16 v[100:103], v[200:203], a[36:39], v[100:103]
    s_add_u32 m0, s47, 32768
    ds_read_b128 a[96:99], v239 offset:24576
    v_mfma_f32_16x16x32_bf16 v[104:107], v[200:203], a[40:43], v[104:107]
    buffer_load_dwordx4 v208, s[68:71], s48 offen offset:0 lds
    v_mfma_f32_16x16x32_bf16 v[108:111], v[200:203], a[44:47], v[108:111]
    v_mfma_f32_16x16x32_bf16 v[0:3], v[176:179], a[48:51], v[0:3]
    ds_read_b64_tr_b16 v[196:197], v223 offset:0
    ds_read_b64_tr_b16 v[198:199], v223 offset:14336
    v_mfma_f32_16x16x32_bf16 v[4:7], v[176:179], a[52:55], v[4:7]
    ds_read_b128 a[100:103], v239 offset:25600
    buffer_load_dwordx4 v209, s[68:71], s48 offen offset:1024 lds
    v_mfma_f32_16x16x32_bf16 v[8:11], v[176:179], a[56:59], v[8:11]
    v_mfma_f32_16x16x32_bf16 v[12:15], v[176:179], a[60:63], v[12:15]
    s_waitcnt lgkmcnt(10)
    v_mfma_f32_16x16x32_bf16 v[16:19], v[180:183], a[48:51], v[16:19]
    ds_read_b64_tr_b16 v[200:201], v224 offset:0
    ds_read_b64_tr_b16 v[202:203], v224 offset:14336
    v_mfma_f32_16x16x32_bf16 v[20:23], v[180:183], a[52:55], v[20:23]
    ds_read_b128 a[104:107], v239 offset:26624
    buffer_load_dwordx4 v210, s[68:71], s48 offen offset:2048 lds
    v_mfma_f32_16x16x32_bf16 v[24:27], v[180:183], a[56:59], v[24:27]
    v_mfma_f32_16x16x32_bf16 v[28:31], v[180:183], a[60:63], v[28:31]
    s_waitcnt vmcnt(7)
    s_waitcnt lgkmcnt(1)
    s_barrier
    v_mfma_f32_16x16x32_bf16 v[32:35], v[184:187], a[48:51], v[32:35]
    ds_read_b64_tr_b16 v[176:177], v211 offset:0
    ds_read_b64_tr_b16 v[178:179], v211 offset:14336
    v_mfma_f32_16x16x32_bf16 v[36:39], v[184:187], a[52:55], v[36:39]
    s_mov_b32 s48, 172032
    s_add_u32 m0, s47, 135168
    v_mfma_f32_16x16x32_bf16 v[40:43], v[184:187], a[56:59], v[40:43]
    ds_read_b128 a[108:111], v239 offset:27648
    buffer_load_dwordx4 v204, s[68:71], s48 offen offset:0 lds
    v_mfma_f32_16x16x32_bf16 v[44:47], v[184:187], a[60:63], v[44:47]
    v_mfma_f32_16x16x32_bf16 v[48:51], v[188:191], a[48:51], v[48:51]
    ds_read_b64_tr_b16 v[180:181], v212 offset:0
    ds_read_b64_tr_b16 v[182:183], v212 offset:14336
    v_mfma_f32_16x16x32_bf16 v[52:55], v[188:191], a[52:55], v[52:55]
    ds_read_b128 a[112:115], v239 offset:28672
    buffer_load_dwordx4 v205, s[68:71], s48 offen offset:1024 lds
    v_mfma_f32_16x16x32_bf16 v[56:59], v[188:191], a[56:59], v[56:59]
    v_mfma_f32_16x16x32_bf16 v[60:63], v[188:191], a[60:63], v[60:63]
    v_mfma_f32_16x16x32_bf16 v[64:67], v[192:195], a[48:51], v[64:67]
    ds_read_b64_tr_b16 v[184:185], v213 offset:0
    ds_read_b64_tr_b16 v[186:187], v213 offset:14336
    v_mfma_f32_16x16x32_bf16 v[68:71], v[192:195], a[52:55], v[68:71]
    ds_read_b128 a[116:119], v239 offset:29696
    buffer_load_dwordx4 v206, s[68:71], s48 offen offset:2048 lds
    v_mfma_f32_16x16x32_bf16 v[72:75], v[192:195], a[56:59], v[72:75]
    v_mfma_f32_16x16x32_bf16 v[76:79], v[192:195], a[60:63], v[76:79]
    v_mfma_f32_16x16x32_bf16 v[80:83], v[196:199], a[48:51], v[80:83]
    ds_read_b64_tr_b16 v[188:189], v214 offset:0
    ds_read_b64_tr_b16 v[190:191], v214 offset:14336
    v_mfma_f32_16x16x32_bf16 v[84:87], v[196:199], a[52:55], v[84:87]
    ds_read_b128 a[120:123], v239 offset:30720
    buffer_load_dwordx4 v207, s[68:71], s48 offen offset:3072 lds
    v_mfma_f32_16x16x32_bf16 v[88:91], v[196:199], a[56:59], v[88:91]
    v_mfma_f32_16x16x32_bf16 v[92:95], v[196:199], a[60:63], v[92:95]
    v_mfma_f32_16x16x32_bf16 v[96:99], v[200:203], a[48:51], v[96:99]
    ds_read_b64_tr_b16 v[192:193], v215 offset:0
    ds_read_b64_tr_b16 v[194:195], v215 offset:14336
    v_mfma_f32_16x16x32_bf16 v[100:103], v[200:203], a[52:55], v[100:103]
    s_add_u32 m0, s47, 139264
    ds_read_b128 a[124:127], v239 offset:31744
    v_mfma_f32_16x16x32_bf16 v[104:107], v[200:203], a[56:59], v[104:107]
    buffer_load_dwordx4 v208, s[68:71], s48 offen offset:0 lds
    v_mfma_f32_16x16x32_bf16 v[108:111], v[200:203], a[60:63], v[108:111]
    s_waitcnt lgkmcnt(10)
    v_mfma_f32_16x16x32_bf16 v[0:3], v[176:179], a[64:67], v[0:3]
    ds_read_b64_tr_b16 v[196:197], v216 offset:0
    ds_read_b64_tr_b16 v[198:199], v216 offset:14336
    v_mfma_f32_16x16x32_bf16 v[4:7], v[176:179], a[68:71], v[4:7]
    ds_read_b128 a[128:131], v239 offset:32768
    buffer_load_dwordx4 v209, s[68:71], s48 offen offset:1024 lds
    v_mfma_f32_16x16x32_bf16 v[8:11], v[176:179], a[72:75], v[8:11]
    v_mfma_f32_16x16x32_bf16 v[12:15], v[176:179], a[76:79], v[12:15]
    v_mfma_f32_16x16x32_bf16 v[16:19], v[180:183], a[64:67], v[16:19]
    ds_read_b64_tr_b16 v[200:201], v217 offset:0
    ds_read_b64_tr_b16 v[202:203], v217 offset:14336
    v_mfma_f32_16x16x32_bf16 v[20:23], v[180:183], a[68:71], v[20:23]
    ds_read_b128 a[132:135], v239 offset:33792
    buffer_load_dwordx4 v210, s[68:71], s48 offen offset:2048 lds
    v_mfma_f32_16x16x32_bf16 v[24:27], v[180:183], a[72:75], v[24:27]
    v_mfma_f32_16x16x32_bf16 v[28:31], v[180:183], a[76:79], v[28:31]
    s_waitcnt vmcnt(7)
    s_waitcnt lgkmcnt(1)
    s_barrier
    v_mfma_f32_16x16x32_bf16 v[32:35], v[184:187], a[64:67], v[32:35]
    ds_read_b64_tr_b16 v[176:177], v211 offset:28672
    ds_read_b64_tr_b16 v[178:179], v211 offset:43008
    v_mfma_f32_16x16x32_bf16 v[36:39], v[184:187], a[68:71], v[36:39]
    s_mov_b32 s48, 200704
    s_add_u32 m0, s47, 0
    v_mfma_f32_16x16x32_bf16 v[40:43], v[184:187], a[72:75], v[40:43]
    ds_read_b128 a[136:139], v239 offset:34816
    buffer_load_dwordx4 v204, s[68:71], s48 offen offset:0 lds
    v_mfma_f32_16x16x32_bf16 v[44:47], v[184:187], a[76:79], v[44:47]
    v_mfma_f32_16x16x32_bf16 v[48:51], v[188:191], a[64:67], v[48:51]
    ds_read_b64_tr_b16 v[180:181], v212 offset:28672
    ds_read_b64_tr_b16 v[182:183], v212 offset:43008
    v_mfma_f32_16x16x32_bf16 v[52:55], v[188:191], a[68:71], v[52:55]
    ds_read_b128 a[140:143], v239 offset:35840
    buffer_load_dwordx4 v205, s[68:71], s48 offen offset:1024 lds
    v_mfma_f32_16x16x32_bf16 v[56:59], v[188:191], a[72:75], v[56:59]
    v_mfma_f32_16x16x32_bf16 v[60:63], v[188:191], a[76:79], v[60:63]
    v_mfma_f32_16x16x32_bf16 v[64:67], v[192:195], a[64:67], v[64:67]
    ds_read_b64_tr_b16 v[184:185], v213 offset:28672
    ds_read_b64_tr_b16 v[186:187], v213 offset:43008
    v_mfma_f32_16x16x32_bf16 v[68:71], v[192:195], a[68:71], v[68:71]
    ds_read_b128 a[144:147], v239 offset:36864
    buffer_load_dwordx4 v206, s[68:71], s48 offen offset:2048 lds
    v_mfma_f32_16x16x32_bf16 v[72:75], v[192:195], a[72:75], v[72:75]
    v_mfma_f32_16x16x32_bf16 v[76:79], v[192:195], a[76:79], v[76:79]
    v_mfma_f32_16x16x32_bf16 v[80:83], v[196:199], a[64:67], v[80:83]
    ds_read_b64_tr_b16 v[188:189], v214 offset:28672
    ds_read_b64_tr_b16 v[190:191], v214 offset:43008
    v_mfma_f32_16x16x32_bf16 v[84:87], v[196:199], a[68:71], v[84:87]
    ds_read_b128 a[148:151], v239 offset:37888
    buffer_load_dwordx4 v207, s[68:71], s48 offen offset:3072 lds
    v_mfma_f32_16x16x32_bf16 v[88:91], v[196:199], a[72:75], v[88:91]
    v_mfma_f32_16x16x32_bf16 v[92:95], v[196:199], a[76:79], v[92:95]
    s_waitcnt lgkmcnt(10)
    v_mfma_f32_16x16x32_bf16 v[96:99], v[200:203], a[64:67], v[96:99]
    ds_read_b64_tr_b16 v[192:193], v215 offset:28672
    ds_read_b64_tr_b16 v[194:195], v215 offset:43008
    v_mfma_f32_16x16x32_bf16 v[100:103], v[200:203], a[68:71], v[100:103]
    s_add_u32 m0, s47, 4096
    ds_read_b128 a[152:155], v239 offset:38912
    v_mfma_f32_16x16x32_bf16 v[104:107], v[200:203], a[72:75], v[104:107]
    buffer_load_dwordx4 v208, s[68:71], s48 offen offset:0 lds
    v_mfma_f32_16x16x32_bf16 v[108:111], v[200:203], a[76:79], v[108:111]
    v_mfma_f32_16x16x32_bf16 v[0:3], v[176:179], a[80:83], v[0:3]
    ds_read_b64_tr_b16 v[196:197], v216 offset:28672
    ds_read_b64_tr_b16 v[198:199], v216 offset:43008
    v_mfma_f32_16x16x32_bf16 v[4:7], v[176:179], a[84:87], v[4:7]
    ds_read_b128 a[156:159], v239 offset:39936
    buffer_load_dwordx4 v209, s[68:71], s48 offen offset:1024 lds
    v_mfma_f32_16x16x32_bf16 v[8:11], v[176:179], a[88:91], v[8:11]
    v_mfma_f32_16x16x32_bf16 v[12:15], v[176:179], a[92:95], v[12:15]
    s_waitcnt lgkmcnt(10)
    v_mfma_f32_16x16x32_bf16 v[16:19], v[180:183], a[80:83], v[16:19]
    ds_read_b64_tr_b16 v[200:201], v217 offset:28672
    ds_read_b64_tr_b16 v[202:203], v217 offset:43008
    v_mfma_f32_16x16x32_bf16 v[20:23], v[180:183], a[84:87], v[20:23]
    ds_read_b128 a[160:163], v239 offset:40960
    buffer_load_dwordx4 v210, s[68:71], s48 offen offset:2048 lds
    v_mfma_f32_16x16x32_bf16 v[24:27], v[180:183], a[88:91], v[24:27]
    v_mfma_f32_16x16x32_bf16 v[28:31], v[180:183], a[92:95], v[28:31]
    s_waitcnt vmcnt(7)
    s_waitcnt lgkmcnt(1)
    s_barrier
    v_mfma_f32_16x16x32_bf16 v[32:35], v[184:187], a[80:83], v[32:35]
    ds_read_b64_tr_b16 v[176:177], v218 offset:0
    ds_read_b64_tr_b16 v[178:179], v218 offset:14336
    v_mfma_f32_16x16x32_bf16 v[36:39], v[184:187], a[84:87], v[36:39]
    s_mov_b32 s48, 229376
    s_add_u32 m0, s47, 28672
    v_mfma_f32_16x16x32_bf16 v[40:43], v[184:187], a[88:91], v[40:43]
    ds_read_b128 a[164:167], v239 offset:41984
    buffer_load_dwordx4 v204, s[68:71], s48 offen offset:0 lds
    v_mfma_f32_16x16x32_bf16 v[44:47], v[184:187], a[92:95], v[44:47]
    v_mfma_f32_16x16x32_bf16 v[48:51], v[188:191], a[80:83], v[48:51]
    ds_read_b64_tr_b16 v[180:181], v219 offset:0
    ds_read_b64_tr_b16 v[182:183], v219 offset:14336
    v_mfma_f32_16x16x32_bf16 v[52:55], v[188:191], a[84:87], v[52:55]
    ds_read_b128 a[168:171], v239 offset:43008
    buffer_load_dwordx4 v205, s[68:71], s48 offen offset:1024 lds
    v_mfma_f32_16x16x32_bf16 v[56:59], v[188:191], a[88:91], v[56:59]
    v_mfma_f32_16x16x32_bf16 v[60:63], v[188:191], a[92:95], v[60:63]
    v_mfma_f32_16x16x32_bf16 v[64:67], v[192:195], a[80:83], v[64:67]
    ds_read_b64_tr_b16 v[184:185], v220 offset:0
    ds_read_b64_tr_b16 v[186:187], v220 offset:14336
    v_mfma_f32_16x16x32_bf16 v[68:71], v[192:195], a[84:87], v[68:71]
    ds_read_b128 a[172:175], v239 offset:44032
    buffer_load_dwordx4 v206, s[68:71], s48 offen offset:2048 lds
    v_mfma_f32_16x16x32_bf16 v[72:75], v[192:195], a[88:91], v[72:75]
    v_mfma_f32_16x16x32_bf16 v[76:79], v[192:195], a[92:95], v[76:79]
    v_mfma_f32_16x16x32_bf16 v[80:83], v[196:199], a[80:83], v[80:83]
    ds_read_b64_tr_b16 v[188:189], v221 offset:0
    ds_read_b64_tr_b16 v[190:191], v221 offset:14336
    v_mfma_f32_16x16x32_bf16 v[84:87], v[196:199], a[84:87], v[84:87]
    ds_read_b128 a[176:179], v239 offset:45056
    buffer_load_dwordx4 v207, s[68:71], s48 offen offset:3072 lds
    v_mfma_f32_16x16x32_bf16 v[88:91], v[196:199], a[88:91], v[88:91]
    v_mfma_f32_16x16x32_bf16 v[92:95], v[196:199], a[92:95], v[92:95]
    v_mfma_f32_16x16x32_bf16 v[96:99], v[200:203], a[80:83], v[96:99]
    ds_read_b64_tr_b16 v[192:193], v222 offset:0
    ds_read_b64_tr_b16 v[194:195], v222 offset:14336
    v_mfma_f32_16x16x32_bf16 v[100:103], v[200:203], a[84:87], v[100:103]
    s_add_u32 m0, s47, 32768
    ds_read_b128 a[180:183], v239 offset:46080
    v_mfma_f32_16x16x32_bf16 v[104:107], v[200:203], a[88:91], v[104:107]
    buffer_load_dwordx4 v208, s[68:71], s48 offen offset:0 lds
    v_mfma_f32_16x16x32_bf16 v[108:111], v[200:203], a[92:95], v[108:111]
    s_waitcnt lgkmcnt(10)
    v_mfma_f32_16x16x32_bf16 v[0:3], v[176:179], a[96:99], v[0:3]
    ds_read_b64_tr_b16 v[196:197], v223 offset:0
    ds_read_b64_tr_b16 v[198:199], v223 offset:14336
    v_mfma_f32_16x16x32_bf16 v[4:7], v[176:179], a[100:103], v[4:7]
    ds_read_b128 a[184:187], v239 offset:47104
    buffer_load_dwordx4 v209, s[68:71], s48 offen offset:1024 lds
    v_mfma_f32_16x16x32_bf16 v[8:11], v[176:179], a[104:107], v[8:11]
    v_mfma_f32_16x16x32_bf16 v[12:15], v[176:179], a[108:111], v[12:15]
    v_mfma_f32_16x16x32_bf16 v[16:19], v[180:183], a[96:99], v[16:19]
    ds_read_b64_tr_b16 v[200:201], v224 offset:0
    ds_read_b64_tr_b16 v[202:203], v224 offset:14336
    v_mfma_f32_16x16x32_bf16 v[20:23], v[180:183], a[100:103], v[20:23]
    ds_read_b128 a[188:191], v239 offset:48128
    buffer_load_dwordx4 v210, s[68:71], s48 offen offset:2048 lds
    v_mfma_f32_16x16x32_bf16 v[24:27], v[180:183], a[104:107], v[24:27]
    v_mfma_f32_16x16x32_bf16 v[28:31], v[180:183], a[108:111], v[28:31]
    s_waitcnt vmcnt(7)
    s_waitcnt lgkmcnt(1)
    s_barrier
    v_mfma_f32_16x16x32_bf16 v[32:35], v[184:187], a[96:99], v[32:35]
    ds_read_b64_tr_b16 v[176:177], v211 offset:0
    ds_read_b64_tr_b16 v[178:179], v211 offset:14336
    v_mfma_f32_16x16x32_bf16 v[36:39], v[184:187], a[100:103], v[36:39]
    s_mov_b32 s48, 258048
    s_add_u32 m0, s47, 135168
    v_mfma_f32_16x16x32_bf16 v[40:43], v[184:187], a[104:107], v[40:43]
    ds_read_b128 a[192:195], v239 offset:49152
    buffer_load_dwordx4 v204, s[68:71], s48 offen offset:0 lds
    v_mfma_f32_16x16x32_bf16 v[44:47], v[184:187], a[108:111], v[44:47]
    v_mfma_f32_16x16x32_bf16 v[48:51], v[188:191], a[96:99], v[48:51]
    ds_read_b64_tr_b16 v[180:181], v212 offset:0
    ds_read_b64_tr_b16 v[182:183], v212 offset:14336
    v_mfma_f32_16x16x32_bf16 v[52:55], v[188:191], a[100:103], v[52:55]
    ds_read_b128 a[196:199], v239 offset:50176
    buffer_load_dwordx4 v205, s[68:71], s48 offen offset:1024 lds
    v_mfma_f32_16x16x32_bf16 v[56:59], v[188:191], a[104:107], v[56:59]
    v_mfma_f32_16x16x32_bf16 v[60:63], v[188:191], a[108:111], v[60:63]
    v_mfma_f32_16x16x32_bf16 v[64:67], v[192:195], a[96:99], v[64:67]
    ds_read_b64_tr_b16 v[184:185], v213 offset:0
    ds_read_b64_tr_b16 v[186:187], v213 offset:14336
    v_mfma_f32_16x16x32_bf16 v[68:71], v[192:195], a[100:103], v[68:71]
    ds_read_b128 a[200:203], v239 offset:51200
    buffer_load_dwordx4 v206, s[68:71], s48 offen offset:2048 lds
    v_mfma_f32_16x16x32_bf16 v[72:75], v[192:195], a[104:107], v[72:75]
    v_mfma_f32_16x16x32_bf16 v[76:79], v[192:195], a[108:111], v[76:79]
    v_mfma_f32_16x16x32_bf16 v[80:83], v[196:199], a[96:99], v[80:83]
    ds_read_b64_tr_b16 v[188:189], v214 offset:0
    ds_read_b64_tr_b16 v[190:191], v214 offset:14336
    v_mfma_f32_16x16x32_bf16 v[84:87], v[196:199], a[100:103], v[84:87]
    ds_read_b128 a[204:207], v239 offset:52224
    buffer_load_dwordx4 v207, s[68:71], s48 offen offset:3072 lds
    v_mfma_f32_16x16x32_bf16 v[88:91], v[196:199], a[104:107], v[88:91]
    v_mfma_f32_16x16x32_bf16 v[92:95], v[196:199], a[108:111], v[92:95]
    s_waitcnt lgkmcnt(10)
    v_mfma_f32_16x16x32_bf16 v[96:99], v[200:203], a[96:99], v[96:99]
    ds_read_b64_tr_b16 v[192:193], v215 offset:0
    ds_read_b64_tr_b16 v[194:195], v215 offset:14336
    v_mfma_f32_16x16x32_bf16 v[100:103], v[200:203], a[100:103], v[100:103]
    s_add_u32 m0, s47, 139264
    ds_read_b128 a[208:211], v239 offset:53248
    v_mfma_f32_16x16x32_bf16 v[104:107], v[200:203], a[104:107], v[104:107]
    buffer_load_dwordx4 v208, s[68:71], s48 offen offset:0 lds
    v_mfma_f32_16x16x32_bf16 v[108:111], v[200:203], a[108:111], v[108:111]
    v_mfma_f32_16x16x32_bf16 v[0:3], v[176:179], a[112:115], v[0:3]
    ds_read_b64_tr_b16 v[196:197], v216 offset:0
    ds_read_b64_tr_b16 v[198:199], v216 offset:14336
    v_mfma_f32_16x16x32_bf16 v[4:7], v[176:179], a[116:119], v[4:7]
    ds_read_b128 a[212:215], v239 offset:54272
    buffer_load_dwordx4 v209, s[68:71], s48 offen offset:1024 lds
    v_mfma_f32_16x16x32_bf16 v[8:11], v[176:179], a[120:123], v[8:11]
    v_mfma_f32_16x16x32_bf16 v[12:15], v[176:179], a[124:127], v[12:15]
    s_waitcnt lgkmcnt(10)
    v_mfma_f32_16x16x32_bf16 v[16:19], v[180:183], a[112:115], v[16:19]
    ds_read_b64_tr_b16 v[200:201], v217 offset:0
    ds_read_b64_tr_b16 v[202:203], v217 offset:14336
    v_mfma_f32_16x16x32_bf16 v[20:23], v[180:183], a[116:119], v[20:23]
    ds_read_b128 a[216:219], v239 offset:55296
    buffer_load_dwordx4 v210, s[68:71], s48 offen offset:2048 lds
    v_mfma_f32_16x16x32_bf16 v[24:27], v[180:183], a[120:123], v[24:27]
    v_mfma_f32_16x16x32_bf16 v[28:31], v[180:183], a[124:127], v[28:31]
    s_waitcnt vmcnt(7)
    s_waitcnt lgkmcnt(1)
    s_barrier
    v_mfma_f32_16x16x32_bf16 v[32:35], v[184:187], a[112:115], v[32:35]
    ds_read_b64_tr_b16 v[176:177], v211 offset:28672
    ds_read_b64_tr_b16 v[178:179], v211 offset:43008
    v_mfma_f32_16x16x32_bf16 v[36:39], v[184:187], a[116:119], v[36:39]
    s_mov_b32 s48, 286720
    s_add_u32 m0, s47, 0
    v_mfma_f32_16x16x32_bf16 v[40:43], v[184:187], a[120:123], v[40:43]
    ds_read_b128 a[220:223], v239 offset:56320
    buffer_load_dwordx4 v204, s[68:71], s48 offen offset:0 lds
    v_mfma_f32_16x16x32_bf16 v[44:47], v[184:187], a[124:127], v[44:47]
    v_mfma_f32_16x16x32_bf16 v[48:51], v[188:191], a[112:115], v[48:51]
    ds_read_b64_tr_b16 v[180:181], v212 offset:28672
    ds_read_b64_tr_b16 v[182:183], v212 offset:43008
    v_mfma_f32_16x16x32_bf16 v[52:55], v[188:191], a[116:119], v[52:55]
    ds_read_b128 a[224:227], v239 offset:57344
    buffer_load_dwordx4 v205, s[68:71], s48 offen offset:1024 lds
    v_mfma_f32_16x16x32_bf16 v[56:59], v[188:191], a[120:123], v[56:59]
    v_mfma_f32_16x16x32_bf16 v[60:63], v[188:191], a[124:127], v[60:63]
    v_mfma_f32_16x16x32_bf16 v[64:67], v[192:195], a[112:115], v[64:67]
    ds_read_b64_tr_b16 v[184:185], v213 offset:28672
    ds_read_b64_tr_b16 v[186:187], v213 offset:43008
    v_mfma_f32_16x16x32_bf16 v[68:71], v[192:195], a[116:119], v[68:71]
    ds_read_b128 a[228:231], v239 offset:58368
    buffer_load_dwordx4 v206, s[68:71], s48 offen offset:2048 lds
    v_mfma_f32_16x16x32_bf16 v[72:75], v[192:195], a[120:123], v[72:75]
    v_mfma_f32_16x16x32_bf16 v[76:79], v[192:195], a[124:127], v[76:79]
    v_mfma_f32_16x16x32_bf16 v[80:83], v[196:199], a[112:115], v[80:83]
    ds_read_b64_tr_b16 v[188:189], v214 offset:28672
    ds_read_b64_tr_b16 v[190:191], v214 offset:43008
    v_mfma_f32_16x16x32_bf16 v[84:87], v[196:199], a[116:119], v[84:87]
    ds_read_b128 a[232:235], v239 offset:59392
    buffer_load_dwordx4 v207, s[68:71], s48 offen offset:3072 lds
    v_mfma_f32_16x16x32_bf16 v[88:91], v[196:199], a[120:123], v[88:91]
    v_mfma_f32_16x16x32_bf16 v[92:95], v[196:199], a[124:127], v[92:95]
    v_mfma_f32_16x16x32_bf16 v[96:99], v[200:203], a[112:115], v[96:99]
    ds_read_b64_tr_b16 v[192:193], v215 offset:28672
    ds_read_b64_tr_b16 v[194:195], v215 offset:43008
    v_mfma_f32_16x16x32_bf16 v[100:103], v[200:203], a[116:119], v[100:103]
    s_add_u32 m0, s47, 4096
    ds_read_b128 a[236:239], v239 offset:60416
    v_mfma_f32_16x16x32_bf16 v[104:107], v[200:203], a[120:123], v[104:107]
    buffer_load_dwordx4 v208, s[68:71], s48 offen offset:0 lds
    v_mfma_f32_16x16x32_bf16 v[108:111], v[200:203], a[124:127], v[108:111]
    s_waitcnt lgkmcnt(10)
    v_mfma_f32_16x16x32_bf16 v[0:3], v[176:179], a[128:131], v[0:3]
    ds_read_b64_tr_b16 v[196:197], v216 offset:28672
    ds_read_b64_tr_b16 v[198:199], v216 offset:43008
    v_mfma_f32_16x16x32_bf16 v[4:7], v[176:179], a[132:135], v[4:7]
    ds_read_b128 a[240:243], v239 offset:61440
    buffer_load_dwordx4 v209, s[68:71], s48 offen offset:1024 lds
    v_mfma_f32_16x16x32_bf16 v[8:11], v[176:179], a[136:139], v[8:11]
    v_mfma_f32_16x16x32_bf16 v[12:15], v[176:179], a[140:143], v[12:15]
    v_mfma_f32_16x16x32_bf16 v[16:19], v[180:183], a[128:131], v[16:19]
    ds_read_b64_tr_b16 v[200:201], v217 offset:28672
    ds_read_b64_tr_b16 v[202:203], v217 offset:43008
    v_mfma_f32_16x16x32_bf16 v[20:23], v[180:183], a[132:135], v[20:23]
    ds_read_b128 a[244:247], v239 offset:62464
    buffer_load_dwordx4 v210, s[68:71], s48 offen offset:2048 lds
    v_mfma_f32_16x16x32_bf16 v[24:27], v[180:183], a[136:139], v[24:27]
    v_mfma_f32_16x16x32_bf16 v[28:31], v[180:183], a[140:143], v[28:31]
    s_waitcnt vmcnt(7)
    s_waitcnt lgkmcnt(1)
    s_barrier
    v_mfma_f32_16x16x32_bf16 v[32:35], v[184:187], a[128:131], v[32:35]
    ds_read_b64_tr_b16 v[176:177], v218 offset:0
    ds_read_b64_tr_b16 v[178:179], v218 offset:14336
    v_mfma_f32_16x16x32_bf16 v[36:39], v[184:187], a[132:135], v[36:39]
    s_mov_b32 s48, 315392
    s_add_u32 m0, s47, 28672
    v_mfma_f32_16x16x32_bf16 v[40:43], v[184:187], a[136:139], v[40:43]
    ds_read_b128 a[248:251], v239 offset:63488
    buffer_load_dwordx4 v204, s[68:71], s48 offen offset:0 lds
    v_mfma_f32_16x16x32_bf16 v[44:47], v[184:187], a[140:143], v[44:47]
    v_mfma_f32_16x16x32_bf16 v[48:51], v[188:191], a[128:131], v[48:51]
    ds_read_b64_tr_b16 v[180:181], v219 offset:0
    ds_read_b64_tr_b16 v[182:183], v219 offset:14336
    v_mfma_f32_16x16x32_bf16 v[52:55], v[188:191], a[132:135], v[52:55]
    ds_read_b128 a[252:255], v239 offset:64512
    buffer_load_dwordx4 v205, s[68:71], s48 offen offset:1024 lds
    v_mfma_f32_16x16x32_bf16 v[56:59], v[188:191], a[136:139], v[56:59]
    v_mfma_f32_16x16x32_bf16 v[60:63], v[188:191], a[140:143], v[60:63]
    v_mfma_f32_16x16x32_bf16 v[64:67], v[192:195], a[128:131], v[64:67]
    ds_read_b64_tr_b16 v[184:185], v220 offset:0
    ds_read_b64_tr_b16 v[186:187], v220 offset:14336
    v_mfma_f32_16x16x32_bf16 v[68:71], v[192:195], a[132:135], v[68:71]
    buffer_load_dwordx4 v206, s[68:71], s48 offen offset:2048 lds
    v_mfma_f32_16x16x32_bf16 v[72:75], v[192:195], a[136:139], v[72:75]
    v_mfma_f32_16x16x32_bf16 v[76:79], v[192:195], a[140:143], v[76:79]
    v_mfma_f32_16x16x32_bf16 v[80:83], v[196:199], a[128:131], v[80:83]
    ds_read_b64_tr_b16 v[188:189], v221 offset:0
    ds_read_b64_tr_b16 v[190:191], v221 offset:14336
    v_mfma_f32_16x16x32_bf16 v[84:87], v[196:199], a[132:135], v[84:87]
    buffer_load_dwordx4 v207, s[68:71], s48 offen offset:3072 lds
    v_mfma_f32_16x16x32_bf16 v[88:91], v[196:199], a[136:139], v[88:91]
    v_mfma_f32_16x16x32_bf16 v[92:95], v[196:199], a[140:143], v[92:95]
    s_waitcnt lgkmcnt(8)
    v_mfma_f32_16x16x32_bf16 v[96:99], v[200:203], a[128:131], v[96:99]
    ds_read_b64_tr_b16 v[192:193], v222 offset:0
    ds_read_b64_tr_b16 v[194:195], v222 offset:14336
    v_mfma_f32_16x16x32_bf16 v[100:103], v[200:203], a[132:135], v[100:103]
    s_add_u32 m0, s47, 32768
    v_mfma_f32_16x16x32_bf16 v[104:107], v[200:203], a[136:139], v[104:107]
    buffer_load_dwordx4 v208, s[68:71], s48 offen offset:0 lds
    v_mfma_f32_16x16x32_bf16 v[108:111], v[200:203], a[140:143], v[108:111]
    v_mfma_f32_16x16x32_bf16 v[0:3], v[176:179], a[144:147], v[0:3]
    ds_read_b64_tr_b16 v[196:197], v223 offset:0
    ds_read_b64_tr_b16 v[198:199], v223 offset:14336
    v_mfma_f32_16x16x32_bf16 v[4:7], v[176:179], a[148:151], v[4:7]
    buffer_load_dwordx4 v209, s[68:71], s48 offen offset:1024 lds
    v_mfma_f32_16x16x32_bf16 v[8:11], v[176:179], a[152:155], v[8:11]
    v_mfma_f32_16x16x32_bf16 v[12:15], v[176:179], a[156:159], v[12:15]
    s_waitcnt lgkmcnt(6)
    v_mfma_f32_16x16x32_bf16 v[16:19], v[180:183], a[144:147], v[16:19]
    ds_read_b64_tr_b16 v[200:201], v224 offset:0
    ds_read_b64_tr_b16 v[202:203], v224 offset:14336
    v_mfma_f32_16x16x32_bf16 v[20:23], v[180:183], a[148:151], v[20:23]
    buffer_load_dwordx4 v210, s[68:71], s48 offen offset:2048 lds
    v_mfma_f32_16x16x32_bf16 v[24:27], v[180:183], a[152:155], v[24:27]
    v_mfma_f32_16x16x32_bf16 v[28:31], v[180:183], a[156:159], v[28:31]
    s_waitcnt vmcnt(7)
    s_waitcnt lgkmcnt(0)
    s_barrier
    v_mfma_f32_16x16x32_bf16 v[32:35], v[184:187], a[144:147], v[32:35]
    ds_read_b64_tr_b16 v[176:177], v211 offset:0
    ds_read_b64_tr_b16 v[178:179], v211 offset:14336
    v_mfma_f32_16x16x32_bf16 v[36:39], v[184:187], a[148:151], v[36:39]
    s_mov_b32 s48, 344064
    s_add_u32 m0, s47, 135168
    v_mfma_f32_16x16x32_bf16 v[40:43], v[184:187], a[152:155], v[40:43]
    buffer_load_dwordx4 v204, s[68:71], s48 offen offset:0 lds
    v_mfma_f32_16x16x32_bf16 v[44:47], v[184:187], a[156:159], v[44:47]
    v_mfma_f32_16x16x32_bf16 v[48:51], v[188:191], a[144:147], v[48:51]
    ds_read_b64_tr_b16 v[180:181], v212 offset:0
    ds_read_b64_tr_b16 v[182:183], v212 offset:14336
    v_mfma_f32_16x16x32_bf16 v[52:55], v[188:191], a[148:151], v[52:55]
    buffer_load_dwordx4 v205, s[68:71], s48 offen offset:1024 lds
    v_mfma_f32_16x16x32_bf16 v[56:59], v[188:191], a[152:155], v[56:59]
    v_mfma_f32_16x16x32_bf16 v[60:63], v[188:191], a[156:159], v[60:63]
    v_mfma_f32_16x16x32_bf16 v[64:67], v[192:195], a[144:147], v[64:67]
    ds_read_b64_tr_b16 v[184:185], v213 offset:0
    ds_read_b64_tr_b16 v[186:187], v213 offset:14336
    v_mfma_f32_16x16x32_bf16 v[68:71], v[192:195], a[148:151], v[68:71]
    buffer_load_dwordx4 v206, s[68:71], s48 offen offset:2048 lds
    v_mfma_f32_16x16x32_bf16 v[72:75], v[192:195], a[152:155], v[72:75]
    v_mfma_f32_16x16x32_bf16 v[76:79], v[192:195], a[156:159], v[76:79]
    v_mfma_f32_16x16x32_bf16 v[80:83], v[196:199], a[144:147], v[80:83]
    ds_read_b64_tr_b16 v[188:189], v214 offset:0
    ds_read_b64_tr_b16 v[190:191], v214 offset:14336
    v_mfma_f32_16x16x32_bf16 v[84:87], v[196:199], a[148:151], v[84:87]
    buffer_load_dwordx4 v207, s[68:71], s48 offen offset:3072 lds
    v_mfma_f32_16x16x32_bf16 v[88:91], v[196:199], a[152:155], v[88:91]
    v_mfma_f32_16x16x32_bf16 v[92:95], v[196:199], a[156:159], v[92:95]
    v_mfma_f32_16x16x32_bf16 v[96:99], v[200:203], a[144:147], v[96:99]
    ds_read_b64_tr_b16 v[192:193], v215 offset:0
    ds_read_b64_tr_b16 v[194:195], v215 offset:14336
    v_mfma_f32_16x16x32_bf16 v[100:103], v[200:203], a[148:151], v[100:103]
    s_add_u32 m0, s47, 139264
    v_mfma_f32_16x16x32_bf16 v[104:107], v[200:203], a[152:155], v[104:107]
    buffer_load_dwordx4 v208, s[68:71], s48 offen offset:0 lds
    v_mfma_f32_16x16x32_bf16 v[108:111], v[200:203], a[156:159], v[108:111]
    s_waitcnt lgkmcnt(6)
    v_mfma_f32_16x16x32_bf16 v[0:3], v[176:179], a[160:163], v[0:3]
    ds_read_b64_tr_b16 v[196:197], v216 offset:0
    ds_read_b64_tr_b16 v[198:199], v216 offset:14336
    v_mfma_f32_16x16x32_bf16 v[4:7], v[176:179], a[164:167], v[4:7]
    buffer_load_dwordx4 v209, s[68:71], s48 offen offset:1024 lds
    v_mfma_f32_16x16x32_bf16 v[8:11], v[176:179], a[168:171], v[8:11]
    v_mfma_f32_16x16x32_bf16 v[12:15], v[176:179], a[172:175], v[12:15]
    v_mfma_f32_16x16x32_bf16 v[16:19], v[180:183], a[160:163], v[16:19]
    ds_read_b64_tr_b16 v[200:201], v217 offset:0
    ds_read_b64_tr_b16 v[202:203], v217 offset:14336
    v_mfma_f32_16x16x32_bf16 v[20:23], v[180:183], a[164:167], v[20:23]
    buffer_load_dwordx4 v210, s[68:71], s48 offen offset:2048 lds
    v_mfma_f32_16x16x32_bf16 v[24:27], v[180:183], a[168:171], v[24:27]
    v_mfma_f32_16x16x32_bf16 v[28:31], v[180:183], a[172:175], v[28:31]
    s_waitcnt vmcnt(7)
    s_waitcnt lgkmcnt(0)
    s_barrier
    v_mfma_f32_16x16x32_bf16 v[32:35], v[184:187], a[160:163], v[32:35]
    ds_read_b64_tr_b16 v[176:177], v211 offset:28672
    ds_read_b64_tr_b16 v[178:179], v211 offset:43008
    v_mfma_f32_16x16x32_bf16 v[36:39], v[184:187], a[164:167], v[36:39]
    s_mov_b32 s48, 372736
    s_add_u32 m0, s47, 0
    v_mfma_f32_16x16x32_bf16 v[40:43], v[184:187], a[168:171], v[40:43]
    buffer_load_dwordx4 v204, s[68:71], s48 offen offset:0 lds
    v_mfma_f32_16x16x32_bf16 v[44:47], v[184:187], a[172:175], v[44:47]
    v_mfma_f32_16x16x32_bf16 v[48:51], v[188:191], a[160:163], v[48:51]
    ds_read_b64_tr_b16 v[180:181], v212 offset:28672
    ds_read_b64_tr_b16 v[182:183], v212 offset:43008
    v_mfma_f32_16x16x32_bf16 v[52:55], v[188:191], a[164:167], v[52:55]
    buffer_load_dwordx4 v205, s[68:71], s48 offen offset:1024 lds
    v_mfma_f32_16x16x32_bf16 v[56:59], v[188:191], a[168:171], v[56:59]
    v_mfma_f32_16x16x32_bf16 v[60:63], v[188:191], a[172:175], v[60:63]
    v_mfma_f32_16x16x32_bf16 v[64:67], v[192:195], a[160:163], v[64:67]
    ds_read_b64_tr_b16 v[184:185], v213 offset:28672
    ds_read_b64_tr_b16 v[186:187], v213 offset:43008
    v_mfma_f32_16x16x32_bf16 v[68:71], v[192:195], a[164:167], v[68:71]
    buffer_load_dwordx4 v206, s[68:71], s48 offen offset:2048 lds
    v_mfma_f32_16x16x32_bf16 v[72:75], v[192:195], a[168:171], v[72:75]
    v_mfma_f32_16x16x32_bf16 v[76:79], v[192:195], a[172:175], v[76:79]
    v_mfma_f32_16x16x32_bf16 v[80:83], v[196:199], a[160:163], v[80:83]
    ds_read_b64_tr_b16 v[188:189], v214 offset:28672
    ds_read_b64_tr_b16 v[190:191], v214 offset:43008
    v_mfma_f32_16x16x32_bf16 v[84:87], v[196:199], a[164:167], v[84:87]
    buffer_load_dwordx4 v207, s[68:71], s48 offen offset:3072 lds
    v_mfma_f32_16x16x32_bf16 v[88:91], v[196:199], a[168:171], v[88:91]
    v_mfma_f32_16x16x32_bf16 v[92:95], v[196:199], a[172:175], v[92:95]
    s_waitcnt lgkmcnt(6)
    v_mfma_f32_16x16x32_bf16 v[96:99], v[200:203], a[160:163], v[96:99]
    ds_read_b64_tr_b16 v[192:193], v215 offset:28672
    ds_read_b64_tr_b16 v[194:195], v215 offset:43008
    v_mfma_f32_16x16x32_bf16 v[100:103], v[200:203], a[164:167], v[100:103]
    s_add_u32 m0, s47, 4096
    v_mfma_f32_16x16x32_bf16 v[104:107], v[200:203], a[168:171], v[104:107]
    buffer_load_dwordx4 v208, s[68:71], s48 offen offset:0 lds
    v_mfma_f32_16x16x32_bf16 v[108:111], v[200:203], a[172:175], v[108:111]
    v_mfma_f32_16x16x32_bf16 v[0:3], v[176:179], a[176:179], v[0:3]
    ds_read_b64_tr_b16 v[196:197], v216 offset:28672
    ds_read_b64_tr_b16 v[198:199], v216 offset:43008
    v_mfma_f32_16x16x32_bf16 v[4:7], v[176:179], a[180:183], v[4:7]
    buffer_load_dwordx4 v209, s[68:71], s48 offen offset:1024 lds
    v_mfma_f32_16x16x32_bf16 v[8:11], v[176:179], a[184:187], v[8:11]
    v_mfma_f32_16x16x32_bf16 v[12:15], v[176:179], a[188:191], v[12:15]
    s_waitcnt lgkmcnt(6)
    v_mfma_f32_16x16x32_bf16 v[16:19], v[180:183], a[176:179], v[16:19]
    ds_read_b64_tr_b16 v[200:201], v217 offset:28672
    ds_read_b64_tr_b16 v[202:203], v217 offset:43008
    v_mfma_f32_16x16x32_bf16 v[20:23], v[180:183], a[180:183], v[20:23]
    buffer_load_dwordx4 v210, s[68:71], s48 offen offset:2048 lds
    v_mfma_f32_16x16x32_bf16 v[24:27], v[180:183], a[184:187], v[24:27]
    v_mfma_f32_16x16x32_bf16 v[28:31], v[180:183], a[188:191], v[28:31]
    s_waitcnt vmcnt(7)
    s_waitcnt lgkmcnt(0)
    s_barrier
    v_mfma_f32_16x16x32_bf16 v[32:35], v[184:187], a[176:179], v[32:35]
    ds_read_b64_tr_b16 v[176:177], v218 offset:0
    ds_read_b64_tr_b16 v[178:179], v218 offset:14336
    v_mfma_f32_16x16x32_bf16 v[36:39], v[184:187], a[180:183], v[36:39]
    s_mov_b32 s48, 401408
    s_add_u32 m0, s47, 28672
    v_mfma_f32_16x16x32_bf16 v[40:43], v[184:187], a[184:187], v[40:43]
    buffer_load_dwordx4 v204, s[68:71], s48 offen offset:0 lds
    v_mfma_f32_16x16x32_bf16 v[44:47], v[184:187], a[188:191], v[44:47]
    v_mfma_f32_16x16x32_bf16 v[48:51], v[188:191], a[176:179], v[48:51]
    ds_read_b64_tr_b16 v[180:181], v219 offset:0
    ds_read_b64_tr_b16 v[182:183], v219 offset:14336
    v_mfma_f32_16x16x32_bf16 v[52:55], v[188:191], a[180:183], v[52:55]
    buffer_load_dwordx4 v205, s[68:71], s48 offen offset:1024 lds
    v_mfma_f32_16x16x32_bf16 v[56:59], v[188:191], a[184:187], v[56:59]
    v_mfma_f32_16x16x32_bf16 v[60:63], v[188:191], a[188:191], v[60:63]
    v_mfma_f32_16x16x32_bf16 v[64:67], v[192:195], a[176:179], v[64:67]
    ds_read_b64_tr_b16 v[184:185], v220 offset:0
    ds_read_b64_tr_b16 v[186:187], v220 offset:14336
    v_mfma_f32_16x16x32_bf16 v[68:71], v[192:195], a[180:183], v[68:71]
    buffer_load_dwordx4 v206, s[68:71], s48 offen offset:2048 lds
    v_mfma_f32_16x16x32_bf16 v[72:75], v[192:195], a[184:187], v[72:75]
    v_mfma_f32_16x16x32_bf16 v[76:79], v[192:195], a[188:191], v[76:79]
    v_mfma_f32_16x16x32_bf16 v[80:83], v[196:199], a[176:179], v[80:83]
    ds_read_b64_tr_b16 v[188:189], v221 offset:0
    ds_read_b64_tr_b16 v[190:191], v221 offset:14336
    v_mfma_f32_16x16x32_bf16 v[84:87], v[196:199], a[180:183], v[84:87]
    buffer_load_dwordx4 v207, s[68:71], s48 offen offset:3072 lds
    v_mfma_f32_16x16x32_bf16 v[88:91], v[196:199], a[184:187], v[88:91]
    v_mfma_f32_16x16x32_bf16 v[92:95], v[196:199], a[188:191], v[92:95]
    v_mfma_f32_16x16x32_bf16 v[96:99], v[200:203], a[176:179], v[96:99]
    ds_read_b64_tr_b16 v[192:193], v222 offset:0
    ds_read_b64_tr_b16 v[194:195], v222 offset:14336
    v_mfma_f32_16x16x32_bf16 v[100:103], v[200:203], a[180:183], v[100:103]
    s_add_u32 m0, s47, 32768
    v_mfma_f32_16x16x32_bf16 v[104:107], v[200:203], a[184:187], v[104:107]
    buffer_load_dwordx4 v208, s[68:71], s48 offen offset:0 lds
    v_mfma_f32_16x16x32_bf16 v[108:111], v[200:203], a[188:191], v[108:111]
    s_waitcnt lgkmcnt(6)
    v_mfma_f32_16x16x32_bf16 v[0:3], v[176:179], a[192:195], v[0:3]
    ds_read_b64_tr_b16 v[196:197], v223 offset:0
    ds_read_b64_tr_b16 v[198:199], v223 offset:14336
    v_mfma_f32_16x16x32_bf16 v[4:7], v[176:179], a[196:199], v[4:7]
    buffer_load_dwordx4 v209, s[68:71], s48 offen offset:1024 lds
    v_mfma_f32_16x16x32_bf16 v[8:11], v[176:179], a[200:203], v[8:11]
    v_mfma_f32_16x16x32_bf16 v[12:15], v[176:179], a[204:207], v[12:15]
    v_mfma_f32_16x16x32_bf16 v[16:19], v[180:183], a[192:195], v[16:19]
    ds_read_b64_tr_b16 v[200:201], v224 offset:0
    ds_read_b64_tr_b16 v[202:203], v224 offset:14336
    v_mfma_f32_16x16x32_bf16 v[20:23], v[180:183], a[196:199], v[20:23]
    buffer_load_dwordx4 v210, s[68:71], s48 offen offset:2048 lds
    v_mfma_f32_16x16x32_bf16 v[24:27], v[180:183], a[200:203], v[24:27]
    v_mfma_f32_16x16x32_bf16 v[28:31], v[180:183], a[204:207], v[28:31]
    s_waitcnt vmcnt(7)
    s_waitcnt lgkmcnt(0)
    s_barrier
    v_mfma_f32_16x16x32_bf16 v[32:35], v[184:187], a[192:195], v[32:35]
    ds_read_b64_tr_b16 v[176:177], v211 offset:0
    ds_read_b64_tr_b16 v[178:179], v211 offset:14336
    v_mfma_f32_16x16x32_bf16 v[36:39], v[184:187], a[196:199], v[36:39]
    s_mov_b32 s48, 430080
    s_add_u32 m0, s47, 135168
    v_mfma_f32_16x16x32_bf16 v[40:43], v[184:187], a[200:203], v[40:43]
    buffer_load_dwordx4 v204, s[68:71], s48 offen offset:0 lds
    v_mfma_f32_16x16x32_bf16 v[44:47], v[184:187], a[204:207], v[44:47]
    v_mfma_f32_16x16x32_bf16 v[48:51], v[188:191], a[192:195], v[48:51]
    ds_read_b64_tr_b16 v[180:181], v212 offset:0
    ds_read_b64_tr_b16 v[182:183], v212 offset:14336
    v_mfma_f32_16x16x32_bf16 v[52:55], v[188:191], a[196:199], v[52:55]
    buffer_load_dwordx4 v205, s[68:71], s48 offen offset:1024 lds
    v_mfma_f32_16x16x32_bf16 v[56:59], v[188:191], a[200:203], v[56:59]
    v_mfma_f32_16x16x32_bf16 v[60:63], v[188:191], a[204:207], v[60:63]
    v_mfma_f32_16x16x32_bf16 v[64:67], v[192:195], a[192:195], v[64:67]
    ds_read_b64_tr_b16 v[184:185], v213 offset:0
    ds_read_b64_tr_b16 v[186:187], v213 offset:14336
    v_mfma_f32_16x16x32_bf16 v[68:71], v[192:195], a[196:199], v[68:71]
    buffer_load_dwordx4 v206, s[68:71], s48 offen offset:2048 lds
    v_mfma_f32_16x16x32_bf16 v[72:75], v[192:195], a[200:203], v[72:75]
    v_mfma_f32_16x16x32_bf16 v[76:79], v[192:195], a[204:207], v[76:79]
    v_mfma_f32_16x16x32_bf16 v[80:83], v[196:199], a[192:195], v[80:83]
    ds_read_b64_tr_b16 v[188:189], v214 offset:0
    ds_read_b64_tr_b16 v[190:191], v214 offset:14336
    v_mfma_f32_16x16x32_bf16 v[84:87], v[196:199], a[196:199], v[84:87]
    buffer_load_dwordx4 v207, s[68:71], s48 offen offset:3072 lds
    v_mfma_f32_16x16x32_bf16 v[88:91], v[196:199], a[200:203], v[88:91]
    v_mfma_f32_16x16x32_bf16 v[92:95], v[196:199], a[204:207], v[92:95]
    s_waitcnt lgkmcnt(6)
    v_mfma_f32_16x16x32_bf16 v[96:99], v[200:203], a[192:195], v[96:99]
    ds_read_b64_tr_b16 v[192:193], v215 offset:0
    ds_read_b64_tr_b16 v[194:195], v215 offset:14336
    v_mfma_f32_16x16x32_bf16 v[100:103], v[200:203], a[196:199], v[100:103]
    s_add_u32 m0, s47, 139264
    v_mfma_f32_16x16x32_bf16 v[104:107], v[200:203], a[200:203], v[104:107]
    buffer_load_dwordx4 v208, s[68:71], s48 offen offset:0 lds
    v_mfma_f32_16x16x32_bf16 v[108:111], v[200:203], a[204:207], v[108:111]
    v_mfma_f32_16x16x32_bf16 v[0:3], v[176:179], a[208:211], v[0:3]
    ds_read_b64_tr_b16 v[196:197], v216 offset:0
    ds_read_b64_tr_b16 v[198:199], v216 offset:14336
    v_mfma_f32_16x16x32_bf16 v[4:7], v[176:179], a[212:215], v[4:7]
    buffer_load_dwordx4 v209, s[68:71], s48 offen offset:1024 lds
    v_mfma_f32_16x16x32_bf16 v[8:11], v[176:179], a[216:219], v[8:11]
    v_mfma_f32_16x16x32_bf16 v[12:15], v[176:179], a[220:223], v[12:15]
    s_waitcnt lgkmcnt(6)
    v_mfma_f32_16x16x32_bf16 v[16:19], v[180:183], a[208:211], v[16:19]
    ds_read_b64_tr_b16 v[200:201], v217 offset:0
    ds_read_b64_tr_b16 v[202:203], v217 offset:14336
    v_mfma_f32_16x16x32_bf16 v[20:23], v[180:183], a[212:215], v[20:23]
    buffer_load_dwordx4 v210, s[68:71], s48 offen offset:2048 lds
    v_mfma_f32_16x16x32_bf16 v[24:27], v[180:183], a[216:219], v[24:27]
    v_mfma_f32_16x16x32_bf16 v[28:31], v[180:183], a[220:223], v[28:31]
    s_waitcnt vmcnt(0)
    s_waitcnt lgkmcnt(0)
    s_barrier
    v_mfma_f32_16x16x32_bf16 v[32:35], v[184:187], a[208:211], v[32:35]
    ds_read_b64_tr_b16 v[176:177], v211 offset:28672
    ds_read_b64_tr_b16 v[178:179], v211 offset:43008
    v_mfma_f32_16x16x32_bf16 v[36:39], v[184:187], a[212:215], v[36:39]
    v_mfma_f32_16x16x32_bf16 v[40:43], v[184:187], a[216:219], v[40:43]
    v_mfma_f32_16x16x32_bf16 v[44:47], v[184:187], a[220:223], v[44:47]
    v_mfma_f32_16x16x32_bf16 v[48:51], v[188:191], a[208:211], v[48:51]
    ds_read_b64_tr_b16 v[180:181], v218 offset:0
    ds_read_b64_tr_b16 v[182:183], v218 offset:14336
    v_mfma_f32_16x16x32_bf16 v[52:55], v[188:191], a[212:215], v[52:55]
    v_mfma_f32_16x16x32_bf16 v[56:59], v[188:191], a[216:219], v[56:59]
    v_mfma_f32_16x16x32_bf16 v[60:63], v[188:191], a[220:223], v[60:63]
    v_mfma_f32_16x16x32_bf16 v[64:67], v[192:195], a[208:211], v[64:67]
    ds_read_b64_tr_b16 v[184:185], v212 offset:28672
    ds_read_b64_tr_b16 v[186:187], v212 offset:43008
    v_mfma_f32_16x16x32_bf16 v[68:71], v[192:195], a[212:215], v[68:71]
    v_mfma_f32_16x16x32_bf16 v[72:75], v[192:195], a[216:219], v[72:75]
    v_mfma_f32_16x16x32_bf16 v[76:79], v[192:195], a[220:223], v[76:79]
    v_mfma_f32_16x16x32_bf16 v[80:83], v[196:199], a[208:211], v[80:83]
    ds_read_b64_tr_b16 v[188:189], v219 offset:0
    ds_read_b64_tr_b16 v[190:191], v219 offset:14336
    v_mfma_f32_16x16x32_bf16 v[84:87], v[196:199], a[212:215], v[84:87]
    v_mfma_f32_16x16x32_bf16 v[88:91], v[196:199], a[216:219], v[88:91]
    v_mfma_f32_16x16x32_bf16 v[92:95], v[196:199], a[220:223], v[92:95]
    v_mfma_f32_16x16x32_bf16 v[96:99], v[200:203], a[208:211], v[96:99]
    ds_read_b64_tr_b16 v[192:193], v213 offset:28672
    ds_read_b64_tr_b16 v[194:195], v213 offset:43008
    v_mfma_f32_16x16x32_bf16 v[100:103], v[200:203], a[212:215], v[100:103]
    v_mfma_f32_16x16x32_bf16 v[104:107], v[200:203], a[216:219], v[104:107]
    v_mfma_f32_16x16x32_bf16 v[108:111], v[200:203], a[220:223], v[108:111]
    s_waitcnt lgkmcnt(6)
    v_mfma_f32_16x16x32_bf16 v[0:3], v[176:179], a[224:227], v[0:3]
    ds_read_b64_tr_b16 v[196:197], v220 offset:0
    ds_read_b64_tr_b16 v[198:199], v220 offset:14336
    v_mfma_f32_16x16x32_bf16 v[4:7], v[176:179], a[228:231], v[4:7]
    v_mfma_f32_16x16x32_bf16 v[8:11], v[176:179], a[232:235], v[8:11]
    v_mfma_f32_16x16x32_bf16 v[12:15], v[176:179], a[236:239], v[12:15]
    v_mfma_f32_16x16x32_bf16 v[0:3], v[180:183], a[240:243], v[0:3]
    ds_read_b64_tr_b16 v[200:201], v214 offset:28672
    ds_read_b64_tr_b16 v[202:203], v214 offset:43008
    v_mfma_f32_16x16x32_bf16 v[4:7], v[180:183], a[244:247], v[4:7]
    v_mfma_f32_16x16x32_bf16 v[8:11], v[180:183], a[248:251], v[8:11]
    v_mfma_f32_16x16x32_bf16 v[12:15], v[180:183], a[252:255], v[12:15]
    s_waitcnt lgkmcnt(6)
    v_mfma_f32_16x16x32_bf16 v[16:19], v[184:187], a[224:227], v[16:19]
    ds_read_b64_tr_b16 v[176:177], v221 offset:0
    ds_read_b64_tr_b16 v[178:179], v221 offset:14336
    v_mfma_f32_16x16x32_bf16 v[20:23], v[184:187], a[228:231], v[20:23]
    v_mfma_f32_16x16x32_bf16 v[24:27], v[184:187], a[232:235], v[24:27]
    v_mfma_f32_16x16x32_bf16 v[28:31], v[184:187], a[236:239], v[28:31]
    v_mfma_f32_16x16x32_bf16 v[16:19], v[188:191], a[240:243], v[16:19]
    ds_read_b64_tr_b16 v[180:181], v215 offset:28672
    ds_read_b64_tr_b16 v[182:183], v215 offset:43008
    v_mfma_f32_16x16x32_bf16 v[20:23], v[188:191], a[244:247], v[20:23]
    v_cvt_pk_bf16_f32 v0, v0, v1
    v_cvt_pk_bf16_f32 v1, v2, v3
    v_mfma_f32_16x16x32_bf16 v[24:27], v[188:191], a[248:251], v[24:27]
    v_cvt_pk_bf16_f32 v2, v4, v5
    v_cvt_pk_bf16_f32 v3, v6, v7
    v_mfma_f32_16x16x32_bf16 v[28:31], v[188:191], a[252:255], v[28:31]
    buffer_store_dwordx4 v[0:3], v244, s[16:19], s50 offen offset:0 sc1
    s_waitcnt lgkmcnt(6)
    v_mfma_f32_16x16x32_bf16 v[32:35], v[192:195], a[224:227], v[32:35]
    v_cvt_pk_bf16_f32 v8, v8, v9
    v_cvt_pk_bf16_f32 v9, v10, v11
    v_mfma_f32_16x16x32_bf16 v[36:39], v[192:195], a[228:231], v[36:39]
    v_cvt_pk_bf16_f32 v10, v12, v13
    v_cvt_pk_bf16_f32 v11, v14, v15
    v_mfma_f32_16x16x32_bf16 v[40:43], v[192:195], a[232:235], v[40:43]
    buffer_store_dwordx4 v[8:11], v244, s[16:19], s52 offen offset:0 sc1
    ds_read_b64_tr_b16 v[184:185], v222 offset:0
    v_mfma_f32_16x16x32_bf16 v[44:47], v[192:195], a[236:239], v[44:47]
    ds_read_b64_tr_b16 v[186:187], v222 offset:14336
    v_mfma_f32_16x16x32_bf16 v[32:35], v[196:199], a[240:243], v[32:35]
    ds_read_b64_tr_b16 v[188:189], v216 offset:28672
    ds_read_b64_tr_b16 v[190:191], v216 offset:43008
    v_mfma_f32_16x16x32_bf16 v[36:39], v[196:199], a[244:247], v[36:39]
    v_cvt_pk_bf16_f32 v16, v16, v17
    v_cvt_pk_bf16_f32 v17, v18, v19
    v_mfma_f32_16x16x32_bf16 v[40:43], v[196:199], a[248:251], v[40:43]
    v_cvt_pk_bf16_f32 v18, v20, v21
    v_cvt_pk_bf16_f32 v19, v22, v23
    v_mfma_f32_16x16x32_bf16 v[44:47], v[196:199], a[252:255], v[44:47]
    buffer_store_dwordx4 v[16:19], v244, s[16:19], s50 offen offset:1024 sc1
    s_waitcnt lgkmcnt(6)
    v_mfma_f32_16x16x32_bf16 v[48:51], v[200:203], a[224:227], v[48:51]
    v_cvt_pk_bf16_f32 v24, v24, v25
    v_cvt_pk_bf16_f32 v25, v26, v27
    v_mfma_f32_16x16x32_bf16 v[52:55], v[200:203], a[228:231], v[52:55]
    v_cvt_pk_bf16_f32 v26, v28, v29
    v_cvt_pk_bf16_f32 v27, v30, v31
    v_mfma_f32_16x16x32_bf16 v[56:59], v[200:203], a[232:235], v[56:59]
    buffer_store_dwordx4 v[24:27], v244, s[16:19], s52 offen offset:1024 sc1
    ds_read_b64_tr_b16 v[192:193], v223 offset:0
    v_mfma_f32_16x16x32_bf16 v[60:63], v[200:203], a[236:239], v[60:63]
    ds_read_b64_tr_b16 v[194:195], v223 offset:14336
    v_mfma_f32_16x16x32_bf16 v[48:51], v[176:179], a[240:243], v[48:51]
    ds_read_b64_tr_b16 v[196:197], v217 offset:28672
    ds_read_b64_tr_b16 v[198:199], v217 offset:43008
    v_mfma_f32_16x16x32_bf16 v[52:55], v[176:179], a[244:247], v[52:55]
    v_cvt_pk_bf16_f32 v32, v32, v33
    v_cvt_pk_bf16_f32 v33, v34, v35
    v_mfma_f32_16x16x32_bf16 v[56:59], v[176:179], a[248:251], v[56:59]
    v_cvt_pk_bf16_f32 v34, v36, v37
    v_cvt_pk_bf16_f32 v35, v38, v39
    v_mfma_f32_16x16x32_bf16 v[60:63], v[176:179], a[252:255], v[60:63]
    buffer_store_dwordx4 v[32:35], v244, s[16:19], s50 offen offset:2048 sc1
    s_waitcnt lgkmcnt(6)
    v_mfma_f32_16x16x32_bf16 v[64:67], v[180:183], a[224:227], v[64:67]
    v_cvt_pk_bf16_f32 v40, v40, v41
    v_cvt_pk_bf16_f32 v41, v42, v43
    v_mfma_f32_16x16x32_bf16 v[68:71], v[180:183], a[228:231], v[68:71]
    v_cvt_pk_bf16_f32 v42, v44, v45
    v_cvt_pk_bf16_f32 v43, v46, v47
    v_mfma_f32_16x16x32_bf16 v[72:75], v[180:183], a[232:235], v[72:75]
    buffer_store_dwordx4 v[40:43], v244, s[16:19], s52 offen offset:2048 sc1
    ds_read_b64_tr_b16 v[200:201], v224 offset:0
    v_mfma_f32_16x16x32_bf16 v[76:79], v[180:183], a[236:239], v[76:79]
    ds_read_b64_tr_b16 v[202:203], v224 offset:14336
    v_mfma_f32_16x16x32_bf16 v[64:67], v[184:187], a[240:243], v[64:67]
    v_cvt_pk_bf16_f32 v48, v48, v49
    v_cvt_pk_bf16_f32 v49, v50, v51
    v_mfma_f32_16x16x32_bf16 v[68:71], v[184:187], a[244:247], v[68:71]
    v_cvt_pk_bf16_f32 v50, v52, v53
    v_cvt_pk_bf16_f32 v51, v54, v55
    v_mfma_f32_16x16x32_bf16 v[72:75], v[184:187], a[248:251], v[72:75]
    buffer_store_dwordx4 v[48:51], v244, s[16:19], s50 offen offset:3072 sc1
    v_cvt_pk_bf16_f32 v56, v56, v57
    v_mfma_f32_16x16x32_bf16 v[76:79], v[184:187], a[252:255], v[76:79]
    v_cvt_pk_bf16_f32 v57, v58, v59
    s_waitcnt lgkmcnt(4)
    v_mfma_f32_16x16x32_bf16 v[80:83], v[188:191], a[224:227], v[80:83]
    v_cvt_pk_bf16_f32 v58, v60, v61
    v_cvt_pk_bf16_f32 v59, v62, v63
    v_mfma_f32_16x16x32_bf16 v[84:87], v[188:191], a[228:231], v[84:87]
    buffer_store_dwordx4 v[56:59], v244, s[16:19], s52 offen offset:3072 sc1
    v_mfma_f32_16x16x32_bf16 v[88:91], v[188:191], a[232:235], v[88:91]
    v_mfma_f32_16x16x32_bf16 v[92:95], v[188:191], a[236:239], v[92:95]
    v_mfma_f32_16x16x32_bf16 v[80:83], v[192:195], a[240:243], v[80:83]
    v_cvt_pk_bf16_f32 v64, v64, v65
    v_cvt_pk_bf16_f32 v65, v66, v67
    v_mfma_f32_16x16x32_bf16 v[84:87], v[192:195], a[244:247], v[84:87]
    v_cvt_pk_bf16_f32 v66, v68, v69
    v_cvt_pk_bf16_f32 v67, v70, v71
    v_mfma_f32_16x16x32_bf16 v[88:91], v[192:195], a[248:251], v[88:91]
    buffer_store_dwordx4 v[64:67], v244, s[16:19], s51 offen offset:0 sc1
    v_cvt_pk_bf16_f32 v72, v72, v73
    v_mfma_f32_16x16x32_bf16 v[92:95], v[192:195], a[252:255], v[92:95]
    v_cvt_pk_bf16_f32 v73, v74, v75
    s_waitcnt lgkmcnt(0)
    v_mfma_f32_16x16x32_bf16 v[96:99], v[196:199], a[224:227], v[96:99]
    v_cvt_pk_bf16_f32 v74, v76, v77
    v_cvt_pk_bf16_f32 v75, v78, v79
    v_mfma_f32_16x16x32_bf16 v[100:103], v[196:199], a[228:231], v[100:103]
    buffer_store_dwordx4 v[72:75], v244, s[16:19], s53 offen offset:0 sc1
    v_mfma_f32_16x16x32_bf16 v[104:107], v[196:199], a[232:235], v[104:107]
    v_mfma_f32_16x16x32_bf16 v[108:111], v[196:199], a[236:239], v[108:111]
    v_mfma_f32_16x16x32_bf16 v[96:99], v[200:203], a[240:243], v[96:99]
    v_cvt_pk_bf16_f32 v80, v80, v81
    v_cvt_pk_bf16_f32 v81, v82, v83
    v_mfma_f32_16x16x32_bf16 v[100:103], v[200:203], a[244:247], v[100:103]
    v_cvt_pk_bf16_f32 v82, v84, v85
    v_cvt_pk_bf16_f32 v83, v86, v87
    v_mfma_f32_16x16x32_bf16 v[104:107], v[200:203], a[248:251], v[104:107]
    buffer_store_dwordx4 v[80:83], v244, s[16:19], s51 offen offset:1024 sc1
    v_cvt_pk_bf16_f32 v88, v88, v89
    v_mfma_f32_16x16x32_bf16 v[108:111], v[200:203], a[252:255], v[108:111]
    v_cvt_pk_bf16_f32 v89, v90, v91
    v_cvt_pk_bf16_f32 v90, v92, v93
    s_nop 7
    v_cvt_pk_bf16_f32 v91, v94, v95
    buffer_store_dwordx4 v[88:91], v244, s[16:19], s53 offen offset:1024 sc1
    v_cvt_pk_bf16_f32 v96, v96, v97
    v_cvt_pk_bf16_f32 v97, v98, v99
    v_cvt_pk_bf16_f32 v98, v100, v101
    v_cvt_pk_bf16_f32 v99, v102, v103
    buffer_store_dwordx4 v[96:99], v244, s[16:19], s51 offen offset:2048 sc1
    v_cvt_pk_bf16_f32 v104, v104, v105
    v_cvt_pk_bf16_f32 v105, v106, v107
    v_cvt_pk_bf16_f32 v106, v108, v109
    v_cvt_pk_bf16_f32 v107, v110, v111
    buffer_store_dwordx4 v[104:107], v244, s[16:19], s53 offen offset:2048 sc1
    s_lshl_b32 s46, s27, 6
    s_nop 0
    v_add_u32 v0, s46, v240
    s_load_dwordx2 s[48:49], s[0:1], 0
    s_load_dwordx8 s[52:59], s[0:1], 48
    s_load_dwordx2 s[50:51], s[0:1], 96
    s_load_dwordx2 s[12:13], s[0:1], 112
    v_and_b32 v1, 63, v0
    v_lshrrev_b32 v5, 6, v0
    v_lshrrev_b32 v2, 4, v1
    v_readfirstlane_b32 s3, v5
    v_bfe_u32 v3, v1, 2, 2
    v_and_b32 v4, 3, v1
    v_lshlrev_b32 v7, 4, v1
    s_and_b32 s4, s2, 7
    s_lshr_b32 s5, s2, 3
    s_lshl_b32 s6, s4, 3
    s_lshr_b32 s8, s5, 2
    s_add_u32 s6, s6, s8
    s_and_b32 s7, s5, 3
    v_lshrrev_b32 v9, 4, v0
    v_lshlrev_b32 v10, 11, v9
    v_lshl_add_u32 v10, v3, 8, v10
    v_lshl_add_u32 v10, v4, 4, v10
    v_lshlrev_b32 v12, 7, v9
    v_lshl_add_u32 v12, v3, 4, v12
    v_mul_u32_u24 v11, 896, v4
    v_lshrrev_b32 v5, 1, v12
    v_add_u32 v11, v11, v5
    v_lshlrev_b32 v15, 10, v9
    v_lshl_add_u32 v15, v3, 8, v15
    v_lshl_add_u32 v15, v4, 4, v15
    v_mov_b32 v5, 0x40000000
    v_cmp_gt_u32 vcc, 224, v0
    s_nop 1
    v_cndmask_b32 v10, v5, v10, vcc
    v_cndmask_b32 v11, v5, v11, vcc
    v_cndmask_b32 v12, v5, v12, vcc
    v_cndmask_b32 v15, v5, v15, vcc
    s_lshl_b32 s8, s3, 6
    v_lshlrev_b32 v14, 4, v4
    v_add_u32 v14, 121856, v14
    v_add_u32 v13, s8, v14
    s_mul_i32 s9, s6, 28672
    s_lshl_b32 s10, s7, 6
    s_add_u32 s9, s9, s10
    s_add_u32 s10, s9, 4194304
    s_lshl_b32 s11, s6, 5
    s_lshl_b32 s14, s7, 2
    s_add_u32 s11, s11, s14
    s_mul_i32 s11, s11, 896
    s_add_u32 s15, s11, 14336
    s_waitcnt lgkmcnt(0)
    s_mov_b32 s16, s48
    s_mov_b32 s17, s49
    s_mov_b32 s18, 0x1c0000
    s_mov_b32 s19, 0x20000
    s_mov_b32 s20, s12
    s_mov_b32 s21, s13
    s_mov_b32 s22, 0x10000000
    s_mov_b32 s23, 0x20000
    s_mov_b32 s24, s52
    s_mov_b32 s25, s53
    s_mov_b32 s26, 0x188000
    s_mov_b32 s27, 0x20000
    s_lshl_b32 s8, s5, 7
    s_lshl_b32 s14, s4, 2
    s_add_u32 s8, s8, s14
    s_add_u32 s8, s8, 135168
    s_waitcnt vmcnt(0)
    s_barrier
    s_cmp_lg_u32 s3, 0
    s_cbranch_scc1 KT_sig0
    v_mov_b32 v144, 1
    v_mov_b32 v145, 0
    s_mov_b64 exec, 1
    buffer_store_dword v144, v145, s[20:23], s8 offen sc1
    s_mov_b64 exec, -1
KT_sig0:
    v_mov_b32 v145, 0
    s_mov_b32 s46, 0x40000
KT_pm:
    buffer_load_dword v144, v145, s[96:99], 0 offen offset:128 sc1
    s_waitcnt vmcnt(0)
    v_readfirstlane_b32 s47, v144
    s_sub_u32 s46, s46, 1
    s_cmp_eq_u32 s46, 0
    s_cbranch_scc1 KT_pmd
    s_cmp_lt_u32 s47, 56
    s_cbranch_scc1 KT_pm
KT_pmd:
    buffer_load_dwordx2 v[80:81], v11, s[16:19], s11 offen offset:0
    buffer_load_dwordx2 v[82:83], v11, s[16:19], s15 offen offset:0
    buffer_load_dwordx2 v[84:85], v11, s[16:19], s11 offen offset:32
    buffer_load_dwordx2 v[86:87], v11, s[16:19], s15 offen offset:32
    s_mov_b32 s14, 3584
    s_mov_b32 s8, 7168
    buffer_load_dwordx4 v[88:91], v12, s[20:23], s14 offen offset:0 sc1
    buffer_load_dwordx4 v[96:99], v12, s[20:23], s14 offen offset:1792 sc1
    buffer_load_dwordx4 v[104:107], v12, s[20:23], s8 offen offset:0 sc1
    buffer_load_dwordx4 v[92:95], v12, s[20:23], s14 offen offset:64 sc1
    buffer_load_dwordx4 v[100:103], v12, s[20:23], s14 offen offset:1856 sc1
    buffer_load_dwordx4 v[108:111], v12, s[20:23], s8 offen offset:64 sc1
    s_mov_b32 s44, 0x3b124925
    s_mov_b32 s45, 0x3727c5ac
    s_and_b32 s28, s5, 1
    s_lshr_b32 s29, s5, 1
    v_and_b32 v5, 15, v1
    v_lshlrev_b32 v6, 1, v2
    v_xor_b32 v5, v5, v6
    v_mul_u32_u24 v6, 3584, v2
    v_lshl_add_u32 v5, v5, 4, v6
    s_mul_i32 s30, s3, 14336
    s_lshl_b32 s31, s29, 8
    s_add_u32 s30, s30, s31
    v_add_u32 v128, s30, v5
    v_add_u32 v129, 56256, v128
    s_mul_i32 s32, s3, 2176
    s_mov_b32 s33, 0
    s_add_u32 m0, s32, 0
    s_nop 0
    buffer_load_dwordx4 v128, s[24:27], s33 offen lds
    buffer_load_dwordx4 v129, s[24:27], s33 offen offset:1088 lds
    s_mov_b32 s33, 114688
    s_add_u32 m0, s32, 8704
    s_nop 0
    buffer_load_dwordx4 v128, s[24:27], s33 offen lds
    buffer_load_dwordx4 v129, s[24:27], s33 offen offset:1088 lds
    s_mov_b32 s33, 229376
    s_add_u32 m0, s32, 17408
    s_nop 0
    buffer_load_dwordx4 v128, s[24:27], s33 offen lds
    buffer_load_dwordx4 v129, s[24:27], s33 offen offset:1088 lds
    s_mov_b32 s33, 344064
    s_add_u32 m0, s32, 26112
    s_nop 0
    buffer_load_dwordx4 v128, s[24:27], s33 offen lds
    buffer_load_dwordx4 v129, s[24:27], s33 offen offset:1088 lds
    s_mov_b32 s33, 458752
    s_add_u32 m0, s32, 34816
    s_nop 0
    buffer_load_dwordx4 v128, s[24:27], s33 offen lds
    buffer_load_dwordx4 v129, s[24:27], s33 offen offset:1088 lds
    s_mov_b32 s33, 573440
    s_add_u32 m0, s32, 43520
    s_nop 0
    buffer_load_dwordx4 v128, s[24:27], s33 offen lds
    buffer_load_dwordx4 v129, s[24:27], s33 offen offset:1088 lds
    s_mov_b32 s33, 688128
    s_add_u32 m0, s32, 52224
    s_nop 0
    buffer_load_dwordx4 v128, s[24:27], s33 offen lds
    buffer_load_dwordx4 v129, s[24:27], s33 offen offset:1088 lds
    s_mov_b32 s33, 802816
    s_add_u32 m0, s32, 60928
    s_nop 0
    buffer_load_dwordx4 v128, s[24:27], s33 offen lds
    buffer_load_dwordx4 v129, s[24:27], s33 offen offset:1088 lds
    s_mov_b32 s33, 917504
    s_add_u32 m0, s32, 69632
    s_nop 0
    buffer_load_dwordx4 v128, s[24:27], s33 offen lds
    buffer_load_dwordx4 v129, s[24:27], s33 offen offset:1088 lds
    s_mov_b32 s33, 1032192
    s_add_u32 m0, s32, 78336
    s_nop 0
    buffer_load_dwordx4 v128, s[24:27], s33 offen lds
    buffer_load_dwordx4 v129, s[24:27], s33 offen offset:1088 lds
    s_mov_b32 s33, 1146880
    s_add_u32 m0, s32, 87040
    s_nop 0
    buffer_load_dwordx4 v128, s[24:27], s33 offen lds
    buffer_load_dwordx4 v129, s[24:27], s33 offen offset:1088 lds
    s_mov_b32 s33, 1261568
    s_add_u32 m0, s32, 95744
    s_nop 0
    buffer_load_dwordx4 v128, s[24:27], s33 offen lds
    buffer_load_dwordx4 v129, s[24:27], s33 offen offset:1088 lds
    s_mov_b32 s33, 1376256
    s_add_u32 m0, s32, 104448
    s_nop 0
    buffer_load_dwordx4 v128, s[24:27], s33 offen lds
    buffer_load_dwordx4 v129, s[24:27], s33 offen offset:1088 lds
    s_mov_b32 s33, 1490944
    s_add_u32 m0, s32, 113152
    s_nop 0
    buffer_load_dwordx4 v128, s[24:27], s33 offen lds
    buffer_load_dwordx4 v129, s[24:27], s33 offen offset:1088 lds
    s_lshr_b32 s8, s6, 1
    s_lshl_b32 s8, s8, 7
    s_add_u32 s8, s8, 135168
    s_cmp_lg_u32 s3, 0
    s_cbranch_scc1 KT_go0
    v_min_u32 v145, 7, v1
    v_lshlrev_b32 v145, 2, v145
    s_mov_b32 s46, 0x40000
KT_poll0:
    buffer_load_dword v144, v145, s[20:23], s8 offen sc1
    s_waitcnt vmcnt(0)
    v_cmp_ne_u32 vcc, 0, v144
    s_nop 1
    s_and_b32 s47, vcc_lo, 0xff
    s_cmp_eq_u32 s47, 0xff
    s_cbranch_scc1 KT_got0
    s_sleep 1
    s_sub_u32 s46, s46, 1
    s_cmp_lg_u32 s46, 0
    s_cbranch_scc1 KT_poll0
KT_got0:
KT_go0:
    s_barrier
    buffer_load_dwordx4 v[16:19], v10, s[20:23], s10 offen sc1
    buffer_load_dwordx4 v[20:23], v10, s[20:23], s10 offen offset:1024 sc1
    s_add_u32 s10, s10, 1835008
    buffer_load_dwordx4 v[24:27], v10, s[20:23], s10 offen sc1
    buffer_load_dwordx4 v[28:31], v10, s[20:23], s10 offen offset:1024 sc1
    s_add_u32 s10, s10, 1835008
    buffer_load_dwordx4 v[32:35], v10, s[20:23], s10 offen sc1
    buffer_load_dwordx4 v[36:39], v10, s[20:23], s10 offen offset:1024 sc1
    s_add_u32 s10, s10, 1835008
    buffer_load_dwordx4 v[40:43], v10, s[20:23], s10 offen sc1
    buffer_load_dwordx4 v[44:47], v10, s[20:23], s10 offen offset:1024 sc1
    s_add_u32 s10, s10, 1835008
    buffer_load_dwordx4 v[48:51], v10, s[20:23], s10 offen sc1
    buffer_load_dwordx4 v[52:55], v10, s[20:23], s10 offen offset:1024 sc1
    s_add_u32 s10, s10, 1835008
    buffer_load_dwordx4 v[56:59], v10, s[20:23], s10 offen sc1
    buffer_load_dwordx4 v[60:63], v10, s[20:23], s10 offen offset:1024 sc1
    s_add_u32 s10, s10, 1835008
    buffer_load_dwordx4 v[64:67], v10, s[20:23], s10 offen sc1
    buffer_load_dwordx4 v[68:71], v10, s[20:23], s10 offen offset:1024 sc1
    s_add_u32 s10, s10, 1835008
    buffer_load_dwordx4 v[72:75], v10, s[20:23], s10 offen sc1
    buffer_load_dwordx4 v[76:79], v10, s[20:23], s10 offen offset:1024 sc1
    s_add_u32 s10, s10, 1835008
    s_waitcnt vmcnt(14)
    v_lshlrev_b32 v112, 16, v16
    v_and_b32 v113, 0xffff0000, v16
    v_lshlrev_b32 v114, 16, v17
    v_and_b32 v115, 0xffff0000, v17
    v_lshlrev_b32 v116, 16, v18
    v_and_b32 v117, 0xffff0000, v18
    v_lshlrev_b32 v118, 16, v19
    v_and_b32 v119, 0xffff0000, v19
    v_lshlrev_b32 v120, 16, v20
    v_and_b32 v121, 0xffff0000, v20
    v_lshlrev_b32 v122, 16, v21
    v_and_b32 v123, 0xffff0000, v21
    v_lshlrev_b32 v124, 16, v22
    v_and_b32 v125, 0xffff0000, v22
    v_lshlrev_b32 v126, 16, v23
    v_and_b32 v127, 0xffff0000, v23
    s_waitcnt vmcnt(12)
    v_lshlrev_b32 v130, 16, v24
    v_and_b32 v131, 0xffff0000, v24
    v_lshlrev_b32 v132, 16, v25
    v_and_b32 v133, 0xffff0000, v25
    v_lshlrev_b32 v134, 16, v26
    v_and_b32 v135, 0xffff0000, v26
    v_lshlrev_b32 v136, 16, v27
    v_and_b32 v137, 0xffff0000, v27
    v_pk_add_f32 v[112:113], v[112:113], v[130:131]
    v_pk_add_f32 v[114:115], v[114:115], v[132:133]
    v_pk_add_f32 v[116:117], v[116:117], v[134:135]
    v_pk_add_f32 v[118:119], v[118:119], v[136:137]
    v_lshlrev_b32 v130, 16, v28
    v_and_b32 v131, 0xffff0000, v28
    v_lshlrev_b32 v132, 16, v29
    v_and_b32 v133, 0xffff0000, v29
    v_lshlrev_b32 v134, 16, v30
    v_and_b32 v135, 0xffff0000, v30
    v_lshlrev_b32 v136, 16, v31
    v_and_b32 v137, 0xffff0000, v31
    v_pk_add_f32 v[120:121], v[120:121], v[130:131]
    v_pk_add_f32 v[122:123], v[122:123], v[132:133]
    v_pk_add_f32 v[124:125], v[124:125], v[134:135]
    v_pk_add_f32 v[126:127], v[126:127], v[136:137]
    s_waitcnt vmcnt(10)
    v_lshlrev_b32 v130, 16, v32
    v_and_b32 v131, 0xffff0000, v32
    v_lshlrev_b32 v132, 16, v33
    v_and_b32 v133, 0xffff0000, v33
    v_lshlrev_b32 v134, 16, v34
    v_and_b32 v135, 0xffff0000, v34
    v_lshlrev_b32 v136, 16, v35
    v_and_b32 v137, 0xffff0000, v35
    v_pk_add_f32 v[112:113], v[112:113], v[130:131]
    v_pk_add_f32 v[114:115], v[114:115], v[132:133]
    v_pk_add_f32 v[116:117], v[116:117], v[134:135]
    v_pk_add_f32 v[118:119], v[118:119], v[136:137]
    v_lshlrev_b32 v130, 16, v36
    v_and_b32 v131, 0xffff0000, v36
    v_lshlrev_b32 v132, 16, v37
    v_and_b32 v133, 0xffff0000, v37
    v_lshlrev_b32 v134, 16, v38
    v_and_b32 v135, 0xffff0000, v38
    v_lshlrev_b32 v136, 16, v39
    v_and_b32 v137, 0xffff0000, v39
    v_pk_add_f32 v[120:121], v[120:121], v[130:131]
    v_pk_add_f32 v[122:123], v[122:123], v[132:133]
    v_pk_add_f32 v[124:125], v[124:125], v[134:135]
    v_pk_add_f32 v[126:127], v[126:127], v[136:137]
    s_waitcnt vmcnt(8)
    v_lshlrev_b32 v130, 16, v40
    v_and_b32 v131, 0xffff0000, v40
    v_lshlrev_b32 v132, 16, v41
    v_and_b32 v133, 0xffff0000, v41
    v_lshlrev_b32 v134, 16, v42
    v_and_b32 v135, 0xffff0000, v42
    v_lshlrev_b32 v136, 16, v43
    v_and_b32 v137, 0xffff0000, v43
    v_pk_add_f32 v[112:113], v[112:113], v[130:131]
    v_pk_add_f32 v[114:115], v[114:115], v[132:133]
    v_pk_add_f32 v[116:117], v[116:117], v[134:135]
    v_pk_add_f32 v[118:119], v[118:119], v[136:137]
    v_lshlrev_b32 v130, 16, v44
    v_and_b32 v131, 0xffff0000, v44
    v_lshlrev_b32 v132, 16, v45
    v_and_b32 v133, 0xffff0000, v45
    v_lshlrev_b32 v134, 16, v46
    v_and_b32 v135, 0xffff0000, v46
    v_lshlrev_b32 v136, 16, v47
    v_and_b32 v137, 0xffff0000, v47
    v_pk_add_f32 v[120:121], v[120:121], v[130:131]
    v_pk_add_f32 v[122:123], v[122:123], v[132:133]
    v_pk_add_f32 v[124:125], v[124:125], v[134:135]
    v_pk_add_f32 v[126:127], v[126:127], v[136:137]
    s_waitcnt vmcnt(6)
    v_lshlrev_b32 v130, 16, v48
    v_and_b32 v131, 0xffff0000, v48
    v_lshlrev_b32 v132, 16, v49
    v_and_b32 v133, 0xffff0000, v49
    v_lshlrev_b32 v134, 16, v50
    v_and_b32 v135, 0xffff0000, v50
    v_lshlrev_b32 v136, 16, v51
    v_and_b32 v137, 0xffff0000, v51
    v_pk_add_f32 v[112:113], v[112:113], v[130:131]
    v_pk_add_f32 v[114:115], v[114:115], v[132:133]
    v_pk_add_f32 v[116:117], v[116:117], v[134:135]
    v_pk_add_f32 v[118:119], v[118:119], v[136:137]
    v_lshlrev_b32 v130, 16, v52
    v_and_b32 v131, 0xffff0000, v52
    v_lshlrev_b32 v132, 16, v53
    v_and_b32 v133, 0xffff0000, v53
    v_lshlrev_b32 v134, 16, v54
    v_and_b32 v135, 0xffff0000, v54
    v_lshlrev_b32 v136, 16, v55
    v_and_b32 v137, 0xffff0000, v55
    v_pk_add_f32 v[120:121], v[120:121], v[130:131]
    v_pk_add_f32 v[122:123], v[122:123], v[132:133]
    v_pk_add_f32 v[124:125], v[124:125], v[134:135]
    v_pk_add_f32 v[126:127], v[126:127], v[136:137]
    s_waitcnt vmcnt(4)
    v_lshlrev_b32 v130, 16, v56
    v_and_b32 v131, 0xffff0000, v56
    v_lshlrev_b32 v132, 16, v57
    v_and_b32 v133, 0xffff0000, v57
    v_lshlrev_b32 v134, 16, v58
    v_and_b32 v135, 0xffff0000, v58
    v_lshlrev_b32 v136, 16, v59
    v_and_b32 v137, 0xffff0000, v59
    v_pk_add_f32 v[112:113], v[112:113], v[130:131]
    v_pk_add_f32 v[114:115], v[114:115], v[132:133]
    v_pk_add_f32 v[116:117], v[116:117], v[134:135]
    v_pk_add_f32 v[118:119], v[118:119], v[136:137]
    v_lshlrev_b32 v130, 16, v60
    v_and_b32 v131, 0xffff0000, v60
    v_lshlrev_b32 v132, 16, v61
    v_and_b32 v133, 0xffff0000, v61
    v_lshlrev_b32 v134, 16, v62
    v_and_b32 v135, 0xffff0000, v62
    v_lshlrev_b32 v136, 16, v63
    v_and_b32 v137, 0xffff0000, v63
    v_pk_add_f32 v[120:121], v[120:121], v[130:131]
    v_pk_add_f32 v[122:123], v[122:123], v[132:133]
    v_pk_add_f32 v[124:125], v[124:125], v[134:135]
    v_pk_add_f32 v[126:127], v[126:127], v[136:137]
    s_waitcnt vmcnt(2)
    v_lshlrev_b32 v130, 16, v64
    v_and_b32 v131, 0xffff0000, v64
    v_lshlrev_b32 v132, 16, v65
    v_and_b32 v133, 0xffff0000, v65
    v_lshlrev_b32 v134, 16, v66
    v_and_b32 v135, 0xffff0000, v66
    v_lshlrev_b32 v136, 16, v67
    v_and_b32 v137, 0xffff0000, v67
    v_pk_add_f32 v[112:113], v[112:113], v[130:131]
    v_pk_add_f32 v[114:115], v[114:115], v[132:133]
    v_pk_add_f32 v[116:117], v[116:117], v[134:135]
    v_pk_add_f32 v[118:119], v[118:119], v[136:137]
    v_lshlrev_b32 v130, 16, v68
    v_and_b32 v131, 0xffff0000, v68
    v_lshlrev_b32 v132, 16, v69
    v_and_b32 v133, 0xffff0000, v69
    v_lshlrev_b32 v134, 16, v70
    v_and_b32 v135, 0xffff0000, v70
    v_lshlrev_b32 v136, 16, v71
    v_and_b32 v137, 0xffff0000, v71
    v_pk_add_f32 v[120:121], v[120:121], v[130:131]
    v_pk_add_f32 v[122:123], v[122:123], v[132:133]
    v_pk_add_f32 v[124:125], v[124:125], v[134:135]
    v_pk_add_f32 v[126:127], v[126:127], v[136:137]
    s_waitcnt vmcnt(0)
    v_lshlrev_b32 v130, 16, v72
    v_and_b32 v131, 0xffff0000, v72
    v_lshlrev_b32 v132, 16, v73
    v_and_b32 v133, 0xffff0000, v73
    v_lshlrev_b32 v134, 16, v74
    v_and_b32 v135, 0xffff0000, v74
    v_lshlrev_b32 v136, 16, v75
    v_and_b32 v137, 0xffff0000, v75
    v_pk_add_f32 v[112:113], v[112:113], v[130:131]
    v_pk_add_f32 v[114:115], v[114:115], v[132:133]
    v_pk_add_f32 v[116:117], v[116:117], v[134:135]
    v_pk_add_f32 v[118:119], v[118:119], v[136:137]
    v_lshlrev_b32 v130, 16, v76
    v_and_b32 v131, 0xffff0000, v76
    v_lshlrev_b32 v132, 16, v77
    v_and_b32 v133, 0xffff0000, v77
    v_lshlrev_b32 v134, 16, v78
    v_and_b32 v135, 0xffff0000, v78
    v_lshlrev_b32 v136, 16, v79
    v_and_b32 v137, 0xffff0000, v79
    v_pk_add_f32 v[120:121], v[120:121], v[130:131]
    v_pk_add_f32 v[122:123], v[122:123], v[132:133]
    v_pk_add_f32 v[124:125], v[124:125], v[134:135]
    v_pk_add_f32 v[126:127], v[126:127], v[136:137]
    s_add_u32 s10, s9, 20971520
    v_lshlrev_b32 v130, 16, v80
    v_and_b32 v131, 0xffff0000, v80
    v_lshlrev_b32 v132, 16, v81
    v_and_b32 v133, 0xffff0000, v81
    v_lshlrev_b32 v134, 16, v82
    v_and_b32 v135, 0xffff0000, v82
    v_lshlrev_b32 v136, 16, v83
    v_and_b32 v137, 0xffff0000, v83
    v_fma_f32 v112, v112, v88, v130
    v_fma_f32 v113, v113, v89, v131
    v_fma_f32 v114, v114, v90, v132
    v_fma_f32 v115, v115, v91, v133
    v_fma_f32 v116, v116, v88, v134
    v_fma_f32 v117, v117, v89, v135
    v_fma_f32 v118, v118, v90, v136
    v_fma_f32 v119, v119, v91, v137
    v_cvt_pk_bf16_f32 v80, v112, v113
    v_cvt_pk_bf16_f32 v81, v114, v115
    v_cvt_pk_bf16_f32 v82, v116, v117
    v_cvt_pk_bf16_f32 v83, v118, v119
    buffer_store_dwordx4 v[80:83], v10, s[20:23], s10 offen offset:0 sc1
    v_lshlrev_b32 v130, 16, v84
    v_and_b32 v131, 0xffff0000, v84
    v_lshlrev_b32 v132, 16, v85
    v_and_b32 v133, 0xffff0000, v85
    v_lshlrev_b32 v134, 16, v86
    v_and_b32 v135, 0xffff0000, v86
    v_lshlrev_b32 v136, 16, v87
    v_and_b32 v137, 0xffff0000, v87
    v_fma_f32 v120, v120, v92, v130
    v_fma_f32 v121, v121, v93, v131
    v_fma_f32 v122, v122, v94, v132
    v_fma_f32 v123, v123, v95, v133
    v_fma_f32 v124, v124, v92, v134
    v_fma_f32 v125, v125, v93, v135
    v_fma_f32 v126, v126, v94, v136
    v_fma_f32 v127, v127, v95, v137
    v_cvt_pk_bf16_f32 v84, v120, v121
    v_cvt_pk_bf16_f32 v85, v122, v123
    v_cvt_pk_bf16_f32 v86, v124, v125
    v_cvt_pk_bf16_f32 v87, v126, v127
    buffer_store_dwordx4 v[84:87], v10, s[20:23], s10 offen offset:1024 sc1
    v_add_f32 v140, v112, v113
    v_mul_f32 v142, v112, v112
    v_add_f32 v140, v140, v114
    v_add_f32 v140, v140, v115
    v_add_f32 v140, v140, v120
    v_add_f32 v140, v140, v121
    v_add_f32 v140, v140, v122
    v_add_f32 v140, v140, v123
    v_fmac_f32 v142, v113, v113
    v_fmac_f32 v142, v114, v114
    v_fmac_f32 v142, v115, v115
    v_fmac_f32 v142, v120, v120
    v_fmac_f32 v142, v121, v121
    v_fmac_f32 v142, v122, v122
    v_fmac_f32 v142, v123, v123
    v_add_f32 v141, v116, v117
    v_mul_f32 v143, v116, v116
    v_add_f32 v141, v141, v118
    v_add_f32 v141, v141, v119
    v_add_f32 v141, v141, v124
    v_add_f32 v141, v141, v125
    v_add_f32 v141, v141, v126
    v_add_f32 v141, v141, v127
    v_fmac_f32 v143, v117, v117
    v_fmac_f32 v143, v118, v118
    v_fmac_f32 v143, v119, v119
    v_fmac_f32 v143, v124, v124
    v_fmac_f32 v143, v125, v125
    v_fmac_f32 v143, v126, v126
    v_fmac_f32 v143, v127, v127
    s_nop 1
    v_add_f32_dpp v140, v140, v140 row_ror:8 row_mask:0xf bank_mask:0xf
    v_add_f32_dpp v141, v141, v141 row_ror:8 row_mask:0xf bank_mask:0xf
    v_add_f32_dpp v142, v142, v142 row_ror:8 row_mask:0xf bank_mask:0xf
    v_add_f32_dpp v143, v143, v143 row_ror:8 row_mask:0xf bank_mask:0xf
    s_nop 1
    v_add_f32_dpp v140, v140, v140 row_ror:4 row_mask:0xf bank_mask:0xf
    v_add_f32_dpp v141, v141, v141 row_ror:4 row_mask:0xf bank_mask:0xf
    v_add_f32_dpp v142, v142, v142 row_ror:4 row_mask:0xf bank_mask:0xf
    v_add_f32_dpp v143, v143, v143 row_ror:4 row_mask:0xf bank_mask:0xf
    v_mov_b32 v16, v140
    v_mov_b32 v17, v141
    v_mov_b32 v18, v142
    v_mov_b32 v19, v143
    s_nop 1
    v_permlane16_swap_b32 v140, v16
    v_permlane16_swap_b32 v141, v17
    v_permlane16_swap_b32 v142, v18
    v_permlane16_swap_b32 v143, v19
    s_nop 1
    v_add_f32 v140, v140, v16
    v_add_f32 v141, v141, v17
    v_add_f32 v142, v142, v18
    v_add_f32 v143, v143, v19
    v_mov_b32 v16, v140
    v_mov_b32 v17, v141
    v_mov_b32 v18, v142
    v_mov_b32 v19, v143
    s_nop 1
    v_permlane32_swap_b32 v140, v16
    v_permlane32_swap_b32 v141, v17
    v_permlane32_swap_b32 v142, v18
    v_permlane32_swap_b32 v143, v19
    s_nop 1
    v_add_f32 v140, v140, v16
    v_add_f32 v141, v141, v17
    v_add_f32 v142, v142, v18
    v_add_f32 v143, v143, v19
    s_mov_b64 exec, 0xf
    ds_write_b128 v13, v[140:143] offset:0
    s_mov_b64 exec, -1
    s_waitcnt lgkmcnt(0)
    s_barrier
    ds_read_b128 v[16:19], v14 offset:0
    ds_read_b128 v[20:23], v14 offset:64
    ds_read_b128 v[24:27], v14 offset:128
    ds_read_b128 v[28:31], v14 offset:192
    s_waitcnt lgkmcnt(0)
    v_add_f32 v140, v16, v20
    v_add_f32 v141, v17, v21
    v_add_f32 v142, v18, v22
    v_add_f32 v143, v19, v23
    v_add_f32 v140, v140, v24
    v_add_f32 v141, v141, v25
    v_add_f32 v142, v142, v26
    v_add_f32 v143, v143, v27
    v_add_f32 v140, v140, v28
    v_add_f32 v141, v141, v29
    v_add_f32 v142, v142, v30
    v_add_f32 v143, v143, v31
    v_mul_f32 v140, s44, v140
    v_mul_f32 v141, s44, v141
    v_mul_f32 v142, s44, v142
    v_mul_f32 v143, s44, v143
    v_fma_f32 v142, -v140, v140, v142
    v_fma_f32 v143, -v141, v141, v143
    v_max_f32 v142, 0, v142
    v_max_f32 v143, 0, v143
    v_add_f32 v142, s45, v142
    v_add_f32 v143, s45, v143
    v_rsq_f32 v142, v142
    v_rsq_f32 v143, v143
    s_nop 0
    v_sub_f32 v112, v112, v140
    v_sub_f32 v113, v113, v140
    v_sub_f32 v114, v114, v140
    v_sub_f32 v115, v115, v140
    v_sub_f32 v116, v116, v141
    v_sub_f32 v117, v117, v141
    v_sub_f32 v118, v118, v141
    v_sub_f32 v119, v119, v141
    v_mul_f32 v112, v112, v142
    v_mul_f32 v113, v113, v142
    v_mul_f32 v114, v114, v142
    v_mul_f32 v115, v115, v142
    v_mul_f32 v116, v116, v143
    v_mul_f32 v117, v117, v143
    v_mul_f32 v118, v118, v143
    v_mul_f32 v119, v119, v143
    v_fma_f32 v112, v112, v104, v96
    v_fma_f32 v113, v113, v105, v97
    v_fma_f32 v114, v114, v106, v98
    v_fma_f32 v115, v115, v107, v99
    v_fma_f32 v116, v116, v104, v96
    v_fma_f32 v117, v117, v105, v97
    v_fma_f32 v118, v118, v106, v98
    v_fma_f32 v119, v119, v107, v99
    v_sub_f32 v120, v120, v140
    v_sub_f32 v121, v121, v140
    v_sub_f32 v122, v122, v140
    v_sub_f32 v123, v123, v140
    v_sub_f32 v124, v124, v141
    v_sub_f32 v125, v125, v141
    v_sub_f32 v126, v126, v141
    v_sub_f32 v127, v127, v141
    v_mul_f32 v120, v120, v142
    v_mul_f32 v121, v121, v142
    v_mul_f32 v122, v122, v142
    v_mul_f32 v123, v123, v142
    v_mul_f32 v124, v124, v143
    v_mul_f32 v125, v125, v143
    v_mul_f32 v126, v126, v143
    v_mul_f32 v127, v127, v143
    v_fma_f32 v120, v120, v108, v100
    v_fma_f32 v121, v121, v109, v101
    v_fma_f32 v122, v122, v110, v102
    v_fma_f32 v123, v123, v111, v103
    v_fma_f32 v124, v124, v108, v100
    v_fma_f32 v125, v125, v109, v101
    v_fma_f32 v126, v126, v110, v102
    v_fma_f32 v127, v127, v111, v103
    v_add_f32 v140, v112, v113
    v_mul_f32 v142, v112, v112
    v_add_f32 v140, v140, v114
    v_add_f32 v140, v140, v115
    v_add_f32 v140, v140, v120
    v_add_f32 v140, v140, v121
    v_add_f32 v140, v140, v122
    v_add_f32 v140, v140, v123
    v_fmac_f32 v142, v113, v113
    v_fmac_f32 v142, v114, v114
    v_fmac_f32 v142, v115, v115
    v_fmac_f32 v142, v120, v120
    v_fmac_f32 v142, v121, v121
    v_fmac_f32 v142, v122, v122
    v_fmac_f32 v142, v123, v123
    v_add_f32 v141, v116, v117
    v_mul_f32 v143, v116, v116
    v_add_f32 v141, v141, v118
    v_add_f32 v141, v141, v119
    v_add_f32 v141, v141, v124
    v_add_f32 v141, v141, v125
    v_add_f32 v141, v141, v126
    v_add_f32 v141, v141, v127
    v_fmac_f32 v143, v117, v117
    v_fmac_f32 v143, v118, v118
    v_fmac_f32 v143, v119, v119
    v_fmac_f32 v143, v124, v124
    v_fmac_f32 v143, v125, v125
    v_fmac_f32 v143, v126, v126
    v_fmac_f32 v143, v127, v127
    s_nop 1
    v_add_f32_dpp v140, v140, v140 row_ror:8 row_mask:0xf bank_mask:0xf
    v_add_f32_dpp v141, v141, v141 row_ror:8 row_mask:0xf bank_mask:0xf
    v_add_f32_dpp v142, v142, v142 row_ror:8 row_mask:0xf bank_mask:0xf
    v_add_f32_dpp v143, v143, v143 row_ror:8 row_mask:0xf bank_mask:0xf
    s_nop 1
    v_add_f32_dpp v140, v140, v140 row_ror:4 row_mask:0xf bank_mask:0xf
    v_add_f32_dpp v141, v141, v141 row_ror:4 row_mask:0xf bank_mask:0xf
    v_add_f32_dpp v142, v142, v142 row_ror:4 row_mask:0xf bank_mask:0xf
    v_add_f32_dpp v143, v143, v143 row_ror:4 row_mask:0xf bank_mask:0xf
    v_mov_b32 v16, v140
    v_mov_b32 v17, v141
    v_mov_b32 v18, v142
    v_mov_b32 v19, v143
    s_nop 1
    v_permlane16_swap_b32 v140, v16
    v_permlane16_swap_b32 v141, v17
    v_permlane16_swap_b32 v142, v18
    v_permlane16_swap_b32 v143, v19
    s_nop 1
    v_add_f32 v140, v140, v16
    v_add_f32 v141, v141, v17
    v_add_f32 v142, v142, v18
    v_add_f32 v143, v143, v19
    v_mov_b32 v16, v140
    v_mov_b32 v17, v141
    v_mov_b32 v18, v142
    v_mov_b32 v19, v143
    s_nop 1
    v_permlane32_swap_b32 v140, v16
    v_permlane32_swap_b32 v141, v17
    v_permlane32_swap_b32 v142, v18
    v_permlane32_swap_b32 v143, v19
    s_nop 1
    v_add_f32 v140, v140, v16
    v_add_f32 v141, v141, v17
    v_add_f32 v142, v142, v18
    v_add_f32 v143, v143, v19
    s_mov_b64 exec, 0xf
    ds_write_b128 v13, v[140:143] offset:512
    s_mov_b64 exec, -1
    s_waitcnt lgkmcnt(0)
    s_barrier
    ds_read_b128 v[16:19], v14 offset:512
    ds_read_b128 v[20:23], v14 offset:576
    ds_read_b128 v[24:27], v14 offset:640
    ds_read_b128 v[28:31], v14 offset:704
    s_waitcnt lgkmcnt(0)
    v_add_f32 v140, v16, v20
    v_add_f32 v141, v17, v21
    v_add_f32 v142, v18, v22
    v_add_f32 v143, v19, v23
    v_add_f32 v140, v140, v24
    v_add_f32 v141, v141, v25
    v_add_f32 v142, v142, v26
    v_add_f32 v143, v143, v27
    v_add_f32 v140, v140, v28
    v_add_f32 v141, v141, v29
    v_add_f32 v142, v142, v30
    v_add_f32 v143, v143, v31
    v_mul_f32 v140, s44, v140
    v_mul_f32 v141, s44, v141
    v_mul_f32 v142, s44, v142
    v_mul_f32 v143, s44, v143
    v_fma_f32 v142, -v140, v140, v142
    v_fma_f32 v143, -v141, v141, v143
    v_max_f32 v142, 0, v142
    v_max_f32 v143, 0, v143
    v_add_f32 v142, s45, v142
    v_add_f32 v143, s45, v143
    v_rsq_f32 v142, v142
    v_rsq_f32 v143, v143
    s_nop 0
    s_mul_i32 s10, s6, 28672
    s_lshl_b32 s11, s7, 6
    s_add_u32 s10, s10, s11
    s_add_u32 s10, s10, 25165824
    v_sub_f32 v112, v112, v140
    v_sub_f32 v113, v113, v140
    v_sub_f32 v114, v114, v140
    v_sub_f32 v115, v115, v140
    v_sub_f32 v116, v116, v141
    v_sub_f32 v117, v117, v141
    v_sub_f32 v118, v118, v141
    v_sub_f32 v119, v119, v141
    v_mul_f32 v112, v112, v142
    v_mul_f32 v113, v113, v142
    v_mul_f32 v114, v114, v142
    v_mul_f32 v115, v115, v142
    v_mul_f32 v116, v116, v143
    v_mul_f32 v117, v117, v143
    v_mul_f32 v118, v118, v143
    v_mul_f32 v119, v119, v143
    v_cvt_pk_bf16_f32 v132, v112, v113
    v_cvt_pk_bf16_f32 v133, v114, v115
    v_cvt_pk_bf16_f32 v136, v116, v117
    v_cvt_pk_bf16_f32 v137, v118, v119
    v_sub_f32 v120, v120, v140
    v_sub_f32 v121, v121, v140
    v_sub_f32 v122, v122, v140
    v_sub_f32 v123, v123, v140
    v_sub_f32 v124, v124, v141
    v_sub_f32 v125, v125, v141
    v_sub_f32 v126, v126, v141
    v_sub_f32 v127, v127, v141
    v_mul_f32 v120, v120, v142
    v_mul_f32 v121, v121, v142
    v_mul_f32 v122, v122, v142
    v_mul_f32 v123, v123, v142
    v_mul_f32 v124, v124, v143
    v_mul_f32 v125, v125, v143
    v_mul_f32 v126, v126, v143
    v_mul_f32 v127, v127, v143
    v_cvt_pk_bf16_f32 v134, v120, v121
    v_cvt_pk_bf16_f32 v135, v122, v123
    v_cvt_pk_bf16_f32 v138, v124, v125
    v_cvt_pk_bf16_f32 v139, v126, v127
    s_add_u32 s8, s10, 14336
    buffer_store_dwordx4 v[132:135], v15, s[20:23], s10 offen sc1
    buffer_store_dwordx4 v[136:139], v15, s[20:23], s8 offen sc1
    s_lshl_b32 s8, s4, 1
    s_lshr_b32 s10, s5, 4
    s_add_u32 s8, s8, s10
    s_lshl_b32 s8, s8, 7
    s_and_b32 s10, s5, 15
    s_lshl_b32 s10, s10, 2
    s_add_u32 s8, s8, s10
    s_add_u32 s8, s8, 131072
    s_waitcnt vmcnt(0)
    s_barrier
    s_cmp_lg_u32 s3, 0
    s_cbranch_scc1 KT_sig1
    v_mov_b32 v16, 1
    v_mov_b32 v17, 0
    s_mov_b64 exec, 1
    buffer_store_dword v16, v17, s[20:23], s8 offen sc1
    s_mov_b64 exec, -1
KT_sig1:
    s_cmp_ge_u32 s5, 28
    s_cbranch_scc1 KT_idle
    s_mov_b32 s16, s54
    s_mov_b32 s17, s55
    s_mov_b32 s18, 0xe00
    s_mov_b32 s19, 0x20000
    v_mul_u32_u24 v5, 2176, v2
    v_lshl_add_u32 v5, v3, 8, v5
    v_lshl_add_u32 v5, v4, 3, v5
    v_xor_b32 v6, 0, v3
    v_lshl_add_u32 v9, v6, 5, v5
    v_add_u32 v13, 60928, v9
    v_xor_b32 v6, 1, v3
    v_lshl_add_u32 v10, v6, 5, v5
    v_add_u32 v14, 60928, v10
    v_xor_b32 v6, 2, v3
    v_lshl_add_u32 v11, v6, 5, v5
    v_add_u32 v15, 60928, v11
    v_xor_b32 v6, 3, v3
    v_lshl_add_u32 v12, v6, 5, v5
    v_add_u32 v16, 60928, v12
    v_lshlrev_b32 v17, 3, v2
    buffer_load_dwordx2 v[48:49], v17, s[16:19], s31 offen offset:0
    buffer_load_dwordx2 v[50:51], v17, s[16:19], s31 offen offset:32
    buffer_load_dwordx2 v[52:53], v17, s[16:19], s31 offen offset:64
    buffer_load_dwordx2 v[54:55], v17, s[16:19], s31 offen offset:96
    buffer_load_dwordx2 v[56:57], v17, s[16:19], s31 offen offset:128
    buffer_load_dwordx2 v[58:59], v17, s[16:19], s31 offen offset:160
    buffer_load_dwordx2 v[60:61], v17, s[16:19], s31 offen offset:192
    buffer_load_dwordx2 v[62:63], v17, s[16:19], s31 offen offset:224
    s_lshl_b32 s34, s4, 1
    s_add_u32 s34, s34, s28
    s_lshl_b32 s35, s34, 3
    s_lshl_b32 s8, s3, 1
    s_add_u32 s35, s35, s8
    s_lshl_b32 s8, s34, 7
    s_add_u32 s8, s8, 131072
    s_mul_i32 s15, s35, 14336
    s_add_u32 s15, s15, 25165824
    v_add_u32 v132, 4096, v7
    v_add_u32 v133, 8192, v7
    v_add_u32 v134, 12288, v7
    v_add_u32 v135, 16384, v7
    v_add_u32 v136, 20480, v7
    v_add_u32 v137, 24576, v7
    s_waitcnt vmcnt(0)
    v_lshlrev_b32 v64, 16, v48
    v_and_b32 v65, 0xffff0000, v48
    v_lshlrev_b32 v66, 16, v49
    v_and_b32 v67, 0xffff0000, v49
    v_lshlrev_b32 v68, 16, v48
    v_and_b32 v69, 0xffff0000, v48
    v_lshlrev_b32 v70, 16, v49
    v_and_b32 v71, 0xffff0000, v49
    v_lshlrev_b32 v72, 16, v50
    v_and_b32 v73, 0xffff0000, v50
    v_lshlrev_b32 v74, 16, v51
    v_and_b32 v75, 0xffff0000, v51
    v_lshlrev_b32 v76, 16, v50
    v_and_b32 v77, 0xffff0000, v50
    v_lshlrev_b32 v78, 16, v51
    v_and_b32 v79, 0xffff0000, v51
    v_lshlrev_b32 v80, 16, v52
    v_and_b32 v81, 0xffff0000, v52
    v_lshlrev_b32 v82, 16, v53
    v_and_b32 v83, 0xffff0000, v53
    v_lshlrev_b32 v84, 16, v52
    v_and_b32 v85, 0xffff0000, v52
    v_lshlrev_b32 v86, 16, v53
    v_and_b32 v87, 0xffff0000, v53
    v_lshlrev_b32 v88, 16, v54
    v_and_b32 v89, 0xffff0000, v54
    v_lshlrev_b32 v90, 16, v55
    v_and_b32 v91, 0xffff0000, v55
    v_lshlrev_b32 v92, 16, v54
    v_and_b32 v93, 0xffff0000, v54
    v_lshlrev_b32 v94, 16, v55
    v_and_b32 v95, 0xffff0000, v55
    v_lshlrev_b32 v96, 16, v56
    v_and_b32 v97, 0xffff0000, v56
    v_lshlrev_b32 v98, 16, v57
    v_and_b32 v99, 0xffff0000, v57
    v_lshlrev_b32 v100, 16, v56
    v_and_b32 v101, 0xffff0000, v56
    v_lshlrev_b32 v102, 16, v57
    v_and_b32 v103, 0xffff0000, v57
    v_lshlrev_b32 v104, 16, v58
    v_and_b32 v105, 0xffff0000, v58
    v_lshlrev_b32 v106, 16, v59
    v_and_b32 v107, 0xffff0000, v59
    v_lshlrev_b32 v108, 16, v58
    v_and_b32 v109, 0xffff0000, v58
    v_lshlrev_b32 v110, 16, v59
    v_and_b32 v111, 0xffff0000, v59
    v_lshlrev_b32 v112, 16, v60
    v_and_b32 v113, 0xffff0000, v60
    v_lshlrev_b32 v114, 16, v61
    v_and_b32 v115, 0xffff0000, v61
    v_lshlrev_b32 v116, 16, v60
    v_and_b32 v117, 0xffff0000, v60
    v_lshlrev_b32 v118, 16, v61
    v_and_b32 v119, 0xffff0000, v61
    v_lshlrev_b32 v120, 16, v62
    v_and_b32 v121, 0xffff0000, v62
    v_lshlrev_b32 v122, 16, v63
    v_and_b32 v123, 0xffff0000, v63
    v_lshlrev_b32 v124, 16, v62
    v_and_b32 v125, 0xffff0000, v62
    v_lshlrev_b32 v126, 16, v63
    v_and_b32 v127, 0xffff0000, v63
    s_mov_b32 s24, s56
    s_mov_b32 s25, s57
    s_mov_b32 s26, 0x188000
    s_mov_b32 s27, 0x20000
    s_and_b32 s36, s5, 3
    s_lshr_b32 s37, s5, 2
    v_lshrrev_b32 v5, 3, v1
    v_mul_u32_u24 v6, 896, v5
    v_and_b32 v5, 6, v5
    v_and_b32 v8, 7, v1
    v_xor_b32 v5, v5, v8
    v_lshl_add_u32 v5, v5, 4, v6
    s_mul_i32 s10, s3, 401408
    s_lshl_b32 s38, s37, 7
    s_add_u32 s10, s10, s38
    v_add_u32 v128, s10, v5
    v_add_u32 v129, 6144, v128
    v_add_u32 v130, 12288, v128
    v_add_u32 v131, 18432, v128
    s_lshl_b32 s39, s3, 12
    s_mov_b32 s33, 0
    s_add_u32 m0, s39, 131072
    s_nop 0
    buffer_load_dwordx4 v128, s[24:27], s33 offen offset:0 lds
    buffer_load_dwordx4 v129, s[24:27], s33 offen offset:1024 lds
    buffer_load_dwordx4 v130, s[24:27], s33 offen offset:2048 lds
    buffer_load_dwordx4 v131, s[24:27], s33 offen offset:3072 lds
    s_mov_b32 s33, 28672
    s_add_u32 m0, s39, 147456
    s_nop 0
    buffer_load_dwordx4 v128, s[24:27], s33 offen offset:0 lds
    buffer_load_dwordx4 v129, s[24:27], s33 offen offset:1024 lds
    buffer_load_dwordx4 v130, s[24:27], s33 offen offset:2048 lds
    buffer_load_dwordx4 v131, s[24:27], s33 offen offset:3072 lds
    s_cmp_lg_u32 s3, 0
    s_cbranch_scc1 KT_go1
    v_min_u32 v19, 15, v1
    v_lshlrev_b32 v19, 2, v19
    s_mov_b32 s46, 0x40000
KT_poll1:
    buffer_load_dword v18, v19, s[20:23], s8 offen sc1
    s_waitcnt vmcnt(0)
    v_cmp_ne_u32 vcc, 0, v18
    s_nop 1
    s_and_b32 s47, vcc_lo, 0xffff
    s_cmp_eq_u32 s47, 0xffff
    s_cbranch_scc1 KT_got1
    s_sleep 1
    s_sub_u32 s46, s46, 1
    s_cmp_lg_u32 s46, 0
    s_cbranch_scc1 KT_poll1
KT_got1:
KT_go1:
    s_barrier
    buffer_load_dwordx4 a[0:3], v7, s[20:23], s15 offen offset:0 sc1
    buffer_load_dwordx4 a[4:7], v134, s[20:23], s15 offen offset:2048 sc1
    buffer_load_dwordx4 a[8:11], v7, s[20:23], s15 offen offset:1024 sc1
    buffer_load_dwordx4 a[12:15], v134, s[20:23], s15 offen offset:3072 sc1
    buffer_load_dwordx4 a[16:19], v7, s[20:23], s15 offen offset:2048 sc1
    buffer_load_dwordx4 a[20:23], v135, s[20:23], s15 offen offset:0 sc1
    buffer_load_dwordx4 a[24:27], v7, s[20:23], s15 offen offset:3072 sc1
    buffer_load_dwordx4 a[28:31], v135, s[20:23], s15 offen offset:1024 sc1
    buffer_load_dwordx4 a[32:35], v132, s[20:23], s15 offen offset:0 sc1
    buffer_load_dwordx4 a[36:39], v135, s[20:23], s15 offen offset:2048 sc1
    buffer_load_dwordx4 a[40:43], v132, s[20:23], s15 offen offset:1024 sc1
    buffer_load_dwordx4 a[44:47], v135, s[20:23], s15 offen offset:3072 sc1
    buffer_load_dwordx4 a[48:51], v132, s[20:23], s15 offen offset:2048 sc1
    buffer_load_dwordx4 a[52:55], v136, s[20:23], s15 offen offset:0 sc1
    buffer_load_dwordx4 a[56:59], v132, s[20:23], s15 offen offset:3072 sc1
    buffer_load_dwordx4 a[60:63], v136, s[20:23], s15 offen offset:1024 sc1
    buffer_load_dwordx4 a[64:67], v133, s[20:23], s15 offen offset:0 sc1
    buffer_load_dwordx4 a[68:71], v136, s[20:23], s15 offen offset:2048 sc1
    buffer_load_dwordx4 a[72:75], v133, s[20:23], s15 offen offset:1024 sc1
    buffer_load_dwordx4 a[76:79], v136, s[20:23], s15 offen offset:3072 sc1
    buffer_load_dwordx4 a[80:83], v133, s[20:23], s15 offen offset:2048 sc1
    buffer_load_dwordx4 a[84:87], v137, s[20:23], s15 offen offset:0 sc1
    buffer_load_dwordx4 a[88:91], v133, s[20:23], s15 offen offset:3072 sc1
    buffer_load_dwordx4 a[92:95], v137, s[20:23], s15 offen offset:1024 sc1
    buffer_load_dwordx4 a[96:99], v134, s[20:23], s15 offen offset:0 sc1
    buffer_load_dwordx4 a[100:103], v137, s[20:23], s15 offen offset:2048 sc1
    buffer_load_dwordx4 a[104:107], v134, s[20:23], s15 offen offset:1024 sc1
    buffer_load_dwordx4 a[108:111], v137, s[20:23], s15 offen offset:3072 sc1
    v_mov_b32 v48, 0xbdd2d3e8
    v_mov_b32 v50, 0xc0135761
    v_mov_b32 v52, 1.0
    v_mov_b32 v49, 0xbdd2d3e8
    v_mov_b32 v51, 0xc0135761
    v_mov_b32 v53, 1.0
    s_mul_i32 s15, s35, 57344
    s_lshl_b32 s10, s29, 12
    s_add_u32 s15, s15, s10
    s_add_u32 s15, s15, 29360128
    s_add_u32 s14, s15, 57344
    ds_read_b64_tr_b16 v[20:21], v9 offset:0
    ds_read_b64_tr_b16 v[22:23], v9 offset:1088
    ds_read_b64_tr_b16 v[24:25], v10 offset:0
    ds_read_b64_tr_b16 v[26:27], v10 offset:1088
    ds_read_b64_tr_b16 v[28:29], v11 offset:0
    ds_read_b64_tr_b16 v[30:31], v11 offset:1088
    ds_read_b64_tr_b16 v[32:33], v12 offset:0
    ds_read_b64_tr_b16 v[34:35], v12 offset:1088
    ds_read_b64_tr_b16 v[36:37], v9 offset:128
    ds_read_b64_tr_b16 v[38:39], v9 offset:1216
    s_waitcnt vmcnt(26)
    s_waitcnt lgkmcnt(6)
    v_mfma_f32_16x16x32_bf16 v[64:67], v[20:23], a[0:3], v[64:67]
    ds_read_b64_tr_b16 v[40:41], v10 offset:128
    ds_read_b64_tr_b16 v[42:43], v10 offset:1216
    v_mfma_f32_16x16x32_bf16 v[68:71], v[20:23], a[4:7], v[68:71]
    v_mfma_f32_16x16x32_bf16 v[72:75], v[24:27], a[0:3], v[72:75]
    ds_read_b64_tr_b16 v[44:45], v11 offset:128
    ds_read_b64_tr_b16 v[46:47], v11 offset:1216
    v_mfma_f32_16x16x32_bf16 v[76:79], v[24:27], a[4:7], v[76:79]
    s_waitcnt lgkmcnt(6)
    v_mfma_f32_16x16x32_bf16 v[80:83], v[28:31], a[0:3], v[80:83]
    ds_read_b64_tr_b16 v[20:21], v12 offset:128
    ds_read_b64_tr_b16 v[22:23], v12 offset:1216
    v_mfma_f32_16x16x32_bf16 v[84:87], v[28:31], a[4:7], v[84:87]
    v_mfma_f32_16x16x32_bf16 v[88:91], v[32:35], a[0:3], v[88:91]
    ds_read_b64_tr_b16 v[24:25], v9 offset:8704
    ds_read_b64_tr_b16 v[26:27], v9 offset:9792
    v_mfma_f32_16x16x32_bf16 v[92:95], v[32:35], a[4:7], v[92:95]
    s_waitcnt lgkmcnt(6)
    v_mfma_f32_16x16x32_bf16 v[96:99], v[36:39], a[0:3], v[96:99]
    ds_read_b64_tr_b16 v[28:29], v10 offset:8704
    ds_read_b64_tr_b16 v[30:31], v10 offset:9792
    v_mfma_f32_16x16x32_bf16 v[100:103], v[36:39], a[4:7], v[100:103]
    v_mfma_f32_16x16x32_bf16 v[104:107], v[40:43], a[0:3], v[104:107]
    ds_read_b64_tr_b16 v[32:33], v11 offset:8704
    ds_read_b64_tr_b16 v[34:35], v11 offset:9792
    v_mfma_f32_16x16x32_bf16 v[108:111], v[40:43], a[4:7], v[108:111]
    s_waitcnt lgkmcnt(6)
    v_mfma_f32_16x16x32_bf16 v[112:115], v[44:47], a[0:3], v[112:115]
    ds_read_b64_tr_b16 v[36:37], v12 offset:8704
    ds_read_b64_tr_b16 v[38:39], v12 offset:9792
    v_mfma_f32_16x16x32_bf16 v[116:119], v[44:47], a[4:7], v[116:119]
    v_mfma_f32_16x16x32_bf16 v[120:123], v[20:23], a[0:3], v[120:123]
    ds_read_b64_tr_b16 v[40:41], v9 offset:8832
    ds_read_b64_tr_b16 v[42:43], v9 offset:9920
    v_mfma_f32_16x16x32_bf16 v[124:127], v[20:23], a[4:7], v[124:127]
    s_waitcnt vmcnt(24)
    s_waitcnt lgkmcnt(6)
    v_mfma_f32_16x16x32_bf16 v[64:67], v[24:27], a[8:11], v[64:67]
    ds_read_b64_tr_b16 v[44:45], v10 offset:8832
    ds_read_b64_tr_b16 v[46:47], v10 offset:9920
    v_mfma_f32_16x16x32_bf16 v[68:71], v[24:27], a[12:15], v[68:71]
    v_mfma_f32_16x16x32_bf16 v[72:75], v[28:31], a[8:11], v[72:75]
    ds_read_b64_tr_b16 v[20:21], v11 offset:8832
    ds_read_b64_tr_b16 v[22:23], v11 offset:9920
    v_mfma_f32_16x16x32_bf16 v[76:79], v[28:31], a[12:15], v[76:79]
    s_waitcnt lgkmcnt(6)
    v_mfma_f32_16x16x32_bf16 v[80:83], v[32:35], a[8:11], v[80:83]
    ds_read_b64_tr_b16 v[24:25], v12 offset:8832
    ds_read_b64_tr_b16 v[26:27], v12 offset:9920
    v_mfma_f32_16x16x32_bf16 v[84:87], v[32:35], a[12:15], v[84:87]
    v_mfma_f32_16x16x32_bf16 v[88:91], v[36:39], a[8:11], v[88:91]
    ds_read_b64_tr_b16 v[28:29], v9 offset:17408
    ds_read_b64_tr_b16 v[30:31], v9 offset:18496
    v_mfma_f32_16x16x32_bf16 v[92:95], v[36:39], a[12:15], v[92:95]
    s_waitcnt lgkmcnt(6)
    v_mfma_f32_16x16x32_bf16 v[96:99], v[40:43], a[8:11], v[96:99]
    ds_read_b64_tr_b16 v[32:33], v10 offset:17408
    ds_read_b64_tr_b16 v[34:35], v10 offset:18496
    v_mfma_f32_16x16x32_bf16 v[100:103], v[40:43], a[12:15], v[100:103]
    v_mfma_f32_16x16x32_bf16 v[104:107], v[44:47], a[8:11], v[104:107]
    ds_read_b64_tr_b16 v[36:37], v11 offset:17408
    ds_read_b64_tr_b16 v[38:39], v11 offset:18496
    v_mfma_f32_16x16x32_bf16 v[108:111], v[44:47], a[12:15], v[108:111]
    s_waitcnt lgkmcnt(6)
    v_mfma_f32_16x16x32_bf16 v[112:115], v[20:23], a[8:11], v[112:115]
    ds_read_b64_tr_b16 v[40:41], v12 offset:17408
    ds_read_b64_tr_b16 v[42:43], v12 offset:18496
    v_mfma_f32_16x16x32_bf16 v[116:119], v[20:23], a[12:15], v[116:119]
    v_mfma_f32_16x16x32_bf16 v[120:123], v[24:27], a[8:11], v[120:123]
    ds_read_b64_tr_b16 v[44:45], v9 offset:17536
    ds_read_b64_tr_b16 v[46:47], v9 offset:18624
    v_mfma_f32_16x16x32_bf16 v[124:127], v[24:27], a[12:15], v[124:127]
    s_waitcnt vmcnt(22)
    s_waitcnt lgkmcnt(6)
    v_mfma_f32_16x16x32_bf16 v[64:67], v[28:31], a[16:19], v[64:67]
    ds_read_b64_tr_b16 v[20:21], v10 offset:17536
    ds_read_b64_tr_b16 v[22:23], v10 offset:18624
    v_mfma_f32_16x16x32_bf16 v[68:71], v[28:31], a[20:23], v[68:71]
    v_mfma_f32_16x16x32_bf16 v[72:75], v[32:35], a[16:19], v[72:75]
    ds_read_b64_tr_b16 v[24:25], v11 offset:17536
    ds_read_b64_tr_b16 v[26:27], v11 offset:18624
    v_mfma_f32_16x16x32_bf16 v[76:79], v[32:35], a[20:23], v[76:79]
    s_waitcnt lgkmcnt(6)
    v_mfma_f32_16x16x32_bf16 v[80:83], v[36:39], a[16:19], v[80:83]
    ds_read_b64_tr_b16 v[28:29], v12 offset:17536
    ds_read_b64_tr_b16 v[30:31], v12 offset:18624
    v_mfma_f32_16x16x32_bf16 v[84:87], v[36:39], a[20:23], v[84:87]
    v_mfma_f32_16x16x32_bf16 v[88:91], v[40:43], a[16:19], v[88:91]
    ds_read_b64_tr_b16 v[32:33], v9 offset:26112
    ds_read_b64_tr_b16 v[34:35], v9 offset:27200
    v_mfma_f32_16x16x32_bf16 v[92:95], v[40:43], a[20:23], v[92:95]
    s_waitcnt lgkmcnt(6)
    v_mfma_f32_16x16x32_bf16 v[96:99], v[44:47], a[16:19], v[96:99]
    ds_read_b64_tr_b16 v[36:37], v10 offset:26112
    ds_read_b64_tr_b16 v[38:39], v10 offset:27200
    v_mfma_f32_16x16x32_bf16 v[100:103], v[44:47], a[20:23], v[100:103]
    v_mfma_f32_16x16x32_bf16 v[104:107], v[20:23], a[16:19], v[104:107]
    ds_read_b64_tr_b16 v[40:41], v11 offset:26112
    ds_read_b64_tr_b16 v[42:43], v11 offset:27200
    v_mfma_f32_16x16x32_bf16 v[108:111], v[20:23], a[20:23], v[108:111]
    s_waitcnt lgkmcnt(6)
    v_mfma_f32_16x16x32_bf16 v[112:115], v[24:27], a[16:19], v[112:115]
    ds_read_b64_tr_b16 v[44:45], v12 offset:26112
    ds_read_b64_tr_b16 v[46:47], v12 offset:27200
    v_mfma_f32_16x16x32_bf16 v[116:119], v[24:27], a[20:23], v[116:119]
    v_mfma_f32_16x16x32_bf16 v[120:123], v[28:31], a[16:19], v[120:123]
    ds_read_b64_tr_b16 v[20:21], v9 offset:26240
    ds_read_b64_tr_b16 v[22:23], v9 offset:27328
    v_mfma_f32_16x16x32_bf16 v[124:127], v[28:31], a[20:23], v[124:127]
    s_waitcnt vmcnt(20)
    s_waitcnt lgkmcnt(6)
    v_mfma_f32_16x16x32_bf16 v[64:67], v[32:35], a[24:27], v[64:67]
    ds_read_b64_tr_b16 v[24:25], v10 offset:26240
    ds_read_b64_tr_b16 v[26:27], v10 offset:27328
    v_mfma_f32_16x16x32_bf16 v[68:71], v[32:35], a[28:31], v[68:71]
    v_mfma_f32_16x16x32_bf16 v[72:75], v[36:39], a[24:27], v[72:75]
    ds_read_b64_tr_b16 v[28:29], v11 offset:26240
    ds_read_b64_tr_b16 v[30:31], v11 offset:27328
    v_mfma_f32_16x16x32_bf16 v[76:79], v[36:39], a[28:31], v[76:79]
    s_waitcnt lgkmcnt(6)
    v_mfma_f32_16x16x32_bf16 v[80:83], v[40:43], a[24:27], v[80:83]
    ds_read_b64_tr_b16 v[32:33], v12 offset:26240
    ds_read_b64_tr_b16 v[34:35], v12 offset:27328
    v_mfma_f32_16x16x32_bf16 v[84:87], v[40:43], a[28:31], v[84:87]
    v_mfma_f32_16x16x32_bf16 v[88:91], v[44:47], a[24:27], v[88:91]
    ds_read_b64_tr_b16 v[36:37], v9 offset:34816
    ds_read_b64_tr_b16 v[38:39], v9 offset:35904
    v_mfma_f32_16x16x32_bf16 v[92:95], v[44:47], a[28:31], v[92:95]
    s_waitcnt lgkmcnt(6)
    v_mfma_f32_16x16x32_bf16 v[96:99], v[20:23], a[24:27], v[96:99]
    ds_read_b64_tr_b16 v[40:41], v10 offset:34816
    ds_read_b64_tr_b16 v[42:43], v10 offset:35904
    v_mfma_f32_16x16x32_bf16 v[100:103], v[20:23], a[28:31], v[100:103]
    v_mfma_f32_16x16x32_bf16 v[104:107], v[24:27], a[24:27], v[104:107]
    ds_read_b64_tr_b16 v[44:45], v11 offset:34816
    ds_read_b64_tr_b16 v[46:47], v11 offset:35904
    v_mfma_f32_16x16x32_bf16 v[108:111], v[24:27], a[28:31], v[108:111]
    s_waitcnt lgkmcnt(6)
    v_mfma_f32_16x16x32_bf16 v[112:115], v[28:31], a[24:27], v[112:115]
    ds_read_b64_tr_b16 v[20:21], v12 offset:34816
    ds_read_b64_tr_b16 v[22:23], v12 offset:35904
    v_mfma_f32_16x16x32_bf16 v[116:119], v[28:31], a[28:31], v[116:119]
    v_mfma_f32_16x16x32_bf16 v[120:123], v[32:35], a[24:27], v[120:123]
    ds_read_b64_tr_b16 v[24:25], v9 offset:34944
    ds_read_b64_tr_b16 v[26:27], v9 offset:36032
    v_mfma_f32_16x16x32_bf16 v[124:127], v[32:35], a[28:31], v[124:127]
    s_waitcnt vmcnt(18)
    s_waitcnt lgkmcnt(6)
    v_mfma_f32_16x16x32_bf16 v[64:67], v[36:39], a[32:35], v[64:67]
    ds_read_b64_tr_b16 v[28:29], v10 offset:34944
    ds_read_b64_tr_b16 v[30:31], v10 offset:36032
    v_mfma_f32_16x16x32_bf16 v[68:71], v[36:39], a[36:39], v[68:71]
    v_mfma_f32_16x16x32_bf16 v[72:75], v[40:43], a[32:35], v[72:75]
    ds_read_b64_tr_b16 v[32:33], v11 offset:34944
    ds_read_b64_tr_b16 v[34:35], v11 offset:36032
    v_mfma_f32_16x16x32_bf16 v[76:79], v[40:43], a[36:39], v[76:79]
    s_waitcnt lgkmcnt(6)
    v_mfma_f32_16x16x32_bf16 v[80:83], v[44:47], a[32:35], v[80:83]
    ds_read_b64_tr_b16 v[36:37], v12 offset:34944
    ds_read_b64_tr_b16 v[38:39], v12 offset:36032
    v_mfma_f32_16x16x32_bf16 v[84:87], v[44:47], a[36:39], v[84:87]
    v_mfma_f32_16x16x32_bf16 v[88:91], v[20:23], a[32:35], v[88:91]
    ds_read_b64_tr_b16 v[40:41], v9 offset:43520
    ds_read_b64_tr_b16 v[42:43], v9 offset:44608
    v_mfma_f32_16x16x32_bf16 v[92:95], v[20:23], a[36:39], v[92:95]
    s_waitcnt lgkmcnt(6)
    v_mfma_f32_16x16x32_bf16 v[96:99], v[24:27], a[32:35], v[96:99]
    ds_read_b64_tr_b16 v[44:45], v10 offset:43520
    ds_read_b64_tr_b16 v[46:47], v10 offset:44608
    v_mfma_f32_16x16x32_bf16 v[100:103], v[24:27], a[36:39], v[100:103]
    v_mfma_f32_16x16x32_bf16 v[104:107], v[28:31], a[32:35], v[104:107]
    ds_read_b64_tr_b16 v[20:21], v11 offset:43520
    ds_read_b64_tr_b16 v[22:23], v11 offset:44608
    v_mfma_f32_16x16x32_bf16 v[108:111], v[28:31], a[36:39], v[108:111]
    s_waitcnt lgkmcnt(6)
    v_mfma_f32_16x16x32_bf16 v[112:115], v[32:35], a[32:35], v[112:115]
    ds_read_b64_tr_b16 v[24:25], v12 offset:43520
    ds_read_b64_tr_b16 v[26:27], v12 offset:44608
    v_mfma_f32_16x16x32_bf16 v[116:119], v[32:35], a[36:39], v[116:119]
    v_mfma_f32_16x16x32_bf16 v[120:123], v[36:39], a[32:35], v[120:123]
    ds_read_b64_tr_b16 v[28:29], v9 offset:43648
    ds_read_b64_tr_b16 v[30:31], v9 offset:44736
    v_mfma_f32_16x16x32_bf16 v[124:127], v[36:39], a[36:39], v[124:127]
    s_waitcnt vmcnt(16)
    s_waitcnt lgkmcnt(6)
    v_mfma_f32_16x16x32_bf16 v[64:67], v[40:43], a[40:43], v[64:67]
    ds_read_b64_tr_b16 v[32:33], v10 offset:43648
    ds_read_b64_tr_b16 v[34:35], v10 offset:44736
    v_mfma_f32_16x16x32_bf16 v[68:71], v[40:43], a[44:47], v[68:71]
    v_mfma_f32_16x16x32_bf16 v[72:75], v[44:47], a[40:43], v[72:75]
    ds_read_b64_tr_b16 v[36:37], v11 offset:43648
    ds_read_b64_tr_b16 v[38:39], v11 offset:44736
    v_mfma_f32_16x16x32_bf16 v[76:79], v[44:47], a[44:47], v[76:79]
    s_waitcnt lgkmcnt(6)
    v_mfma_f32_16x16x32_bf16 v[80:83], v[20:23], a[40:43], v[80:83]
    ds_read_b64_tr_b16 v[40:41], v12 offset:43648
    ds_read_b64_tr_b16 v[42:43], v12 offset:44736
    v_mfma_f32_16x16x32_bf16 v[84:87], v[20:23], a[44:47], v[84:87]
    v_mfma_f32_16x16x32_bf16 v[88:91], v[24:27], a[40:43], v[88:91]
    ds_read_b64_tr_b16 v[44:45], v9 offset:52224
    ds_read_b64_tr_b16 v[46:47], v9 offset:53312
    v_mfma_f32_16x16x32_bf16 v[92:95], v[24:27], a[44:47], v[92:95]
    s_waitcnt lgkmcnt(6)
    v_mfma_f32_16x16x32_bf16 v[96:99], v[28:31], a[40:43], v[96:99]
    ds_read_b64_tr_b16 v[20:21], v10 offset:52224
    ds_read_b64_tr_b16 v[22:23], v10 offset:53312
    v_mfma_f32_16x16x32_bf16 v[100:103], v[28:31], a[44:47], v[100:103]
    v_mfma_f32_16x16x32_bf16 v[104:107], v[32:35], a[40:43], v[104:107]
    ds_read_b64_tr_b16 v[24:25], v11 offset:52224
    ds_read_b64_tr_b16 v[26:27], v11 offset:53312
    v_mfma_f32_16x16x32_bf16 v[108:111], v[32:35], a[44:47], v[108:111]
    s_waitcnt lgkmcnt(6)
    v_mfma_f32_16x16x32_bf16 v[112:115], v[36:39], a[40:43], v[112:115]
    ds_read_b64_tr_b16 v[28:29], v12 offset:52224
    ds_read_b64_tr_b16 v[30:31], v12 offset:53312
    v_mfma_f32_16x16x32_bf16 v[116:119], v[36:39], a[44:47], v[116:119]
    v_mfma_f32_16x16x32_bf16 v[120:123], v[40:43], a[40:43], v[120:123]
    ds_read_b64_tr_b16 v[32:33], v9 offset:52352
    ds_read_b64_tr_b16 v[34:35], v9 offset:53440
    v_mfma_f32_16x16x32_bf16 v[124:127], v[40:43], a[44:47], v[124:127]
    s_waitcnt vmcnt(14)
    s_waitcnt lgkmcnt(6)
    v_mfma_f32_16x16x32_bf16 v[64:67], v[44:47], a[48:51], v[64:67]
    ds_read_b64_tr_b16 v[36:37], v10 offset:52352
    ds_read_b64_tr_b16 v[38:39], v10 offset:53440
    v_mfma_f32_16x16x32_bf16 v[68:71], v[44:47], a[52:55], v[68:71]
    v_mfma_f32_16x16x32_bf16 v[72:75], v[20:23], a[48:51], v[72:75]
    ds_read_b64_tr_b16 v[40:41], v11 offset:52352
    ds_read_b64_tr_b16 v[42:43], v11 offset:53440
    v_mfma_f32_16x16x32_bf16 v[76:79], v[20:23], a[52:55], v[76:79]
    s_waitcnt lgkmcnt(6)
    v_mfma_f32_16x16x32_bf16 v[80:83], v[24:27], a[48:51], v[80:83]
    ds_read_b64_tr_b16 v[44:45], v12 offset:52352
    ds_read_b64_tr_b16 v[46:47], v12 offset:53440
    v_mfma_f32_16x16x32_bf16 v[84:87], v[24:27], a[52:55], v[84:87]
    v_mfma_f32_16x16x32_bf16 v[88:91], v[28:31], a[48:51], v[88:91]
    ds_read_b64_tr_b16 v[20:21], v13 offset:0
    ds_read_b64_tr_b16 v[22:23], v13 offset:1088
    v_mfma_f32_16x16x32_bf16 v[92:95], v[28:31], a[52:55], v[92:95]
    s_waitcnt lgkmcnt(6)
    v_mfma_f32_16x16x32_bf16 v[96:99], v[32:35], a[48:51], v[96:99]
    ds_read_b64_tr_b16 v[24:25], v14 offset:0
    ds_read_b64_tr_b16 v[26:27], v14 offset:1088
    v_mfma_f32_16x16x32_bf16 v[100:103], v[32:35], a[52:55], v[100:103]
    v_mfma_f32_16x16x32_bf16 v[104:107], v[36:39], a[48:51], v[104:107]
    ds_read_b64_tr_b16 v[28:29], v15 offset:0
    ds_read_b64_tr_b16 v[30:31], v15 offset:1088
    v_mfma_f32_16x16x32_bf16 v[108:111], v[36:39], a[52:55], v[108:111]
    s_waitcnt lgkmcnt(6)
    v_mfma_f32_16x16x32_bf16 v[112:115], v[40:43], a[48:51], v[112:115]
    ds_read_b64_tr_b16 v[32:33], v16 offset:0
    ds_read_b64_tr_b16 v[34:35], v16 offset:1088
    v_mfma_f32_16x16x32_bf16 v[116:119], v[40:43], a[52:55], v[116:119]
    v_mfma_f32_16x16x32_bf16 v[120:123], v[44:47], a[48:51], v[120:123]
    ds_read_b64_tr_b16 v[36:37], v13 offset:128
    ds_read_b64_tr_b16 v[38:39], v13 offset:1216
    v_mfma_f32_16x16x32_bf16 v[124:127], v[44:47], a[52:55], v[124:127]
    s_waitcnt vmcnt(12)
    s_waitcnt lgkmcnt(6)
    v_mfma_f32_16x16x32_bf16 v[64:67], v[20:23], a[56:59], v[64:67]
    ds_read_b64_tr_b16 v[40:41], v14 offset:128
    ds_read_b64_tr_b16 v[42:43], v14 offset:1216
    v_mfma_f32_16x16x32_bf16 v[68:71], v[20:23], a[60:63], v[68:71]
    v_mfma_f32_16x16x32_bf16 v[72:75], v[24:27], a[56:59], v[72:75]
    ds_read_b64_tr_b16 v[44:45], v15 offset:128
    ds_read_b64_tr_b16 v[46:47], v15 offset:1216
    v_mfma_f32_16x16x32_bf16 v[76:79], v[24:27], a[60:63], v[76:79]
    s_waitcnt lgkmcnt(6)
    v_mfma_f32_16x16x32_bf16 v[80:83], v[28:31], a[56:59], v[80:83]
    ds_read_b64_tr_b16 v[20:21], v16 offset:128
    ds_read_b64_tr_b16 v[22:23], v16 offset:1216
    v_mfma_f32_16x16x32_bf16 v[84:87], v[28:31], a[60:63], v[84:87]
    v_mfma_f32_16x16x32_bf16 v[88:91], v[32:35], a[56:59], v[88:91]
    ds_read_b64_tr_b16 v[24:25], v13 offset:8704
    ds_read_b64_tr_b16 v[26:27], v13 offset:9792
    v_mfma_f32_16x16x32_bf16 v[92:95], v[32:35], a[60:63], v[92:95]
    s_waitcnt lgkmcnt(6)
    v_mfma_f32_16x16x32_bf16 v[96:99], v[36:39], a[56:59], v[96:99]
    ds_read_b64_tr_b16 v[28:29], v14 offset:8704
    ds_read_b64_tr_b16 v[30:31], v14 offset:9792
    v_mfma_f32_16x16x32_bf16 v[100:103], v[36:39], a[60:63], v[100:103]
    v_mfma_f32_16x16x32_bf16 v[104:107], v[40:43], a[56:59], v[104:107]
    ds_read_b64_tr_b16 v[32:33], v15 offset:8704
    ds_read_b64_tr_b16 v[34:35], v15 offset:9792
    v_mfma_f32_16x16x32_bf16 v[108:111], v[40:43], a[60:63], v[108:111]
    s_waitcnt lgkmcnt(6)
    v_mfma_f32_16x16x32_bf16 v[112:115], v[44:47], a[56:59], v[112:115]
    ds_read_b64_tr_b16 v[36:37], v16 offset:8704
    ds_read_b64_tr_b16 v[38:39], v16 offset:9792
    v_mfma_f32_16x16x32_bf16 v[116:119], v[44:47], a[60:63], v[116:119]
    v_mfma_f32_16x16x32_bf16 v[120:123], v[20:23], a[56:59], v[120:123]
    ds_read_b64_tr_b16 v[40:41], v13 offset:8832
    ds_read_b64_tr_b16 v[42:43], v13 offset:9920
    v_mfma_f32_16x16x32_bf16 v[124:127], v[20:23], a[60:63], v[124:127]
    s_waitcnt vmcnt(10)
    s_waitcnt lgkmcnt(6)
    v_mfma_f32_16x16x32_bf16 v[64:67], v[24:27], a[64:67], v[64:67]
    ds_read_b64_tr_b16 v[44:45], v14 offset:8832
    ds_read_b64_tr_b16 v[46:47], v14 offset:9920
    v_mfma_f32_16x16x32_bf16 v[68:71], v[24:27], a[68:71], v[68:71]
    v_mfma_f32_16x16x32_bf16 v[72:75], v[28:31], a[64:67], v[72:75]
    ds_read_b64_tr_b16 v[20:21], v15 offset:8832
    ds_read_b64_tr_b16 v[22:23], v15 offset:9920
    v_mfma_f32_16x16x32_bf16 v[76:79], v[28:31], a[68:71], v[76:79]
    s_waitcnt lgkmcnt(6)
    v_mfma_f32_16x16x32_bf16 v[80:83], v[32:35], a[64:67], v[80:83]
    ds_read_b64_tr_b16 v[24:25], v16 offset:8832
    ds_read_b64_tr_b16 v[26:27], v16 offset:9920
    v_mfma_f32_16x16x32_bf16 v[84:87], v[32:35], a[68:71], v[84:87]
    v_mfma_f32_16x16x32_bf16 v[88:91], v[36:39], a[64:67], v[88:91]
    ds_read_b64_tr_b16 v[28:29], v13 offset:17408
    ds_read_b64_tr_b16 v[30:31], v13 offset:18496
    v_mfma_f32_16x16x32_bf16 v[92:95], v[36:39], a[68:71], v[92:95]
    s_waitcnt lgkmcnt(6)
    v_mfma_f32_16x16x32_bf16 v[96:99], v[40:43], a[64:67], v[96:99]
    ds_read_b64_tr_b16 v[32:33], v14 offset:17408
    ds_read_b64_tr_b16 v[34:35], v14 offset:18496
    v_mfma_f32_16x16x32_bf16 v[100:103], v[40:43], a[68:71], v[100:103]
    v_mfma_f32_16x16x32_bf16 v[104:107], v[44:47], a[64:67], v[104:107]
    ds_read_b64_tr_b16 v[36:37], v15 offset:17408
    ds_read_b64_tr_b16 v[38:39], v15 offset:18496
    v_mfma_f32_16x16x32_bf16 v[108:111], v[44:47], a[68:71], v[108:111]
    s_waitcnt lgkmcnt(6)
    v_mfma_f32_16x16x32_bf16 v[112:115], v[20:23], a[64:67], v[112:115]
    ds_read_b64_tr_b16 v[40:41], v16 offset:17408
    ds_read_b64_tr_b16 v[42:43], v16 offset:18496
    v_mfma_f32_16x16x32_bf16 v[116:119], v[20:23], a[68:71], v[116:119]
    v_mfma_f32_16x16x32_bf16 v[120:123], v[24:27], a[64:67], v[120:123]
    ds_read_b64_tr_b16 v[44:45], v13 offset:17536
    ds_read_b64_tr_b16 v[46:47], v13 offset:18624
    v_mfma_f32_16x16x32_bf16 v[124:127], v[24:27], a[68:71], v[124:127]
    s_waitcnt vmcnt(8)
    s_waitcnt lgkmcnt(6)
    v_mfma_f32_16x16x32_bf16 v[64:67], v[28:31], a[72:75], v[64:67]
    ds_read_b64_tr_b16 v[20:21], v14 offset:17536
    ds_read_b64_tr_b16 v[22:23], v14 offset:18624
    v_mfma_f32_16x16x32_bf16 v[68:71], v[28:31], a[76:79], v[68:71]
    v_mfma_f32_16x16x32_bf16 v[72:75], v[32:35], a[72:75], v[72:75]
    ds_read_b64_tr_b16 v[24:25], v15 offset:17536
    ds_read_b64_tr_b16 v[26:27], v15 offset:18624
    v_mfma_f32_16x16x32_bf16 v[76:79], v[32:35], a[76:79], v[76:79]
    s_waitcnt lgkmcnt(6)
    v_mfma_f32_16x16x32_bf16 v[80:83], v[36:39], a[72:75], v[80:83]
    ds_read_b64_tr_b16 v[28:29], v16 offset:17536
    ds_read_b64_tr_b16 v[30:31], v16 offset:18624
    v_mfma_f32_16x16x32_bf16 v[84:87], v[36:39], a[76:79], v[84:87]
    v_mfma_f32_16x16x32_bf16 v[88:91], v[40:43], a[72:75], v[88:91]
    ds_read_b64_tr_b16 v[32:33], v13 offset:26112
    ds_read_b64_tr_b16 v[34:35], v13 offset:27200
    v_mfma_f32_16x16x32_bf16 v[92:95], v[40:43], a[76:79], v[92:95]
    s_waitcnt lgkmcnt(6)
    v_mfma_f32_16x16x32_bf16 v[96:99], v[44:47], a[72:75], v[96:99]
    ds_read_b64_tr_b16 v[36:37], v14 offset:26112
    ds_read_b64_tr_b16 v[38:39], v14 offset:27200
    v_mfma_f32_16x16x32_bf16 v[100:103], v[44:47], a[76:79], v[100:103]
    v_mfma_f32_16x16x32_bf16 v[104:107], v[20:23], a[72:75], v[104:107]
    ds_read_b64_tr_b16 v[40:41], v15 offset:26112
    ds_read_b64_tr_b16 v[42:43], v15 offset:27200
    v_mfma_f32_16x16x32_bf16 v[108:111], v[20:23], a[76:79], v[108:111]
    s_waitcnt lgkmcnt(6)
    v_mfma_f32_16x16x32_bf16 v[112:115], v[24:27], a[72:75], v[112:115]
    ds_read_b64_tr_b16 v[44:45], v16 offset:26112
    ds_read_b64_tr_b16 v[46:47], v16 offset:27200
    v_mfma_f32_16x16x32_bf16 v[116:119], v[24:27], a[76:79], v[116:119]
    v_mfma_f32_16x16x32_bf16 v[120:123], v[28:31], a[72:75], v[120:123]
    ds_read_b64_tr_b16 v[20:21], v13 offset:26240
    ds_read_b64_tr_b16 v[22:23], v13 offset:27328
    v_mfma_f32_16x16x32_bf16 v[124:127], v[28:31], a[76:79], v[124:127]
    s_waitcnt vmcnt(6)
    s_waitcnt lgkmcnt(6)
    v_mfma_f32_16x16x32_bf16 v[64:67], v[32:35], a[80:83], v[64:67]
    ds_read_b64_tr_b16 v[24:25], v14 offset:26240
    ds_read_b64_tr_b16 v[26:27], v14 offset:27328
    v_mfma_f32_16x16x32_bf16 v[68:71], v[32:35], a[84:87], v[68:71]
    v_mfma_f32_16x16x32_bf16 v[72:75], v[36:39], a[80:83], v[72:75]
    ds_read_b64_tr_b16 v[28:29], v15 offset:26240
    ds_read_b64_tr_b16 v[30:31], v15 offset:27328
    v_mfma_f32_16x16x32_bf16 v[76:79], v[36:39], a[84:87], v[76:79]
    s_waitcnt lgkmcnt(6)
    v_mfma_f32_16x16x32_bf16 v[80:83], v[40:43], a[80:83], v[80:83]
    ds_read_b64_tr_b16 v[32:33], v16 offset:26240
    ds_read_b64_tr_b16 v[34:35], v16 offset:27328
    v_mfma_f32_16x16x32_bf16 v[84:87], v[40:43], a[84:87], v[84:87]
    v_mfma_f32_16x16x32_bf16 v[88:91], v[44:47], a[80:83], v[88:91]
    ds_read_b64_tr_b16 v[36:37], v13 offset:34816
    ds_read_b64_tr_b16 v[38:39], v13 offset:35904
    v_mfma_f32_16x16x32_bf16 v[92:95], v[44:47], a[84:87], v[92:95]
    s_waitcnt lgkmcnt(6)
    v_mfma_f32_16x16x32_bf16 v[96:99], v[20:23], a[80:83], v[96:99]
    ds_read_b64_tr_b16 v[40:41], v14 offset:34816
    ds_read_b64_tr_b16 v[42:43], v14 offset:35904
    v_mfma_f32_16x16x32_bf16 v[100:103], v[20:23], a[84:87], v[100:103]
    v_mfma_f32_16x16x32_bf16 v[104:107], v[24:27], a[80:83], v[104:107]
    ds_read_b64_tr_b16 v[44:45], v15 offset:34816
    ds_read_b64_tr_b16 v[46:47], v15 offset:35904
    v_mfma_f32_16x16x32_bf16 v[108:111], v[24:27], a[84:87], v[108:111]
    s_waitcnt lgkmcnt(6)
    v_mfma_f32_16x16x32_bf16 v[112:115], v[28:31], a[80:83], v[112:115]
    ds_read_b64_tr_b16 v[20:21], v16 offset:34816
    ds_read_b64_tr_b16 v[22:23], v16 offset:35904
    v_mfma_f32_16x16x32_bf16 v[116:119], v[28:31], a[84:87], v[116:119]
    v_mfma_f32_16x16x32_bf16 v[120:123], v[32:35], a[80:83], v[120:123]
    ds_read_b64_tr_b16 v[24:25], v13 offset:34944
    ds_read_b64_tr_b16 v[26:27], v13 offset:36032
    v_mfma_f32_16x16x32_bf16 v[124:127], v[32:35], a[84:87], v[124:127]
    s_waitcnt vmcnt(4)
    s_waitcnt lgkmcnt(6)
    v_mfma_f32_16x16x32_bf16 v[64:67], v[36:39], a[88:91], v[64:67]
    ds_read_b64_tr_b16 v[28:29], v14 offset:34944
    ds_read_b64_tr_b16 v[30:31], v14 offset:36032
    v_mfma_f32_16x16x32_bf16 v[68:71], v[36:39], a[92:95], v[68:71]
    v_mfma_f32_16x16x32_bf16 v[72:75], v[40:43], a[88:91], v[72:75]
    ds_read_b64_tr_b16 v[32:33], v15 offset:34944
    ds_read_b64_tr_b16 v[34:35], v15 offset:36032
    v_mfma_f32_16x16x32_bf16 v[76:79], v[40:43], a[92:95], v[76:79]
    s_waitcnt lgkmcnt(6)
    v_mfma_f32_16x16x32_bf16 v[80:83], v[44:47], a[88:91], v[80:83]
    ds_read_b64_tr_b16 v[36:37], v16 offset:34944
    ds_read_b64_tr_b16 v[38:39], v16 offset:36032
    v_mfma_f32_16x16x32_bf16 v[84:87], v[44:47], a[92:95], v[84:87]
    v_mfma_f32_16x16x32_bf16 v[88:91], v[20:23], a[88:91], v[88:91]
    ds_read_b64_tr_b16 v[40:41], v13 offset:43520
    ds_read_b64_tr_b16 v[42:43], v13 offset:44608
    v_mfma_f32_16x16x32_bf16 v[92:95], v[20:23], a[92:95], v[92:95]
    s_waitcnt lgkmcnt(6)
    v_mfma_f32_16x16x32_bf16 v[96:99], v[24:27], a[88:91], v[96:99]
    ds_read_b64_tr_b16 v[44:45], v14 offset:43520
    ds_read_b64_tr_b16 v[46:47], v14 offset:44608
    v_mfma_f32_16x16x32_bf16 v[100:103], v[24:27], a[92:95], v[100:103]
    v_mfma_f32_16x16x32_bf16 v[104:107], v[28:31], a[88:91], v[104:107]
    ds_read_b64_tr_b16 v[20:21], v15 offset:43520
    ds_read_b64_tr_b16 v[22:23], v15 offset:44608
    v_mfma_f32_16x16x32_bf16 v[108:111], v[28:31], a[92:95], v[108:111]
    s_waitcnt lgkmcnt(6)
    v_mfma_f32_16x16x32_bf16 v[112:115], v[32:35], a[88:91], v[112:115]
    ds_read_b64_tr_b16 v[24:25], v16 offset:43520
    ds_read_b64_tr_b16 v[26:27], v16 offset:44608
    v_mfma_f32_16x16x32_bf16 v[116:119], v[32:35], a[92:95], v[116:119]
    v_mfma_f32_16x16x32_bf16 v[120:123], v[36:39], a[88:91], v[120:123]
    ds_read_b64_tr_b16 v[28:29], v13 offset:43648
    ds_read_b64_tr_b16 v[30:31], v13 offset:44736
    v_mfma_f32_16x16x32_bf16 v[124:127], v[36:39], a[92:95], v[124:127]
    s_waitcnt vmcnt(2)
    s_waitcnt lgkmcnt(6)
    v_mfma_f32_16x16x32_bf16 v[64:67], v[40:43], a[96:99], v[64:67]
    ds_read_b64_tr_b16 v[32:33], v14 offset:43648
    ds_read_b64_tr_b16 v[34:35], v14 offset:44736
    v_mfma_f32_16x16x32_bf16 v[68:71], v[40:43], a[100:103], v[68:71]
    v_mfma_f32_16x16x32_bf16 v[72:75], v[44:47], a[96:99], v[72:75]
    ds_read_b64_tr_b16 v[36:37], v15 offset:43648
    ds_read_b64_tr_b16 v[38:39], v15 offset:44736
    v_mfma_f32_16x16x32_bf16 v[76:79], v[44:47], a[100:103], v[76:79]
    s_waitcnt lgkmcnt(6)
    v_mfma_f32_16x16x32_bf16 v[80:83], v[20:23], a[96:99], v[80:83]
    ds_read_b64_tr_b16 v[40:41], v16 offset:43648
    ds_read_b64_tr_b16 v[42:43], v16 offset:44736
    v_mfma_f32_16x16x32_bf16 v[84:87], v[20:23], a[100:103], v[84:87]
    v_mfma_f32_16x16x32_bf16 v[88:91], v[24:27], a[96:99], v[88:91]
    ds_read_b64_tr_b16 v[44:45], v13 offset:52224
    ds_read_b64_tr_b16 v[46:47], v13 offset:53312
    v_mfma_f32_16x16x32_bf16 v[92:95], v[24:27], a[100:103], v[92:95]
    s_waitcnt lgkmcnt(6)
    v_mfma_f32_16x16x32_bf16 v[96:99], v[28:31], a[96:99], v[96:99]
    ds_read_b64_tr_b16 v[20:21], v14 offset:52224
    ds_read_b64_tr_b16 v[22:23], v14 offset:53312
    v_mfma_f32_16x16x32_bf16 v[100:103], v[28:31], a[100:103], v[100:103]
    v_mfma_f32_16x16x32_bf16 v[104:107], v[32:35], a[96:99], v[104:107]
    ds_read_b64_tr_b16 v[24:25], v15 offset:52224
    ds_read_b64_tr_b16 v[26:27], v15 offset:53312
    v_mfma_f32_16x16x32_bf16 v[108:111], v[32:35], a[100:103], v[108:111]
    s_waitcnt lgkmcnt(6)
    v_mfma_f32_16x16x32_bf16 v[112:115], v[36:39], a[96:99], v[112:115]
    ds_read_b64_tr_b16 v[28:29], v16 offset:52224
    ds_read_b64_tr_b16 v[30:31], v16 offset:53312
    v_mfma_f32_16x16x32_bf16 v[116:119], v[36:39], a[100:103], v[116:119]
    v_mfma_f32_16x16x32_bf16 v[120:123], v[40:43], a[96:99], v[120:123]
    ds_read_b64_tr_b16 v[32:33], v13 offset:52352
    ds_read_b64_tr_b16 v[34:35], v13 offset:53440
    v_mfma_f32_16x16x32_bf16 v[124:127], v[40:43], a[100:103], v[124:127]
    s_waitcnt vmcnt(0)
    s_waitcnt lgkmcnt(6)
    v_mfma_f32_16x16x32_bf16 v[64:67], v[44:47], a[104:107], v[64:67]
    ds_read_b64_tr_b16 v[36:37], v14 offset:52352
    ds_read_b64_tr_b16 v[38:39], v14 offset:53440
    v_mfma_f32_16x16x32_bf16 v[68:71], v[44:47], a[108:111], v[68:71]
    v_mfma_f32_16x16x32_bf16 v[72:75], v[20:23], a[104:107], v[72:75]
    ds_read_b64_tr_b16 v[40:41], v15 offset:52352
    ds_read_b64_tr_b16 v[42:43], v15 offset:53440
    v_mfma_f32_16x16x32_bf16 v[76:79], v[20:23], a[108:111], v[76:79]
    s_waitcnt lgkmcnt(6)
    v_mfma_f32_16x16x32_bf16 v[80:83], v[24:27], a[104:107], v[80:83]
    ds_read_b64_tr_b16 v[44:45], v16 offset:52352
    ds_read_b64_tr_b16 v[46:47], v16 offset:53440
    v_mfma_f32_16x16x32_bf16 v[84:87], v[24:27], a[108:111], v[84:87]
    v_mfma_f32_16x16x32_bf16 v[88:91], v[28:31], a[104:107], v[88:91]
    v_mfma_f32_16x16x32_bf16 v[92:95], v[28:31], a[108:111], v[92:95]
    s_waitcnt lgkmcnt(4)
    v_mfma_f32_16x16x32_bf16 v[96:99], v[32:35], a[104:107], v[96:99]
    v_mfma_f32_16x16x32_bf16 v[100:103], v[32:35], a[108:111], v[100:103]
    v_mfma_f32_16x16x32_bf16 v[104:107], v[36:39], a[104:107], v[104:107]
    v_mfma_f32_16x16x32_bf16 v[108:111], v[36:39], a[108:111], v[108:111]
    s_waitcnt lgkmcnt(0)
    v_mfma_f32_16x16x32_bf16 v[112:115], v[40:43], a[104:107], v[112:115]
    v_mfma_f32_16x16x32_bf16 v[116:119], v[40:43], a[108:111], v[116:119]
    v_mfma_f32_16x16x32_bf16 v[120:123], v[44:47], a[104:107], v[120:123]
    v_mfma_f32_16x16x32_bf16 v[124:127], v[44:47], a[108:111], v[124:127]
    s_barrier
    s_nop 4
    v_pk_mul_f32 v[140:141], v[64:65], v[64:65]
    v_pk_mul_f32 v[142:143], v[66:67], v[66:67]
    v_pk_mul_f32 v[144:145], v[72:73], v[72:73]
    v_pk_mul_f32 v[146:147], v[74:75], v[74:75]
    v_pk_fma_f32 v[140:141], v[140:141], v[48:49], v[50:51]
    v_pk_fma_f32 v[142:143], v[142:143], v[48:49], v[50:51]
    v_pk_fma_f32 v[144:145], v[144:145], v[48:49], v[50:51]
    v_pk_fma_f32 v[146:147], v[146:147], v[48:49], v[50:51]
    v_pk_mul_f32 v[140:141], v[140:141], v[64:65]
    v_pk_mul_f32 v[142:143], v[142:143], v[66:67]
    v_pk_mul_f32 v[144:145], v[144:145], v[72:73]
    s_mov_b32 s33, 57344
    s_add_u32 m0, s39, 0
    s_nop 0
    buffer_load_dwordx4 v128, s[24:27], s33 offen offset:0 lds
    buffer_load_dwordx4 v129, s[24:27], s33 offen offset:1024 lds
    buffer_load_dwordx4 v130, s[24:27], s33 offen offset:2048 lds
    buffer_load_dwordx4 v131, s[24:27], s33 offen offset:3072 lds
    v_pk_mul_f32 v[146:147], v[146:147], v[74:75]
    v_exp_f32 v140, v140
    v_exp_f32 v141, v141
    v_exp_f32 v142, v142
    v_exp_f32 v143, v143
    v_exp_f32 v144, v144
    v_exp_f32 v145, v145
    v_exp_f32 v146, v146
    v_exp_f32 v147, v147
    v_pk_add_f32 v[140:141], v[140:141], v[52:53]
    v_pk_add_f32 v[142:143], v[142:143], v[52:53]
    v_pk_add_f32 v[144:145], v[144:145], v[52:53]
    v_pk_add_f32 v[146:147], v[146:147], v[52:53]
    v_rcp_f32 v140, v140
    v_rcp_f32 v141, v141
    v_rcp_f32 v142, v142
    v_rcp_f32 v143, v143
    v_rcp_f32 v144, v144
    v_rcp_f32 v145, v145
    v_rcp_f32 v146, v146
    v_rcp_f32 v147, v147
    v_pk_mul_f32 v[140:141], v[140:141], v[64:65]
    v_pk_mul_f32 v[142:143], v[142:143], v[66:67]
    v_pk_mul_f32 v[144:145], v[144:145], v[72:73]
    v_pk_mul_f32 v[146:147], v[146:147], v[74:75]
    v_cvt_pk_bf16_f32 v56, v140, v141
    v_cvt_pk_bf16_f32 v57, v142, v143
    v_cvt_pk_bf16_f32 v58, v144, v145
    v_cvt_pk_bf16_f32 v59, v146, v147
    buffer_store_dwordx4 v[56:59], v7, s[20:23], s15 offen offset:0 sc1
    s_mov_b32 s33, 86016
    s_add_u32 m0, s39, 16384
    s_nop 0
    buffer_load_dwordx4 v128, s[24:27], s33 offen offset:0 lds
    buffer_load_dwordx4 v129, s[24:27], s33 offen offset:1024 lds
    buffer_load_dwordx4 v130, s[24:27], s33 offen offset:2048 lds
    buffer_load_dwordx4 v131, s[24:27], s33 offen offset:3072 lds
    v_pk_mul_f32 v[148:149], v[68:69], v[68:69]
    v_pk_mul_f32 v[150:151], v[70:71], v[70:71]
    v_pk_mul_f32 v[152:153], v[76:77], v[76:77]
    v_pk_mul_f32 v[154:155], v[78:79], v[78:79]
    v_pk_fma_f32 v[148:149], v[148:149], v[48:49], v[50:51]
    v_pk_fma_f32 v[150:151], v[150:151], v[48:49], v[50:51]
    v_pk_fma_f32 v[152:153], v[152:153], v[48:49], v[50:51]
    v_pk_fma_f32 v[154:155], v[154:155], v[48:49], v[50:51]
    v_pk_mul_f32 v[148:149], v[148:149], v[68:69]
    v_pk_mul_f32 v[150:151], v[150:151], v[70:71]
    v_pk_mul_f32 v[152:153], v[152:153], v[76:77]
    v_pk_mul_f32 v[154:155], v[154:155], v[78:79]
    v_exp_f32 v148, v148
    v_exp_f32 v149, v149
    v_exp_f32 v150, v150
    v_exp_f32 v151, v151
    v_exp_f32 v152, v152
    v_exp_f32 v153, v153
    v_exp_f32 v154, v154
    v_exp_f32 v155, v155
    v_pk_add_f32 v[148:149], v[148:149], v[52:53]
    v_pk_add_f32 v[150:151], v[150:151], v[52:53]
    v_pk_add_f32 v[152:153], v[152:153], v[52:53]
    v_pk_add_f32 v[154:155], v[154:155], v[52:53]
    v_rcp_f32 v148, v148
    v_rcp_f32 v149, v149
    v_rcp_f32 v150, v150
    v_rcp_f32 v151, v151
    v_rcp_f32 v152, v152
    v_rcp_f32 v153, v153
    s_mov_b32 s33, 114688
    s_add_u32 m0, s39, 32768
    s_nop 0
    buffer_load_dwordx4 v128, s[24:27], s33 offen offset:0 lds
    buffer_load_dwordx4 v129, s[24:27], s33 offen offset:1024 lds
    buffer_load_dwordx4 v130, s[24:27], s33 offen offset:2048 lds
    buffer_load_dwordx4 v131, s[24:27], s33 offen offset:3072 lds
    v_rcp_f32 v154, v154
    v_rcp_f32 v155, v155
    v_pk_mul_f32 v[148:149], v[148:149], v[68:69]
    v_pk_mul_f32 v[150:151], v[150:151], v[70:71]
    v_pk_mul_f32 v[152:153], v[152:153], v[76:77]
    v_pk_mul_f32 v[154:155], v[154:155], v[78:79]
    v_cvt_pk_bf16_f32 v60, v148, v149
    v_cvt_pk_bf16_f32 v61, v150, v151
    v_cvt_pk_bf16_f32 v62, v152, v153
    v_cvt_pk_bf16_f32 v63, v154, v155
    buffer_store_dwordx4 v[60:63], v7, s[20:23], s14 offen offset:0 sc1
    v_pk_mul_f32 v[140:141], v[80:81], v[80:81]
    v_pk_mul_f32 v[142:143], v[82:83], v[82:83]
    v_pk_mul_f32 v[144:145], v[88:89], v[88:89]
    v_pk_mul_f32 v[146:147], v[90:91], v[90:91]
    v_pk_fma_f32 v[140:141], v[140:141], v[48:49], v[50:51]
    v_pk_fma_f32 v[142:143], v[142:143], v[48:49], v[50:51]
    v_pk_fma_f32 v[144:145], v[144:145], v[48:49], v[50:51]
    v_pk_fma_f32 v[146:147], v[146:147], v[48:49], v[50:51]
    v_pk_mul_f32 v[140:141], v[140:141], v[80:81]
    v_pk_mul_f32 v[142:143], v[142:143], v[82:83]
    v_pk_mul_f32 v[144:145], v[144:145], v[88:89]
    v_pk_mul_f32 v[146:147], v[146:147], v[90:91]
    v_exp_f32 v140, v140
    v_exp_f32 v141, v141
    v_exp_f32 v142, v142
    v_exp_f32 v143, v143
    v_exp_f32 v144, v144
    v_exp_f32 v145, v145
    v_exp_f32 v146, v146
    s_mov_b32 s33, 143360
    s_add_u32 m0, s39, 49152
    s_nop 0
    buffer_load_dwordx4 v128, s[24:27], s33 offen offset:0 lds
    buffer_load_dwordx4 v129, s[24:27], s33 offen offset:1024 lds
    buffer_load_dwordx4 v130, s[24:27], s33 offen offset:2048 lds
    buffer_load_dwordx4 v131, s[24:27], s33 offen offset:3072 lds
    v_exp_f32 v147, v147
    v_pk_add_f32 v[140:141], v[140:141], v[52:53]
    v_pk_add_f32 v[142:143], v[142:143], v[52:53]
    v_pk_add_f32 v[144:145], v[144:145], v[52:53]
    v_pk_add_f32 v[146:147], v[146:147], v[52:53]
    v_rcp_f32 v140, v140
    v_rcp_f32 v141, v141
    v_rcp_f32 v142, v142
    v_rcp_f32 v143, v143
    v_rcp_f32 v144, v144
    v_rcp_f32 v145, v145
    v_rcp_f32 v146, v146
    v_rcp_f32 v147, v147
    v_pk_mul_f32 v[140:141], v[140:141], v[80:81]
    v_pk_mul_f32 v[142:143], v[142:143], v[82:83]
    v_pk_mul_f32 v[144:145], v[144:145], v[88:89]
    v_pk_mul_f32 v[146:147], v[146:147], v[90:91]
    v_cvt_pk_bf16_f32 v56, v140, v141
    v_cvt_pk_bf16_f32 v57, v142, v143
    v_cvt_pk_bf16_f32 v58, v144, v145
    v_cvt_pk_bf16_f32 v59, v146, v147
    buffer_store_dwordx4 v[56:59], v7, s[20:23], s15 offen offset:1024 sc1
    v_pk_mul_f32 v[148:149], v[84:85], v[84:85]
    v_pk_mul_f32 v[150:151], v[86:87], v[86:87]
    v_pk_mul_f32 v[152:153], v[92:93], v[92:93]
    v_pk_mul_f32 v[154:155], v[94:95], v[94:95]
    v_pk_fma_f32 v[148:149], v[148:149], v[48:49], v[50:51]
    v_pk_fma_f32 v[150:151], v[150:151], v[48:49], v[50:51]
    v_pk_fma_f32 v[152:153], v[152:153], v[48:49], v[50:51]
    v_pk_fma_f32 v[154:155], v[154:155], v[48:49], v[50:51]
    s_mov_b32 s33, 172032
    s_add_u32 m0, s39, 65536
    s_nop 0
    buffer_load_dwordx4 v128, s[24:27], s33 offen offset:0 lds
    buffer_load_dwordx4 v129, s[24:27], s33 offen offset:1024 lds
    buffer_load_dwordx4 v130, s[24:27], s33 offen offset:2048 lds
    buffer_load_dwordx4 v131, s[24:27], s33 offen offset:3072 lds
    v_pk_mul_f32 v[148:149], v[148:149], v[84:85]
    v_pk_mul_f32 v[150:151], v[150:151], v[86:87]
    v_pk_mul_f32 v[152:153], v[152:153], v[92:93]
    v_pk_mul_f32 v[154:155], v[154:155], v[94:95]
    v_exp_f32 v148, v148
    v_exp_f32 v149, v149
    v_exp_f32 v150, v150
    v_exp_f32 v151, v151
    v_exp_f32 v152, v152
    v_exp_f32 v153, v153
    v_exp_f32 v154, v154
    v_exp_f32 v155, v155
    v_pk_add_f32 v[148:149], v[148:149], v[52:53]
    v_pk_add_f32 v[150:151], v[150:151], v[52:53]
    v_pk_add_f32 v[152:153], v[152:153], v[52:53]
    v_pk_add_f32 v[154:155], v[154:155], v[52:53]
    v_rcp_f32 v148, v148
    v_rcp_f32 v149, v149
    v_rcp_f32 v150, v150
    v_rcp_f32 v151, v151
    v_rcp_f32 v152, v152
    v_rcp_f32 v153, v153
    v_rcp_f32 v154, v154
    v_rcp_f32 v155, v155
    v_pk_mul_f32 v[148:149], v[148:149], v[84:85]
    v_pk_mul_f32 v[150:151], v[150:151], v[86:87]
    v_pk_mul_f32 v[152:153], v[152:153], v[92:93]
    v_pk_mul_f32 v[154:155], v[154:155], v[94:95]
    v_cvt_pk_bf16_f32 v60, v148, v149
    v_cvt_pk_bf16_f32 v61, v150, v151
    s_mov_b32 s33, 200704
    s_add_u32 m0, s39, 81920
    s_nop 0
    buffer_load_dwordx4 v128, s[24:27], s33 offen offset:0 lds
    buffer_load_dwordx4 v129, s[24:27], s33 offen offset:1024 lds
    buffer_load_dwordx4 v130, s[24:27], s33 offen offset:2048 lds
    buffer_load_dwordx4 v131, s[24:27], s33 offen offset:3072 lds
    v_cvt_pk_bf16_f32 v62, v152, v153
    v_cvt_pk_bf16_f32 v63, v154, v155
    buffer_store_dwordx4 v[60:63], v7, s[20:23], s14 offen offset:1024 sc1
    v_pk_mul_f32 v[140:141], v[96:97], v[96:97]
    v_pk_mul_f32 v[142:143], v[98:99], v[98:99]
    v_pk_mul_f32 v[144:145], v[104:105], v[104:105]
    v_pk_mul_f32 v[146:147], v[106:107], v[106:107]
    v_pk_fma_f32 v[140:141], v[140:141], v[48:49], v[50:51]
    v_pk_fma_f32 v[142:143], v[142:143], v[48:49], v[50:51]
    v_pk_fma_f32 v[144:145], v[144:145], v[48:49], v[50:51]
    v_pk_fma_f32 v[146:147], v[146:147], v[48:49], v[50:51]
    v_pk_mul_f32 v[140:141], v[140:141], v[96:97]
    v_pk_mul_f32 v[142:143], v[142:143], v[98:99]
    v_pk_mul_f32 v[144:145], v[144:145], v[104:105]
    v_pk_mul_f32 v[146:147], v[146:147], v[106:107]
    v_exp_f32 v140, v140
    v_exp_f32 v141, v141
    v_exp_f32 v142, v142
    v_exp_f32 v143, v143
    v_exp_f32 v144, v144
    v_exp_f32 v145, v145
    v_exp_f32 v146, v146
    v_exp_f32 v147, v147
    v_pk_add_f32 v[140:141], v[140:141], v[52:53]
    v_pk_add_f32 v[142:143], v[142:143], v[52:53]
    v_pk_add_f32 v[144:145], v[144:145], v[52:53]
    v_pk_add_f32 v[146:147], v[146:147], v[52:53]
    v_rcp_f32 v140, v140
    v_rcp_f32 v141, v141
    v_rcp_f32 v142, v142
    s_mov_b32 s33, 229376
    s_add_u32 m0, s39, 98304
    s_nop 0
    buffer_load_dwordx4 v128, s[24:27], s33 offen offset:0 lds
    buffer_load_dwordx4 v129, s[24:27], s33 offen offset:1024 lds
    buffer_load_dwordx4 v130, s[24:27], s33 offen offset:2048 lds
    buffer_load_dwordx4 v131, s[24:27], s33 offen offset:3072 lds
    v_rcp_f32 v143, v143
    v_rcp_f32 v144, v144
    v_rcp_f32 v145, v145
    v_rcp_f32 v146, v146
    v_rcp_f32 v147, v147
    v_pk_mul_f32 v[140:141], v[140:141], v[96:97]
    v_pk_mul_f32 v[142:143], v[142:143], v[98:99]
    v_pk_mul_f32 v[144:145], v[144:145], v[104:105]
    v_pk_mul_f32 v[146:147], v[146:147], v[106:107]
    v_cvt_pk_bf16_f32 v56, v140, v141
    v_cvt_pk_bf16_f32 v57, v142, v143
    v_cvt_pk_bf16_f32 v58, v144, v145
    v_cvt_pk_bf16_f32 v59, v146, v147
    buffer_store_dwordx4 v[56:59], v7, s[20:23], s15 offen offset:2048 sc1
    v_pk_mul_f32 v[148:149], v[100:101], v[100:101]
    v_pk_mul_f32 v[150:151], v[102:103], v[102:103]
    v_pk_mul_f32 v[152:153], v[108:109], v[108:109]
    v_pk_mul_f32 v[154:155], v[110:111], v[110:111]
    v_pk_fma_f32 v[148:149], v[148:149], v[48:49], v[50:51]
    v_pk_fma_f32 v[150:151], v[150:151], v[48:49], v[50:51]
    v_pk_fma_f32 v[152:153], v[152:153], v[48:49], v[50:51]
    v_pk_fma_f32 v[154:155], v[154:155], v[48:49], v[50:51]
    v_pk_mul_f32 v[148:149], v[148:149], v[100:101]
    v_pk_mul_f32 v[150:151], v[150:151], v[102:103]
    v_pk_mul_f32 v[152:153], v[152:153], v[108:109]
    v_pk_mul_f32 v[154:155], v[154:155], v[110:111]
    v_exp_f32 v148, v148
    v_exp_f32 v149, v149
    v_exp_f32 v150, v150
    v_exp_f32 v151, v151
    v_exp_f32 v152, v152
    v_exp_f32 v153, v153
    v_exp_f32 v154, v154
    v_exp_f32 v155, v155
    v_pk_add_f32 v[148:149], v[148:149], v[52:53]
    v_pk_add_f32 v[150:151], v[150:151], v[52:53]
    v_pk_add_f32 v[152:153], v[152:153], v[52:53]
    v_pk_add_f32 v[154:155], v[154:155], v[52:53]
    v_rcp_f32 v148, v148
    v_rcp_f32 v149, v149
    v_rcp_f32 v150, v150
    v_rcp_f32 v151, v151
    v_rcp_f32 v152, v152
    v_rcp_f32 v153, v153
    v_rcp_f32 v154, v154
    v_rcp_f32 v155, v155
    v_pk_mul_f32 v[148:149], v[148:149], v[100:101]
    v_pk_mul_f32 v[150:151], v[150:151], v[102:103]
    v_pk_mul_f32 v[152:153], v[152:153], v[108:109]
    v_pk_mul_f32 v[154:155], v[154:155], v[110:111]
    v_cvt_pk_bf16_f32 v60, v148, v149
    v_cvt_pk_bf16_f32 v61, v150, v151
    v_cvt_pk_bf16_f32 v62, v152, v153
    v_cvt_pk_bf16_f32 v63, v154, v155
    buffer_store_dwordx4 v[60:63], v7, s[20:23], s14 offen offset:2048 sc1
    v_pk_mul_f32 v[140:141], v[112:113], v[112:113]
    v_pk_mul_f32 v[142:143], v[114:115], v[114:115]
    v_pk_mul_f32 v[144:145], v[120:121], v[120:121]
    v_pk_mul_f32 v[146:147], v[122:123], v[122:123]
    v_pk_fma_f32 v[140:141], v[140:141], v[48:49], v[50:51]
    v_pk_fma_f32 v[142:143], v[142:143], v[48:49], v[50:51]
    v_pk_fma_f32 v[144:145], v[144:145], v[48:49], v[50:51]
    v_pk_fma_f32 v[146:147], v[146:147], v[48:49], v[50:51]
    v_pk_mul_f32 v[140:141], v[140:141], v[112:113]
    v_pk_mul_f32 v[142:143], v[142:143], v[114:115]
    v_pk_mul_f32 v[144:145], v[144:145], v[120:121]
    v_pk_mul_f32 v[146:147], v[146:147], v[122:123]
    v_exp_f32 v140, v140
    v_exp_f32 v141, v141
    v_exp_f32 v142, v142
    v_exp_f32 v143, v143
    v_exp_f32 v144, v144
    v_exp_f32 v145, v145
    v_exp_f32 v146, v146
    v_exp_f32 v147, v147
    v_pk_add_f32 v[140:141], v[140:141], v[52:53]
    v_pk_add_f32 v[142:143], v[142:143], v[52:53]
    v_pk_add_f32 v[144:145], v[144:145], v[52:53]
    v_pk_add_f32 v[146:147], v[146:147], v[52:53]
    v_rcp_f32 v140, v140
    v_rcp_f32 v141, v141
    v_rcp_f32 v142, v142
    v_rcp_f32 v143, v143
    v_rcp_f32 v144, v144
    v_rcp_f32 v145, v145
    v_rcp_f32 v146, v146
    v_rcp_f32 v147, v147
    v_pk_mul_f32 v[140:141], v[140:141], v[112:113]
    v_pk_mul_f32 v[142:143], v[142:143], v[114:115]
    v_pk_mul_f32 v[144:145], v[144:145], v[120:121]
    v_pk_mul_f32 v[146:147], v[146:147], v[122:123]
    v_cvt_pk_bf16_f32 v56, v140, v141
    v_cvt_pk_bf16_f32 v57, v142, v143
    v_cvt_pk_bf16_f32 v58, v144, v145
    v_cvt_pk_bf16_f32 v59, v146, v147
    buffer_store_dwordx4 v[56:59], v7, s[20:23], s15 offen offset:3072 sc1
    v_pk_mul_f32 v[148:149], v[116:117], v[116:117]
    v_pk_mul_f32 v[150:151], v[118:119], v[118:119]
    v_pk_mul_f32 v[152:153], v[124:125], v[124:125]
    v_pk_mul_f32 v[154:155], v[126:127], v[126:127]
    v_pk_fma_f32 v[148:149], v[148:149], v[48:49], v[50:51]
    v_pk_fma_f32 v[150:151], v[150:151], v[48:49], v[50:51]
    v_pk_fma_f32 v[152:153], v[152:153], v[48:49], v[50:51]
    v_pk_fma_f32 v[154:155], v[154:155], v[48:49], v[50:51]
    v_pk_mul_f32 v[148:149], v[148:149], v[116:117]
    v_pk_mul_f32 v[150:151], v[150:151], v[118:119]
    v_pk_mul_f32 v[152:153], v[152:153], v[124:125]
    v_pk_mul_f32 v[154:155], v[154:155], v[126:127]
    v_exp_f32 v148, v148
    v_exp_f32 v149, v149
    v_exp_f32 v150, v150
    v_exp_f32 v151, v151
    v_exp_f32 v152, v152
    v_exp_f32 v153, v153
    v_exp_f32 v154, v154
    v_exp_f32 v155, v155
    v_pk_add_f32 v[148:149], v[148:149], v[52:53]
    v_pk_add_f32 v[150:151], v[150:151], v[52:53]
    v_pk_add_f32 v[152:153], v[152:153], v[52:53]
    v_pk_add_f32 v[154:155], v[154:155], v[52:53]
    v_rcp_f32 v148, v148
    v_rcp_f32 v149, v149
    v_rcp_f32 v150, v150
    v_rcp_f32 v151, v151
    v_rcp_f32 v152, v152
    v_rcp_f32 v153, v153
    v_rcp_f32 v154, v154
    v_rcp_f32 v155, v155
    v_pk_mul_f32 v[148:149], v[148:149], v[116:117]
    v_pk_mul_f32 v[150:151], v[150:151], v[118:119]
    v_pk_mul_f32 v[152:153], v[152:153], v[124:125]
    v_pk_mul_f32 v[154:155], v[154:155], v[126:127]
    v_cvt_pk_bf16_f32 v60, v148, v149
    v_cvt_pk_bf16_f32 v61, v150, v151
    v_cvt_pk_bf16_f32 v62, v152, v153
    v_cvt_pk_bf16_f32 v63, v154, v155
    buffer_store_dwordx4 v[60:63], v7, s[20:23], s14 offen offset:3072 sc1
    s_lshl_b32 s8, s34, 7
    s_lshl_b32 s10, s29, 2
    s_add_u32 s8, s8, s10
    s_add_u32 s8, s8, 133120
    s_waitcnt vmcnt(0)
    s_barrier
    s_cmp_lg_u32 s3, 0
    s_cbranch_scc1 KT_sig2
    v_mov_b32 v18, 1
    v_mov_b32 v19, 0
    s_mov_b64 exec, 1
    buffer_store_dword v18, v19, s[20:23], s8 offen sc1
    s_mov_b64 exec, -1
KT_sig2:
    s_mov_b32 s16, s58
    s_mov_b32 s17, s59
    s_mov_b32 s18, 0x380
    s_mov_b32 s19, 0x20000
    s_mov_b32 s40, s50
    s_mov_b32 s41, s51
    s_mov_b32 s42, 0x1c0000
    s_mov_b32 s43, 0x20000
    v_and_b32 v5, 1, v2
    v_lshl_add_u32 v5, v5, 2, v3
    v_lshrrev_b32 v8, 1, v5
    v_lshlrev_b32 v5, 7, v5
    v_lshrrev_b32 v6, 1, v2
    v_lshl_add_u32 v5, v6, 10, v5
    v_lshl_add_u32 v5, v4, 3, v5
    v_add_u32 v5, s39, v5
    v_xor_b32 v6, 0, v8
    v_lshl_add_u32 v9, v6, 5, v5
    v_add_u32 v156, 65536, v9
    v_add_u32 v160, 131072, v9
    v_xor_b32 v6, 1, v8
    v_lshl_add_u32 v10, v6, 5, v5
    v_add_u32 v157, 65536, v10
    v_add_u32 v161, 131072, v10
    v_xor_b32 v6, 2, v8
    v_lshl_add_u32 v11, v6, 5, v5
    v_add_u32 v158, 65536, v11
    v_add_u32 v162, 131072, v11
    v_xor_b32 v6, 3, v8
    v_lshl_add_u32 v12, v6, 5, v5
    v_add_u32 v159, 65536, v12
    v_add_u32 v163, 131072, v12
    s_lshl_b32 s35, s4, 4
    s_lshl_b32 s10, s36, 2
    s_add_u32 s35, s35, s10
    s_mul_i32 s15, s35, 57344
    s_mul_i32 s10, s3, 14336
    s_add_u32 s15, s15, s10
    s_add_u32 s15, s15, 29360128
    s_add_u32 s60, s15, 0
    s_add_u32 s61, s15, 57344
    s_add_u32 s62, s15, 114688
    s_add_u32 s63, s15, 172032
    v_lshlrev_b32 v6, 4, v2
    s_lshl_b32 s10, s37, 8
    s_add_u32 s10, s10, 8960
    v_lshlrev_b32 v8, 3, v2
    buffer_load_dwordx4 v[140:143], v6, s[20:23], s10 offen offset:0 sc1
    buffer_load_dwordx2 v[56:57], v8, s[16:19], s38 offen offset:0
    buffer_load_dwordx4 v[144:147], v6, s[20:23], s10 offen offset:64 sc1
    buffer_load_dwordx2 v[58:59], v8, s[16:19], s38 offen offset:32
    buffer_load_dwordx4 v[148:151], v6, s[20:23], s10 offen offset:128 sc1
    buffer_load_dwordx2 v[60:61], v8, s[16:19], s38 offen offset:64
    buffer_load_dwordx4 v[152:155], v6, s[20:23], s10 offen offset:192 sc1
    buffer_load_dwordx2 v[62:63], v8, s[16:19], s38 offen offset:96
    s_add_u32 s29, s35, s3
    s_lshr_b32 s30, s29, 1
    s_mul_i32 s30, s30, 28672
    s_lshl_b32 s10, s37, 12
    s_add_u32 s30, s30, s10
    s_and_b32 s10, s29, 1
    s_lshl_b32 s10, s10, 3
    s_add_u32 s30, s30, s10
    s_add_u32 s30, s30, 20971520
    s_lshl_b32 s8, s4, 1
    s_lshr_b32 s10, s36, 1
    s_add_u32 s8, s8, s10
    s_lshl_b32 s8, s8, 7
    s_add_u32 s8, s8, 133120
    s_cmp_lg_u32 s3, 0
    s_cbranch_scc1 KT_go2
    v_min_u32 v19, 13, v1
    v_lshlrev_b32 v19, 2, v19
    s_mov_b32 s46, 0x40000
KT_poll2:
    buffer_load_dword v18, v19, s[20:23], s8 offen sc1
    s_waitcnt vmcnt(0)
    v_cmp_ne_u32 vcc, 0, v18
    s_nop 1
    s_and_b32 s47, vcc_lo, 0x3fff
    s_cmp_eq_u32 s47, 0x3fff
    s_cbranch_scc1 KT_got2
    s_sleep 1
    s_sub_u32 s46, s46, 1
    s_cmp_lg_u32 s46, 0
    s_cbranch_scc1 KT_poll2
KT_got2:
KT_go2:
    s_barrier
    buffer_load_dwordx4 a[0:3], v7, s[20:23], s60 offen offset:0 sc1
    buffer_load_dwordx4 a[4:7], v7, s[20:23], s61 offen offset:0 sc1
    buffer_load_dwordx4 a[8:11], v7, s[20:23], s62 offen offset:0 sc1
    buffer_load_dwordx4 a[12:15], v7, s[20:23], s63 offen offset:0 sc1
    buffer_load_dwordx4 a[16:19], v7, s[20:23], s60 offen offset:1024 sc1
    buffer_load_dwordx4 a[20:23], v7, s[20:23], s61 offen offset:1024 sc1
    buffer_load_dwordx4 a[24:27], v7, s[20:23], s62 offen offset:1024 sc1
    buffer_load_dwordx4 a[28:31], v7, s[20:23], s63 offen offset:1024 sc1
    buffer_load_dwordx4 a[32:35], v7, s[20:23], s60 offen offset:2048 sc1
    buffer_load_dwordx4 a[36:39], v7, s[20:23], s61 offen offset:2048 sc1
    buffer_load_dwordx4 a[40:43], v7, s[20:23], s62 offen offset:2048 sc1
    buffer_load_dwordx4 a[44:47], v7, s[20:23], s63 offen offset:2048 sc1
    buffer_load_dwordx4 a[48:51], v7, s[20:23], s60 offen offset:3072 sc1
    buffer_load_dwordx4 a[52:55], v7, s[20:23], s61 offen offset:3072 sc1
    buffer_load_dwordx4 a[56:59], v7, s[20:23], s62 offen offset:3072 sc1
    buffer_load_dwordx4 a[60:63], v7, s[20:23], s63 offen offset:3072 sc1
    buffer_load_dwordx4 a[64:67], v132, s[20:23], s60 offen offset:0 sc1
    buffer_load_dwordx4 a[68:71], v132, s[20:23], s61 offen offset:0 sc1
    buffer_load_dwordx4 a[72:75], v132, s[20:23], s62 offen offset:0 sc1
    buffer_load_dwordx4 a[76:79], v132, s[20:23], s63 offen offset:0 sc1
    buffer_load_dwordx4 a[80:83], v132, s[20:23], s60 offen offset:1024 sc1
    buffer_load_dwordx4 a[84:87], v132, s[20:23], s61 offen offset:1024 sc1
    buffer_load_dwordx4 a[88:91], v132, s[20:23], s62 offen offset:1024 sc1
    buffer_load_dwordx4 a[92:95], v132, s[20:23], s63 offen offset:1024 sc1
    ds_read_b64_tr_b16 v[20:21], v160 offset:0
    ds_read_b64_tr_b16 v[22:23], v160 offset:2048
    ds_read_b64_tr_b16 v[24:25], v161 offset:0
    ds_read_b64_tr_b16 v[26:27], v161 offset:2048
    ds_read_b64_tr_b16 v[28:29], v162 offset:0
    ds_read_b64_tr_b16 v[30:31], v162 offset:2048
    ds_read_b64_tr_b16 v[32:33], v163 offset:0
    ds_read_b64_tr_b16 v[34:35], v163 offset:2048
    ds_read_b64_tr_b16 v[36:37], v160 offset:16384
    ds_read_b64_tr_b16 v[38:39], v160 offset:18432
    s_waitcnt vmcnt(20)
    s_waitcnt lgkmcnt(6)
    v_mfma_f32_16x16x32_bf16 v[64:67], v[20:23], a[0:3], 0
    ds_read_b64_tr_b16 v[40:41], v161 offset:16384
    ds_read_b64_tr_b16 v[42:43], v161 offset:18432
    v_mfma_f32_16x16x32_bf16 v[80:83], v[20:23], a[4:7], 0
    buffer_load_dwordx4 a[96:99], v132, s[20:23], s60 offen offset:2048 sc1
    v_mfma_f32_16x16x32_bf16 v[96:99], v[20:23], a[8:11], 0
    buffer_load_dwordx4 a[100:103], v132, s[20:23], s61 offen offset:2048 sc1
    v_mfma_f32_16x16x32_bf16 v[112:115], v[20:23], a[12:15], 0
    v_mfma_f32_16x16x32_bf16 v[68:71], v[24:27], a[0:3], 0
    ds_read_b64_tr_b16 v[44:45], v162 offset:16384
    ds_read_b64_tr_b16 v[46:47], v162 offset:18432
    v_mfma_f32_16x16x32_bf16 v[84:87], v[24:27], a[4:7], 0
    buffer_load_dwordx4 a[104:107], v132, s[20:23], s62 offen offset:2048 sc1
    v_mfma_f32_16x16x32_bf16 v[100:103], v[24:27], a[8:11], 0
    buffer_load_dwordx4 a[108:111], v132, s[20:23], s63 offen offset:2048 sc1
    v_mfma_f32_16x16x32_bf16 v[116:119], v[24:27], a[12:15], 0
    s_waitcnt lgkmcnt(6)
    v_mfma_f32_16x16x32_bf16 v[72:75], v[28:31], a[0:3], 0
    ds_read_b64_tr_b16 v[20:21], v163 offset:16384
    ds_read_b64_tr_b16 v[22:23], v163 offset:18432
    v_mfma_f32_16x16x32_bf16 v[88:91], v[28:31], a[4:7], 0
    v_mfma_f32_16x16x32_bf16 v[104:107], v[28:31], a[8:11], 0
    v_mfma_f32_16x16x32_bf16 v[120:123], v[28:31], a[12:15], 0
    v_mfma_f32_16x16x32_bf16 v[76:79], v[32:35], a[0:3], 0
    ds_read_b64_tr_b16 v[24:25], v9 offset:0
    ds_read_b64_tr_b16 v[26:27], v9 offset:2048
    v_mfma_f32_16x16x32_bf16 v[92:95], v[32:35], a[4:7], 0
    v_mfma_f32_16x16x32_bf16 v[108:111], v[32:35], a[8:11], 0
    v_mfma_f32_16x16x32_bf16 v[124:127], v[32:35], a[12:15], 0
    s_waitcnt vmcnt(20)
    s_waitcnt lgkmcnt(6)
    v_mfma_f32_16x16x32_bf16 v[64:67], v[36:39], a[16:19], v[64:67]
    ds_read_b64_tr_b16 v[28:29], v10 offset:0
    ds_read_b64_tr_b16 v[30:31], v10 offset:2048
    v_mfma_f32_16x16x32_bf16 v[80:83], v[36:39], a[20:23], v[80:83]
    buffer_load_dwordx4 a[112:115], v132, s[20:23], s60 offen offset:3072 sc1
    v_mfma_f32_16x16x32_bf16 v[96:99], v[36:39], a[24:27], v[96:99]
    buffer_load_dwordx4 a[116:119], v132, s[20:23], s61 offen offset:3072 sc1
    v_mfma_f32_16x16x32_bf16 v[112:115], v[36:39], a[28:31], v[112:115]
    v_mfma_f32_16x16x32_bf16 v[68:71], v[40:43], a[16:19], v[68:71]
    ds_read_b64_tr_b16 v[32:33], v11 offset:0
    ds_read_b64_tr_b16 v[34:35], v11 offset:2048
    v_mfma_f32_16x16x32_bf16 v[84:87], v[40:43], a[20:23], v[84:87]
    buffer_load_dwordx4 a[120:123], v132, s[20:23], s62 offen offset:3072 sc1
    v_mfma_f32_16x16x32_bf16 v[100:103], v[40:43], a[24:27], v[100:103]
    buffer_load_dwordx4 a[124:127], v132, s[20:23], s63 offen offset:3072 sc1
    v_mfma_f32_16x16x32_bf16 v[116:119], v[40:43], a[28:31], v[116:119]
    s_waitcnt lgkmcnt(6)
    v_mfma_f32_16x16x32_bf16 v[72:75], v[44:47], a[16:19], v[72:75]
    ds_read_b64_tr_b16 v[36:37], v12 offset:0
    ds_read_b64_tr_b16 v[38:39], v12 offset:2048
    v_mfma_f32_16x16x32_bf16 v[88:91], v[44:47], a[20:23], v[88:91]
    v_mfma_f32_16x16x32_bf16 v[104:107], v[44:47], a[24:27], v[104:107]
    v_mfma_f32_16x16x32_bf16 v[120:123], v[44:47], a[28:31], v[120:123]
    v_mfma_f32_16x16x32_bf16 v[76:79], v[20:23], a[16:19], v[76:79]
    ds_read_b64_tr_b16 v[40:41], v9 offset:16384
    ds_read_b64_tr_b16 v[42:43], v9 offset:18432
    v_mfma_f32_16x16x32_bf16 v[92:95], v[20:23], a[20:23], v[92:95]
    v_mfma_f32_16x16x32_bf16 v[108:111], v[20:23], a[24:27], v[108:111]
    v_mfma_f32_16x16x32_bf16 v[124:127], v[20:23], a[28:31], v[124:127]
    s_waitcnt vmcnt(20)
    s_waitcnt lgkmcnt(6)
    v_mfma_f32_16x16x32_bf16 v[64:67], v[24:27], a[32:35], v[64:67]
    ds_read_b64_tr_b16 v[44:45], v10 offset:16384
    ds_read_b64_tr_b16 v[46:47], v10 offset:18432
    v_mfma_f32_16x16x32_bf16 v[80:83], v[24:27], a[36:39], v[80:83]
    buffer_load_dwordx4 a[128:131], v133, s[20:23], s60 offen offset:0 sc1
    v_mfma_f32_16x16x32_bf16 v[96:99], v[24:27], a[40:43], v[96:99]
    buffer_load_dwordx4 a[132:135], v133, s[20:23], s61 offen offset:0 sc1
    v_mfma_f32_16x16x32_bf16 v[112:115], v[24:27], a[44:47], v[112:115]
    v_mfma_f32_16x16x32_bf16 v[68:71], v[28:31], a[32:35], v[68:71]
    ds_read_b64_tr_b16 v[20:21], v11 offset:16384
    ds_read_b64_tr_b16 v[22:23], v11 offset:18432
    v_mfma_f32_16x16x32_bf16 v[84:87], v[28:31], a[36:39], v[84:87]
    buffer_load_dwordx4 a[136:139], v133, s[20:23], s62 offen offset:0 sc1
    v_mfma_f32_16x16x32_bf16 v[100:103], v[28:31], a[40:43], v[100:103]
    buffer_load_dwordx4 a[140:143], v133, s[20:23], s63 offen offset:0 sc1
    v_mfma_f32_16x16x32_bf16 v[116:119], v[28:31], a[44:47], v[116:119]
    s_waitcnt lgkmcnt(6)
    v_mfma_f32_16x16x32_bf16 v[72:75], v[32:35], a[32:35], v[72:75]
    ds_read_b64_tr_b16 v[24:25], v12 offset:16384
    ds_read_b64_tr_b16 v[26:27], v12 offset:18432
    v_mfma_f32_16x16x32_bf16 v[88:91], v[32:35], a[36:39], v[88:91]
    v_mfma_f32_16x16x32_bf16 v[104:107], v[32:35], a[40:43], v[104:107]
    v_mfma_f32_16x16x32_bf16 v[120:123], v[32:35], a[44:47], v[120:123]
    v_mfma_f32_16x16x32_bf16 v[76:79], v[36:39], a[32:35], v[76:79]
    ds_read_b64_tr_b16 v[28:29], v9 offset:32768
    ds_read_b64_tr_b16 v[30:31], v9 offset:34816
    v_mfma_f32_16x16x32_bf16 v[92:95], v[36:39], a[36:39], v[92:95]
    v_mfma_f32_16x16x32_bf16 v[108:111], v[36:39], a[40:43], v[108:111]
    v_mfma_f32_16x16x32_bf16 v[124:127], v[36:39], a[44:47], v[124:127]
    s_waitcnt vmcnt(20)
    s_waitcnt lgkmcnt(6)
    v_mfma_f32_16x16x32_bf16 v[64:67], v[40:43], a[48:51], v[64:67]
    ds_read_b64_tr_b16 v[32:33], v10 offset:32768
    ds_read_b64_tr_b16 v[34:35], v10 offset:34816
    v_mfma_f32_16x16x32_bf16 v[80:83], v[40:43], a[52:55], v[80:83]
    buffer_load_dwordx4 a[144:147], v133, s[20:23], s60 offen offset:1024 sc1
    v_mfma_f32_16x16x32_bf16 v[96:99], v[40:43], a[56:59], v[96:99]
    buffer_load_dwordx4 a[148:151], v133, s[20:23], s61 offen offset:1024 sc1
    v_mfma_f32_16x16x32_bf16 v[112:115], v[40:43], a[60:63], v[112:115]
    v_mfma_f32_16x16x32_bf16 v[68:71], v[44:47], a[48:51], v[68:71]
    ds_read_b64_tr_b16 v[36:37], v11 offset:32768
    ds_read_b64_tr_b16 v[38:39], v11 offset:34816
    v_mfma_f32_16x16x32_bf16 v[84:87], v[44:47], a[52:55], v[84:87]
    buffer_load_dwordx4 a[152:155], v133, s[20:23], s62 offen offset:1024 sc1
    v_mfma_f32_16x16x32_bf16 v[100:103], v[44:47], a[56:59], v[100:103]
    buffer_load_dwordx4 a[156:159], v133, s[20:23], s63 offen offset:1024 sc1
    v_mfma_f32_16x16x32_bf16 v[116:119], v[44:47], a[60:63], v[116:119]
    s_waitcnt lgkmcnt(6)
    v_mfma_f32_16x16x32_bf16 v[72:75], v[20:23], a[48:51], v[72:75]
    ds_read_b64_tr_b16 v[40:41], v12 offset:32768
    ds_read_b64_tr_b16 v[42:43], v12 offset:34816
    v_mfma_f32_16x16x32_bf16 v[88:91], v[20:23], a[52:55], v[88:91]
    s_mov_b32 s33, 258048
    s_add_u32 m0, s39, 114688
    v_mfma_f32_16x16x32_bf16 v[104:107], v[20:23], a[56:59], v[104:107]
    buffer_load_dwordx4 v128, s[24:27], s33 offen offset:0 lds
    v_mfma_f32_16x16x32_bf16 v[120:123], v[20:23], a[60:63], v[120:123]
    buffer_load_dwordx4 v129, s[24:27], s33 offen offset:1024 lds
    v_mfma_f32_16x16x32_bf16 v[76:79], v[24:27], a[48:51], v[76:79]
    ds_read_b64_tr_b16 v[44:45], v9 offset:49152
    ds_read_b64_tr_b16 v[46:47], v9 offset:51200
    v_mfma_f32_16x16x32_bf16 v[92:95], v[24:27], a[52:55], v[92:95]
    buffer_load_dwordx4 v130, s[24:27], s33 offen offset:2048 lds
    v_mfma_f32_16x16x32_bf16 v[108:111], v[24:27], a[56:59], v[108:111]
    v_mfma_f32_16x16x32_bf16 v[124:127], v[24:27], a[60:63], v[124:127]
    s_waitcnt vmcnt(23)
    s_waitcnt lgkmcnt(6)
    v_mfma_f32_16x16x32_bf16 v[64:67], v[28:31], a[64:67], v[64:67]
    buffer_load_dwordx4 v131, s[24:27], s33 offen offset:3072 lds
    ds_read_b64_tr_b16 v[20:21], v10 offset:49152
    v_mfma_f32_16x16x32_bf16 v[80:83], v[28:31], a[68:71], v[80:83]
    ds_read_b64_tr_b16 v[22:23], v10 offset:51200
    buffer_load_dwordx4 a[160:163], v133, s[20:23], s60 offen offset:2048 sc1
    v_mfma_f32_16x16x32_bf16 v[96:99], v[28:31], a[72:75], v[96:99]
    buffer_load_dwordx4 a[164:167], v133, s[20:23], s61 offen offset:2048 sc1
    v_mfma_f32_16x16x32_bf16 v[112:115], v[28:31], a[76:79], v[112:115]
    v_mfma_f32_16x16x32_bf16 v[68:71], v[32:35], a[64:67], v[68:71]
    ds_read_b64_tr_b16 v[24:25], v11 offset:49152
    ds_read_b64_tr_b16 v[26:27], v11 offset:51200
    v_mfma_f32_16x16x32_bf16 v[84:87], v[32:35], a[68:71], v[84:87]
    buffer_load_dwordx4 a[168:171], v133, s[20:23], s62 offen offset:2048 sc1
    v_mfma_f32_16x16x32_bf16 v[100:103], v[32:35], a[72:75], v[100:103]
    buffer_load_dwordx4 a[172:175], v133, s[20:23], s63 offen offset:2048 sc1
    v_mfma_f32_16x16x32_bf16 v[116:119], v[32:35], a[76:79], v[116:119]
    s_waitcnt lgkmcnt(6)
    v_mfma_f32_16x16x32_bf16 v[72:75], v[36:39], a[64:67], v[72:75]
    ds_read_b64_tr_b16 v[28:29], v12 offset:49152
    ds_read_b64_tr_b16 v[30:31], v12 offset:51200
    v_mfma_f32_16x16x32_bf16 v[88:91], v[36:39], a[68:71], v[88:91]
    s_mov_b32 s33, 286720
    s_add_u32 m0, s39, 131072
    v_mfma_f32_16x16x32_bf16 v[104:107], v[36:39], a[72:75], v[104:107]
    buffer_load_dwordx4 v128, s[24:27], s33 offen offset:0 lds
    v_mfma_f32_16x16x32_bf16 v[120:123], v[36:39], a[76:79], v[120:123]
    buffer_load_dwordx4 v129, s[24:27], s33 offen offset:1024 lds
    v_mfma_f32_16x16x32_bf16 v[76:79], v[40:43], a[64:67], v[76:79]
    ds_read_b64_tr_b16 v[32:33], v156 offset:0
    ds_read_b64_tr_b16 v[34:35], v156 offset:2048
    v_mfma_f32_16x16x32_bf16 v[92:95], v[40:43], a[68:71], v[92:95]
    buffer_load_dwordx4 v130, s[24:27], s33 offen offset:2048 lds
    v_mfma_f32_16x16x32_bf16 v[108:111], v[40:43], a[72:75], v[108:111]
    v_mfma_f32_16x16x32_bf16 v[124:127], v[40:43], a[76:79], v[124:127]
    s_waitcnt vmcnt(27)
    s_waitcnt lgkmcnt(6)
    v_mfma_f32_16x16x32_bf16 v[64:67], v[44:47], a[80:83], v[64:67]
    buffer_load_dwordx4 v131, s[24:27], s33 offen offset:3072 lds
    ds_read_b64_tr_b16 v[36:37], v157 offset:0
    v_mfma_f32_16x16x32_bf16 v[80:83], v[44:47], a[84:87], v[80:83]
    ds_read_b64_tr_b16 v[38:39], v157 offset:2048
    buffer_load_dwordx4 a[176:179], v133, s[20:23], s60 offen offset:3072 sc1
    v_mfma_f32_16x16x32_bf16 v[96:99], v[44:47], a[88:91], v[96:99]
    buffer_load_dwordx4 a[180:183], v133, s[20:23], s61 offen offset:3072 sc1
    v_mfma_f32_16x16x32_bf16 v[112:115], v[44:47], a[92:95], v[112:115]
    v_mfma_f32_16x16x32_bf16 v[68:71], v[20:23], a[80:83], v[68:71]
    ds_read_b64_tr_b16 v[40:41], v158 offset:0
    ds_read_b64_tr_b16 v[42:43], v158 offset:2048
    v_mfma_f32_16x16x32_bf16 v[84:87], v[20:23], a[84:87], v[84:87]
    buffer_load_dwordx4 a[184:187], v133, s[20:23], s62 offen offset:3072 sc1
    v_mfma_f32_16x16x32_bf16 v[100:103], v[20:23], a[88:91], v[100:103]
    buffer_load_dwordx4 a[188:191], v133, s[20:23], s63 offen offset:3072 sc1
    v_mfma_f32_16x16x32_bf16 v[116:119], v[20:23], a[92:95], v[116:119]
    s_waitcnt lgkmcnt(6)
    v_mfma_f32_16x16x32_bf16 v[72:75], v[24:27], a[80:83], v[72:75]
    ds_read_b64_tr_b16 v[44:45], v159 offset:0
    ds_read_b64_tr_b16 v[46:47], v159 offset:2048
    v_mfma_f32_16x16x32_bf16 v[88:91], v[24:27], a[84:87], v[88:91]
    s_mov_b32 s33, 315392
    s_add_u32 m0, s39, 147456
    v_mfma_f32_16x16x32_bf16 v[104:107], v[24:27], a[88:91], v[104:107]
    buffer_load_dwordx4 v128, s[24:27], s33 offen offset:0 lds
    v_mfma_f32_16x16x32_bf16 v[120:123], v[24:27], a[92:95], v[120:123]
    buffer_load_dwordx4 v129, s[24:27], s33 offen offset:1024 lds
    v_mfma_f32_16x16x32_bf16 v[76:79], v[28:31], a[80:83], v[76:79]
    ds_read_b64_tr_b16 v[20:21], v156 offset:16384
    ds_read_b64_tr_b16 v[22:23], v156 offset:18432
    v_mfma_f32_16x16x32_bf16 v[92:95], v[28:31], a[84:87], v[92:95]
    buffer_load_dwordx4 v130, s[24:27], s33 offen offset:2048 lds
    v_mfma_f32_16x16x32_bf16 v[108:111], v[28:31], a[88:91], v[108:111]
    v_mfma_f32_16x16x32_bf16 v[124:127], v[28:31], a[92:95], v[124:127]
    s_waitcnt vmcnt(31)
    s_waitcnt lgkmcnt(6)
    v_mfma_f32_16x16x32_bf16 v[64:67], v[32:35], a[96:99], v[64:67]
    buffer_load_dwordx4 v131, s[24:27], s33 offen offset:3072 lds
    ds_read_b64_tr_b16 v[24:25], v157 offset:16384
    v_mfma_f32_16x16x32_bf16 v[80:83], v[32:35], a[100:103], v[80:83]
    ds_read_b64_tr_b16 v[26:27], v157 offset:18432
    buffer_load_dwordx4 a[192:195], v134, s[20:23], s60 offen offset:0 sc1
    v_mfma_f32_16x16x32_bf16 v[96:99], v[32:35], a[104:107], v[96:99]
    buffer_load_dwordx4 a[196:199], v134, s[20:23], s61 offen offset:0 sc1
    v_mfma_f32_16x16x32_bf16 v[112:115], v[32:35], a[108:111], v[112:115]
    v_mfma_f32_16x16x32_bf16 v[68:71], v[36:39], a[96:99], v[68:71]
    ds_read_b64_tr_b16 v[28:29], v158 offset:16384
    ds_read_b64_tr_b16 v[30:31], v158 offset:18432
    v_mfma_f32_16x16x32_bf16 v[84:87], v[36:39], a[100:103], v[84:87]
    buffer_load_dwordx4 a[200:203], v134, s[20:23], s62 offen offset:0 sc1
    v_mfma_f32_16x16x32_bf16 v[100:103], v[36:39], a[104:107], v[100:103]
    buffer_load_dwordx4 a[204:207], v134, s[20:23], s63 offen offset:0 sc1
    v_mfma_f32_16x16x32_bf16 v[116:119], v[36:39], a[108:111], v[116:119]
    s_waitcnt lgkmcnt(6)
    v_mfma_f32_16x16x32_bf16 v[72:75], v[40:43], a[96:99], v[72:75]
    ds_read_b64_tr_b16 v[32:33], v159 offset:16384
    ds_read_b64_tr_b16 v[34:35], v159 offset:18432
    v_mfma_f32_16x16x32_bf16 v[88:91], v[40:43], a[100:103], v[88:91]
    s_mov_b32 s33, 344064
    s_add_u32 m0, s39, 0
    v_mfma_f32_16x16x32_bf16 v[104:107], v[40:43], a[104:107], v[104:107]
    buffer_load_dwordx4 v128, s[24:27], s33 offen offset:0 lds
    v_mfma_f32_16x16x32_bf16 v[120:123], v[40:43], a[108:111], v[120:123]
    buffer_load_dwordx4 v129, s[24:27], s33 offen offset:1024 lds
    v_mfma_f32_16x16x32_bf16 v[76:79], v[44:47], a[96:99], v[76:79]
    ds_read_b64_tr_b16 v[36:37], v156 offset:32768
    ds_read_b64_tr_b16 v[38:39], v156 offset:34816
    v_mfma_f32_16x16x32_bf16 v[92:95], v[44:47], a[100:103], v[92:95]
    buffer_load_dwordx4 v130, s[24:27], s33 offen offset:2048 lds
    v_mfma_f32_16x16x32_bf16 v[108:111], v[44:47], a[104:107], v[108:111]
    v_mfma_f32_16x16x32_bf16 v[124:127], v[44:47], a[108:111], v[124:127]
    s_waitcnt vmcnt(35)
    s_waitcnt lgkmcnt(6)
    v_mfma_f32_16x16x32_bf16 v[64:67], v[20:23], a[112:115], v[64:67]
    buffer_load_dwordx4 v131, s[24:27], s33 offen offset:3072 lds
    ds_read_b64_tr_b16 v[40:41], v157 offset:32768
    v_mfma_f32_16x16x32_bf16 v[80:83], v[20:23], a[116:119], v[80:83]
    ds_read_b64_tr_b16 v[42:43], v157 offset:34816
    buffer_load_dwordx4 a[208:211], v134, s[20:23], s60 offen offset:1024 sc1
    v_mfma_f32_16x16x32_bf16 v[96:99], v[20:23], a[120:123], v[96:99]
    buffer_load_dwordx4 a[212:215], v134, s[20:23], s61 offen offset:1024 sc1
    v_mfma_f32_16x16x32_bf16 v[112:115], v[20:23], a[124:127], v[112:115]
    v_mfma_f32_16x16x32_bf16 v[68:71], v[24:27], a[112:115], v[68:71]
    ds_read_b64_tr_b16 v[44:45], v158 offset:32768
    ds_read_b64_tr_b16 v[46:47], v158 offset:34816
    v_mfma_f32_16x16x32_bf16 v[84:87], v[24:27], a[116:119], v[84:87]
    buffer_load_dwordx4 a[216:219], v134, s[20:23], s62 offen offset:1024 sc1
    v_mfma_f32_16x16x32_bf16 v[100:103], v[24:27], a[120:123], v[100:103]
    buffer_load_dwordx4 a[220:223], v134, s[20:23], s63 offen offset:1024 sc1
    v_mfma_f32_16x16x32_bf16 v[116:119], v[24:27], a[124:127], v[116:119]
    s_waitcnt lgkmcnt(6)
    v_mfma_f32_16x16x32_bf16 v[72:75], v[28:31], a[112:115], v[72:75]
    ds_read_b64_tr_b16 v[20:21], v159 offset:32768
    ds_read_b64_tr_b16 v[22:23], v159 offset:34816
    v_mfma_f32_16x16x32_bf16 v[88:91], v[28:31], a[116:119], v[88:91]
    s_mov_b32 s33, 372736
    s_add_u32 m0, s39, 16384
    v_mfma_f32_16x16x32_bf16 v[104:107], v[28:31], a[120:123], v[104:107]
    buffer_load_dwordx4 v128, s[24:27], s33 offen offset:0 lds
    v_mfma_f32_16x16x32_bf16 v[120:123], v[28:31], a[124:127], v[120:123]
    buffer_load_dwordx4 v129, s[24:27], s33 offen offset:1024 lds
    v_mfma_f32_16x16x32_bf16 v[76:79], v[32:35], a[112:115], v[76:79]
    s_waitcnt vmcnt(30)
    ds_read_b64_tr_b16 v[24:25], v156 offset:49152
    v_mfma_f32_16x16x32_bf16 v[92:95], v[32:35], a[116:119], v[92:95]
    ds_read_b64_tr_b16 v[26:27], v156 offset:51200
    buffer_load_dwordx4 v130, s[24:27], s33 offen offset:2048 lds
    v_mfma_f32_16x16x32_bf16 v[108:111], v[32:35], a[120:123], v[108:111]
    v_mfma_f32_16x16x32_bf16 v[124:127], v[32:35], a[124:127], v[124:127]
    s_waitcnt lgkmcnt(6)
    v_mfma_f32_16x16x32_bf16 v[64:67], v[36:39], a[128:131], v[64:67]
    buffer_load_dwordx4 v131, s[24:27], s33 offen offset:3072 lds
    buffer_load_dwordx2 v[48:49], v7, s[20:23], s30 offen offset:0 sc1
    v_mfma_f32_16x16x32_bf16 v[80:83], v[36:39], a[132:135], v[80:83]
    buffer_load_dwordx2 v[50:51], v7, s[20:23], s30 offen offset:1024 sc1
    ds_read_b64_tr_b16 v[28:29], v157 offset:49152
    v_mfma_f32_16x16x32_bf16 v[96:99], v[36:39], a[136:139], v[96:99]
    ds_read_b64_tr_b16 v[30:31], v157 offset:51200
    buffer_load_dwordx2 v[52:53], v7, s[20:23], s30 offen offset:2048 sc1
    v_mfma_f32_16x16x32_bf16 v[112:115], v[36:39], a[140:143], v[112:115]
    v_mfma_f32_16x16x32_bf16 v[68:71], v[40:43], a[128:131], v[68:71]
    ds_read_b64_tr_b16 v[32:33], v158 offset:49152
    ds_read_b64_tr_b16 v[34:35], v158 offset:51200
    v_mfma_f32_16x16x32_bf16 v[84:87], v[40:43], a[132:135], v[84:87]
    buffer_load_dwordx2 v[54:55], v7, s[20:23], s30 offen offset:3072 sc1
    v_mfma_f32_16x16x32_bf16 v[100:103], v[40:43], a[136:139], v[100:103]
    v_mfma_f32_16x16x32_bf16 v[116:119], v[40:43], a[140:143], v[116:119]
    s_waitcnt lgkmcnt(6)
    v_mfma_f32_16x16x32_bf16 v[72:75], v[44:47], a[128:131], v[72:75]
    ds_read_b64_tr_b16 v[36:37], v159 offset:49152
    ds_read_b64_tr_b16 v[38:39], v159 offset:51200
    v_mfma_f32_16x16x32_bf16 v[88:91], v[44:47], a[132:135], v[88:91]
    v_mfma_f32_16x16x32_bf16 v[104:107], v[44:47], a[136:139], v[104:107]
    v_mfma_f32_16x16x32_bf16 v[120:123], v[44:47], a[140:143], v[120:123]
    v_mfma_f32_16x16x32_bf16 v[76:79], v[20:23], a[128:131], v[76:79]
    s_waitcnt vmcnt(28)
    ds_read_b64_tr_b16 v[40:41], v160 offset:0
    v_mfma_f32_16x16x32_bf16 v[92:95], v[20:23], a[132:135], v[92:95]
    ds_read_b64_tr_b16 v[42:43], v160 offset:2048
    v_mfma_f32_16x16x32_bf16 v[108:111], v[20:23], a[136:139], v[108:111]
    v_mfma_f32_16x16x32_bf16 v[124:127], v[20:23], a[140:143], v[124:127]
    s_waitcnt lgkmcnt(6)
    v_mfma_f32_16x16x32_bf16 v[64:67], v[24:27], a[144:147], v[64:67]
    ds_read_b64_tr_b16 v[44:45], v161 offset:0
    ds_read_b64_tr_b16 v[46:47], v161 offset:2048
    v_mfma_f32_16x16x32_bf16 v[80:83], v[24:27], a[148:151], v[80:83]
    v_mfma_f32_16x16x32_bf16 v[96:99], v[24:27], a[152:155], v[96:99]
    v_mfma_f32_16x16x32_bf16 v[112:115], v[24:27], a[156:159], v[112:115]
    v_mfma_f32_16x16x32_bf16 v[68:71], v[28:31], a[144:147], v[68:71]
    ds_read_b64_tr_b16 v[20:21], v162 offset:0
    ds_read_b64_tr_b16 v[22:23], v162 offset:2048
    v_mfma_f32_16x16x32_bf16 v[84:87], v[28:31], a[148:151], v[84:87]
    v_mfma_f32_16x16x32_bf16 v[100:103], v[28:31], a[152:155], v[100:103]
    v_mfma_f32_16x16x32_bf16 v[116:119], v[28:31], a[156:159], v[116:119]
    s_waitcnt lgkmcnt(6)
    v_mfma_f32_16x16x32_bf16 v[72:75], v[32:35], a[144:147], v[72:75]
    ds_read_b64_tr_b16 v[24:25], v163 offset:0
    ds_read_b64_tr_b16 v[26:27], v163 offset:2048
    v_mfma_f32_16x16x32_bf16 v[88:91], v[32:35], a[148:151], v[88:91]
    v_mfma_f32_16x16x32_bf16 v[104:107], v[32:35], a[152:155], v[104:107]
    v_mfma_f32_16x16x32_bf16 v[120:123], v[32:35], a[156:159], v[120:123]
    v_mfma_f32_16x16x32_bf16 v[76:79], v[36:39], a[144:147], v[76:79]
    s_waitcnt vmcnt(20)
    ds_read_b64_tr_b16 v[28:29], v160 offset:16384
    v_mfma_f32_16x16x32_bf16 v[92:95], v[36:39], a[148:151], v[92:95]
    ds_read_b64_tr_b16 v[30:31], v160 offset:18432
    v_mfma_f32_16x16x32_bf16 v[108:111], v[36:39], a[152:155], v[108:111]
    v_mfma_f32_16x16x32_bf16 v[124:127], v[36:39], a[156:159], v[124:127]
    s_waitcnt lgkmcnt(6)
    v_mfma_f32_16x16x32_bf16 v[64:67], v[40:43], a[160:163], v[64:67]
    ds_read_b64_tr_b16 v[32:33], v161 offset:16384
    ds_read_b64_tr_b16 v[34:35], v161 offset:18432
    v_mfma_f32_16x16x32_bf16 v[80:83], v[40:43], a[164:167], v[80:83]
    v_mfma_f32_16x16x32_bf16 v[96:99], v[40:43], a[168:171], v[96:99]
    v_mfma_f32_16x16x32_bf16 v[112:115], v[40:43], a[172:175], v[112:115]
    v_mfma_f32_16x16x32_bf16 v[68:71], v[44:47], a[160:163], v[68:71]
    ds_read_b64_tr_b16 v[36:37], v162 offset:16384
    ds_read_b64_tr_b16 v[38:39], v162 offset:18432
    v_mfma_f32_16x16x32_bf16 v[84:87], v[44:47], a[164:167], v[84:87]
    v_mfma_f32_16x16x32_bf16 v[100:103], v[44:47], a[168:171], v[100:103]
    v_mfma_f32_16x16x32_bf16 v[116:119], v[44:47], a[172:175], v[116:119]
    s_waitcnt lgkmcnt(6)
    v_mfma_f32_16x16x32_bf16 v[72:75], v[20:23], a[160:163], v[72:75]
    ds_read_b64_tr_b16 v[40:41], v163 offset:16384
    ds_read_b64_tr_b16 v[42:43], v163 offset:18432
    v_mfma_f32_16x16x32_bf16 v[88:91], v[20:23], a[164:167], v[88:91]
    v_mfma_f32_16x16x32_bf16 v[104:107], v[20:23], a[168:171], v[104:107]
    v_mfma_f32_16x16x32_bf16 v[120:123], v[20:23], a[172:175], v[120:123]
    v_mfma_f32_16x16x32_bf16 v[76:79], v[24:27], a[160:163], v[76:79]
    s_waitcnt vmcnt(12)
    ds_read_b64_tr_b16 v[44:45], v9 offset:0
    v_mfma_f32_16x16x32_bf16 v[92:95], v[24:27], a[164:167], v[92:95]
    ds_read_b64_tr_b16 v[46:47], v9 offset:2048
    v_mfma_f32_16x16x32_bf16 v[108:111], v[24:27], a[168:171], v[108:111]
    v_mfma_f32_16x16x32_bf16 v[124:127], v[24:27], a[172:175], v[124:127]
    s_waitcnt lgkmcnt(6)
    v_mfma_f32_16x16x32_bf16 v[64:67], v[28:31], a[176:179], v[64:67]
    ds_read_b64_tr_b16 v[20:21], v10 offset:0
    ds_read_b64_tr_b16 v[22:23], v10 offset:2048
    v_mfma_f32_16x16x32_bf16 v[80:83], v[28:31], a[180:183], v[80:83]
    v_mfma_f32_16x16x32_bf16 v[96:99], v[28:31], a[184:187], v[96:99]
    v_mfma_f32_16x16x32_bf16 v[112:115], v[28:31], a[188:191], v[112:115]
    v_mfma_f32_16x16x32_bf16 v[68:71], v[32:35], a[176:179], v[68:71]
    ds_read_b64_tr_b16 v[24:25], v11 offset:0
    ds_read_b64_tr_b16 v[26:27], v11 offset:2048
    v_mfma_f32_16x16x32_bf16 v[84:87], v[32:35], a[180:183], v[84:87]
    v_mfma_f32_16x16x32_bf16 v[100:103], v[32:35], a[184:187], v[100:103]
    v_mfma_f32_16x16x32_bf16 v[116:119], v[32:35], a[188:191], v[116:119]
    s_waitcnt lgkmcnt(6)
    v_mfma_f32_16x16x32_bf16 v[72:75], v[36:39], a[176:179], v[72:75]
    ds_read_b64_tr_b16 v[28:29], v12 offset:0
    ds_read_b64_tr_b16 v[30:31], v12 offset:2048
    v_mfma_f32_16x16x32_bf16 v[88:91], v[36:39], a[180:183], v[88:91]
    v_mfma_f32_16x16x32_bf16 v[104:107], v[36:39], a[184:187], v[104:107]
    v_mfma_f32_16x16x32_bf16 v[120:123], v[36:39], a[188:191], v[120:123]
    v_mfma_f32_16x16x32_bf16 v[76:79], v[40:43], a[176:179], v[76:79]
    s_waitcnt vmcnt(4)
    ds_read_b64_tr_b16 v[32:33], v9 offset:16384
    v_mfma_f32_16x16x32_bf16 v[92:95], v[40:43], a[180:183], v[92:95]
    ds_read_b64_tr_b16 v[34:35], v9 offset:18432
    v_mfma_f32_16x16x32_bf16 v[108:111], v[40:43], a[184:187], v[108:111]
    v_mfma_f32_16x16x32_bf16 v[124:127], v[40:43], a[188:191], v[124:127]
    s_waitcnt lgkmcnt(6)
    v_mfma_f32_16x16x32_bf16 v[64:67], v[44:47], a[192:195], v[64:67]
    ds_read_b64_tr_b16 v[36:37], v10 offset:16384
    ds_read_b64_tr_b16 v[38:39], v10 offset:18432
    v_mfma_f32_16x16x32_bf16 v[80:83], v[44:47], a[196:199], v[80:83]
    v_mfma_f32_16x16x32_bf16 v[96:99], v[44:47], a[200:203], v[96:99]
    v_mfma_f32_16x16x32_bf16 v[112:115], v[44:47], a[204:207], v[112:115]
    v_mfma_f32_16x16x32_bf16 v[68:71], v[20:23], a[192:195], v[68:71]
    ds_read_b64_tr_b16 v[40:41], v11 offset:16384
    ds_read_b64_tr_b16 v[42:43], v11 offset:18432
    v_mfma_f32_16x16x32_bf16 v[84:87], v[20:23], a[196:199], v[84:87]
    v_mfma_f32_16x16x32_bf16 v[100:103], v[20:23], a[200:203], v[100:103]
    v_mfma_f32_16x16x32_bf16 v[116:119], v[20:23], a[204:207], v[116:119]
    s_waitcnt lgkmcnt(6)
    v_mfma_f32_16x16x32_bf16 v[72:75], v[24:27], a[192:195], v[72:75]
    ds_read_b64_tr_b16 v[44:45], v12 offset:16384
    ds_read_b64_tr_b16 v[46:47], v12 offset:18432
    v_mfma_f32_16x16x32_bf16 v[88:91], v[24:27], a[196:199], v[88:91]
    v_mfma_f32_16x16x32_bf16 v[104:107], v[24:27], a[200:203], v[104:107]
    v_mfma_f32_16x16x32_bf16 v[120:123], v[24:27], a[204:207], v[120:123]
    v_mfma_f32_16x16x32_bf16 v[76:79], v[28:31], a[192:195], v[76:79]
    v_mfma_f32_16x16x32_bf16 v[92:95], v[28:31], a[196:199], v[92:95]
    v_mfma_f32_16x16x32_bf16 v[108:111], v[28:31], a[200:203], v[108:111]
    v_mfma_f32_16x16x32_bf16 v[124:127], v[28:31], a[204:207], v[124:127]
    s_waitcnt lgkmcnt(4)
    v_mfma_f32_16x16x32_bf16 v[64:67], v[32:35], a[208:211], v[64:67]
    v_mfma_f32_16x16x32_bf16 v[80:83], v[32:35], a[212:215], v[80:83]
    v_mfma_f32_16x16x32_bf16 v[96:99], v[32:35], a[216:219], v[96:99]
    v_mfma_f32_16x16x32_bf16 v[112:115], v[32:35], a[220:223], v[112:115]
    v_mfma_f32_16x16x32_bf16 v[68:71], v[36:39], a[208:211], v[68:71]
    v_mfma_f32_16x16x32_bf16 v[84:87], v[36:39], a[212:215], v[84:87]
    v_mfma_f32_16x16x32_bf16 v[100:103], v[36:39], a[216:219], v[100:103]
    v_mfma_f32_16x16x32_bf16 v[116:119], v[36:39], a[220:223], v[116:119]
    s_waitcnt lgkmcnt(0)
    v_mfma_f32_16x16x32_bf16 v[72:75], v[40:43], a[208:211], v[72:75]
    v_mfma_f32_16x16x32_bf16 v[88:91], v[40:43], a[212:215], v[88:91]
    v_mfma_f32_16x16x32_bf16 v[104:107], v[40:43], a[216:219], v[104:107]
    v_mfma_f32_16x16x32_bf16 v[120:123], v[40:43], a[220:223], v[120:123]
    v_mfma_f32_16x16x32_bf16 v[76:79], v[44:47], a[208:211], v[76:79]
    v_mfma_f32_16x16x32_bf16 v[92:95], v[44:47], a[212:215], v[92:95]
    v_mfma_f32_16x16x32_bf16 v[108:111], v[44:47], a[216:219], v[108:111]
    v_mfma_f32_16x16x32_bf16 v[124:127], v[44:47], a[220:223], v[124:127]
    s_lshl_b32 s10, s3, 14
    v_add_u32 v13, s10, v7
    s_lshl_b32 s10, s3, 12
    v_add_u32 v14, s10, v7
    s_barrier
    s_nop 3
    ds_write_b128 v13, v[64:67] offset:0
    ds_write_b128 v13, v[68:71] offset:1024
    ds_write_b128 v13, v[72:75] offset:2048
    ds_write_b128 v13, v[76:79] offset:3072
    ds_write_b128 v13, v[80:83] offset:4096
    ds_write_b128 v13, v[84:87] offset:5120
    ds_write_b128 v13, v[88:91] offset:6144
    ds_write_b128 v13, v[92:95] offset:7168
    ds_write_b128 v13, v[96:99] offset:8192
    ds_write_b128 v13, v[100:103] offset:9216
    ds_write_b128 v13, v[104:107] offset:10240
    ds_write_b128 v13, v[108:111] offset:11264
    ds_write_b128 v13, v[112:115] offset:12288
    ds_write_b128 v13, v[116:119] offset:13312
    ds_write_b128 v13, v[120:123] offset:14336
    ds_write_b128 v13, v[124:127] offset:15360
    s_waitcnt lgkmcnt(0)
    s_barrier
    ds_read_b128 v[64:67], v14 offset:0
    ds_read_b128 v[68:71], v14 offset:1024
    ds_read_b128 v[72:75], v14 offset:2048
    ds_read_b128 v[76:79], v14 offset:3072
    ds_read_b128 v[80:83], v14 offset:16384
    ds_read_b128 v[84:87], v14 offset:17408
    ds_read_b128 v[88:91], v14 offset:18432
    ds_read_b128 v[92:95], v14 offset:19456
    ds_read_b128 v[96:99], v14 offset:32768
    ds_read_b128 v[100:103], v14 offset:33792
    ds_read_b128 v[104:107], v14 offset:34816
    ds_read_b128 v[108:111], v14 offset:35840
    ds_read_b128 v[112:115], v14 offset:49152
    ds_read_b128 v[116:119], v14 offset:50176
    ds_read_b128 v[120:123], v14 offset:51200
    ds_read_b128 v[124:127], v14 offset:52224
    v_and_b32 v5, 15, v1
    v_mul_u32_u24 v5, 896, v5
    v_lshl_add_u32 v5, v2, 3, v5
    s_mul_i32 s10, s29, 14336
    s_add_u32 s10, s10, s38
    s_waitcnt vmcnt(0) lgkmcnt(0)
    v_pk_add_f32 v[64:65], v[64:65], v[80:81]
    v_pk_add_f32 v[66:67], v[66:67], v[82:83]
    v_pk_add_f32 v[64:65], v[64:65], v[96:97]
    v_pk_add_f32 v[66:67], v[66:67], v[98:99]
    v_pk_add_f32 v[64:65], v[64:65], v[112:113]
    v_pk_add_f32 v[66:67], v[66:67], v[114:115]
    v_lshlrev_b32 v20, 16, v56
    v_and_b32 v21, 0xffff0000, v56
    v_lshlrev_b32 v24, 16, v48
    v_and_b32 v25, 0xffff0000, v48
    v_lshlrev_b32 v22, 16, v57
    v_and_b32 v23, 0xffff0000, v57
    v_lshlrev_b32 v26, 16, v49
    v_and_b32 v27, 0xffff0000, v49
    v_add_f32 v64, v64, v20
    v_add_f32 v65, v65, v21
    v_add_f32 v66, v66, v22
    v_add_f32 v67, v67, v23
    v_fma_f32 v64, v64, v140, v24
    v_fma_f32 v65, v65, v141, v25
    v_fma_f32 v66, v66, v142, v26
    v_fma_f32 v67, v67, v143, v27
    v_cvt_pk_bf16_f32 v64, v64, v65
    v_cvt_pk_bf16_f32 v65, v66, v67
    buffer_store_dwordx2 v[64:65], v5, s[40:43], s10 offen offset:0
    v_pk_add_f32 v[68:69], v[68:69], v[84:85]
    v_pk_add_f32 v[70:71], v[70:71], v[86:87]
    v_pk_add_f32 v[68:69], v[68:69], v[100:101]
    v_pk_add_f32 v[70:71], v[70:71], v[102:103]
    v_pk_add_f32 v[68:69], v[68:69], v[116:117]
    v_pk_add_f32 v[70:71], v[70:71], v[118:119]
    v_lshlrev_b32 v20, 16, v58
    v_and_b32 v21, 0xffff0000, v58
    v_lshlrev_b32 v24, 16, v50
    v_and_b32 v25, 0xffff0000, v50
    v_lshlrev_b32 v22, 16, v59
    v_and_b32 v23, 0xffff0000, v59
    v_lshlrev_b32 v26, 16, v51
    v_and_b32 v27, 0xffff0000, v51
    v_add_f32 v68, v68, v20
    v_add_f32 v69, v69, v21
    v_add_f32 v70, v70, v22
    v_add_f32 v71, v71, v23
    v_fma_f32 v68, v68, v144, v24
    v_fma_f32 v69, v69, v145, v25
    v_fma_f32 v70, v70, v146, v26
    v_fma_f32 v71, v71, v147, v27
    v_cvt_pk_bf16_f32 v68, v68, v69
    v_cvt_pk_bf16_f32 v69, v70, v71
    buffer_store_dwordx2 v[68:69], v5, s[40:43], s10 offen offset:32
    v_pk_add_f32 v[72:73], v[72:73], v[88:89]
    v_pk_add_f32 v[74:75], v[74:75], v[90:91]
    v_pk_add_f32 v[72:73], v[72:73], v[104:105]
    v_pk_add_f32 v[74:75], v[74:75], v[106:107]
    v_pk_add_f32 v[72:73], v[72:73], v[120:121]
    v_pk_add_f32 v[74:75], v[74:75], v[122:123]
    v_lshlrev_b32 v20, 16, v60
    v_and_b32 v21, 0xffff0000, v60
    v_lshlrev_b32 v24, 16, v52
    v_and_b32 v25, 0xffff0000, v52
    v_lshlrev_b32 v22, 16, v61
    v_and_b32 v23, 0xffff0000, v61
    v_lshlrev_b32 v26, 16, v53
    v_and_b32 v27, 0xffff0000, v53
    v_add_f32 v72, v72, v20
    v_add_f32 v73, v73, v21
    v_add_f32 v74, v74, v22
    v_add_f32 v75, v75, v23
    v_fma_f32 v72, v72, v148, v24
    v_fma_f32 v73, v73, v149, v25
    v_fma_f32 v74, v74, v150, v26
    v_fma_f32 v75, v75, v151, v27
    v_cvt_pk_bf16_f32 v72, v72, v73
    v_cvt_pk_bf16_f32 v73, v74, v75
    buffer_store_dwordx2 v[72:73], v5, s[40:43], s10 offen offset:64
    v_pk_add_f32 v[76:77], v[76:77], v[92:93]
    v_pk_add_f32 v[78:79], v[78:79], v[94:95]
    v_pk_add_f32 v[76:77], v[76:77], v[108:109]
    v_pk_add_f32 v[78:79], v[78:79], v[110:111]
    v_pk_add_f32 v[76:77], v[76:77], v[124:125]
    v_pk_add_f32 v[78:79], v[78:79], v[126:127]
    v_lshlrev_b32 v20, 16, v62
    v_and_b32 v21, 0xffff0000, v62
    v_lshlrev_b32 v24, 16, v54
    v_and_b32 v25, 0xffff0000, v54
    v_lshlrev_b32 v22, 16, v63
    v_and_b32 v23, 0xffff0000, v63
    v_lshlrev_b32 v26, 16, v55
    v_and_b32 v27, 0xffff0000, v55
    v_add_f32 v76, v76, v20
    v_add_f32 v77, v77, v21
    v_add_f32 v78, v78, v22
    v_add_f32 v79, v79, v23
    v_fma_f32 v76, v76, v152, v24
    v_fma_f32 v77, v77, v153, v25
    v_fma_f32 v78, v78, v154, v26
    v_fma_f32 v79, v79, v155, v27
    v_cvt_pk_bf16_f32 v76, v76, v77
    v_cvt_pk_bf16_f32 v77, v78, v79
    buffer_store_dwordx2 v[76:77], v5, s[40:43], s10 offen offset:96
    s_branch KT_end
KT_idle:
    s_mov_b32 s24, s56
    s_mov_b32 s25, s57
    s_mov_b32 s26, 0x188000
    s_mov_b32 s27, 0x20000
    v_lshlrev_b32 v9, 7, v0
    s_sub_u32 s8, s5, 28
    s_mul_i32 s8, s8, 425984
    buffer_load_dword v10, v9, s[24:27], s8 offen
    s_add_u32 s8, s8, 32768
    buffer_load_dword v10, v9, s[24:27], s8 offen
    s_add_u32 s8, s8, 32768
    buffer_load_dword v10, v9, s[24:27], s8 offen
    s_add_u32 s8, s8, 32768
    buffer_load_dword v10, v9, s[24:27], s8 offen
    s_add_u32 s8, s8, 32768
    buffer_load_dword v10, v9, s[24:27], s8 offen
    s_add_u32 s8, s8, 32768
    buffer_load_dword v10, v9, s[24:27], s8 offen
    s_add_u32 s8, s8, 32768
    buffer_load_dword v10, v9, s[24:27], s8 offen
    s_add_u32 s8, s8, 32768
    buffer_load_dword v10, v9, s[24:27], s8 offen
    s_add_u32 s8, s8, 32768
    buffer_load_dword v10, v9, s[24:27], s8 offen
    s_add_u32 s8, s8, 32768
    buffer_load_dword v10, v9, s[24:27], s8 offen
    s_add_u32 s8, s8, 32768
    buffer_load_dword v10, v9, s[24:27], s8 offen
    s_add_u32 s8, s8, 32768
    buffer_load_dword v10, v9, s[24:27], s8 offen
    s_add_u32 s8, s8, 32768
    buffer_load_dword v10, v9, s[24:27], s8 offen
    s_add_u32 s8, s8, 32768
    s_waitcnt vmcnt(0)
KT_end:
K2_end:
    s_endpgm
K2_tramp_0:
    s_call_b64 s[30:31], K2_slow_0
    s_branch K2_ret_0
K2_tramp_1:
    s_call_b64 s[30:31], K2_slow_1
    s_branch K2_ret_1
K2_tramp_2:
    s_call_b64 s[30:31], K2_slow_0
    s_branch K2_ret_2
K2_tramp_3:
    s_call_b64 s[30:31], K2_slow_1
    s_branch K2_ret_3
K2_tramp_4:
    s_call_b64 s[30:31], K2_slow_0
    s_branch K2_ret_4
K2_tramp_5:
    s_call_b64 s[30:31], K2_slow_1
    s_branch K2_ret_5
K2_tramp_7:
    s_call_b64 s[30:31], K2_slow_1
    s_branch K2_ret_7
K2_tramp_8:
    s_call_b64 s[30:31], K2_slow_0
    s_branch K2_ret_8
K2_tramp_9:
    s_call_b64 s[30:31], K2_slow_1
    s_branch K2_ret_9
K2_tramp_6:
    s_mov_b32 s44, 0xff800000
    s_call_b64 s[30:31], K2_slow_0
    s_mov_b32 s44, 0
    v_mov_b32 v241, 0
    v_mov_b32 v242, 0
    v_mov_b32 v243, 0
    v_mov_b32 v244, 0
    s_branch K2_ret_6
K2_slow_0:
    s_waitcnt vmcnt(0)
    s_nop 15
    v_bfe_u32 v251, v250, 6, 4
    v_lshrrev_b32 v249, 10, v250
    v_lshlrev_b32 v249, 4, v249
    v_lshl_add_u32 v251, v251, 9, v249
    s_sub_u32 s28, s20, 32768
    s_add_u32 s29, s28, 8192
    buffer_load_dwordx4 v[252:255], v251, s[12:15], s28 offen offset:0
    s_waitcnt vmcnt(0)
    v_mfma_f32_16x16x32_bf16 v[128:131], v[252:255], v[0:3], v[192:195]
    v_mfma_f32_16x16x32_bf16 v[136:139], v[252:255], v[32:35], v[196:199]
    v_mfma_f32_16x16x32_bf16 v[144:147], v[252:255], v[64:67], v[200:203]
    v_mfma_f32_16x16x32_bf16 v[152:155], v[252:255], v[96:99], v[204:207]
    s_nop 7
    buffer_load_dwordx4 v[252:255], v251, s[12:15], s28 offen offset:64
    s_waitcnt vmcnt(0)
    v_mfma_f32_16x16x32_bf16 v[128:131], v[252:255], v[4:7], v[128:131]
    v_mfma_f32_16x16x32_bf16 v[136:139], v[252:255], v[36:39], v[136:139]
    v_mfma_f32_16x16x32_bf16 v[144:147], v[252:255], v[68:71], v[144:147]
    v_mfma_f32_16x16x32_bf16 v[152:155], v[252:255], v[100:103], v[152:155]
    s_nop 7
    buffer_load_dwordx4 v[252:255], v251, s[12:15], s28 offen offset:128
    s_waitcnt vmcnt(0)
    v_mfma_f32_16x16x32_bf16 v[128:131], v[252:255], v[8:11], v[128:131]
    v_mfma_f32_16x16x32_bf16 v[136:139], v[252:255], v[40:43], v[136:139]
    v_mfma_f32_16x16x32_bf16 v[144:147], v[252:255], v[72:75], v[144:147]
    v_mfma_f32_16x16x32_bf16 v[152:155], v[252:255], v[104:107], v[152:155]
    s_nop 7
    buffer_load_dwordx4 v[252:255], v251, s[12:15], s28 offen offset:192
    s_waitcnt vmcnt(0)
    v_mfma_f32_16x16x32_bf16 v[128:131], v[252:255], v[12:15], v[128:131]
    v_mfma_f32_16x16x32_bf16 v[136:139], v[252:255], v[44:47], v[136:139]
    v_mfma_f32_16x16x32_bf16 v[144:147], v[252:255], v[76:79], v[144:147]
    v_mfma_f32_16x16x32_bf16 v[152:155], v[252:255], v[108:111], v[152:155]
    s_nop 7
    buffer_load_dwordx4 v[252:255], v251, s[12:15], s28 offen offset:256
    s_waitcnt vmcnt(0)
    v_mfma_f32_16x16x32_bf16 v[128:131], v[252:255], v[16:19], v[128:131]
    v_mfma_f32_16x16x32_bf16 v[136:139], v[252:255], v[48:51], v[136:139]
    v_mfma_f32_16x16x32_bf16 v[144:147], v[252:255], v[80:83], v[144:147]
    v_mfma_f32_16x16x32_bf16 v[152:155], v[252:255], v[112:115], v[152:155]
    s_nop 7
    buffer_load_dwordx4 v[252:255], v251, s[12:15], s28 offen offset:320
    s_waitcnt vmcnt(0)
    v_mfma_f32_16x16x32_bf16 v[128:131], v[252:255], v[20:23], v[128:131]
    v_mfma_f32_16x16x32_bf16 v[136:139], v[252:255], v[52:55], v[136:139]
    v_mfma_f32_16x16x32_bf16 v[144:147], v[252:255], v[84:87], v[144:147]
    v_mfma_f32_16x16x32_bf16 v[152:155], v[252:255], v[116:119], v[152:155]
    s_nop 7
    buffer_load_dwordx4 v[252:255], v251, s[12:15], s28 offen offset:384
    s_waitcnt vmcnt(0)
    v_mfma_f32_16x16x32_bf16 v[128:131], v[252:255], v[24:27], v[128:131]
    v_mfma_f32_16x16x32_bf16 v[136:139], v[252:255], v[56:59], v[136:139]
    v_mfma_f32_16x16x32_bf16 v[144:147], v[252:255], v[88:91], v[144:147]
    v_mfma_f32_16x16x32_bf16 v[152:155], v[252:255], v[120:123], v[152:155]
    s_nop 7
    buffer_load_dwordx4 v[252:255], v251, s[12:15], s28 offen offset:448
    s_waitcnt vmcnt(0)
    v_mfma_f32_16x16x32_bf16 v[128:131], v[252:255], v[28:31], v[128:131]
    v_mfma_f32_16x16x32_bf16 v[136:139], v[252:255], v[60:63], v[136:139]
    v_mfma_f32_16x16x32_bf16 v[144:147], v[252:255], v[92:95], v[144:147]
    v_mfma_f32_16x16x32_bf16 v[152:155], v[252:255], v[124:127], v[152:155]
    s_nop 7
    buffer_load_dwordx4 v[252:255], v251, s[12:15], s29 offen offset:0
    s_waitcnt vmcnt(0)
    v_mfma_f32_16x16x32_bf16 v[132:135], v[252:255], v[0:3], v[192:195]
    v_mfma_f32_16x16x32_bf16 v[140:143], v[252:255], v[32:35], v[196:199]
    v_mfma_f32_16x16x32_bf16 v[148:151], v[252:255], v[64:67], v[200:203]
    v_mfma_f32_16x16x32_bf16 v[156:159], v[252:255], v[96:99], v[204:207]
    s_nop 7
    buffer_load_dwordx4 v[252:255], v251, s[12:15], s29 offen offset:64
    s_waitcnt vmcnt(0)
    v_mfma_f32_16x16x32_bf16 v[132:135], v[252:255], v[4:7], v[132:135]
    v_mfma_f32_16x16x32_bf16 v[140:143], v[252:255], v[36:39], v[140:143]
    v_mfma_f32_16x16x32_bf16 v[148:151], v[252:255], v[68:71], v[148:151]
    v_mfma_f32_16x16x32_bf16 v[156:159], v[252:255], v[100:103], v[156:159]
    s_nop 7
    buffer_load_dwordx4 v[252:255], v251, s[12:15], s29 offen offset:128
    s_waitcnt vmcnt(0)
    v_mfma_f32_16x16x32_bf16 v[132:135], v[252:255], v[8:11], v[132:135]
    v_mfma_f32_16x16x32_bf16 v[140:143], v[252:255], v[40:43], v[140:143]
    v_mfma_f32_16x16x32_bf16 v[148:151], v[252:255], v[72:75], v[148:151]
    v_mfma_f32_16x16x32_bf16 v[156:159], v[252:255], v[104:107], v[156:159]
    s_nop 7
    buffer_load_dwordx4 v[252:255], v251, s[12:15], s29 offen offset:192
    s_waitcnt vmcnt(0)
    v_mfma_f32_16x16x32_bf16 v[132:135], v[252:255], v[12:15], v[132:135]
    v_mfma_f32_16x16x32_bf16 v[140:143], v[252:255], v[44:47], v[140:143]
    v_mfma_f32_16x16x32_bf16 v[148:151], v[252:255], v[76:79], v[148:151]
    v_mfma_f32_16x16x32_bf16 v[156:159], v[252:255], v[108:111], v[156:159]
    s_nop 7
    buffer_load_dwordx4 v[252:255], v251, s[12:15], s29 offen offset:256
    s_waitcnt vmcnt(0)
    v_mfma_f32_16x16x32_bf16 v[132:135], v[252:255], v[16:19], v[132:135]
    v_mfma_f32_16x16x32_bf16 v[140:143], v[252:255], v[48:51], v[140:143]
    v_mfma_f32_16x16x32_bf16 v[148:151], v[252:255], v[80:83], v[148:151]
    v_mfma_f32_16x16x32_bf16 v[156:159], v[252:255], v[112:115], v[156:159]
    s_nop 7
    buffer_load_dwordx4 v[252:255], v251, s[12:15], s29 offen offset:320
    s_waitcnt vmcnt(0)
    v_mfma_f32_16x16x32_bf16 v[132:135], v[252:255], v[20:23], v[132:135]
    v_mfma_f32_16x16x32_bf16 v[140:143], v[252:255], v[52:55], v[140:143]
    v_mfma_f32_16x16x32_bf16 v[148:151], v[252:255], v[84:87], v[148:151]
    v_mfma_f32_16x16x32_bf16 v[156:159], v[252:255], v[116:119], v[156:159]
    s_nop 7
    buffer_load_dwordx4 v[252:255], v251, s[12:15], s29 offen offset:384
    s_waitcnt vmcnt(0)
    v_mfma_f32_16x16x32_bf16 v[132:135], v[252:255], v[24:27], v[132:135]
    v_mfma_f32_16x16x32_bf16 v[140:143], v[252:255], v[56:59], v[140:143]
    v_mfma_f32_16x16x32_bf16 v[148:151], v[252:255], v[88:91], v[148:151]
    v_mfma_f32_16x16x32_bf16 v[156:159], v[252:255], v[120:123], v[156:159]
    s_nop 7
    buffer_load_dwordx4 v[252:255], v251, s[12:15], s29 offen offset:448
    s_waitcnt vmcnt(0)
    v_mfma_f32_16x16x32_bf16 v[132:135], v[252:255], v[28:31], v[132:135]
    v_mfma_f32_16x16x32_bf16 v[140:143], v[252:255], v[60:63], v[140:143]
    v_mfma_f32_16x16x32_bf16 v[148:151], v[252:255], v[92:95], v[148:151]
    v_mfma_f32_16x16x32_bf16 v[156:159], v[252:255], v[124:127], v[156:159]
    s_nop 7
    s_nop 7
    v_max3_f32 v251, v128, v129, v130
    v_max3_f32 v251, v251, v131, v132
    v_max3_f32 v251, v251, v133, v134
    v_max_f32 v251, v251, v135
    v_mov_b32 v252, v251
    s_nop 1
    v_permlane16_swap_b32 v251, v252
    s_nop 1
    v_max_f32 v251, v251, v252
    v_mov_b32 v252, v251
    s_nop 1
    v_permlane32_swap_b32 v251, v252
    s_nop 1
    v_max_f32 v251, v251, v252
    v_max_f32 v251, s44, v251
    v_exp_f32 v249, -v251
    v_sub_f32 v192, v192, v251
    v_sub_f32 v193, v193, v251
    v_sub_f32 v194, v194, v251
    v_sub_f32 v195, v195, v251
    v_sub_f32 v128, v128, v251
    v_sub_f32 v160, v160, v251
    v_sub_f32 v129, v129, v251
    v_sub_f32 v161, v161, v251
    v_sub_f32 v130, v130, v251
    v_sub_f32 v162, v162, v251
    v_sub_f32 v131, v131, v251
    v_sub_f32 v163, v163, v251
    v_sub_f32 v132, v132, v251
    v_sub_f32 v164, v164, v251
    v_sub_f32 v133, v133, v251
    v_sub_f32 v165, v165, v251
    v_sub_f32 v134, v134, v251
    v_sub_f32 v166, v166, v251
    v_sub_f32 v135, v135, v251
    v_sub_f32 v167, v167, v251
    v_mul_f32 v241, v241, v249
    v_accvgpr_read_b32 v252, a0
    v_accvgpr_read_b32 v253, a1
    v_accvgpr_read_b32 v254, a2
    v_accvgpr_read_b32 v255, a3
    v_mul_f32 v252, v252, v249
    v_mul_f32 v253, v253, v249
    v_mul_f32 v254, v254, v249
    v_mul_f32 v255, v255, v249
    v_accvgpr_write_b32 a0, v252
    v_accvgpr_write_b32 a1, v253
    v_accvgpr_write_b32 a2, v254
    v_accvgpr_write_b32 a3, v255
    v_accvgpr_read_b32 v252, a16
    v_accvgpr_read_b32 v253, a17
    v_accvgpr_read_b32 v254, a18
    v_accvgpr_read_b32 v255, a19
    v_mul_f32 v252, v252, v249
    v_mul_f32 v253, v253, v249
    v_mul_f32 v254, v254, v249
    v_mul_f32 v255, v255, v249
    v_accvgpr_write_b32 a16, v252
    v_accvgpr_write_b32 a17, v253
    v_accvgpr_write_b32 a18, v254
    v_accvgpr_write_b32 a19, v255
    v_accvgpr_read_b32 v252, a32
    v_accvgpr_read_b32 v253, a33
    v_accvgpr_read_b32 v254, a34
    v_accvgpr_read_b32 v255, a35
    v_mul_f32 v252, v252, v249
    v_mul_f32 v253, v253, v249
    v_mul_f32 v254, v254, v249
    v_mul_f32 v255, v255, v249
    v_accvgpr_write_b32 a32, v252
    v_accvgpr_write_b32 a33, v253
    v_accvgpr_write_b32 a34, v254
    v_accvgpr_write_b32 a35, v255
    v_accvgpr_read_b32 v252, a48
    v_accvgpr_read_b32 v253, a49
    v_accvgpr_read_b32 v254, a50
    v_accvgpr_read_b32 v255, a51
    v_mul_f32 v252, v252, v249
    v_mul_f32 v253, v253, v249
    v_mul_f32 v254, v254, v249
    v_mul_f32 v255, v255, v249
    v_accvgpr_write_b32 a48, v252
    v_accvgpr_write_b32 a49, v253
    v_accvgpr_write_b32 a50, v254
    v_accvgpr_write_b32 a51, v255
    v_accvgpr_read_b32 v252, a64
    v_accvgpr_read_b32 v253, a65
    v_accvgpr_read_b32 v254, a66
    v_accvgpr_read_b32 v255, a67
    v_mul_f32 v252, v252, v249
    v_mul_f32 v253, v253, v249
    v_mul_f32 v254, v254, v249
    v_mul_f32 v255, v255, v249
    v_accvgpr_write_b32 a64, v252
    v_accvgpr_write_b32 a65, v253
    v_accvgpr_write_b32 a66, v254
    v_accvgpr_write_b32 a67, v255
    v_accvgpr_read_b32 v252, a80
    v_accvgpr_read_b32 v253, a81
    v_accvgpr_read_b32 v254, a82
    v_accvgpr_read_b32 v255, a83
    v_mul_f32 v252, v252, v249
    v_mul_f32 v253, v253, v249
    v_mul_f32 v254, v254, v249
    v_mul_f32 v255, v255, v249
    v_accvgpr_write_b32 a80, v252
    v_accvgpr_write_b32 a81, v253
    v_accvgpr_write_b32 a82, v254
    v_accvgpr_write_b32 a83, v255
    v_accvgpr_read_b32 v252, a96
    v_accvgpr_read_b32 v253, a97
    v_accvgpr_read_b32 v254, a98
    v_accvgpr_read_b32 v255, a99
    v_mul_f32 v252, v252, v249
    v_mul_f32 v253, v253, v249
    v_mul_f32 v254, v254, v249
    v_mul_f32 v255, v255, v249
    v_accvgpr_write_b32 a96, v252
    v_accvgpr_write_b32 a97, v253
    v_accvgpr_write_b32 a98, v254
    v_accvgpr_write_b32 a99, v255
    v_accvgpr_read_b32 v252, a112
    v_accvgpr_read_b32 v253, a113
    v_accvgpr_read_b32 v254, a114
    v_accvgpr_read_b32 v255, a115
    v_mul_f32 v252, v252, v249
    v_mul_f32 v253, v253, v249
    v_mul_f32 v254, v254, v249
    v_mul_f32 v255, v255, v249
    v_accvgpr_write_b32 a112, v252
    v_accvgpr_write_b32 a113, v253
    v_accvgpr_write_b32 a114, v254
    v_accvgpr_write_b32 a115, v255
    v_accvgpr_read_b32 v252, a128
    v_accvgpr_read_b32 v253, a129
    v_accvgpr_read_b32 v254, a130
    v_accvgpr_read_b32 v255, a131
    v_mul_f32 v252, v252, v249
    v_mul_f32 v253, v253, v249
    v_mul_f32 v254, v254, v249
    v_mul_f32 v255, v255, v249
    v_accvgpr_write_b32 a128, v252
    v_accvgpr_write_b32 a129, v253
    v_accvgpr_write_b32 a130, v254
    v_accvgpr_write_b32 a131, v255
    v_accvgpr_read_b32 v252, a144
    v_accvgpr_read_b32 v253, a145
    v_accvgpr_read_b32 v254, a146
    v_accvgpr_read_b32 v255, a147
    v_mul_f32 v252, v252, v249
    v_mul_f32 v253, v253, v249
    v_mul_f32 v254, v254, v249
    v_mul_f32 v255, v255, v249
    v_accvgpr_write_b32 a144, v252
    v_accvgpr_write_b32 a145, v253
    v_accvgpr_write_b32 a146, v254
    v_accvgpr_write_b32 a147, v255
    v_accvgpr_read_b32 v252, a160
    v_accvgpr_read_b32 v253, a161
    v_accvgpr_read_b32 v254, a162
    v_accvgpr_read_b32 v255, a163
    v_mul_f32 v252, v252, v249
    v_mul_f32 v253, v253, v249
    v_mul_f32 v254, v254, v249
    v_mul_f32 v255, v255, v249
    v_accvgpr_write_b32 a160, v252
    v_accvgpr_write_b32 a161, v253
    v_accvgpr_write_b32 a162, v254
    v_accvgpr_write_b32 a163, v255
    v_accvgpr_read_b32 v252, a176
    v_accvgpr_read_b32 v253, a177
    v_accvgpr_read_b32 v254, a178
    v_accvgpr_read_b32 v255, a179
    v_mul_f32 v252, v252, v249
    v_mul_f32 v253, v253, v249
    v_mul_f32 v254, v254, v249
    v_mul_f32 v255, v255, v249
    v_accvgpr_write_b32 a176, v252
    v_accvgpr_write_b32 a177, v253
    v_accvgpr_write_b32 a178, v254
    v_accvgpr_write_b32 a179, v255
    v_accvgpr_read_b32 v252, a192
    v_accvgpr_read_b32 v253, a193
    v_accvgpr_read_b32 v254, a194
    v_accvgpr_read_b32 v255, a195
    v_mul_f32 v252, v252, v249
    v_mul_f32 v253, v253, v249
    v_mul_f32 v254, v254, v249
    v_mul_f32 v255, v255, v249
    v_accvgpr_write_b32 a192, v252
    v_accvgpr_write_b32 a193, v253
    v_accvgpr_write_b32 a194, v254
    v_accvgpr_write_b32 a195, v255
    v_accvgpr_read_b32 v252, a208
    v_accvgpr_read_b32 v253, a209
    v_accvgpr_read_b32 v254, a210
    v_accvgpr_read_b32 v255, a211
    v_mul_f32 v252, v252, v249
    v_mul_f32 v253, v253, v249
    v_mul_f32 v254, v254, v249
    v_mul_f32 v255, v255, v249
    v_accvgpr_write_b32 a208, v252
    v_accvgpr_write_b32 a209, v253
    v_accvgpr_write_b32 a210, v254
    v_accvgpr_write_b32 a211, v255
    v_accvgpr_read_b32 v252, a224
    v_accvgpr_read_b32 v253, a225
    v_accvgpr_read_b32 v254, a226
    v_accvgpr_read_b32 v255, a227
    v_mul_f32 v252, v252, v249
    v_mul_f32 v253, v253, v249
    v_mul_f32 v254, v254, v249
    v_mul_f32 v255, v255, v249
    v_accvgpr_write_b32 a224, v252
    v_accvgpr_write_b32 a225, v253
    v_accvgpr_write_b32 a226, v254
    v_accvgpr_write_b32 a227, v255
    v_accvgpr_read_b32 v252, a240
    v_accvgpr_read_b32 v253, a241
    v_accvgpr_read_b32 v254, a242
    v_accvgpr_read_b32 v255, a243
    v_mul_f32 v252, v252, v249
    v_mul_f32 v253, v253, v249
    v_mul_f32 v254, v254, v249
    v_mul_f32 v255, v255, v249
    v_accvgpr_write_b32 a240, v252
    v_accvgpr_write_b32 a241, v253
    v_accvgpr_write_b32 a242, v254
    v_accvgpr_write_b32 a243, v255
    v_exp_f32 v128, v128
    v_exp_f32 v129, v129
    v_exp_f32 v130, v130
    v_add_f32 v245, v128, v129
    v_cvt_pk_bf16_f32 v128, v128, v129
    v_exp_f32 v131, v131
    v_add_f32 v245, v245, v130
    v_exp_f32 v132, v132
    v_add_f32 v245, v245, v131
    v_cvt_pk_bf16_f32 v129, v130, v131
    v_exp_f32 v133, v133
    v_add_f32 v245, v245, v132
    v_exp_f32 v134, v134
    v_add_f32 v245, v245, v133
    v_cvt_pk_bf16_f32 v130, v132, v133
    v_exp_f32 v135, v135
    v_add_f32 v245, v245, v134
    v_add_f32 v245, v245, v135
    v_cvt_pk_bf16_f32 v131, v134, v135
    v_max3_f32 v251, v136, v137, v138
    v_max3_f32 v251, v251, v139, v140
    v_max3_f32 v251, v251, v141, v142
    v_max_f32 v251, v251, v143
    v_mov_b32 v252, v251
    s_nop 1
    v_permlane16_swap_b32 v251, v252
    s_nop 1
    v_max_f32 v251, v251, v252
    v_mov_b32 v252, v251
    s_nop 1
    v_permlane32_swap_b32 v251, v252
    s_nop 1
    v_max_f32 v251, v251, v252
    v_max_f32 v251, s44, v251
    v_exp_f32 v249, -v251
    v_sub_f32 v196, v196, v251
    v_sub_f32 v197, v197, v251
    v_sub_f32 v198, v198, v251
    v_sub_f32 v199, v199, v251
    v_sub_f32 v136, v136, v251
    v_sub_f32 v168, v168, v251
    v_sub_f32 v137, v137, v251
    v_sub_f32 v169, v169, v251
    v_sub_f32 v138, v138, v251
    v_sub_f32 v170, v170, v251
    v_sub_f32 v139, v139, v251
    v_sub_f32 v171, v171, v251
    v_sub_f32 v140, v140, v251
    v_sub_f32 v172, v172, v251
    v_sub_f32 v141, v141, v251
    v_sub_f32 v173, v173, v251
    v_sub_f32 v142, v142, v251
    v_sub_f32 v174, v174, v251
    v_sub_f32 v143, v143, v251
    v_sub_f32 v175, v175, v251
    v_mul_f32 v242, v242, v249
    v_accvgpr_read_b32 v252, a4
    v_accvgpr_read_b32 v253, a5
    v_accvgpr_read_b32 v254, a6
    v_accvgpr_read_b32 v255, a7
    v_mul_f32 v252, v252, v249
    v_mul_f32 v253, v253, v249
    v_mul_f32 v254, v254, v249
    v_mul_f32 v255, v255, v249
    v_accvgpr_write_b32 a4, v252
    v_accvgpr_write_b32 a5, v253
    v_accvgpr_write_b32 a6, v254
    v_accvgpr_write_b32 a7, v255
    v_accvgpr_read_b32 v252, a20
    v_accvgpr_read_b32 v253, a21
    v_accvgpr_read_b32 v254, a22
    v_accvgpr_read_b32 v255, a23
    v_mul_f32 v252, v252, v249
    v_mul_f32 v253, v253, v249
    v_mul_f32 v254, v254, v249
    v_mul_f32 v255, v255, v249
    v_accvgpr_write_b32 a20, v252
    v_accvgpr_write_b32 a21, v253
    v_accvgpr_write_b32 a22, v254
    v_accvgpr_write_b32 a23, v255
    v_accvgpr_read_b32 v252, a36
    v_accvgpr_read_b32 v253, a37
    v_accvgpr_read_b32 v254, a38
    v_accvgpr_read_b32 v255, a39
    v_mul_f32 v252, v252, v249
    v_mul_f32 v253, v253, v249
    v_mul_f32 v254, v254, v249
    v_mul_f32 v255, v255, v249
    v_accvgpr_write_b32 a36, v252
    v_accvgpr_write_b32 a37, v253
    v_accvgpr_write_b32 a38, v254
    v_accvgpr_write_b32 a39, v255
    v_accvgpr_read_b32 v252, a52
    v_accvgpr_read_b32 v253, a53
    v_accvgpr_read_b32 v254, a54
    v_accvgpr_read_b32 v255, a55
    v_mul_f32 v252, v252, v249
    v_mul_f32 v253, v253, v249
    v_mul_f32 v254, v254, v249
    v_mul_f32 v255, v255, v249
    v_accvgpr_write_b32 a52, v252
    v_accvgpr_write_b32 a53, v253
    v_accvgpr_write_b32 a54, v254
    v_accvgpr_write_b32 a55, v255
    v_accvgpr_read_b32 v252, a68
    v_accvgpr_read_b32 v253, a69
    v_accvgpr_read_b32 v254, a70
    v_accvgpr_read_b32 v255, a71
    v_mul_f32 v252, v252, v249
    v_mul_f32 v253, v253, v249
    v_mul_f32 v254, v254, v249
    v_mul_f32 v255, v255, v249
    v_accvgpr_write_b32 a68, v252
    v_accvgpr_write_b32 a69, v253
    v_accvgpr_write_b32 a70, v254
    v_accvgpr_write_b32 a71, v255
    v_accvgpr_read_b32 v252, a84
    v_accvgpr_read_b32 v253, a85
    v_accvgpr_read_b32 v254, a86
    v_accvgpr_read_b32 v255, a87
    v_mul_f32 v252, v252, v249
    v_mul_f32 v253, v253, v249
    v_mul_f32 v254, v254, v249
    v_mul_f32 v255, v255, v249
    v_accvgpr_write_b32 a84, v252
    v_accvgpr_write_b32 a85, v253
    v_accvgpr_write_b32 a86, v254
    v_accvgpr_write_b32 a87, v255
    v_accvgpr_read_b32 v252, a100
    v_accvgpr_read_b32 v253, a101
    v_accvgpr_read_b32 v254, a102
    v_accvgpr_read_b32 v255, a103
    v_mul_f32 v252, v252, v249
    v_mul_f32 v253, v253, v249
    v_mul_f32 v254, v254, v249
    v_mul_f32 v255, v255, v249
    v_accvgpr_write_b32 a100, v252
    v_accvgpr_write_b32 a101, v253
    v_accvgpr_write_b32 a102, v254
    v_accvgpr_write_b32 a103, v255
    v_accvgpr_read_b32 v252, a116
    v_accvgpr_read_b32 v253, a117
    v_accvgpr_read_b32 v254, a118
    v_accvgpr_read_b32 v255, a119
    v_mul_f32 v252, v252, v249
    v_mul_f32 v253, v253, v249
    v_mul_f32 v254, v254, v249
    v_mul_f32 v255, v255, v249
    v_accvgpr_write_b32 a116, v252
    v_accvgpr_write_b32 a117, v253
    v_accvgpr_write_b32 a118, v254
    v_accvgpr_write_b32 a119, v255
    v_accvgpr_read_b32 v252, a132
    v_accvgpr_read_b32 v253, a133
    v_accvgpr_read_b32 v254, a134
    v_accvgpr_read_b32 v255, a135
    v_mul_f32 v252, v252, v249
    v_mul_f32 v253, v253, v249
    v_mul_f32 v254, v254, v249
    v_mul_f32 v255, v255, v249
    v_accvgpr_write_b32 a132, v252
    v_accvgpr_write_b32 a133, v253
    v_accvgpr_write_b32 a134, v254
    v_accvgpr_write_b32 a135, v255
    v_accvgpr_read_b32 v252, a148
    v_accvgpr_read_b32 v253, a149
    v_accvgpr_read_b32 v254, a150
    v_accvgpr_read_b32 v255, a151
    v_mul_f32 v252, v252, v249
    v_mul_f32 v253, v253, v249
    v_mul_f32 v254, v254, v249
    v_mul_f32 v255, v255, v249
    v_accvgpr_write_b32 a148, v252
    v_accvgpr_write_b32 a149, v253
    v_accvgpr_write_b32 a150, v254
    v_accvgpr_write_b32 a151, v255
    v_accvgpr_read_b32 v252, a164
    v_accvgpr_read_b32 v253, a165
    v_accvgpr_read_b32 v254, a166
    v_accvgpr_read_b32 v255, a167
    v_mul_f32 v252, v252, v249
    v_mul_f32 v253, v253, v249
    v_mul_f32 v254, v254, v249
    v_mul_f32 v255, v255, v249
    v_accvgpr_write_b32 a164, v252
    v_accvgpr_write_b32 a165, v253
    v_accvgpr_write_b32 a166, v254
    v_accvgpr_write_b32 a167, v255
    v_accvgpr_read_b32 v252, a180
    v_accvgpr_read_b32 v253, a181
    v_accvgpr_read_b32 v254, a182
    v_accvgpr_read_b32 v255, a183
    v_mul_f32 v252, v252, v249
    v_mul_f32 v253, v253, v249
    v_mul_f32 v254, v254, v249
    v_mul_f32 v255, v255, v249
    v_accvgpr_write_b32 a180, v252
    v_accvgpr_write_b32 a181, v253
    v_accvgpr_write_b32 a182, v254
    v_accvgpr_write_b32 a183, v255
    v_accvgpr_read_b32 v252, a196
    v_accvgpr_read_b32 v253, a197
    v_accvgpr_read_b32 v254, a198
    v_accvgpr_read_b32 v255, a199
    v_mul_f32 v252, v252, v249
    v_mul_f32 v253, v253, v249
    v_mul_f32 v254, v254, v249
    v_mul_f32 v255, v255, v249
    v_accvgpr_write_b32 a196, v252
    v_accvgpr_write_b32 a197, v253
    v_accvgpr_write_b32 a198, v254
    v_accvgpr_write_b32 a199, v255
    v_accvgpr_read_b32 v252, a212
    v_accvgpr_read_b32 v253, a213
    v_accvgpr_read_b32 v254, a214
    v_accvgpr_read_b32 v255, a215
    v_mul_f32 v252, v252, v249
    v_mul_f32 v253, v253, v249
    v_mul_f32 v254, v254, v249
    v_mul_f32 v255, v255, v249
    v_accvgpr_write_b32 a212, v252
    v_accvgpr_write_b32 a213, v253
    v_accvgpr_write_b32 a214, v254
    v_accvgpr_write_b32 a215, v255
    v_accvgpr_read_b32 v252, a228
    v_accvgpr_read_b32 v253, a229
    v_accvgpr_read_b32 v254, a230
    v_accvgpr_read_b32 v255, a231
    v_mul_f32 v252, v252, v249
    v_mul_f32 v253, v253, v249
    v_mul_f32 v254, v254, v249
    v_mul_f32 v255, v255, v249
    v_accvgpr_write_b32 a228, v252
    v_accvgpr_write_b32 a229, v253
    v_accvgpr_write_b32 a230, v254
    v_accvgpr_write_b32 a231, v255
    v_accvgpr_read_b32 v252, a244
    v_accvgpr_read_b32 v253, a245
    v_accvgpr_read_b32 v254, a246
    v_accvgpr_read_b32 v255, a247
    v_mul_f32 v252, v252, v249
    v_mul_f32 v253, v253, v249
    v_mul_f32 v254, v254, v249
    v_mul_f32 v255, v255, v249
    v_accvgpr_write_b32 a244, v252
    v_accvgpr_write_b32 a245, v253
    v_accvgpr_write_b32 a246, v254
    v_accvgpr_write_b32 a247, v255
    v_exp_f32 v136, v136
    v_exp_f32 v137, v137
    v_exp_f32 v138, v138
    v_add_f32 v246, v136, v137
    v_cvt_pk_bf16_f32 v136, v136, v137
    v_exp_f32 v139, v139
    v_add_f32 v246, v246, v138
    v_exp_f32 v140, v140
    v_add_f32 v246, v246, v139
    v_cvt_pk_bf16_f32 v137, v138, v139
    v_exp_f32 v141, v141
    v_add_f32 v246, v246, v140
    v_exp_f32 v142, v142
    v_add_f32 v246, v246, v141
    v_cvt_pk_bf16_f32 v138, v140, v141
    v_exp_f32 v143, v143
    v_add_f32 v246, v246, v142
    v_add_f32 v246, v246, v143
    v_cvt_pk_bf16_f32 v139, v142, v143
    v_max3_f32 v251, v144, v145, v146
    v_max3_f32 v251, v251, v147, v148
    v_max3_f32 v251, v251, v149, v150
    v_max_f32 v251, v251, v151
    v_mov_b32 v252, v251
    s_nop 1
    v_permlane16_swap_b32 v251, v252
    s_nop 1
    v_max_f32 v251, v251, v252
    v_mov_b32 v252, v251
    s_nop 1
    v_permlane32_swap_b32 v251, v252
    s_nop 1
    v_max_f32 v251, v251, v252
    v_max_f32 v251, s44, v251
    v_exp_f32 v249, -v251
    v_sub_f32 v200, v200, v251
    v_sub_f32 v201, v201, v251
    v_sub_f32 v202, v202, v251
    v_sub_f32 v203, v203, v251
    v_sub_f32 v144, v144, v251
    v_sub_f32 v176, v176, v251
    v_sub_f32 v145, v145, v251
    v_sub_f32 v177, v177, v251
    v_sub_f32 v146, v146, v251
    v_sub_f32 v178, v178, v251
    v_sub_f32 v147, v147, v251
    v_sub_f32 v179, v179, v251
    v_sub_f32 v148, v148, v251
    v_sub_f32 v180, v180, v251
    v_sub_f32 v149, v149, v251
    v_sub_f32 v181, v181, v251
    v_sub_f32 v150, v150, v251
    v_sub_f32 v182, v182, v251
    v_sub_f32 v151, v151, v251
    v_sub_f32 v183, v183, v251
    v_mul_f32 v243, v243, v249
    v_accvgpr_read_b32 v252, a8
    v_accvgpr_read_b32 v253, a9
    v_accvgpr_read_b32 v254, a10
    v_accvgpr_read_b32 v255, a11
    v_mul_f32 v252, v252, v249
    v_mul_f32 v253, v253, v249
    v_mul_f32 v254, v254, v249
    v_mul_f32 v255, v255, v249
    v_accvgpr_write_b32 a8, v252
    v_accvgpr_write_b32 a9, v253
    v_accvgpr_write_b32 a10, v254
    v_accvgpr_write_b32 a11, v255
    v_accvgpr_read_b32 v252, a24
    v_accvgpr_read_b32 v253, a25
    v_accvgpr_read_b32 v254, a26
    v_accvgpr_read_b32 v255, a27
    v_mul_f32 v252, v252, v249
    v_mul_f32 v253, v253, v249
    v_mul_f32 v254, v254, v249
    v_mul_f32 v255, v255, v249
    v_accvgpr_write_b32 a24, v252
    v_accvgpr_write_b32 a25, v253
    v_accvgpr_write_b32 a26, v254
    v_accvgpr_write_b32 a27, v255
    v_accvgpr_read_b32 v252, a40
    v_accvgpr_read_b32 v253, a41
    v_accvgpr_read_b32 v254, a42
    v_accvgpr_read_b32 v255, a43
    v_mul_f32 v252, v252, v249
    v_mul_f32 v253, v253, v249
    v_mul_f32 v254, v254, v249
    v_mul_f32 v255, v255, v249
    v_accvgpr_write_b32 a40, v252
    v_accvgpr_write_b32 a41, v253
    v_accvgpr_write_b32 a42, v254
    v_accvgpr_write_b32 a43, v255
    v_accvgpr_read_b32 v252, a56
    v_accvgpr_read_b32 v253, a57
    v_accvgpr_read_b32 v254, a58
    v_accvgpr_read_b32 v255, a59
    v_mul_f32 v252, v252, v249
    v_mul_f32 v253, v253, v249
    v_mul_f32 v254, v254, v249
    v_mul_f32 v255, v255, v249
    v_accvgpr_write_b32 a56, v252
    v_accvgpr_write_b32 a57, v253
    v_accvgpr_write_b32 a58, v254
    v_accvgpr_write_b32 a59, v255
    v_accvgpr_read_b32 v252, a72
    v_accvgpr_read_b32 v253, a73
    v_accvgpr_read_b32 v254, a74
    v_accvgpr_read_b32 v255, a75
    v_mul_f32 v252, v252, v249
    v_mul_f32 v253, v253, v249
    v_mul_f32 v254, v254, v249
    v_mul_f32 v255, v255, v249
    v_accvgpr_write_b32 a72, v252
    v_accvgpr_write_b32 a73, v253
    v_accvgpr_write_b32 a74, v254
    v_accvgpr_write_b32 a75, v255
    v_accvgpr_read_b32 v252, a88
    v_accvgpr_read_b32 v253, a89
    v_accvgpr_read_b32 v254, a90
    v_accvgpr_read_b32 v255, a91
    v_mul_f32 v252, v252, v249
    v_mul_f32 v253, v253, v249
    v_mul_f32 v254, v254, v249
    v_mul_f32 v255, v255, v249
    v_accvgpr_write_b32 a88, v252
    v_accvgpr_write_b32 a89, v253
    v_accvgpr_write_b32 a90, v254
    v_accvgpr_write_b32 a91, v255
    v_accvgpr_read_b32 v252, a104
    v_accvgpr_read_b32 v253, a105
    v_accvgpr_read_b32 v254, a106
    v_accvgpr_read_b32 v255, a107
    v_mul_f32 v252, v252, v249
    v_mul_f32 v253, v253, v249
    v_mul_f32 v254, v254, v249
    v_mul_f32 v255, v255, v249
    v_accvgpr_write_b32 a104, v252
    v_accvgpr_write_b32 a105, v253
    v_accvgpr_write_b32 a106, v254
    v_accvgpr_write_b32 a107, v255
    v_accvgpr_read_b32 v252, a120
    v_accvgpr_read_b32 v253, a121
    v_accvgpr_read_b32 v254, a122
    v_accvgpr_read_b32 v255, a123
    v_mul_f32 v252, v252, v249
    v_mul_f32 v253, v253, v249
    v_mul_f32 v254, v254, v249
    v_mul_f32 v255, v255, v249
    v_accvgpr_write_b32 a120, v252
    v_accvgpr_write_b32 a121, v253
    v_accvgpr_write_b32 a122, v254
    v_accvgpr_write_b32 a123, v255
    v_accvgpr_read_b32 v252, a136
    v_accvgpr_read_b32 v253, a137
    v_accvgpr_read_b32 v254, a138
    v_accvgpr_read_b32 v255, a139
    v_mul_f32 v252, v252, v249
    v_mul_f32 v253, v253, v249
    v_mul_f32 v254, v254, v249
    v_mul_f32 v255, v255, v249
    v_accvgpr_write_b32 a136, v252
    v_accvgpr_write_b32 a137, v253
    v_accvgpr_write_b32 a138, v254
    v_accvgpr_write_b32 a139, v255
    v_accvgpr_read_b32 v252, a152
    v_accvgpr_read_b32 v253, a153
    v_accvgpr_read_b32 v254, a154
    v_accvgpr_read_b32 v255, a155
    v_mul_f32 v252, v252, v249
    v_mul_f32 v253, v253, v249
    v_mul_f32 v254, v254, v249
    v_mul_f32 v255, v255, v249
    v_accvgpr_write_b32 a152, v252
    v_accvgpr_write_b32 a153, v253
    v_accvgpr_write_b32 a154, v254
    v_accvgpr_write_b32 a155, v255
    v_accvgpr_read_b32 v252, a168
    v_accvgpr_read_b32 v253, a169
    v_accvgpr_read_b32 v254, a170
    v_accvgpr_read_b32 v255, a171
    v_mul_f32 v252, v252, v249
    v_mul_f32 v253, v253, v249
    v_mul_f32 v254, v254, v249
    v_mul_f32 v255, v255, v249
    v_accvgpr_write_b32 a168, v252
    v_accvgpr_write_b32 a169, v253
    v_accvgpr_write_b32 a170, v254
    v_accvgpr_write_b32 a171, v255
    v_accvgpr_read_b32 v252, a184
    v_accvgpr_read_b32 v253, a185
    v_accvgpr_read_b32 v254, a186
    v_accvgpr_read_b32 v255, a187
    v_mul_f32 v252, v252, v249
    v_mul_f32 v253, v253, v249
    v_mul_f32 v254, v254, v249
    v_mul_f32 v255, v255, v249
    v_accvgpr_write_b32 a184, v252
    v_accvgpr_write_b32 a185, v253
    v_accvgpr_write_b32 a186, v254
    v_accvgpr_write_b32 a187, v255
    v_accvgpr_read_b32 v252, a200
    v_accvgpr_read_b32 v253, a201
    v_accvgpr_read_b32 v254, a202
    v_accvgpr_read_b32 v255, a203
    v_mul_f32 v252, v252, v249
    v_mul_f32 v253, v253, v249
    v_mul_f32 v254, v254, v249
    v_mul_f32 v255, v255, v249
    v_accvgpr_write_b32 a200, v252
    v_accvgpr_write_b32 a201, v253
    v_accvgpr_write_b32 a202, v254
    v_accvgpr_write_b32 a203, v255
    v_accvgpr_read_b32 v252, a216
    v_accvgpr_read_b32 v253, a217
    v_accvgpr_read_b32 v254, a218
    v_accvgpr_read_b32 v255, a219
    v_mul_f32 v252, v252, v249
    v_mul_f32 v253, v253, v249
    v_mul_f32 v254, v254, v249
    v_mul_f32 v255, v255, v249
    v_accvgpr_write_b32 a216, v252
    v_accvgpr_write_b32 a217, v253
    v_accvgpr_write_b32 a218, v254
    v_accvgpr_write_b32 a219, v255
    v_accvgpr_read_b32 v252, a232
    v_accvgpr_read_b32 v253, a233
    v_accvgpr_read_b32 v254, a234
    v_accvgpr_read_b32 v255, a235
    v_mul_f32 v252, v252, v249
    v_mul_f32 v253, v253, v249
    v_mul_f32 v254, v254, v249
    v_mul_f32 v255, v255, v249
    v_accvgpr_write_b32 a232, v252
    v_accvgpr_write_b32 a233, v253
    v_accvgpr_write_b32 a234, v254
    v_accvgpr_write_b32 a235, v255
    v_accvgpr_read_b32 v252, a248
    v_accvgpr_read_b32 v253, a249
    v_accvgpr_read_b32 v254, a250
    v_accvgpr_read_b32 v255, a251
    v_mul_f32 v252, v252, v249
    v_mul_f32 v253, v253, v249
    v_mul_f32 v254, v254, v249
    v_mul_f32 v255, v255, v249
    v_accvgpr_write_b32 a248, v252
    v_accvgpr_write_b32 a249, v253
    v_accvgpr_write_b32 a250, v254
    v_accvgpr_write_b32 a251, v255
    v_exp_f32 v144, v144
    v_exp_f32 v145, v145
    v_exp_f32 v146, v146
    v_add_f32 v247, v144, v145
    v_cvt_pk_bf16_f32 v144, v144, v145
    v_exp_f32 v147, v147
    v_add_f32 v247, v247, v146
    v_exp_f32 v148, v148
    v_add_f32 v247, v247, v147
    v_cvt_pk_bf16_f32 v145, v146, v147
    v_exp_f32 v149, v149
    v_add_f32 v247, v247, v148
    v_exp_f32 v150, v150
    v_add_f32 v247, v247, v149
    v_cvt_pk_bf16_f32 v146, v148, v149
    v_exp_f32 v151, v151
    v_add_f32 v247, v247, v150
    v_add_f32 v247, v247, v151
    v_cvt_pk_bf16_f32 v147, v150, v151
    v_max3_f32 v251, v152, v153, v154
    v_max3_f32 v251, v251, v155, v156
    v_max3_f32 v251, v251, v157, v158
    v_max_f32 v251, v251, v159
    v_mov_b32 v252, v251
    s_nop 1
    v_permlane16_swap_b32 v251, v252
    s_nop 1
    v_max_f32 v251, v251, v252
    v_mov_b32 v252, v251
    s_nop 1
    v_permlane32_swap_b32 v251, v252
    s_nop 1
    v_max_f32 v251, v251, v252
    v_max_f32 v251, s44, v251
    v_exp_f32 v249, -v251
    v_sub_f32 v204, v204, v251
    v_sub_f32 v205, v205, v251
    v_sub_f32 v206, v206, v251
    v_sub_f32 v207, v207, v251
    v_sub_f32 v152, v152, v251
    v_sub_f32 v184, v184, v251
    v_sub_f32 v153, v153, v251
    v_sub_f32 v185, v185, v251
    v_sub_f32 v154, v154, v251
    v_sub_f32 v186, v186, v251
    v_sub_f32 v155, v155, v251
    v_sub_f32 v187, v187, v251
    v_sub_f32 v156, v156, v251
    v_sub_f32 v188, v188, v251
    v_sub_f32 v157, v157, v251
    v_sub_f32 v189, v189, v251
    v_sub_f32 v158, v158, v251
    v_sub_f32 v190, v190, v251
    v_sub_f32 v159, v159, v251
    v_sub_f32 v191, v191, v251
    v_mul_f32 v244, v244, v249
    v_accvgpr_read_b32 v252, a12
    v_accvgpr_read_b32 v253, a13
    v_accvgpr_read_b32 v254, a14
    v_accvgpr_read_b32 v255, a15
    v_mul_f32 v252, v252, v249
    v_mul_f32 v253, v253, v249
    v_mul_f32 v254, v254, v249
    v_mul_f32 v255, v255, v249
    v_accvgpr_write_b32 a12, v252
    v_accvgpr_write_b32 a13, v253
    v_accvgpr_write_b32 a14, v254
    v_accvgpr_write_b32 a15, v255
    v_accvgpr_read_b32 v252, a28
    v_accvgpr_read_b32 v253, a29
    v_accvgpr_read_b32 v254, a30
    v_accvgpr_read_b32 v255, a31
    v_mul_f32 v252, v252, v249
    v_mul_f32 v253, v253, v249
    v_mul_f32 v254, v254, v249
    v_mul_f32 v255, v255, v249
    v_accvgpr_write_b32 a28, v252
    v_accvgpr_write_b32 a29, v253
    v_accvgpr_write_b32 a30, v254
    v_accvgpr_write_b32 a31, v255
    v_accvgpr_read_b32 v252, a44
    v_accvgpr_read_b32 v253, a45
    v_accvgpr_read_b32 v254, a46
    v_accvgpr_read_b32 v255, a47
    v_mul_f32 v252, v252, v249
    v_mul_f32 v253, v253, v249
    v_mul_f32 v254, v254, v249
    v_mul_f32 v255, v255, v249
    v_accvgpr_write_b32 a44, v252
    v_accvgpr_write_b32 a45, v253
    v_accvgpr_write_b32 a46, v254
    v_accvgpr_write_b32 a47, v255
    v_accvgpr_read_b32 v252, a60
    v_accvgpr_read_b32 v253, a61
    v_accvgpr_read_b32 v254, a62
    v_accvgpr_read_b32 v255, a63
    v_mul_f32 v252, v252, v249
    v_mul_f32 v253, v253, v249
    v_mul_f32 v254, v254, v249
    v_mul_f32 v255, v255, v249
    v_accvgpr_write_b32 a60, v252
    v_accvgpr_write_b32 a61, v253
    v_accvgpr_write_b32 a62, v254
    v_accvgpr_write_b32 a63, v255
    v_accvgpr_read_b32 v252, a76
    v_accvgpr_read_b32 v253, a77
    v_accvgpr_read_b32 v254, a78
    v_accvgpr_read_b32 v255, a79
    v_mul_f32 v252, v252, v249
    v_mul_f32 v253, v253, v249
    v_mul_f32 v254, v254, v249
    v_mul_f32 v255, v255, v249
    v_accvgpr_write_b32 a76, v252
    v_accvgpr_write_b32 a77, v253
    v_accvgpr_write_b32 a78, v254
    v_accvgpr_write_b32 a79, v255
    v_accvgpr_read_b32 v252, a92
    v_accvgpr_read_b32 v253, a93
    v_accvgpr_read_b32 v254, a94
    v_accvgpr_read_b32 v255, a95
    v_mul_f32 v252, v252, v249
    v_mul_f32 v253, v253, v249
    v_mul_f32 v254, v254, v249
    v_mul_f32 v255, v255, v249
    v_accvgpr_write_b32 a92, v252
    v_accvgpr_write_b32 a93, v253
    v_accvgpr_write_b32 a94, v254
    v_accvgpr_write_b32 a95, v255
    v_accvgpr_read_b32 v252, a108
    v_accvgpr_read_b32 v253, a109
    v_accvgpr_read_b32 v254, a110
    v_accvgpr_read_b32 v255, a111
    v_mul_f32 v252, v252, v249
    v_mul_f32 v253, v253, v249
    v_mul_f32 v254, v254, v249
    v_mul_f32 v255, v255, v249
    v_accvgpr_write_b32 a108, v252
    v_accvgpr_write_b32 a109, v253
    v_accvgpr_write_b32 a110, v254
    v_accvgpr_write_b32 a111, v255
    v_accvgpr_read_b32 v252, a124
    v_accvgpr_read_b32 v253, a125
    v_accvgpr_read_b32 v254, a126
    v_accvgpr_read_b32 v255, a127
    v_mul_f32 v252, v252, v249
    v_mul_f32 v253, v253, v249
    v_mul_f32 v254, v254, v249
    v_mul_f32 v255, v255, v249
    v_accvgpr_write_b32 a124, v252
    v_accvgpr_write_b32 a125, v253
    v_accvgpr_write_b32 a126, v254
    v_accvgpr_write_b32 a127, v255
    v_accvgpr_read_b32 v252, a140
    v_accvgpr_read_b32 v253, a141
    v_accvgpr_read_b32 v254, a142
    v_accvgpr_read_b32 v255, a143
    v_mul_f32 v252, v252, v249
    v_mul_f32 v253, v253, v249
    v_mul_f32 v254, v254, v249
    v_mul_f32 v255, v255, v249
    v_accvgpr_write_b32 a140, v252
    v_accvgpr_write_b32 a141, v253
    v_accvgpr_write_b32 a142, v254
    v_accvgpr_write_b32 a143, v255
    v_accvgpr_read_b32 v252, a156
    v_accvgpr_read_b32 v253, a157
    v_accvgpr_read_b32 v254, a158
    v_accvgpr_read_b32 v255, a159
    v_mul_f32 v252, v252, v249
    v_mul_f32 v253, v253, v249
    v_mul_f32 v254, v254, v249
    v_mul_f32 v255, v255, v249
    v_accvgpr_write_b32 a156, v252
    v_accvgpr_write_b32 a157, v253
    v_accvgpr_write_b32 a158, v254
    v_accvgpr_write_b32 a159, v255
    v_accvgpr_read_b32 v252, a172
    v_accvgpr_read_b32 v253, a173
    v_accvgpr_read_b32 v254, a174
    v_accvgpr_read_b32 v255, a175
    v_mul_f32 v252, v252, v249
    v_mul_f32 v253, v253, v249
    v_mul_f32 v254, v254, v249
    v_mul_f32 v255, v255, v249
    v_accvgpr_write_b32 a172, v252
    v_accvgpr_write_b32 a173, v253
    v_accvgpr_write_b32 a174, v254
    v_accvgpr_write_b32 a175, v255
    v_accvgpr_read_b32 v252, a188
    v_accvgpr_read_b32 v253, a189
    v_accvgpr_read_b32 v254, a190
    v_accvgpr_read_b32 v255, a191
    v_mul_f32 v252, v252, v249
    v_mul_f32 v253, v253, v249
    v_mul_f32 v254, v254, v249
    v_mul_f32 v255, v255, v249
    v_accvgpr_write_b32 a188, v252
    v_accvgpr_write_b32 a189, v253
    v_accvgpr_write_b32 a190, v254
    v_accvgpr_write_b32 a191, v255
    v_accvgpr_read_b32 v252, a204
    v_accvgpr_read_b32 v253, a205
    v_accvgpr_read_b32 v254, a206
    v_accvgpr_read_b32 v255, a207
    v_mul_f32 v252, v252, v249
    v_mul_f32 v253, v253, v249
    v_mul_f32 v254, v254, v249
    v_mul_f32 v255, v255, v249
    v_accvgpr_write_b32 a204, v252
    v_accvgpr_write_b32 a205, v253
    v_accvgpr_write_b32 a206, v254
    v_accvgpr_write_b32 a207, v255
    v_accvgpr_read_b32 v252, a220
    v_accvgpr_read_b32 v253, a221
    v_accvgpr_read_b32 v254, a222
    v_accvgpr_read_b32 v255, a223
    v_mul_f32 v252, v252, v249
    v_mul_f32 v253, v253, v249
    v_mul_f32 v254, v254, v249
    v_mul_f32 v255, v255, v249
    v_accvgpr_write_b32 a220, v252
    v_accvgpr_write_b32 a221, v253
    v_accvgpr_write_b32 a222, v254
    v_accvgpr_write_b32 a223, v255
    v_accvgpr_read_b32 v252, a236
    v_accvgpr_read_b32 v253, a237
    v_accvgpr_read_b32 v254, a238
    v_accvgpr_read_b32 v255, a239
    v_mul_f32 v252, v252, v249
    v_mul_f32 v253, v253, v249
    v_mul_f32 v254, v254, v249
    v_mul_f32 v255, v255, v249
    v_accvgpr_write_b32 a236, v252
    v_accvgpr_write_b32 a237, v253
    v_accvgpr_write_b32 a238, v254
    v_accvgpr_write_b32 a239, v255
    v_accvgpr_read_b32 v252, a252
    v_accvgpr_read_b32 v253, a253
    v_accvgpr_read_b32 v254, a254
    v_accvgpr_read_b32 v255, a255
    v_mul_f32 v252, v252, v249
    v_mul_f32 v253, v253, v249
    v_mul_f32 v254, v254, v249
    v_mul_f32 v255, v255, v249
    v_accvgpr_write_b32 a252, v252
    v_accvgpr_write_b32 a253, v253
    v_accvgpr_write_b32 a254, v254
    v_accvgpr_write_b32 a255, v255
    v_exp_f32 v152, v152
    v_exp_f32 v153, v153
    v_exp_f32 v154, v154
    v_add_f32 v248, v152, v153
    v_cvt_pk_bf16_f32 v152, v152, v153
    v_exp_f32 v155, v155
    v_add_f32 v248, v248, v154
    v_exp_f32 v156, v156
    v_add_f32 v248, v248, v155
    v_cvt_pk_bf16_f32 v153, v154, v155
    v_exp_f32 v157, v157
    v_add_f32 v248, v248, v156
    v_exp_f32 v158, v158
    v_add_f32 v248, v248, v157
    v_cvt_pk_bf16_f32 v154, v156, v157
    v_exp_f32 v159, v159
    v_add_f32 v248, v248, v158
    v_add_f32 v248, v248, v159
    v_cvt_pk_bf16_f32 v155, v158, v159
    s_nop 3
    s_setpc_b64 s[30:31]
K2_slow_1:
    s_waitcnt vmcnt(0)
    s_nop 15
    v_bfe_u32 v251, v250, 6, 4
    v_lshrrev_b32 v249, 10, v250
    v_lshlrev_b32 v249, 4, v249
    v_lshl_add_u32 v251, v251, 9, v249
    s_sub_u32 s28, s20, 32768
    s_add_u32 s29, s28, 8192
    buffer_load_dwordx4 v[252:255], v251, s[12:15], s28 offen offset:0
    s_waitcnt vmcnt(0)
    v_mfma_f32_16x16x32_bf16 v[160:163], v[252:255], v[0:3], v[192:195]
    v_mfma_f32_16x16x32_bf16 v[168:171], v[252:255], v[32:35], v[196:199]
    v_mfma_f32_16x16x32_bf16 v[176:179], v[252:255], v[64:67], v[200:203]
    v_mfma_f32_16x16x32_bf16 v[184:187], v[252:255], v[96:99], v[204:207]
    s_nop 7
    buffer_load_dwordx4 v[252:255], v251, s[12:15], s28 offen offset:64
    s_waitcnt vmcnt(0)
    v_mfma_f32_16x16x32_bf16 v[160:163], v[252:255], v[4:7], v[160:163]
    v_mfma_f32_16x16x32_bf16 v[168:171], v[252:255], v[36:39], v[168:171]
    v_mfma_f32_16x16x32_bf16 v[176:179], v[252:255], v[68:71], v[176:179]
    v_mfma_f32_16x16x32_bf16 v[184:187], v[252:255], v[100:103], v[184:187]
    s_nop 7
    buffer_load_dwordx4 v[252:255], v251, s[12:15], s28 offen offset:128
    s_waitcnt vmcnt(0)
    v_mfma_f32_16x16x32_bf16 v[160:163], v[252:255], v[8:11], v[160:163]
    v_mfma_f32_16x16x32_bf16 v[168:171], v[252:255], v[40:43], v[168:171]
    v_mfma_f32_16x16x32_bf16 v[176:179], v[252:255], v[72:75], v[176:179]
    v_mfma_f32_16x16x32_bf16 v[184:187], v[252:255], v[104:107], v[184:187]
    s_nop 7
    buffer_load_dwordx4 v[252:255], v251, s[12:15], s28 offen offset:192
    s_waitcnt vmcnt(0)
    v_mfma_f32_16x16x32_bf16 v[160:163], v[252:255], v[12:15], v[160:163]
    v_mfma_f32_16x16x32_bf16 v[168:171], v[252:255], v[44:47], v[168:171]
    v_mfma_f32_16x16x32_bf16 v[176:179], v[252:255], v[76:79], v[176:179]
    v_mfma_f32_16x16x32_bf16 v[184:187], v[252:255], v[108:111], v[184:187]
    s_nop 7
    buffer_load_dwordx4 v[252:255], v251, s[12:15], s28 offen offset:256
    s_waitcnt vmcnt(0)
    v_mfma_f32_16x16x32_bf16 v[160:163], v[252:255], v[16:19], v[160:163]
    v_mfma_f32_16x16x32_bf16 v[168:171], v[252:255], v[48:51], v[168:171]
    v_mfma_f32_16x16x32_bf16 v[176:179], v[252:255], v[80:83], v[176:179]
    v_mfma_f32_16x16x32_bf16 v[184:187], v[252:255], v[112:115], v[184:187]
    s_nop 7
    buffer_load_dwordx4 v[252:255], v251, s[12:15], s28 offen offset:320
    s_waitcnt vmcnt(0)
    v_mfma_f32_16x16x32_bf16 v[160:163], v[252:255], v[20:23], v[160:163]
    v_mfma_f32_16x16x32_bf16 v[168:171], v[252:255], v[52:55], v[168:171]
    v_mfma_f32_16x16x32_bf16 v[176:179], v[252:255], v[84:87], v[176:179]
    v_mfma_f32_16x16x32_bf16 v[184:187], v[252:255], v[116:119], v[184:187]
    s_nop 7
    buffer_load_dwordx4 v[252:255], v251, s[12:15], s28 offen offset:384
    s_waitcnt vmcnt(0)
    v_mfma_f32_16x16x32_bf16 v[160:163], v[252:255], v[24:27], v[160:163]
    v_mfma_f32_16x16x32_bf16 v[168:171], v[252:255], v[56:59], v[168:171]
    v_mfma_f32_16x16x32_bf16 v[176:179], v[252:255], v[88:91], v[176:179]
    v_mfma_f32_16x16x32_bf16 v[184:187], v[252:255], v[120:123], v[184:187]
    s_nop 7
    buffer_load_dwordx4 v[252:255], v251, s[12:15], s28 offen offset:448
    s_waitcnt vmcnt(0)
    v_mfma_f32_16x16x32_bf16 v[160:163], v[252:255], v[28:31], v[160:163]
    v_mfma_f32_16x16x32_bf16 v[168:171], v[252:255], v[60:63], v[168:171]
    v_mfma_f32_16x16x32_bf16 v[176:179], v[252:255], v[92:95], v[176:179]
    v_mfma_f32_16x16x32_bf16 v[184:187], v[252:255], v[124:127], v[184:187]
    s_nop 7
    buffer_load_dwordx4 v[252:255], v251, s[12:15], s29 offen offset:0
    s_waitcnt vmcnt(0)
    v_mfma_f32_16x16x32_bf16 v[164:167], v[252:255], v[0:3], v[192:195]
    v_mfma_f32_16x16x32_bf16 v[172:175], v[252:255], v[32:35], v[196:199]
    v_mfma_f32_16x16x32_bf16 v[180:183], v[252:255], v[64:67], v[200:203]
    v_mfma_f32_16x16x32_bf16 v[188:191], v[252:255], v[96:99], v[204:207]
    s_nop 7
    buffer_load_dwordx4 v[252:255], v251, s[12:15], s29 offen offset:64
    s_waitcnt vmcnt(0)
    v_mfma_f32_16x16x32_bf16 v[164:167], v[252:255], v[4:7], v[164:167]
    v_mfma_f32_16x16x32_bf16 v[172:175], v[252:255], v[36:39], v[172:175]
    v_mfma_f32_16x16x32_bf16 v[180:183], v[252:255], v[68:71], v[180:183]
    v_mfma_f32_16x16x32_bf16 v[188:191], v[252:255], v[100:103], v[188:191]
    s_nop 7
    buffer_load_dwordx4 v[252:255], v251, s[12:15], s29 offen offset:128
    s_waitcnt vmcnt(0)
    v_mfma_f32_16x16x32_bf16 v[164:167], v[252:255], v[8:11], v[164:167]
    v_mfma_f32_16x16x32_bf16 v[172:175], v[252:255], v[40:43], v[172:175]
    v_mfma_f32_16x16x32_bf16 v[180:183], v[252:255], v[72:75], v[180:183]
    v_mfma_f32_16x16x32_bf16 v[188:191], v[252:255], v[104:107], v[188:191]
    s_nop 7
    buffer_load_dwordx4 v[252:255], v251, s[12:15], s29 offen offset:192
    s_waitcnt vmcnt(0)
    v_mfma_f32_16x16x32_bf16 v[164:167], v[252:255], v[12:15], v[164:167]
    v_mfma_f32_16x16x32_bf16 v[172:175], v[252:255], v[44:47], v[172:175]
    v_mfma_f32_16x16x32_bf16 v[180:183], v[252:255], v[76:79], v[180:183]
    v_mfma_f32_16x16x32_bf16 v[188:191], v[252:255], v[108:111], v[188:191]
    s_nop 7
    buffer_load_dwordx4 v[252:255], v251, s[12:15], s29 offen offset:256
    s_waitcnt vmcnt(0)
    v_mfma_f32_16x16x32_bf16 v[164:167], v[252:255], v[16:19], v[164:167]
    v_mfma_f32_16x16x32_bf16 v[172:175], v[252:255], v[48:51], v[172:175]
    v_mfma_f32_16x16x32_bf16 v[180:183], v[252:255], v[80:83], v[180:183]
    v_mfma_f32_16x16x32_bf16 v[188:191], v[252:255], v[112:115], v[188:191]
    s_nop 7
    buffer_load_dwordx4 v[252:255], v251, s[12:15], s29 offen offset:320
    s_waitcnt vmcnt(0)
    v_mfma_f32_16x16x32_bf16 v[164:167], v[252:255], v[20:23], v[164:167]
    v_mfma_f32_16x16x32_bf16 v[172:175], v[252:255], v[52:55], v[172:175]
    v_mfma_f32_16x16x32_bf16 v[180:183], v[252:255], v[84:87], v[180:183]
    v_mfma_f32_16x16x32_bf16 v[188:191], v[252:255], v[116:119], v[188:191]
    s_nop 7
    buffer_load_dwordx4 v[252:255], v251, s[12:15], s29 offen offset:384
    s_waitcnt vmcnt(0)
    v_mfma_f32_16x16x32_bf16 v[164:167], v[252:255], v[24:27], v[164:167]
    v_mfma_f32_16x16x32_bf16 v[172:175], v[252:255], v[56:59], v[172:175]
    v_mfma_f32_16x16x32_bf16 v[180:183], v[252:255], v[88:91], v[180:183]
    v_mfma_f32_16x16x32_bf16 v[188:191], v[252:255], v[120:123], v[188:191]
    s_nop 7
    buffer_load_dwordx4 v[252:255], v251, s[12:15], s29 offen offset:448
    s_waitcnt vmcnt(0)
    v_mfma_f32_16x16x32_bf16 v[164:167], v[252:255], v[28:31], v[164:167]
    v_mfma_f32_16x16x32_bf16 v[172:175], v[252:255], v[60:63], v[172:175]
    v_mfma_f32_16x16x32_bf16 v[180:183], v[252:255], v[92:95], v[180:183]
    v_mfma_f32_16x16x32_bf16 v[188:191], v[252:255], v[124:127], v[188:191]
    s_nop 7
    s_nop 7
    v_max3_f32 v251, v160, v161, v162
    v_max3_f32 v251, v251, v163, v164
    v_max3_f32 v251, v251, v165, v166
    v_max_f32 v251, v251, v167
    v_mov_b32 v252, v251
    s_nop 1
    v_permlane16_swap_b32 v251, v252
    s_nop 1
    v_max_f32 v251, v251, v252
    v_mov_b32 v252, v251
    s_nop 1
    v_permlane32_swap_b32 v251, v252
    s_nop 1
    v_max_f32 v251, v251, v252
    v_max_f32 v251, s44, v251
    v_exp_f32 v249, -v251
    v_sub_f32 v192, v192, v251
    v_sub_f32 v193, v193, v251
    v_sub_f32 v194, v194, v251
    v_sub_f32 v195, v195, v251
    v_sub_f32 v160, v160, v251
    v_sub_f32 v128, v128, v251
    v_sub_f32 v161, v161, v251
    v_sub_f32 v129, v129, v251
    v_sub_f32 v162, v162, v251
    v_sub_f32 v130, v130, v251
    v_sub_f32 v163, v163, v251
    v_sub_f32 v131, v131, v251
    v_sub_f32 v164, v164, v251
    v_sub_f32 v132, v132, v251
    v_sub_f32 v165, v165, v251
    v_sub_f32 v133, v133, v251
    v_sub_f32 v166, v166, v251
    v_sub_f32 v134, v134, v251
    v_sub_f32 v167, v167, v251
    v_sub_f32 v135, v135, v251
    v_mul_f32 v241, v241, v249
    v_accvgpr_read_b32 v252, a0
    v_accvgpr_read_b32 v253, a1
    v_accvgpr_read_b32 v254, a2
    v_accvgpr_read_b32 v255, a3
    v_mul_f32 v252, v252, v249
    v_mul_f32 v253, v253, v249
    v_mul_f32 v254, v254, v249
    v_mul_f32 v255, v255, v249
    v_accvgpr_write_b32 a0, v252
    v_accvgpr_write_b32 a1, v253
    v_accvgpr_write_b32 a2, v254
    v_accvgpr_write_b32 a3, v255
    v_accvgpr_read_b32 v252, a16
    v_accvgpr_read_b32 v253, a17
    v_accvgpr_read_b32 v254, a18
    v_accvgpr_read_b32 v255, a19
    v_mul_f32 v252, v252, v249
    v_mul_f32 v253, v253, v249
    v_mul_f32 v254, v254, v249
    v_mul_f32 v255, v255, v249
    v_accvgpr_write_b32 a16, v252
    v_accvgpr_write_b32 a17, v253
    v_accvgpr_write_b32 a18, v254
    v_accvgpr_write_b32 a19, v255
    v_accvgpr_read_b32 v252, a32
    v_accvgpr_read_b32 v253, a33
    v_accvgpr_read_b32 v254, a34
    v_accvgpr_read_b32 v255, a35
    v_mul_f32 v252, v252, v249
    v_mul_f32 v253, v253, v249
    v_mul_f32 v254, v254, v249
    v_mul_f32 v255, v255, v249
    v_accvgpr_write_b32 a32, v252
    v_accvgpr_write_b32 a33, v253
    v_accvgpr_write_b32 a34, v254
    v_accvgpr_write_b32 a35, v255
    v_accvgpr_read_b32 v252, a48
    v_accvgpr_read_b32 v253, a49
    v_accvgpr_read_b32 v254, a50
    v_accvgpr_read_b32 v255, a51
    v_mul_f32 v252, v252, v249
    v_mul_f32 v253, v253, v249
    v_mul_f32 v254, v254, v249
    v_mul_f32 v255, v255, v249
    v_accvgpr_write_b32 a48, v252
    v_accvgpr_write_b32 a49, v253
    v_accvgpr_write_b32 a50, v254
    v_accvgpr_write_b32 a51, v255
    v_accvgpr_read_b32 v252, a64
    v_accvgpr_read_b32 v253, a65
    v_accvgpr_read_b32 v254, a66
    v_accvgpr_read_b32 v255, a67
    v_mul_f32 v252, v252, v249
    v_mul_f32 v253, v253, v249
    v_mul_f32 v254, v254, v249
    v_mul_f32 v255, v255, v249
    v_accvgpr_write_b32 a64, v252
    v_accvgpr_write_b32 a65, v253
    v_accvgpr_write_b32 a66, v254
    v_accvgpr_write_b32 a67, v255
    v_accvgpr_read_b32 v252, a80
    v_accvgpr_read_b32 v253, a81
    v_accvgpr_read_b32 v254, a82
    v_accvgpr_read_b32 v255, a83
    v_mul_f32 v252, v252, v249
    v_mul_f32 v253, v253, v249
    v_mul_f32 v254, v254, v249
    v_mul_f32 v255, v255, v249
    v_accvgpr_write_b32 a80, v252
    v_accvgpr_write_b32 a81, v253
    v_accvgpr_write_b32 a82, v254
    v_accvgpr_write_b32 a83, v255
    v_accvgpr_read_b32 v252, a96
    v_accvgpr_read_b32 v253, a97
    v_accvgpr_read_b32 v254, a98
    v_accvgpr_read_b32 v255, a99
    v_mul_f32 v252, v252, v249
    v_mul_f32 v253, v253, v249
    v_mul_f32 v254, v254, v249
    v_mul_f32 v255, v255, v249
    v_accvgpr_write_b32 a96, v252
    v_accvgpr_write_b32 a97, v253
    v_accvgpr_write_b32 a98, v254
    v_accvgpr_write_b32 a99, v255
    v_accvgpr_read_b32 v252, a112
    v_accvgpr_read_b32 v253, a113
    v_accvgpr_read_b32 v254, a114
    v_accvgpr_read_b32 v255, a115
    v_mul_f32 v252, v252, v249
    v_mul_f32 v253, v253, v249
    v_mul_f32 v254, v254, v249
    v_mul_f32 v255, v255, v249
    v_accvgpr_write_b32 a112, v252
    v_accvgpr_write_b32 a113, v253
    v_accvgpr_write_b32 a114, v254
    v_accvgpr_write_b32 a115, v255
    v_accvgpr_read_b32 v252, a128
    v_accvgpr_read_b32 v253, a129
    v_accvgpr_read_b32 v254, a130
    v_accvgpr_read_b32 v255, a131
    v_mul_f32 v252, v252, v249
    v_mul_f32 v253, v253, v249
    v_mul_f32 v254, v254, v249
    v_mul_f32 v255, v255, v249
    v_accvgpr_write_b32 a128, v252
    v_accvgpr_write_b32 a129, v253
    v_accvgpr_write_b32 a130, v254
    v_accvgpr_write_b32 a131, v255
    v_accvgpr_read_b32 v252, a144
    v_accvgpr_read_b32 v253, a145
    v_accvgpr_read_b32 v254, a146
    v_accvgpr_read_b32 v255, a147
    v_mul_f32 v252, v252, v249
    v_mul_f32 v253, v253, v249
    v_mul_f32 v254, v254, v249
    v_mul_f32 v255, v255, v249
    v_accvgpr_write_b32 a144, v252
    v_accvgpr_write_b32 a145, v253
    v_accvgpr_write_b32 a146, v254
    v_accvgpr_write_b32 a147, v255
    v_accvgpr_read_b32 v252, a160
    v_accvgpr_read_b32 v253, a161
    v_accvgpr_read_b32 v254, a162
    v_accvgpr_read_b32 v255, a163
    v_mul_f32 v252, v252, v249
    v_mul_f32 v253, v253, v249
    v_mul_f32 v254, v254, v249
    v_mul_f32 v255, v255, v249
    v_accvgpr_write_b32 a160, v252
    v_accvgpr_write_b32 a161, v253
    v_accvgpr_write_b32 a162, v254
    v_accvgpr_write_b32 a163, v255
    v_accvgpr_read_b32 v252, a176
    v_accvgpr_read_b32 v253, a177
    v_accvgpr_read_b32 v254, a178
    v_accvgpr_read_b32 v255, a179
    v_mul_f32 v252, v252, v249
    v_mul_f32 v253, v253, v249
    v_mul_f32 v254, v254, v249
    v_mul_f32 v255, v255, v249
    v_accvgpr_write_b32 a176, v252
    v_accvgpr_write_b32 a177, v253
    v_accvgpr_write_b32 a178, v254
    v_accvgpr_write_b32 a179, v255
    v_accvgpr_read_b32 v252, a192
    v_accvgpr_read_b32 v253, a193
    v_accvgpr_read_b32 v254, a194
    v_accvgpr_read_b32 v255, a195
    v_mul_f32 v252, v252, v249
    v_mul_f32 v253, v253, v249
    v_mul_f32 v254, v254, v249
    v_mul_f32 v255, v255, v249
    v_accvgpr_write_b32 a192, v252
    v_accvgpr_write_b32 a193, v253
    v_accvgpr_write_b32 a194, v254
    v_accvgpr_write_b32 a195, v255
    v_accvgpr_read_b32 v252, a208
    v_accvgpr_read_b32 v253, a209
    v_accvgpr_read_b32 v254, a210
    v_accvgpr_read_b32 v255, a211
    v_mul_f32 v252, v252, v249
    v_mul_f32 v253, v253, v249
    v_mul_f32 v254, v254, v249
    v_mul_f32 v255, v255, v249
    v_accvgpr_write_b32 a208, v252
    v_accvgpr_write_b32 a209, v253
    v_accvgpr_write_b32 a210, v254
    v_accvgpr_write_b32 a211, v255
    v_accvgpr_read_b32 v252, a224
    v_accvgpr_read_b32 v253, a225
    v_accvgpr_read_b32 v254, a226
    v_accvgpr_read_b32 v255, a227
    v_mul_f32 v252, v252, v249
    v_mul_f32 v253, v253, v249
    v_mul_f32 v254, v254, v249
    v_mul_f32 v255, v255, v249
    v_accvgpr_write_b32 a224, v252
    v_accvgpr_write_b32 a225, v253
    v_accvgpr_write_b32 a226, v254
    v_accvgpr_write_b32 a227, v255
    v_accvgpr_read_b32 v252, a240
    v_accvgpr_read_b32 v253, a241
    v_accvgpr_read_b32 v254, a242
    v_accvgpr_read_b32 v255, a243
    v_mul_f32 v252, v252, v249
    v_mul_f32 v253, v253, v249
    v_mul_f32 v254, v254, v249
    v_mul_f32 v255, v255, v249
    v_accvgpr_write_b32 a240, v252
    v_accvgpr_write_b32 a241, v253
    v_accvgpr_write_b32 a242, v254
    v_accvgpr_write_b32 a243, v255
    v_exp_f32 v160, v160
    v_exp_f32 v161, v161
    v_exp_f32 v162, v162
    v_add_f32 v245, v160, v161
    v_cvt_pk_bf16_f32 v160, v160, v161
    v_exp_f32 v163, v163
    v_add_f32 v245, v245, v162
    v_exp_f32 v164, v164
    v_add_f32 v245, v245, v163
    v_cvt_pk_bf16_f32 v161, v162, v163
    v_exp_f32 v165, v165
    v_add_f32 v245, v245, v164
    v_exp_f32 v166, v166
    v_add_f32 v245, v245, v165
    v_cvt_pk_bf16_f32 v162, v164, v165
    v_exp_f32 v167, v167
    v_add_f32 v245, v245, v166
    v_add_f32 v245, v245, v167
    v_cvt_pk_bf16_f32 v163, v166, v167
    v_max3_f32 v251, v168, v169, v170
    v_max3_f32 v251, v251, v171, v172
    v_max3_f32 v251, v251, v173, v174
    v_max_f32 v251, v251, v175
    v_mov_b32 v252, v251
    s_nop 1
    v_permlane16_swap_b32 v251, v252
    s_nop 1
    v_max_f32 v251, v251, v252
    v_mov_b32 v252, v251
    s_nop 1
    v_permlane32_swap_b32 v251, v252
    s_nop 1
    v_max_f32 v251, v251, v252
    v_max_f32 v251, s44, v251
    v_exp_f32 v249, -v251
    v_sub_f32 v196, v196, v251
    v_sub_f32 v197, v197, v251
    v_sub_f32 v198, v198, v251
    v_sub_f32 v199, v199, v251
    v_sub_f32 v168, v168, v251
    v_sub_f32 v136, v136, v251
    v_sub_f32 v169, v169, v251
    v_sub_f32 v137, v137, v251
    v_sub_f32 v170, v170, v251
    v_sub_f32 v138, v138, v251
    v_sub_f32 v171, v171, v251
    v_sub_f32 v139, v139, v251
    v_sub_f32 v172, v172, v251
    v_sub_f32 v140, v140, v251
    v_sub_f32 v173, v173, v251
    v_sub_f32 v141, v141, v251
    v_sub_f32 v174, v174, v251
    v_sub_f32 v142, v142, v251
    v_sub_f32 v175, v175, v251
    v_sub_f32 v143, v143, v251
    v_mul_f32 v242, v242, v249
    v_accvgpr_read_b32 v252, a4
    v_accvgpr_read_b32 v253, a5
    v_accvgpr_read_b32 v254, a6
    v_accvgpr_read_b32 v255, a7
    v_mul_f32 v252, v252, v249
    v_mul_f32 v253, v253, v249
    v_mul_f32 v254, v254, v249
    v_mul_f32 v255, v255, v249
    v_accvgpr_write_b32 a4, v252
    v_accvgpr_write_b32 a5, v253
    v_accvgpr_write_b32 a6, v254
    v_accvgpr_write_b32 a7, v255
    v_accvgpr_read_b32 v252, a20
    v_accvgpr_read_b32 v253, a21
    v_accvgpr_read_b32 v254, a22
    v_accvgpr_read_b32 v255, a23
    v_mul_f32 v252, v252, v249
    v_mul_f32 v253, v253, v249
    v_mul_f32 v254, v254, v249
    v_mul_f32 v255, v255, v249
    v_accvgpr_write_b32 a20, v252
    v_accvgpr_write_b32 a21, v253
    v_accvgpr_write_b32 a22, v254
    v_accvgpr_write_b32 a23, v255
    v_accvgpr_read_b32 v252, a36
    v_accvgpr_read_b32 v253, a37
    v_accvgpr_read_b32 v254, a38
    v_accvgpr_read_b32 v255, a39
    v_mul_f32 v252, v252, v249
    v_mul_f32 v253, v253, v249
    v_mul_f32 v254, v254, v249
    v_mul_f32 v255, v255, v249
    v_accvgpr_write_b32 a36, v252
    v_accvgpr_write_b32 a37, v253
    v_accvgpr_write_b32 a38, v254
    v_accvgpr_write_b32 a39, v255
    v_accvgpr_read_b32 v252, a52
    v_accvgpr_read_b32 v253, a53
    v_accvgpr_read_b32 v254, a54
    v_accvgpr_read_b32 v255, a55
    v_mul_f32 v252, v252, v249
    v_mul_f32 v253, v253, v249
    v_mul_f32 v254, v254, v249
    v_mul_f32 v255, v255, v249
    v_accvgpr_write_b32 a52, v252
    v_accvgpr_write_b32 a53, v253
    v_accvgpr_write_b32 a54, v254
    v_accvgpr_write_b32 a55, v255
    v_accvgpr_read_b32 v252, a68
    v_accvgpr_read_b32 v253, a69
    v_accvgpr_read_b32 v254, a70
    v_accvgpr_read_b32 v255, a71
    v_mul_f32 v252, v252, v249
    v_mul_f32 v253, v253, v249
    v_mul_f32 v254, v254, v249
    v_mul_f32 v255, v255, v249
    v_accvgpr_write_b32 a68, v252
    v_accvgpr_write_b32 a69, v253
    v_accvgpr_write_b32 a70, v254
    v_accvgpr_write_b32 a71, v255
    v_accvgpr_read_b32 v252, a84
    v_accvgpr_read_b32 v253, a85
    v_accvgpr_read_b32 v254, a86
    v_accvgpr_read_b32 v255, a87
    v_mul_f32 v252, v252, v249
    v_mul_f32 v253, v253, v249
    v_mul_f32 v254, v254, v249
    v_mul_f32 v255, v255, v249
    v_accvgpr_write_b32 a84, v252
    v_accvgpr_write_b32 a85, v253
    v_accvgpr_write_b32 a86, v254
    v_accvgpr_write_b32 a87, v255
    v_accvgpr_read_b32 v252, a100
    v_accvgpr_read_b32 v253, a101
    v_accvgpr_read_b32 v254, a102
    v_accvgpr_read_b32 v255, a103
    v_mul_f32 v252, v252, v249
    v_mul_f32 v253, v253, v249
    v_mul_f32 v254, v254, v249
    v_mul_f32 v255, v255, v249
    v_accvgpr_write_b32 a100, v252
    v_accvgpr_write_b32 a101, v253
    v_accvgpr_write_b32 a102, v254
    v_accvgpr_write_b32 a103, v255
    v_accvgpr_read_b32 v252, a116
    v_accvgpr_read_b32 v253, a117
    v_accvgpr_read_b32 v254, a118
    v_accvgpr_read_b32 v255, a119
    v_mul_f32 v252, v252, v249
    v_mul_f32 v253, v253, v249
    v_mul_f32 v254, v254, v249
    v_mul_f32 v255, v255, v249
    v_accvgpr_write_b32 a116, v252
    v_accvgpr_write_b32 a117, v253
    v_accvgpr_write_b32 a118, v254
    v_accvgpr_write_b32 a119, v255
    v_accvgpr_read_b32 v252, a132
    v_accvgpr_read_b32 v253, a133
    v_accvgpr_read_b32 v254, a134
    v_accvgpr_read_b32 v255, a135
    v_mul_f32 v252, v252, v249
    v_mul_f32 v253, v253, v249
    v_mul_f32 v254, v254, v249
    v_mul_f32 v255, v255, v249
    v_accvgpr_write_b32 a132, v252
    v_accvgpr_write_b32 a133, v253
    v_accvgpr_write_b32 a134, v254
    v_accvgpr_write_b32 a135, v255
    v_accvgpr_read_b32 v252, a148
    v_accvgpr_read_b32 v253, a149
    v_accvgpr_read_b32 v254, a150
    v_accvgpr_read_b32 v255, a151
    v_mul_f32 v252, v252, v249
    v_mul_f32 v253, v253, v249
    v_mul_f32 v254, v254, v249
    v_mul_f32 v255, v255, v249
    v_accvgpr_write_b32 a148, v252
    v_accvgpr_write_b32 a149, v253
    v_accvgpr_write_b32 a150, v254
    v_accvgpr_write_b32 a151, v255
    v_accvgpr_read_b32 v252, a164
    v_accvgpr_read_b32 v253, a165
    v_accvgpr_read_b32 v254, a166
    v_accvgpr_read_b32 v255, a167
    v_mul_f32 v252, v252, v249
    v_mul_f32 v253, v253, v249
    v_mul_f32 v254, v254, v249
    v_mul_f32 v255, v255, v249
    v_accvgpr_write_b32 a164, v252
    v_accvgpr_write_b32 a165, v253
    v_accvgpr_write_b32 a166, v254
    v_accvgpr_write_b32 a167, v255
    v_accvgpr_read_b32 v252, a180
    v_accvgpr_read_b32 v253, a181
    v_accvgpr_read_b32 v254, a182
    v_accvgpr_read_b32 v255, a183
    v_mul_f32 v252, v252, v249
    v_mul_f32 v253, v253, v249
    v_mul_f32 v254, v254, v249
    v_mul_f32 v255, v255, v249
    v_accvgpr_write_b32 a180, v252
    v_accvgpr_write_b32 a181, v253
    v_accvgpr_write_b32 a182, v254
    v_accvgpr_write_b32 a183, v255
    v_accvgpr_read_b32 v252, a196
    v_accvgpr_read_b32 v253, a197
    v_accvgpr_read_b32 v254, a198
    v_accvgpr_read_b32 v255, a199
    v_mul_f32 v252, v252, v249
    v_mul_f32 v253, v253, v249
    v_mul_f32 v254, v254, v249
    v_mul_f32 v255, v255, v249
    v_accvgpr_write_b32 a196, v252
    v_accvgpr_write_b32 a197, v253
    v_accvgpr_write_b32 a198, v254
    v_accvgpr_write_b32 a199, v255
    v_accvgpr_read_b32 v252, a212
    v_accvgpr_read_b32 v253, a213
    v_accvgpr_read_b32 v254, a214
    v_accvgpr_read_b32 v255, a215
    v_mul_f32 v252, v252, v249
    v_mul_f32 v253, v253, v249
    v_mul_f32 v254, v254, v249
    v_mul_f32 v255, v255, v249
    v_accvgpr_write_b32 a212, v252
    v_accvgpr_write_b32 a213, v253
    v_accvgpr_write_b32 a214, v254
    v_accvgpr_write_b32 a215, v255
    v_accvgpr_read_b32 v252, a228
    v_accvgpr_read_b32 v253, a229
    v_accvgpr_read_b32 v254, a230
    v_accvgpr_read_b32 v255, a231
    v_mul_f32 v252, v252, v249
    v_mul_f32 v253, v253, v249
    v_mul_f32 v254, v254, v249
    v_mul_f32 v255, v255, v249
    v_accvgpr_write_b32 a228, v252
    v_accvgpr_write_b32 a229, v253
    v_accvgpr_write_b32 a230, v254
    v_accvgpr_write_b32 a231, v255
    v_accvgpr_read_b32 v252, a244
    v_accvgpr_read_b32 v253, a245
    v_accvgpr_read_b32 v254, a246
    v_accvgpr_read_b32 v255, a247
    v_mul_f32 v252, v252, v249
    v_mul_f32 v253, v253, v249
    v_mul_f32 v254, v254, v249
    v_mul_f32 v255, v255, v249
    v_accvgpr_write_b32 a244, v252
    v_accvgpr_write_b32 a245, v253
    v_accvgpr_write_b32 a246, v254
    v_accvgpr_write_b32 a247, v255
    v_exp_f32 v168, v168
    v_exp_f32 v169, v169
    v_exp_f32 v170, v170
    v_add_f32 v246, v168, v169
    v_cvt_pk_bf16_f32 v168, v168, v169
    v_exp_f32 v171, v171
    v_add_f32 v246, v246, v170
    v_exp_f32 v172, v172
    v_add_f32 v246, v246, v171
    v_cvt_pk_bf16_f32 v169, v170, v171
    v_exp_f32 v173, v173
    v_add_f32 v246, v246, v172
    v_exp_f32 v174, v174
    v_add_f32 v246, v246, v173
    v_cvt_pk_bf16_f32 v170, v172, v173
    v_exp_f32 v175, v175
    v_add_f32 v246, v246, v174
    v_add_f32 v246, v246, v175
    v_cvt_pk_bf16_f32 v171, v174, v175
    v_max3_f32 v251, v176, v177, v178
    v_max3_f32 v251, v251, v179, v180
    v_max3_f32 v251, v251, v181, v182
    v_max_f32 v251, v251, v183
    v_mov_b32 v252, v251
    s_nop 1
    v_permlane16_swap_b32 v251, v252
    s_nop 1
    v_max_f32 v251, v251, v252
    v_mov_b32 v252, v251
    s_nop 1
    v_permlane32_swap_b32 v251, v252
    s_nop 1
    v_max_f32 v251, v251, v252
    v_max_f32 v251, s44, v251
    v_exp_f32 v249, -v251
    v_sub_f32 v200, v200, v251
    v_sub_f32 v201, v201, v251
    v_sub_f32 v202, v202, v251
    v_sub_f32 v203, v203, v251
    v_sub_f32 v176, v176, v251
    v_sub_f32 v144, v144, v251
    v_sub_f32 v177, v177, v251
    v_sub_f32 v145, v145, v251
    v_sub_f32 v178, v178, v251
    v_sub_f32 v146, v146, v251
    v_sub_f32 v179, v179, v251
    v_sub_f32 v147, v147, v251
    v_sub_f32 v180, v180, v251
    v_sub_f32 v148, v148, v251
    v_sub_f32 v181, v181, v251
    v_sub_f32 v149, v149, v251
    v_sub_f32 v182, v182, v251
    v_sub_f32 v150, v150, v251
    v_sub_f32 v183, v183, v251
    v_sub_f32 v151, v151, v251
    v_mul_f32 v243, v243, v249
    v_accvgpr_read_b32 v252, a8
    v_accvgpr_read_b32 v253, a9
    v_accvgpr_read_b32 v254, a10
    v_accvgpr_read_b32 v255, a11
    v_mul_f32 v252, v252, v249
    v_mul_f32 v253, v253, v249
    v_mul_f32 v254, v254, v249
    v_mul_f32 v255, v255, v249
    v_accvgpr_write_b32 a8, v252
    v_accvgpr_write_b32 a9, v253
    v_accvgpr_write_b32 a10, v254
    v_accvgpr_write_b32 a11, v255
    v_accvgpr_read_b32 v252, a24
    v_accvgpr_read_b32 v253, a25
    v_accvgpr_read_b32 v254, a26
    v_accvgpr_read_b32 v255, a27
    v_mul_f32 v252, v252, v249
    v_mul_f32 v253, v253, v249
    v_mul_f32 v254, v254, v249
    v_mul_f32 v255, v255, v249
    v_accvgpr_write_b32 a24, v252
    v_accvgpr_write_b32 a25, v253
    v_accvgpr_write_b32 a26, v254
    v_accvgpr_write_b32 a27, v255
    v_accvgpr_read_b32 v252, a40
    v_accvgpr_read_b32 v253, a41
    v_accvgpr_read_b32 v254, a42
    v_accvgpr_read_b32 v255, a43
    v_mul_f32 v252, v252, v249
    v_mul_f32 v253, v253, v249
    v_mul_f32 v254, v254, v249
    v_mul_f32 v255, v255, v249
    v_accvgpr_write_b32 a40, v252
    v_accvgpr_write_b32 a41, v253
    v_accvgpr_write_b32 a42, v254
    v_accvgpr_write_b32 a43, v255
    v_accvgpr_read_b32 v252, a56
    v_accvgpr_read_b32 v253, a57
    v_accvgpr_read_b32 v254, a58
    v_accvgpr_read_b32 v255, a59
    v_mul_f32 v252, v252, v249
    v_mul_f32 v253, v253, v249
    v_mul_f32 v254, v254, v249
    v_mul_f32 v255, v255, v249
    v_accvgpr_write_b32 a56, v252
    v_accvgpr_write_b32 a57, v253
    v_accvgpr_write_b32 a58, v254
    v_accvgpr_write_b32 a59, v255
    v_accvgpr_read_b32 v252, a72
    v_accvgpr_read_b32 v253, a73
    v_accvgpr_read_b32 v254, a74
    v_accvgpr_read_b32 v255, a75
    v_mul_f32 v252, v252, v249
    v_mul_f32 v253, v253, v249
    v_mul_f32 v254, v254, v249
    v_mul_f32 v255, v255, v249
    v_accvgpr_write_b32 a72, v252
    v_accvgpr_write_b32 a73, v253
    v_accvgpr_write_b32 a74, v254
    v_accvgpr_write_b32 a75, v255
    v_accvgpr_read_b32 v252, a88
    v_accvgpr_read_b32 v253, a89
    v_accvgpr_read_b32 v254, a90
    v_accvgpr_read_b32 v255, a91
    v_mul_f32 v252, v252, v249
    v_mul_f32 v253, v253, v249
    v_mul_f32 v254, v254, v249
    v_mul_f32 v255, v255, v249
    v_accvgpr_write_b32 a88, v252
    v_accvgpr_write_b32 a89, v253
    v_accvgpr_write_b32 a90, v254
    v_accvgpr_write_b32 a91, v255
    v_accvgpr_read_b32 v252, a104
    v_accvgpr_read_b32 v253, a105
    v_accvgpr_read_b32 v254, a106
    v_accvgpr_read_b32 v255, a107
    v_mul_f32 v252, v252, v249
    v_mul_f32 v253, v253, v249
    v_mul_f32 v254, v254, v249
    v_mul_f32 v255, v255, v249
    v_accvgpr_write_b32 a104, v252
    v_accvgpr_write_b32 a105, v253
    v_accvgpr_write_b32 a106, v254
    v_accvgpr_write_b32 a107, v255
    v_accvgpr_read_b32 v252, a120
    v_accvgpr_read_b32 v253, a121
    v_accvgpr_read_b32 v254, a122
    v_accvgpr_read_b32 v255, a123
    v_mul_f32 v252, v252, v249
    v_mul_f32 v253, v253, v249
    v_mul_f32 v254, v254, v249
    v_mul_f32 v255, v255, v249
    v_accvgpr_write_b32 a120, v252
    v_accvgpr_write_b32 a121, v253
    v_accvgpr_write_b32 a122, v254
    v_accvgpr_write_b32 a123, v255
    v_accvgpr_read_b32 v252, a136
    v_accvgpr_read_b32 v253, a137
    v_accvgpr_read_b32 v254, a138
    v_accvgpr_read_b32 v255, a139
    v_mul_f32 v252, v252, v249
    v_mul_f32 v253, v253, v249
    v_mul_f32 v254, v254, v249
    v_mul_f32 v255, v255, v249
    v_accvgpr_write_b32 a136, v252
    v_accvgpr_write_b32 a137, v253
    v_accvgpr_write_b32 a138, v254
    v_accvgpr_write_b32 a139, v255
    v_accvgpr_read_b32 v252, a152
    v_accvgpr_read_b32 v253, a153
    v_accvgpr_read_b32 v254, a154
    v_accvgpr_read_b32 v255, a155
    v_mul_f32 v252, v252, v249
    v_mul_f32 v253, v253, v249
    v_mul_f32 v254, v254, v249
    v_mul_f32 v255, v255, v249
    v_accvgpr_write_b32 a152, v252
    v_accvgpr_write_b32 a153, v253
    v_accvgpr_write_b32 a154, v254
    v_accvgpr_write_b32 a155, v255
    v_accvgpr_read_b32 v252, a168
    v_accvgpr_read_b32 v253, a169
    v_accvgpr_read_b32 v254, a170
    v_accvgpr_read_b32 v255, a171
    v_mul_f32 v252, v252, v249
    v_mul_f32 v253, v253, v249
    v_mul_f32 v254, v254, v249
    v_mul_f32 v255, v255, v249
    v_accvgpr_write_b32 a168, v252
    v_accvgpr_write_b32 a169, v253
    v_accvgpr_write_b32 a170, v254
    v_accvgpr_write_b32 a171, v255
    v_accvgpr_read_b32 v252, a184
    v_accvgpr_read_b32 v253, a185
    v_accvgpr_read_b32 v254, a186
    v_accvgpr_read_b32 v255, a187
    v_mul_f32 v252, v252, v249
    v_mul_f32 v253, v253, v249
    v_mul_f32 v254, v254, v249
    v_mul_f32 v255, v255, v249
    v_accvgpr_write_b32 a184, v252
    v_accvgpr_write_b32 a185, v253
    v_accvgpr_write_b32 a186, v254
    v_accvgpr_write_b32 a187, v255
    v_accvgpr_read_b32 v252, a200
    v_accvgpr_read_b32 v253, a201
    v_accvgpr_read_b32 v254, a202
    v_accvgpr_read_b32 v255, a203
    v_mul_f32 v252, v252, v249
    v_mul_f32 v253, v253, v249
    v_mul_f32 v254, v254, v249
    v_mul_f32 v255, v255, v249
    v_accvgpr_write_b32 a200, v252
    v_accvgpr_write_b32 a201, v253
    v_accvgpr_write_b32 a202, v254
    v_accvgpr_write_b32 a203, v255
    v_accvgpr_read_b32 v252, a216
    v_accvgpr_read_b32 v253, a217
    v_accvgpr_read_b32 v254, a218
    v_accvgpr_read_b32 v255, a219
    v_mul_f32 v252, v252, v249
    v_mul_f32 v253, v253, v249
    v_mul_f32 v254, v254, v249
    v_mul_f32 v255, v255, v249
    v_accvgpr_write_b32 a216, v252
    v_accvgpr_write_b32 a217, v253
    v_accvgpr_write_b32 a218, v254
    v_accvgpr_write_b32 a219, v255
    v_accvgpr_read_b32 v252, a232
    v_accvgpr_read_b32 v253, a233
    v_accvgpr_read_b32 v254, a234
    v_accvgpr_read_b32 v255, a235
    v_mul_f32 v252, v252, v249
    v_mul_f32 v253, v253, v249
    v_mul_f32 v254, v254, v249
    v_mul_f32 v255, v255, v249
    v_accvgpr_write_b32 a232, v252
    v_accvgpr_write_b32 a233, v253
    v_accvgpr_write_b32 a234, v254
    v_accvgpr_write_b32 a235, v255
    v_accvgpr_read_b32 v252, a248
    v_accvgpr_read_b32 v253, a249
    v_accvgpr_read_b32 v254, a250
    v_accvgpr_read_b32 v255, a251
    v_mul_f32 v252, v252, v249
    v_mul_f32 v253, v253, v249
    v_mul_f32 v254, v254, v249
    v_mul_f32 v255, v255, v249
    v_accvgpr_write_b32 a248, v252
    v_accvgpr_write_b32 a249, v253
    v_accvgpr_write_b32 a250, v254
    v_accvgpr_write_b32 a251, v255
    v_exp_f32 v176, v176
    v_exp_f32 v177, v177
    v_exp_f32 v178, v178
    v_add_f32 v247, v176, v177
    v_cvt_pk_bf16_f32 v176, v176, v177
    v_exp_f32 v179, v179
    v_add_f32 v247, v247, v178
    v_exp_f32 v180, v180
    v_add_f32 v247, v247, v179
    v_cvt_pk_bf16_f32 v177, v178, v179
    v_exp_f32 v181, v181
    v_add_f32 v247, v247, v180
    v_exp_f32 v182, v182
    v_add_f32 v247, v247, v181
    v_cvt_pk_bf16_f32 v178, v180, v181
    v_exp_f32 v183, v183
    v_add_f32 v247, v247, v182
    v_add_f32 v247, v247, v183
    v_cvt_pk_bf16_f32 v179, v182, v183
    v_max3_f32 v251, v184, v185, v186
    v_max3_f32 v251, v251, v187, v188
    v_max3_f32 v251, v251, v189, v190
    v_max_f32 v251, v251, v191
    v_mov_b32 v252, v251
    s_nop 1
    v_permlane16_swap_b32 v251, v252
    s_nop 1
    v_max_f32 v251, v251, v252
    v_mov_b32 v252, v251
    s_nop 1
    v_permlane32_swap_b32 v251, v252
    s_nop 1
    v_max_f32 v251, v251, v252
    v_max_f32 v251, s44, v251
    v_exp_f32 v249, -v251
    v_sub_f32 v204, v204, v251
    v_sub_f32 v205, v205, v251
    v_sub_f32 v206, v206, v251
    v_sub_f32 v207, v207, v251
    v_sub_f32 v184, v184, v251
    v_sub_f32 v152, v152, v251
    v_sub_f32 v185, v185, v251
    v_sub_f32 v153, v153, v251
    v_sub_f32 v186, v186, v251
    v_sub_f32 v154, v154, v251
    v_sub_f32 v187, v187, v251
    v_sub_f32 v155, v155, v251
    v_sub_f32 v188, v188, v251
    v_sub_f32 v156, v156, v251
    v_sub_f32 v189, v189, v251
    v_sub_f32 v157, v157, v251
    v_sub_f32 v190, v190, v251
    v_sub_f32 v158, v158, v251
    v_sub_f32 v191, v191, v251
    v_sub_f32 v159, v159, v251
    v_mul_f32 v244, v244, v249
    v_accvgpr_read_b32 v252, a12
    v_accvgpr_read_b32 v253, a13
    v_accvgpr_read_b32 v254, a14
    v_accvgpr_read_b32 v255, a15
    v_mul_f32 v252, v252, v249
    v_mul_f32 v253, v253, v249
    v_mul_f32 v254, v254, v249
    v_mul_f32 v255, v255, v249
    v_accvgpr_write_b32 a12, v252
    v_accvgpr_write_b32 a13, v253
    v_accvgpr_write_b32 a14, v254
    v_accvgpr_write_b32 a15, v255
    v_accvgpr_read_b32 v252, a28
    v_accvgpr_read_b32 v253, a29
    v_accvgpr_read_b32 v254, a30
    v_accvgpr_read_b32 v255, a31
    v_mul_f32 v252, v252, v249
    v_mul_f32 v253, v253, v249
    v_mul_f32 v254, v254, v249
    v_mul_f32 v255, v255, v249
    v_accvgpr_write_b32 a28, v252
    v_accvgpr_write_b32 a29, v253
    v_accvgpr_write_b32 a30, v254
    v_accvgpr_write_b32 a31, v255
    v_accvgpr_read_b32 v252, a44
    v_accvgpr_read_b32 v253, a45
    v_accvgpr_read_b32 v254, a46
    v_accvgpr_read_b32 v255, a47
    v_mul_f32 v252, v252, v249
    v_mul_f32 v253, v253, v249
    v_mul_f32 v254, v254, v249
    v_mul_f32 v255, v255, v249
    v_accvgpr_write_b32 a44, v252
    v_accvgpr_write_b32 a45, v253
    v_accvgpr_write_b32 a46, v254
    v_accvgpr_write_b32 a47, v255
    v_accvgpr_read_b32 v252, a60
    v_accvgpr_read_b32 v253, a61
    v_accvgpr_read_b32 v254, a62
    v_accvgpr_read_b32 v255, a63
    v_mul_f32 v252, v252, v249
    v_mul_f32 v253, v253, v249
    v_mul_f32 v254, v254, v249
    v_mul_f32 v255, v255, v249
    v_accvgpr_write_b32 a60, v252
    v_accvgpr_write_b32 a61, v253
    v_accvgpr_write_b32 a62, v254
    v_accvgpr_write_b32 a63, v255
    v_accvgpr_read_b32 v252, a76
    v_accvgpr_read_b32 v253, a77
    v_accvgpr_read_b32 v254, a78
    v_accvgpr_read_b32 v255, a79
    v_mul_f32 v252, v252, v249
    v_mul_f32 v253, v253, v249
    v_mul_f32 v254, v254, v249
    v_mul_f32 v255, v255, v249
    v_accvgpr_write_b32 a76, v252
    v_accvgpr_write_b32 a77, v253
    v_accvgpr_write_b32 a78, v254
    v_accvgpr_write_b32 a79, v255
    v_accvgpr_read_b32 v252, a92
    v_accvgpr_read_b32 v253, a93
    v_accvgpr_read_b32 v254, a94
    v_accvgpr_read_b32 v255, a95
    v_mul_f32 v252, v252, v249
    v_mul_f32 v253, v253, v249
    v_mul_f32 v254, v254, v249
    v_mul_f32 v255, v255, v249
    v_accvgpr_write_b32 a92, v252
    v_accvgpr_write_b32 a93, v253
    v_accvgpr_write_b32 a94, v254
    v_accvgpr_write_b32 a95, v255
    v_accvgpr_read_b32 v252, a108
    v_accvgpr_read_b32 v253, a109
    v_accvgpr_read_b32 v254, a110
    v_accvgpr_read_b32 v255, a111
    v_mul_f32 v252, v252, v249
    v_mul_f32 v253, v253, v249
    v_mul_f32 v254, v254, v249
    v_mul_f32 v255, v255, v249
    v_accvgpr_write_b32 a108, v252
    v_accvgpr_write_b32 a109, v253
    v_accvgpr_write_b32 a110, v254
    v_accvgpr_write_b32 a111, v255
    v_accvgpr_read_b32 v252, a124
    v_accvgpr_read_b32 v253, a125
    v_accvgpr_read_b32 v254, a126
    v_accvgpr_read_b32 v255, a127
    v_mul_f32 v252, v252, v249
    v_mul_f32 v253, v253, v249
    v_mul_f32 v254, v254, v249
    v_mul_f32 v255, v255, v249
    v_accvgpr_write_b32 a124, v252
    v_accvgpr_write_b32 a125, v253
    v_accvgpr_write_b32 a126, v254
    v_accvgpr_write_b32 a127, v255
    v_accvgpr_read_b32 v252, a140
    v_accvgpr_read_b32 v253, a141
    v_accvgpr_read_b32 v254, a142
    v_accvgpr_read_b32 v255, a143
    v_mul_f32 v252, v252, v249
    v_mul_f32 v253, v253, v249
    v_mul_f32 v254, v254, v249
    v_mul_f32 v255, v255, v249
    v_accvgpr_write_b32 a140, v252
    v_accvgpr_write_b32 a141, v253
    v_accvgpr_write_b32 a142, v254
    v_accvgpr_write_b32 a143, v255
    v_accvgpr_read_b32 v252, a156
    v_accvgpr_read_b32 v253, a157
    v_accvgpr_read_b32 v254, a158
    v_accvgpr_read_b32 v255, a159
    v_mul_f32 v252, v252, v249
    v_mul_f32 v253, v253, v249
    v_mul_f32 v254, v254, v249
    v_mul_f32 v255, v255, v249
    v_accvgpr_write_b32 a156, v252
    v_accvgpr_write_b32 a157, v253
    v_accvgpr_write_b32 a158, v254
    v_accvgpr_write_b32 a159, v255
    v_accvgpr_read_b32 v252, a172
    v_accvgpr_read_b32 v253, a173
    v_accvgpr_read_b32 v254, a174
    v_accvgpr_read_b32 v255, a175
    v_mul_f32 v252, v252, v249
    v_mul_f32 v253, v253, v249
    v_mul_f32 v254, v254, v249
    v_mul_f32 v255, v255, v249
    v_accvgpr_write_b32 a172, v252
    v_accvgpr_write_b32 a173, v253
    v_accvgpr_write_b32 a174, v254
    v_accvgpr_write_b32 a175, v255
    v_accvgpr_read_b32 v252, a188
    v_accvgpr_read_b32 v253, a189
    v_accvgpr_read_b32 v254, a190
    v_accvgpr_read_b32 v255, a191
    v_mul_f32 v252, v252, v249
    v_mul_f32 v253, v253, v249
    v_mul_f32 v254, v254, v249
    v_mul_f32 v255, v255, v249
    v_accvgpr_write_b32 a188, v252
    v_accvgpr_write_b32 a189, v253
    v_accvgpr_write_b32 a190, v254
    v_accvgpr_write_b32 a191, v255
    v_accvgpr_read_b32 v252, a204
    v_accvgpr_read_b32 v253, a205
    v_accvgpr_read_b32 v254, a206
    v_accvgpr_read_b32 v255, a207
    v_mul_f32 v252, v252, v249
    v_mul_f32 v253, v253, v249
    v_mul_f32 v254, v254, v249
    v_mul_f32 v255, v255, v249
    v_accvgpr_write_b32 a204, v252
    v_accvgpr_write_b32 a205, v253
    v_accvgpr_write_b32 a206, v254
    v_accvgpr_write_b32 a207, v255
    v_accvgpr_read_b32 v252, a220
    v_accvgpr_read_b32 v253, a221
    v_accvgpr_read_b32 v254, a222
    v_accvgpr_read_b32 v255, a223
    v_mul_f32 v252, v252, v249
    v_mul_f32 v253, v253, v249
    v_mul_f32 v254, v254, v249
    v_mul_f32 v255, v255, v249
    v_accvgpr_write_b32 a220, v252
    v_accvgpr_write_b32 a221, v253
    v_accvgpr_write_b32 a222, v254
    v_accvgpr_write_b32 a223, v255
    v_accvgpr_read_b32 v252, a236
    v_accvgpr_read_b32 v253, a237
    v_accvgpr_read_b32 v254, a238
    v_accvgpr_read_b32 v255, a239
    v_mul_f32 v252, v252, v249
    v_mul_f32 v253, v253, v249
    v_mul_f32 v254, v254, v249
    v_mul_f32 v255, v255, v249
    v_accvgpr_write_b32 a236, v252
    v_accvgpr_write_b32 a237, v253
    v_accvgpr_write_b32 a238, v254
    v_accvgpr_write_b32 a239, v255
    v_accvgpr_read_b32 v252, a252
    v_accvgpr_read_b32 v253, a253
    v_accvgpr_read_b32 v254, a254
    v_accvgpr_read_b32 v255, a255
    v_mul_f32 v252, v252, v249
    v_mul_f32 v253, v253, v249
    v_mul_f32 v254, v254, v249
    v_mul_f32 v255, v255, v249
    v_accvgpr_write_b32 a252, v252
    v_accvgpr_write_b32 a253, v253
    v_accvgpr_write_b32 a254, v254
    v_accvgpr_write_b32 a255, v255
    v_exp_f32 v184, v184
    v_exp_f32 v185, v185
    v_exp_f32 v186, v186
    v_add_f32 v248, v184, v185
    v_cvt_pk_bf16_f32 v184, v184, v185
    v_exp_f32 v187, v187
    v_add_f32 v248, v248, v186
    v_exp_f32 v188, v188
    v_add_f32 v248, v248, v187
    v_cvt_pk_bf16_f32 v185, v186, v187
    v_exp_f32 v189, v189
    v_add_f32 v248, v248, v188
    v_exp_f32 v190, v190
    v_add_f32 v248, v248, v189
    v_cvt_pk_bf16_f32 v186, v188, v189
    v_exp_f32 v191, v191
    v_add_f32 v248, v248, v190
    v_add_f32 v248, v248, v191
    v_cvt_pk_bf16_f32 v187, v190, v191
    s_nop 3
    s_setpc_b64 s[30:31]
CODE_END:
.section .rodata,"a"
.p2align 6
.amdhsa_kernel adaLN_cond__gqa_block_cached__mixer_channel_mlp__prompt_kernel
  .amdhsa_next_free_vgpr 512
  .amdhsa_next_free_sgpr 102
  .amdhsa_accum_offset 256
  .amdhsa_group_segment_fixed_size 0
  .amdhsa_kernarg_size 120
  .amdhsa_user_sgpr_count 2
  .amdhsa_user_sgpr_kernarg_segment_ptr 1
  .amdhsa_system_sgpr_workgroup_id_x 1
.end_amdhsa_kernel
```
